```python
import torch

def _softmax(x, axis=-1):
    return torch.softmax(x, dim=axis)
def _gelu(x):
    return torch.nn.functional.gelu(x, approximate="tanh")
def _silu(x):
    return torch.nn.functional.silu(x)
def _sigmoid(x):
    return torch.sigmoid(x)
def _layernorm(x, axis=-1, eps=1e-5):
    m = x.mean(dim=axis, keepdim=True)
    v = x.var(dim=axis, keepdim=True, unbiased=False)
    return (x - m) / torch.sqrt(v + eps)
def _scatter_add(tgt, idx, src, axis=0):
    return tgt.clone().index_add_(axis, idx, src)
def _segment_sum(src, seg, n):
    out = torch.zeros((n,) + src.shape[1:], dtype=src.dtype)
    return out.index_add_(0, seg, src)
def _pad(x, pw):
    flat = tuple(v for pair in reversed(pw) for v in pair)
    return torch.nn.functional.pad(x, flat)

kernel_name = 'parallel_sum__linear_kernel_hedgehog__mixer_s_mlp__prompt'

def setup_inputs():

    _w = (lambda a: (lambda t: t.to(torch.bfloat16) if t.is_floating_point() else t)(torch.as_tensor(a)))
    def _A_setup():
        B, S, D, H = 1, 2048, 640, 32
        Dh = D // H
        return {
            "x": _w((lambda *s: torch.randn(*s, dtype=torch.bfloat16) * 0.05)(B, S, D)),
            "wqkv": _w((lambda *s: torch.randn(*s, dtype=torch.bfloat16) * 0.8)(D, 3 * D)),
            "w_phi": _w((lambda *s: torch.randn(*s, dtype=torch.bfloat16) * 0.8)(H, Dh, Dh) * (Dh ** -0.5)),
            "wo": _w((lambda *s: torch.randn(*s, dtype=torch.bfloat16) * 0.1)(D, D)),
        }
    _A_in = _A_setup()

    def _B_setup():
        B, S, D, F = 1, 2048, 640, 1728
        return {
            "x":  _w((lambda *s: torch.randn(*s, dtype=torch.bfloat16) * 0.05)(B, S, D)),
            "w1": _w((lambda *s: torch.randn(*s, dtype=torch.bfloat16) * 3.2)(D, D) * (D ** -0.5)),
            "w2": _w((lambda *s: torch.randn(*s, dtype=torch.bfloat16) * 3.2)(D, D) * (D ** -0.5)),
            "w3": _w((lambda *s: torch.randn(*s, dtype=torch.bfloat16) * 3.2)(D, F) * (D ** -0.5)),
            "w4": _w((lambda *s: torch.randn(*s, dtype=torch.bfloat16) * 3.2)(F, D) * (F ** -0.5)),
        }
    _B_in = _B_setup()

    return {
        "A_x": _A_in["x"],
        "A_wqkv": _A_in["wqkv"],
        "A_w_phi": _A_in["w_phi"],
        "A_wo": _A_in["wo"],
        "B_x": _B_in["x"],
        "B_w1": _B_in["w1"],
        "B_w2": _B_in["w2"],
        "B_w3": _B_in["w3"],
        "B_w4": _B_in["w4"],
    }

def reference(A_x, A_wqkv, A_w_phi, A_wo, B_x, B_w1, B_w2, B_w3, B_w4):
    def _A_ref(x, wqkv, w_phi, wo):
        B, S, D = x.shape
        H = 32; Dh = D // H
        qkv = (lambda x, *d: x.permute(*d))((x @ wqkv).reshape(B, S, 3, H, Dh), 2, 0, 3, 1, 4)
        q, k, v = qkv[0], qkv[1], qkv[2]
        pq = torch.einsum("bhsd,hdf->bhsf", q, w_phi)
        pk = torch.einsum("bhsd,hdf->bhsf", k, w_phi)
        phi_q = torch.concatenate([_softmax(pq, axis=-1), _softmax(-pq, axis=-1)], axis=-1)
        phi_k = torch.concatenate([_softmax(pk, axis=-1), _softmax(-pk, axis=-1)], axis=-1)
        kv = torch.einsum("bhsf,bhsd->bhfd", phi_k, v)
        z  = torch.einsum("bhsf->bhf", phi_k)
        num = torch.einsum("bhqf,bhfd->bhqd", phi_q, kv)
        den = torch.einsum("bhqf,bhf->bhq", phi_q, z)[..., None] + 1e-6
        o = num / den
        return (lambda x, *d: x.permute(*d))(o, 0, 2, 1, 3).reshape(B, S, D) @ wo

    def _B_ref(x, w1, w2, w3, w4):
        B, S, D = x.shape
        h = _gelu(_layernorm(x, axis=-1) @ w1)
        c = D // 4
        g0 = _pad(h[:, :, 0*c:1*c], ((0, 0), (1, 0), (0, 0)))[:, :S, :]
        g1 = _pad(h[:, :, 1*c:2*c], ((0, 0), (0, 1), (0, 0)))[:, 1:, :]
        g2 = _pad(h[:, :, 2*c:3*c], ((0, 0), (2, 0), (0, 0)))[:, :S, :]
        g3 = _pad(h[:, :, 3*c:   ], ((0, 0), (0, 2), (0, 0)))[:, 2:, :]
        hs = torch.concatenate([g0, g1, g2, g3], axis=-1) @ w2
        x1 = x + hs
        h2 = _gelu(_layernorm(x1, axis=-1) @ w3) @ w4
        return x1 + h2

    x = A_x
    xn = _layernorm(x, axis=-1)
    return x + _A_ref(xn, A_wqkv, A_w_phi, A_wo) + _B_ref(xn, B_w1, B_w2, B_w3, B_w4)
```

```asm
; @launch grid=(256,1,1) block=(256,1,1) lds=163840

.amdgcn_target "amdgcn-amd-amdhsa--gfx950"
.text
.globl parallel_sum__linear_kernel_hedgehog__mixer_s_mlp__prompt_kernel
.p2align 8
.type parallel_sum__linear_kernel_hedgehog__mixer_s_mlp__prompt_kernel,@function
parallel_sum__linear_kernel_hedgehog__mixer_s_mlp__prompt_kernel:
    s_cmp_ge_u32 s2, 256
    s_cbranch_scc1 L_end
    s_load_dwordx16 s[4:19], s[0:1], 0
    s_load_dwordx8 s[20:27], s[0:1], 64
    v_and_b32 v1, 63, v0
    v_lshrrev_b32 v22, 6, v0
    s_nop 0
    v_readfirstlane_b32 s41, v22
    s_and_b32 s44, s2, 7
    s_lshr_b32 s45, s2, 3
    s_and_b32 s86, s45, 7
    s_lshr_b32 s87, s45, 3
    s_lshr_b32 s88, s44, 1
    s_lshl_b32 s42, s88, 2
    s_add_u32 s42, s42, s87
    s_and_b32 s44, s44, 1
    s_mov_b32 s46, 0xFDBA9832
    s_cmp_eq_u32 s44, 0
    s_cselect_b32 s46, 0xEC765410, s46
    s_lshl_b32 s45, s86, 2
    s_lshr_b32 s46, s46, s45
    s_and_b32 s43, s46, 15
    s_mov_b32 s92, s42
    s_mov_b32 s93, s43
    s_mov_b32 s94, s86
    s_mov_b32 s95, s87
    s_mov_b32 s96, s88
    s_mov_b32 s97, s92
    s_mov_b32 s98, s93
    s_mov_b32 s99, s94
    s_mov_b32 s100, s95
    s_mov_b32 s101, s96
    v_mov_b32 v3, 1073741824
    v_cmp_eq_u32 vcc, 0, v0
    s_nop 1
    v_cndmask_b32_e64 v3, v3, 0, vcc
    v_lshlrev_b32 v22, 4, v0
    v_mov_b32 v243, 1073741824
    v_cmp_gt_u32 vcc, 8, v0
    s_nop 1
    v_cndmask_b32 v243, v243, v22, vcc
    s_mov_b32 s60, 1069066811
    s_mov_b32 s61, 1069066811
    s_mov_b32 s62, 3184710632
    s_mov_b32 s63, 3184710632
    v_mov_b32 v20, 3222493025
    v_mov_b32 v21, 3222493025
    s_waitcnt lgkmcnt(0)
    s_mov_b32 s28, s26
    s_mov_b32 s29, s27
    s_mov_b32 s30, 268435456
    s_mov_b32 s31, 0x20000
    s_load_dword s40, s[26:27], 0
    s_mov_b32 s36, s4
    s_mov_b32 s37, s5
    s_mov_b32 s38, 2621440
    s_mov_b32 s39, 0x20000
    v_lshrrev_b32 v52, 2, v1
    v_and_b32 v53, 3, v1
    v_lshlrev_b32 v24, 7, v52
    v_lshl_add_u32 v24, v53, 3, v24
    v_mov_b32 v54, 1073741824
    v_cmp_gt_u32 vcc, 40, v1
    s_nop 1
    v_cndmask_b32 v55, v54, v24, vcc
    s_lshl_b32 s44, s42, 7
    s_lshl_b32 s45, s43, 3
    s_add_u32 s72, s44, s45
    s_lshl_b32 s45, s41, 1
    s_add_u32 s44, s72, s45
    s_mul_i32 s44, s44, 1280
    s_add_u32 s45, s44, 1280
    buffer_load_dwordx2 v[64:65], v55, s[36:39], s44 offen offset:0
    buffer_load_dwordx2 v[66:67], v55, s[36:39], s44 offen offset:32
    buffer_load_dwordx2 v[68:69], v55, s[36:39], s44 offen offset:64
    buffer_load_dwordx2 v[70:71], v55, s[36:39], s44 offen offset:96
    buffer_load_dwordx2 v[72:73], v55, s[36:39], s45 offen offset:0
    buffer_load_dwordx2 v[74:75], v55, s[36:39], s45 offen offset:32
    buffer_load_dwordx2 v[76:77], v55, s[36:39], s45 offen offset:64
    buffer_load_dwordx2 v[78:79], v55, s[36:39], s45 offen offset:96
    s_getpc_b64 s[48:49]
L_pc:
    s_sub_u32 s48, s48, L_pc-parallel_sum__linear_kernel_hedgehog__mixer_s_mlp__prompt_kernel
    s_subb_u32 s49, s49, 0
    s_lshr_b32 s44, s2, 3
    s_mul_i32 s44, s44, 3072
    v_lshlrev_b32 v30, 7, v0
    v_add_u32 v30, s44, v30
    v_cmp_gt_u32 vcc, 24, v0
    s_nop 1
    v_cndmask_b32_e64 v30, 0, v30, vcc
    s_mov_b32 s45, L_code_end-parallel_sum__linear_kernel_hedgehog__mixer_s_mlp__prompt_kernel-4
    v_cmp_gt_u32 vcc, s45, v30
    s_nop 1
    v_cndmask_b32_e64 v30, 0, v30, vcc
    v_mov_b32 v31, s49
    v_add_co_u32 v30, vcc, s48, v30
    s_nop 1
    v_addc_co_u32 v31, vcc, 0, v31, vcc
    global_load_dword v254, v[30:31], off
    s_mov_b32 s44, 1073741824
    s_and_b32 s45, s2, 63
    s_lshl_b32 s45, s45, 7
    s_add_u32 s45, s45, 36864
    s_lshl_b32 s46, s2, 8
    s_add_u32 s46, s46, 266240
    v_mov_b32 v22, 1073741824
    v_mov_b32 v23, s44
    v_cmp_eq_u32 vcc, 0, v0
    s_nop 1
    v_cndmask_b32 v22, v22, v23, vcc
    v_mov_b32 v23, s45
    v_cmp_eq_u32 vcc, 1, v0
    s_nop 1
    v_cndmask_b32 v22, v22, v23, vcc
    v_mov_b32 v23, s46
    v_cmp_eq_u32 vcc, 2, v0
    s_nop 1
    v_cndmask_b32 v22, v22, v23, vcc
    v_add_u32 v23, 128, v23
    v_cmp_eq_u32 vcc, 3, v0
    s_nop 1
    v_cndmask_b32 v22, v22, v23, vcc
    s_sub_u32 s44, s43, 12
    s_and_b32 s45, s44, 1
    s_mul_i32 s46, s45, 1920
    s_mul_i32 s47, s44, 40960
    s_add_u32 s46, s46, s47
    s_mul_i32 s47, s42, 163840
    s_add_u32 s46, s46, s47
    s_add_u32 s46, s46, 4980736
    s_cmp_eq_u32 s45, 1
    s_mov_b32 s47, 163840
    s_cselect_b32 s47, -163840, s47
    v_subrev_u32 v23, 64, v0
    v_cmp_lt_u32 vcc, 19, v23
    v_mov_b32 v24, s47
    s_nop 0
    v_cndmask_b32_e64 v24, 0, v24, vcc
    v_subrev_u32 v26, 20, v23
    v_cndmask_b32 v26, v23, v26, vcc
    v_lshl_add_u32 v24, v26, 11, v24
    v_add_u32 v24, s46, v24
    v_cmp_gt_u32 vcc, 40, v23
    s_cmp_ge_u32 s43, 12
    s_cselect_b64 s[48:49], -1, 0
    s_and_b64 vcc, vcc, s[48:49]
    v_cndmask_b32 v22, v22, v24, vcc
    buffer_load_dword v254, v22, s[28:31], 0 offen
    s_mov_b32 s32, s16
    s_mov_b32 s33, s17
    s_mov_b32 s34, 819200
    s_mov_b32 s35, 0x20000
    v_lshlrev_b32 v22, 7, v0
    v_mov_b32 v23, 1073741824
    v_cmp_gt_u32 vcc, 25, v0
    s_nop 1
    v_cndmask_b32 v22, v23, v22, vcc
    s_mul_i32 s44, s2, 3200
    buffer_load_dword v254, v22, s[32:35], s44 offen
    s_cmp_ge_u32 s43, 12
    s_cselect_b32 s67, 1, 0
    s_mov_b32 s64, 3840
    s_cselect_b32 s64, 1280, s64
    s_cselect_b32 s44, s14, s6
    s_cselect_b32 s45, s15, s7
    s_mov_b32 s46, 2457600
    s_cselect_b32 s46, 819200, s46
    s_mov_b32 s32, s44
    s_mov_b32 s33, s45
    s_mov_b32 s34, s46
    s_mov_b32 s35, 0x20000
    s_mul_i32 s44, s43, 320
    s_mul_i32 s45, s43, 160
    s_add_u32 s45, s45, 640
    s_sub_u32 s46, s44, 3840
    s_cmp_ge_u32 s43, 4
    s_cselect_b32 s65, s45, s44
    s_cselect_b32 s66, 1120, 0
    s_cmp_ge_u32 s43, 12
    s_cselect_b32 s65, s46, s65
    s_cselect_b32 s66, 0, s66
    v_add_u32 v22, 0, v1
    v_mul_u32_u24 v23, 3277, v22
    v_lshrrev_b32 v23, 16, v23
    v_mul_u32_u24 v24, 20, v23
    v_sub_u32 v24, v22, v24
    v_lshrrev_b32 v25, 1, v23
    v_and_b32 v25, 2, v25
    v_xor_b32 v24, v24, v25
    v_mul_lo_u32 v23, v23, s64
    v_lshl_add_u32 v23, v24, 4, v23
    v_mov_b32 v25, s66
    v_cmp_lt_u32 vcc, 9, v24
    s_nop 1
    v_cndmask_b32_e64 v25, 0, v25, vcc
    v_add_u32 v14, v23, v25
    v_add_u32 v22, 64, v1
    v_mul_u32_u24 v23, 3277, v22
    v_lshrrev_b32 v23, 16, v23
    v_mul_u32_u24 v24, 20, v23
    v_sub_u32 v24, v22, v24
    v_lshrrev_b32 v25, 1, v23
    v_and_b32 v25, 2, v25
    v_xor_b32 v24, v24, v25
    v_mul_lo_u32 v23, v23, s64
    v_lshl_add_u32 v23, v24, 4, v23
    v_mov_b32 v25, s66
    v_cmp_lt_u32 vcc, 9, v24
    s_nop 1
    v_cndmask_b32_e64 v25, 0, v25, vcc
    v_add_u32 v15, v23, v25
    v_subrev_u32 v15, 1024, v15
    v_add_u32 v22, 128, v1
    v_mul_u32_u24 v23, 3277, v22
    v_lshrrev_b32 v23, 16, v23
    v_mul_u32_u24 v24, 20, v23
    v_sub_u32 v24, v22, v24
    v_lshrrev_b32 v25, 1, v23
    v_and_b32 v25, 2, v25
    v_xor_b32 v24, v24, v25
    v_mul_lo_u32 v23, v23, s64
    v_lshl_add_u32 v23, v24, 4, v23
    v_mov_b32 v25, s66
    v_cmp_lt_u32 vcc, 9, v24
    s_nop 1
    v_cndmask_b32_e64 v25, 0, v25, vcc
    v_add_u32 v16, v23, v25
    v_subrev_u32 v16, 2048, v16
    v_add_u32 v22, 192, v1
    v_mul_u32_u24 v23, 3277, v22
    v_lshrrev_b32 v23, 16, v23
    v_mul_u32_u24 v24, 20, v23
    v_sub_u32 v24, v22, v24
    v_lshrrev_b32 v25, 1, v23
    v_and_b32 v25, 2, v25
    v_xor_b32 v24, v24, v25
    v_mul_lo_u32 v23, v23, s64
    v_lshl_add_u32 v23, v24, 4, v23
    v_mov_b32 v25, s66
    v_cmp_lt_u32 vcc, 9, v24
    s_nop 1
    v_cndmask_b32_e64 v25, 0, v25, vcc
    v_add_u32 v17, v23, v25
    v_subrev_u32 v17, 3072, v17
    v_add_u32 v22, 256, v1
    v_mul_u32_u24 v23, 3277, v22
    v_lshrrev_b32 v23, 16, v23
    v_mul_u32_u24 v24, 20, v23
    v_sub_u32 v24, v22, v24
    v_lshrrev_b32 v25, 1, v23
    v_and_b32 v25, 2, v25
    v_xor_b32 v24, v24, v25
    v_mul_lo_u32 v23, v23, s64
    v_lshl_add_u32 v23, v24, 4, v23
    v_mov_b32 v25, s66
    v_cmp_lt_u32 vcc, 9, v24
    s_nop 1
    v_cndmask_b32_e64 v25, 0, v25, vcc
    v_add_u32 v18, v23, v25
    s_lshl_b32 s44, s41, 4
    s_mul_i32 s44, s44, s64
    s_add_u32 s51, s44, s65
    s_lshl_b32 s52, s64, 6
    s_mul_i32 s53, s41, 5120
    s_mul_i32 s44, s86, 10
    s_lshr_b32 s44, s44, 3
    s_mul_i32 s45, s87, 10
    s_lshr_b32 s45, s45, 2
    s_add_u32 s50, s44, s45
    s_add_u32 s50, s50, s88
    s_cmp_ge_u32 s50, 10
    s_cselect_b32 s44, 10, 0
    s_sub_u32 s50, s50, s44
    s_cmp_ge_u32 s50, 10
    s_cselect_b32 s44, 10, 0
    s_sub_u32 s50, s50, s44
    s_cmp_ge_u32 s50, 10
    s_cselect_b32 s44, 10, 0
    s_sub_u32 s50, s50, s44
    v_lshrrev_b32 v22, 2, v1
    v_mul_u32_u24 v22, 320, v22
    v_and_b32 v23, 3, v1
    v_mul_u32_u24 v24, 5, v23
    s_cmp_eq_u32 s67, 1
    s_cselect_b64 vcc, -1, 0
    v_cndmask_b32 v24, v24, v23, vcc
    v_lshrrev_b32 v25, 2, v1
    v_and_b32 v25, 4, v25
    s_cmp_eq_u32 s67, 1
    s_cselect_b32 s44, 0, 0
    v_add_u32 v26, s44, v24
    v_xor_b32 v26, v26, v25
    v_lshl_add_u32 v4, v26, 3, v22
    s_cmp_eq_u32 s67, 1
    s_cselect_b32 s44, 4, 1
    v_add_u32 v26, s44, v24
    v_xor_b32 v26, v26, v25
    v_lshl_add_u32 v5, v26, 3, v22
    s_cmp_eq_u32 s67, 1
    s_cselect_b32 s44, 8, 2
    v_add_u32 v26, s44, v24
    v_xor_b32 v26, v26, v25
    v_lshl_add_u32 v6, v26, 3, v22
    s_cmp_eq_u32 s67, 1
    s_cselect_b32 s44, 12, 3
    v_add_u32 v26, s44, v24
    v_xor_b32 v26, v26, v25
    v_lshl_add_u32 v7, v26, 3, v22
    s_cmp_eq_u32 s67, 1
    s_cselect_b32 s44, 16, 4
    v_add_u32 v26, s44, v24
    v_xor_b32 v26, v26, v25
    v_lshl_add_u32 v8, v26, 3, v22
    s_cmp_eq_u32 s67, 1
    s_cselect_b32 s44, 20, 20
    v_add_u32 v26, s44, v24
    v_xor_b32 v26, v26, v25
    v_lshl_add_u32 v9, v26, 3, v22
    s_cmp_eq_u32 s67, 1
    s_cselect_b32 s44, 24, 21
    v_add_u32 v26, s44, v24
    v_xor_b32 v26, v26, v25
    v_lshl_add_u32 v10, v26, 3, v22
    s_cmp_eq_u32 s67, 1
    s_cselect_b32 s44, 28, 22
    v_add_u32 v26, s44, v24
    v_xor_b32 v26, v26, v25
    v_lshl_add_u32 v11, v26, 3, v22
    s_cmp_eq_u32 s67, 1
    s_cselect_b32 s44, 32, 23
    v_add_u32 v26, s44, v24
    v_xor_b32 v26, v26, v25
    v_lshl_add_u32 v12, v26, 3, v22
    s_cmp_eq_u32 s67, 1
    s_cselect_b32 s44, 36, 24
    v_add_u32 v26, s44, v24
    v_xor_b32 v26, v26, v25
    v_lshl_add_u32 v13, v26, 3, v22
    v_lshrrev_b32 v22, 4, v1
    v_lshlrev_b32 v22, 11, v22
    v_and_b32 v23, 15, v1
    v_lshl_add_u32 v22, v23, 4, v22
    s_lshl_b32 s44, s41, 9
    v_add_u32 v19, s44, v22
    s_mul_i32 s54, s42, 163840
    s_add_u32 s54, s54, 2359296
    s_mul_i32 s55, s50, s52
    s_add_u32 s55, s55, s51
    s_mul_i32 s90, s52, 10
    s_add_u32 s90, s90, s51
    s_add_u32 m0, s53, 0
    s_nop 0
    buffer_load_dwordx4 v14, s[32:35], s55 offen offset:0 lds
    buffer_load_dwordx4 v15, s[32:35], s55 offen offset:1024 lds
    buffer_load_dwordx4 v16, s[32:35], s55 offen offset:2048 lds
    buffer_load_dwordx4 v17, s[32:35], s55 offen offset:3072 lds
    s_add_u32 m0, s53, 4096
    s_nop 0
    buffer_load_dwordx4 v18, s[32:35], s55 offen lds
    s_add_u32 s55, s55, s52
    s_cmp_eq_u32 s55, s90
    s_cselect_b32 s55, s51, s55
    s_waitcnt lgkmcnt(0)
    s_mul_i32 s40, s40, 0x9E3779B1
    s_add_u32 s40, s40, 0x7F4A7C15
    v_mov_b32 v2, s40
    v_mov_b32 v244, s40
    v_mov_b32 v245, s40
    v_mov_b32 v246, s40
    v_mov_b32 v247, s40
    s_waitcnt vmcnt(8)
    v_lshlrev_b32 v80, 16, v64
    v_and_b32 v81, 0xffff0000, v64
    v_lshlrev_b32 v82, 16, v65
    v_and_b32 v83, 0xffff0000, v65
    v_lshlrev_b32 v84, 16, v66
    v_and_b32 v85, 0xffff0000, v66
    v_lshlrev_b32 v86, 16, v67
    v_and_b32 v87, 0xffff0000, v67
    v_lshlrev_b32 v88, 16, v68
    v_and_b32 v89, 0xffff0000, v68
    v_lshlrev_b32 v90, 16, v69
    v_and_b32 v91, 0xffff0000, v69
    v_lshlrev_b32 v92, 16, v70
    v_and_b32 v93, 0xffff0000, v70
    v_lshlrev_b32 v94, 16, v71
    v_and_b32 v95, 0xffff0000, v71
    v_lshlrev_b32 v96, 16, v72
    v_and_b32 v97, 0xffff0000, v72
    v_lshlrev_b32 v98, 16, v73
    v_and_b32 v99, 0xffff0000, v73
    v_lshlrev_b32 v100, 16, v74
    v_and_b32 v101, 0xffff0000, v74
    v_lshlrev_b32 v102, 16, v75
    v_and_b32 v103, 0xffff0000, v75
    v_lshlrev_b32 v104, 16, v76
    v_and_b32 v105, 0xffff0000, v76
    v_lshlrev_b32 v106, 16, v77
    v_and_b32 v107, 0xffff0000, v77
    v_lshlrev_b32 v108, 16, v78
    v_and_b32 v109, 0xffff0000, v78
    v_lshlrev_b32 v110, 16, v79
    v_and_b32 v111, 0xffff0000, v79
    v_pk_add_f32 v[32:33], v[80:81], v[82:83]
    v_pk_add_f32 v[34:35], v[96:97], v[98:99]
    v_pk_add_f32 v[32:33], v[32:33], v[84:85]
    v_pk_add_f32 v[34:35], v[34:35], v[100:101]
    v_pk_add_f32 v[32:33], v[32:33], v[86:87]
    v_pk_add_f32 v[34:35], v[34:35], v[102:103]
    v_pk_add_f32 v[32:33], v[32:33], v[88:89]
    v_pk_add_f32 v[34:35], v[34:35], v[104:105]
    v_pk_add_f32 v[32:33], v[32:33], v[90:91]
    v_pk_add_f32 v[34:35], v[34:35], v[106:107]
    v_pk_add_f32 v[32:33], v[32:33], v[92:93]
    v_pk_add_f32 v[34:35], v[34:35], v[108:109]
    v_pk_add_f32 v[32:33], v[32:33], v[94:95]
    v_pk_add_f32 v[34:35], v[34:35], v[110:111]
    v_add_f32 v32, v32, v33
    v_add_f32 v34, v34, v35
    s_nop 0
    v_add_f32_dpp v32, v32, v32 quad_perm:[1,0,3,2] row_mask:0xf bank_mask:0xf
    v_add_f32_dpp v34, v34, v34 quad_perm:[1,0,3,2] row_mask:0xf bank_mask:0xf
    s_nop 0
    v_add_f32_dpp v32, v32, v32 quad_perm:[2,3,0,1] row_mask:0xf bank_mask:0xf
    v_add_f32_dpp v34, v34, v34 quad_perm:[2,3,0,1] row_mask:0xf bank_mask:0xf
    s_nop 0
    v_add_f32_dpp v32, v32, v32 row_half_mirror row_mask:0xf bank_mask:0xf
    v_add_f32_dpp v34, v34, v34 row_half_mirror row_mask:0xf bank_mask:0xf
    s_nop 0
    v_add_f32_dpp v32, v32, v32 row_mirror row_mask:0xf bank_mask:0xf
    v_add_f32_dpp v34, v34, v34 row_mirror row_mask:0xf bank_mask:0xf
    v_mov_b32 v36, v32
    v_mov_b32 v37, v34
    s_nop 0
    v_permlane16_swap_b32 v32, v36
    v_permlane16_swap_b32 v34, v37
    v_add_f32 v32, v32, v36
    v_add_f32 v34, v34, v37
    v_mov_b32 v36, v32
    v_mov_b32 v37, v34
    s_nop 0
    v_permlane32_swap_b32 v32, v36
    v_permlane32_swap_b32 v34, v37
    v_add_f32 v32, v32, v36
    v_add_f32 v34, v34, v37
    v_mul_f32 v32, 3133983949, v32
    v_mul_f32 v34, 3133983949, v34
    v_pk_add_f32 v[80:81], v[80:81], v[32:33] op_sel_hi:[1,0]
    v_pk_add_f32 v[82:83], v[82:83], v[32:33] op_sel_hi:[1,0]
    v_pk_add_f32 v[84:85], v[84:85], v[32:33] op_sel_hi:[1,0]
    v_pk_add_f32 v[86:87], v[86:87], v[32:33] op_sel_hi:[1,0]
    v_pk_add_f32 v[88:89], v[88:89], v[32:33] op_sel_hi:[1,0]
    v_pk_add_f32 v[90:91], v[90:91], v[32:33] op_sel_hi:[1,0]
    v_pk_add_f32 v[92:93], v[92:93], v[32:33] op_sel_hi:[1,0]
    v_pk_add_f32 v[94:95], v[94:95], v[32:33] op_sel_hi:[1,0]
    v_pk_add_f32 v[96:97], v[96:97], v[34:35] op_sel_hi:[1,0]
    v_pk_add_f32 v[98:99], v[98:99], v[34:35] op_sel_hi:[1,0]
    v_pk_add_f32 v[100:101], v[100:101], v[34:35] op_sel_hi:[1,0]
    v_pk_add_f32 v[102:103], v[102:103], v[34:35] op_sel_hi:[1,0]
    v_pk_add_f32 v[104:105], v[104:105], v[34:35] op_sel_hi:[1,0]
    v_pk_add_f32 v[106:107], v[106:107], v[34:35] op_sel_hi:[1,0]
    v_pk_add_f32 v[108:109], v[108:109], v[34:35] op_sel_hi:[1,0]
    v_pk_add_f32 v[110:111], v[110:111], v[34:35] op_sel_hi:[1,0]
    v_pk_mul_f32 v[38:39], v[80:81], v[80:81]
    v_pk_mul_f32 v[40:41], v[96:97], v[96:97]
    v_pk_fma_f32 v[38:39], v[82:83], v[82:83], v[38:39]
    v_pk_fma_f32 v[40:41], v[98:99], v[98:99], v[40:41]
    v_pk_fma_f32 v[38:39], v[84:85], v[84:85], v[38:39]
    v_pk_fma_f32 v[40:41], v[100:101], v[100:101], v[40:41]
    v_pk_fma_f32 v[38:39], v[86:87], v[86:87], v[38:39]
    v_pk_fma_f32 v[40:41], v[102:103], v[102:103], v[40:41]
    v_pk_fma_f32 v[38:39], v[88:89], v[88:89], v[38:39]
    v_pk_fma_f32 v[40:41], v[104:105], v[104:105], v[40:41]
    v_pk_fma_f32 v[38:39], v[90:91], v[90:91], v[38:39]
    v_pk_fma_f32 v[40:41], v[106:107], v[106:107], v[40:41]
    v_pk_fma_f32 v[38:39], v[92:93], v[92:93], v[38:39]
    v_pk_fma_f32 v[40:41], v[108:109], v[108:109], v[40:41]
    v_pk_fma_f32 v[38:39], v[94:95], v[94:95], v[38:39]
    v_pk_fma_f32 v[40:41], v[110:111], v[110:111], v[40:41]
    v_add_f32 v38, v38, v39
    v_add_f32 v40, v40, v41
    v_cmp_gt_u32 vcc, 40, v1
    s_nop 1
    v_cndmask_b32_e64 v38, 0, v38, vcc
    v_cndmask_b32_e64 v40, 0, v40, vcc
    s_nop 0
    v_add_f32_dpp v38, v38, v38 quad_perm:[1,0,3,2] row_mask:0xf bank_mask:0xf
    v_add_f32_dpp v40, v40, v40 quad_perm:[1,0,3,2] row_mask:0xf bank_mask:0xf
    s_nop 0
    v_add_f32_dpp v38, v38, v38 quad_perm:[2,3,0,1] row_mask:0xf bank_mask:0xf
    v_add_f32_dpp v40, v40, v40 quad_perm:[2,3,0,1] row_mask:0xf bank_mask:0xf
    s_nop 0
    v_add_f32_dpp v38, v38, v38 row_half_mirror row_mask:0xf bank_mask:0xf
    v_add_f32_dpp v40, v40, v40 row_half_mirror row_mask:0xf bank_mask:0xf
    s_nop 0
    v_add_f32_dpp v38, v38, v38 row_mirror row_mask:0xf bank_mask:0xf
    v_add_f32_dpp v40, v40, v40 row_mirror row_mask:0xf bank_mask:0xf
    v_mov_b32 v36, v38
    v_mov_b32 v37, v40
    s_nop 0
    v_permlane16_swap_b32 v38, v36
    v_permlane16_swap_b32 v40, v37
    v_add_f32 v38, v38, v36
    v_add_f32 v40, v40, v37
    v_mov_b32 v36, v38
    v_mov_b32 v37, v40
    s_nop 0
    v_permlane32_swap_b32 v38, v36
    v_permlane32_swap_b32 v40, v37
    v_add_f32 v38, v38, v36
    v_add_f32 v40, v40, v37
    s_mov_b32 s44, 986500301
    v_mov_b32 v42, 925353388
    v_mul_f32 v38, s44, v38
    v_mul_f32 v40, s44, v40
    v_add_f32 v39, v42, v38
    v_add_f32 v41, v42, v40
    v_rsq_f32 v32, v39
    v_rsq_f32 v34, v41
    v_mul_f32 v38, v38, v32
    v_mul_f32 v40, v40, v34
    v_fma_f32 v38, v38, v32, v42
    v_fma_f32 v40, v40, v34, v42
    v_rsq_f32 v38, v38
    v_rsq_f32 v40, v40
    v_pk_mul_f32 v[80:81], v[80:81], v[32:33] op_sel_hi:[1,0]
    v_pk_mul_f32 v[82:83], v[82:83], v[32:33] op_sel_hi:[1,0]
    v_pk_mul_f32 v[84:85], v[84:85], v[32:33] op_sel_hi:[1,0]
    v_pk_mul_f32 v[86:87], v[86:87], v[32:33] op_sel_hi:[1,0]
    v_pk_mul_f32 v[88:89], v[88:89], v[32:33] op_sel_hi:[1,0]
    v_pk_mul_f32 v[90:91], v[90:91], v[32:33] op_sel_hi:[1,0]
    v_pk_mul_f32 v[92:93], v[92:93], v[32:33] op_sel_hi:[1,0]
    v_pk_mul_f32 v[94:95], v[94:95], v[32:33] op_sel_hi:[1,0]
    v_pk_mul_f32 v[96:97], v[96:97], v[34:35] op_sel_hi:[1,0]
    v_pk_mul_f32 v[98:99], v[98:99], v[34:35] op_sel_hi:[1,0]
    v_pk_mul_f32 v[100:101], v[100:101], v[34:35] op_sel_hi:[1,0]
    v_pk_mul_f32 v[102:103], v[102:103], v[34:35] op_sel_hi:[1,0]
    v_pk_mul_f32 v[104:105], v[104:105], v[34:35] op_sel_hi:[1,0]
    v_pk_mul_f32 v[106:107], v[106:107], v[34:35] op_sel_hi:[1,0]
    v_pk_mul_f32 v[108:109], v[108:109], v[34:35] op_sel_hi:[1,0]
    v_pk_mul_f32 v[110:111], v[110:111], v[34:35] op_sel_hi:[1,0]
    v_cvt_pk_bf16_f32 v64, v80, v81
    v_cvt_pk_bf16_f32 v65, v82, v83
    v_cvt_pk_bf16_f32 v66, v84, v85
    v_cvt_pk_bf16_f32 v67, v86, v87
    v_cvt_pk_bf16_f32 v68, v88, v89
    v_cvt_pk_bf16_f32 v69, v90, v91
    v_cvt_pk_bf16_f32 v70, v92, v93
    v_cvt_pk_bf16_f32 v71, v94, v95
    v_cvt_pk_bf16_f32 v72, v96, v97
    v_cvt_pk_bf16_f32 v73, v98, v99
    v_cvt_pk_bf16_f32 v74, v100, v101
    v_cvt_pk_bf16_f32 v75, v102, v103
    v_cvt_pk_bf16_f32 v76, v104, v105
    v_cvt_pk_bf16_f32 v77, v106, v107
    v_cvt_pk_bf16_f32 v78, v108, v109
    v_cvt_pk_bf16_f32 v79, v110, v111
    v_lshlrev_b32 v43, 3, v52
    v_add_u32 v43, v43, v53
    v_lshlrev_b32 v43, 7, v43
    s_lshl_b32 s44, s41, 5
    s_add_u32 s44, s44, 143360
    v_add_u32 v43, s44, v43
    s_mov_b32 exec_hi, 0xff
    ds_write_b128 v43, v[64:67] offset:0
    ds_write_b128 v43, v[68:71] offset:512
    ds_write_b128 v43, v[72:75] offset:16
    ds_write_b128 v43, v[76:79] offset:528
    s_mov_b64 exec, -1
    s_lshl_b32 s44, s41, 3
    s_add_u32 s44, s44, 153600
    v_mov_b32 v44, s44
    ds_write_b32 v44, v38 offset:0
    ds_write_b32 v44, v40 offset:4
    s_waitcnt lgkmcnt(0)
    s_barrier
    v_lshlrev_b32 v45, 4, v0
    v_add_u32 v45, 143360, v45
    ds_read_b128 v[64:67], v45 offset:0
    ds_read_b128 v[68:71], v45 offset:4096
    ds_read_b128 v[72:75], v45 offset:8192
    v_lshlrev_b32 v46, 2, v0
    v_and_b32 v48, 7, v0
    v_lshlrev_b32 v47, 2, v48
    v_add_u32 v47, 153600, v47
    ds_read_b32 v49, v47
    v_lshrrev_b32 v50, 3, v0
    v_lshlrev_b32 v50, 11, v50
    v_lshl_add_u32 v50, v48, 4, v50
    v_cmp_gt_u32 vcc, 128, v0
    s_nop 1
    v_cndmask_b32 v51, v54, v50, vcc
    v_cmp_gt_u32 vcc, 8, v0
    s_nop 1
    v_cndmask_b32 v46, v54, v46, vcc
    s_mul_i32 s44, s42, 163840
    s_add_u32 s44, s44, 2359296
    s_lshl_b32 s45, s43, 7
    s_add_u32 s44, s44, s45
    s_add_u32 s45, s44, 0x10000
    s_add_u32 s46, s44, 0x20000
    s_lshl_b32 s47, s72, 2
    s_add_u32 s47, s47, 36864
    s_waitcnt lgkmcnt(0)
    buffer_store_dwordx4 v[64:67], v50, s[28:31], s44 offen sc1
    buffer_store_dwordx4 v[68:71], v50, s[28:31], s45 offen sc1
    buffer_store_dwordx4 v[72:75], v51, s[28:31], s46 offen sc1
    buffer_store_dword v49, v46, s[28:31], s47 offen sc1
    s_mul_i32 s44, s42, 16
    s_add_u32 s44, s44, s43
    s_lshl_b32 s44, s44, 7
    s_add_u32 s44, s44, 27262976
    s_waitcnt vmcnt(0)
    s_barrier
    buffer_store_dwordx4 v[244:247], v243, s[28:31], s44 offen sc1
    s_add_u32 m0, s53, 20480
    s_nop 0
    buffer_load_dwordx4 v14, s[32:35], s55 offen offset:0 lds
    buffer_load_dwordx4 v15, s[32:35], s55 offen offset:1024 lds
    buffer_load_dwordx4 v16, s[32:35], s55 offen offset:2048 lds
    buffer_load_dwordx4 v17, s[32:35], s55 offen offset:3072 lds
    s_add_u32 m0, s53, 24576
    s_nop 0
    buffer_load_dwordx4 v18, s[32:35], s55 offen lds
    s_add_u32 s55, s55, s52
    s_cmp_eq_u32 s55, s90
    s_cselect_b32 s55, s51, s55
    s_mul_i32 s44, s43, 6400
    s_sub_u32 s45, s43, 4
    s_mul_i32 s45, s45, 3200
    s_cmp_ge_u32 s43, 4
    s_cselect_b32 s44, s45, s44
    s_mov_b32 s46, 6400
    s_cselect_b32 s46, 3200, s46
    s_cmp_ge_u32 s43, 12
    s_cselect_b32 s44, 0, s44
    s_cselect_b32 s46, 0, s46
    s_add_u32 s36, s8, s44
    s_addc_u32 s37, s9, 0
    s_mov_b32 s38, s46
    s_mov_b32 s39, 0x20000
    v_lshlrev_b32 v22, 4, v0
    s_lshl_b32 s45, s41, 10
    s_add_u32 m0, s45, 153856
    s_mov_b32 s47, 0
    buffer_load_dwordx4 v22, s[36:39], s47 offen lds
    s_add_u32 m0, s45, 157952
    s_mov_b32 s47, 4096
    buffer_load_dwordx4 v22, s[36:39], s47 offen lds
    s_mul_i32 s44, s42, 16
    s_lshl_b32 s44, s44, 7
    s_add_u32 s44, s44, 27262976
    v_lshlrev_b32 v22, 7, v1
    v_add_u32 v22, s44, v22
    s_waitcnt vmcnt(0)
    s_cmp_lg_u32 s41, 0
    s_cbranch_scc1 L_pskip_3
    s_mov_b32 exec_lo, 65535
    s_mov_b32 exec_hi, 0
    s_mov_b32 s57, 200000
L_poll_1:
    buffer_load_dword v63, v22, s[28:31], 0 offen sc1
    s_waitcnt vmcnt(0)
    v_cmp_ne_u32 vcc, s40, v63
    s_nop 1
    s_cbranch_vccz L_pdone_2
    s_sub_u32 s57, s57, 1
    s_cmp_lg_u32 s57, 0
    s_cbranch_scc1 L_poll_1
L_pdone_2:
    s_mov_b64 exec, -1
L_pskip_3:
    s_barrier
    v_and_b32 v22, 15, v1
    v_lshlrev_b32 v22, 2, v22
    s_lshl_b32 s44, s42, 7
    s_lshl_b32 s45, s41, 5
    s_add_u32 s44, s44, s45
    s_lshl_b32 s44, s44, 2
    s_add_u32 s44, s44, 36864
    buffer_load_dword v58, v22, s[28:31], s44 offen sc1
    buffer_load_dword v60, v22, s[28:31], s44 offen offset:64 sc1
    s_lshl_b32 s56, s50, 14
    s_add_u32 s56, s56, s54
    s_add_u32 s89, s54, 163840
    v_add_u32 v253, 8192, v19
    buffer_load_dwordx4 a[32:35], v19, s[28:31], s56 offen sc1
    buffer_load_dwordx4 a[36:39], v19, s[28:31], s56 offen offset:256 sc1
    buffer_load_dwordx4 a[40:43], v253, s[28:31], s56 offen sc1
    buffer_load_dwordx4 a[44:47], v253, s[28:31], s56 offen offset:256 sc1
    s_add_u32 s56, s56, 16384
    s_cmp_eq_u32 s56, s89
    s_cselect_b32 s56, s54, s56
    buffer_load_dwordx4 a[48:51], v19, s[28:31], s56 offen sc1
    buffer_load_dwordx4 a[52:55], v19, s[28:31], s56 offen offset:256 sc1
    buffer_load_dwordx4 a[56:59], v253, s[28:31], s56 offen sc1
    buffer_load_dwordx4 a[60:63], v253, s[28:31], s56 offen offset:256 sc1
    s_add_u32 s56, s56, 16384
    s_cmp_eq_u32 s56, s89
    s_cselect_b32 s56, s54, s56
    v_lshrrev_b32 v22, 4, v1
    v_and_b32 v23, 3, v1
    v_lshrrev_b32 v24, 2, v1
    v_and_b32 v24, 3, v24
    v_mul_u32_u24 v25, 800, v23
    v_mul_u32_u24 v24, 40, v24
    v_add_u32 v25, v25, v24
    v_cmp_eq_u32 vcc, v22, v23
    v_mov_b32 v26, 160256
    v_add_u32 v27, 153856, v25
    v_cndmask_b32 v248, v26, v27, vcc
    v_add_u32 v27, 154016, v25
    v_cndmask_b32 v249, v26, v27, vcc
    v_add_u32 v27, 154176, v25
    v_cndmask_b32 v250, v26, v27, vcc
    v_add_u32 v27, 154336, v25
    v_cndmask_b32 v251, v26, v27, vcc
    v_add_u32 v27, 154496, v25
    v_cndmask_b32 v252, v26, v27, vcc
    ds_read_b64_tr_b16 a[72:73], v248 offset:0
    ds_read_b64_tr_b16 a[74:75], v249 offset:0
    ds_read_b64_tr_b16 a[76:77], v250 offset:0
    ds_read_b64_tr_b16 a[78:79], v251 offset:0
    ds_read_b64_tr_b16 a[80:81], v252 offset:0
    v_accvgpr_write_b32 a82, 0
    v_accvgpr_write_b32 a83, 0
    ds_read_b64_tr_b16 a[84:85], v248 offset:8
    ds_read_b64_tr_b16 a[86:87], v249 offset:8
    ds_read_b64_tr_b16 a[88:89], v250 offset:8
    ds_read_b64_tr_b16 a[90:91], v251 offset:8
    ds_read_b64_tr_b16 a[92:93], v252 offset:8
    v_accvgpr_write_b32 a94, 0
    v_accvgpr_write_b32 a95, 0
    ds_read_b64_tr_b16 a[96:97], v248 offset:16
    ds_read_b64_tr_b16 a[98:99], v249 offset:16
    ds_read_b64_tr_b16 a[100:101], v250 offset:16
    ds_read_b64_tr_b16 a[102:103], v251 offset:16
    ds_read_b64_tr_b16 a[104:105], v252 offset:16
    v_accvgpr_write_b32 a106, 0
    v_accvgpr_write_b32 a107, 0
    ds_read_b64_tr_b16 a[108:109], v248 offset:24
    ds_read_b64_tr_b16 a[110:111], v249 offset:24
    ds_read_b64_tr_b16 a[112:113], v250 offset:24
    ds_read_b64_tr_b16 a[114:115], v251 offset:24
    ds_read_b64_tr_b16 a[116:117], v252 offset:24
    v_accvgpr_write_b32 a118, 0
    v_accvgpr_write_b32 a119, 0
    ds_read_b64_tr_b16 a[120:121], v248 offset:32
    ds_read_b64_tr_b16 a[122:123], v249 offset:32
    ds_read_b64_tr_b16 a[124:125], v250 offset:32
    ds_read_b64_tr_b16 a[126:127], v251 offset:32
    ds_read_b64_tr_b16 a[128:129], v252 offset:32
    v_accvgpr_write_b32 a130, 0
    v_accvgpr_write_b32 a131, 0
    v_lshrrev_b32 v22, 4, v1
    v_and_b32 v23, 3, v1
    v_lshrrev_b32 v24, 2, v1
    v_and_b32 v24, 3, v24
    v_mul_u32_u24 v25, 800, v23
    v_mul_u32_u24 v24, 40, v24
    v_add_u32 v25, v25, v24
    v_cmp_eq_u32 vcc, v22, v23
    v_mov_b32 v26, 160256
    v_add_u32 v27, 157056, v25
    v_cndmask_b32 v248, v26, v27, vcc
    v_add_u32 v27, 157216, v25
    v_cndmask_b32 v249, v26, v27, vcc
    v_add_u32 v27, 157376, v25
    v_cndmask_b32 v250, v26, v27, vcc
    v_add_u32 v27, 157536, v25
    v_cndmask_b32 v251, v26, v27, vcc
    v_add_u32 v27, 157696, v25
    v_cndmask_b32 v252, v26, v27, vcc
    ds_read_b64_tr_b16 a[132:133], v248 offset:0
    ds_read_b64_tr_b16 a[134:135], v249 offset:0
    ds_read_b64_tr_b16 a[136:137], v250 offset:0
    ds_read_b64_tr_b16 a[138:139], v251 offset:0
    ds_read_b64_tr_b16 a[140:141], v252 offset:0
    v_accvgpr_write_b32 a142, 0
    v_accvgpr_write_b32 a143, 0
    ds_read_b64_tr_b16 a[144:145], v248 offset:8
    ds_read_b64_tr_b16 a[146:147], v249 offset:8
    ds_read_b64_tr_b16 a[148:149], v250 offset:8
    ds_read_b64_tr_b16 a[150:151], v251 offset:8
    ds_read_b64_tr_b16 a[152:153], v252 offset:8
    v_accvgpr_write_b32 a154, 0
    v_accvgpr_write_b32 a155, 0
    ds_read_b64_tr_b16 a[156:157], v248 offset:16
    ds_read_b64_tr_b16 a[158:159], v249 offset:16
    ds_read_b64_tr_b16 a[160:161], v250 offset:16
    ds_read_b64_tr_b16 a[162:163], v251 offset:16
    ds_read_b64_tr_b16 a[164:165], v252 offset:16
    v_accvgpr_write_b32 a166, 0
    v_accvgpr_write_b32 a167, 0
    ds_read_b64_tr_b16 a[168:169], v248 offset:24
    ds_read_b64_tr_b16 a[170:171], v249 offset:24
    ds_read_b64_tr_b16 a[172:173], v250 offset:24
    ds_read_b64_tr_b16 a[174:175], v251 offset:24
    ds_read_b64_tr_b16 a[176:177], v252 offset:24
    v_accvgpr_write_b32 a178, 0
    v_accvgpr_write_b32 a179, 0
    ds_read_b64_tr_b16 a[180:181], v248 offset:32
    ds_read_b64_tr_b16 a[182:183], v249 offset:32
    ds_read_b64_tr_b16 a[184:185], v250 offset:32
    ds_read_b64_tr_b16 a[186:187], v251 offset:32
    ds_read_b64_tr_b16 a[188:189], v252 offset:32
    v_accvgpr_write_b32 a190, 0
    v_accvgpr_write_b32 a191, 0
    s_waitcnt vmcnt(22)
    s_barrier
    ds_read_b64_tr_b16 a[0:1], v4 offset:0
    ds_read_b64_tr_b16 a[2:3], v4 offset:5120
    ds_read_b64_tr_b16 a[4:5], v5 offset:0
    ds_read_b64_tr_b16 a[6:7], v5 offset:5120
    ds_read_b64_tr_b16 a[8:9], v6 offset:0
    ds_read_b64_tr_b16 a[10:11], v6 offset:5120
    ds_read_b64_tr_b16 a[12:13], v7 offset:0
    ds_read_b64_tr_b16 a[14:15], v7 offset:5120
    ds_read_b64_tr_b16 a[16:17], v8 offset:0
    ds_read_b64_tr_b16 a[18:19], v8 offset:5120
    ds_read_b64_tr_b16 a[20:21], v9 offset:0
    ds_read_b64_tr_b16 a[22:23], v9 offset:5120
    s_waitcnt vmcnt(6) lgkmcnt(8)
    v_mfma_f32_16x16x32_bf16 v[64:67], a[0:3], a[32:35], 0
    ds_read_b64_tr_b16 a[24:25], v10 offset:0
    buffer_load_dwordx4 a[64:67], v19, s[28:31], s56 offen sc1
    v_mfma_f32_16x16x32_bf16 v[68:71], a[0:3], a[36:39], 0
    ds_read_b64_tr_b16 a[26:27], v10 offset:5120
    buffer_load_dwordx4 a[68:71], v19, s[28:31], s56 offen offset:256 sc1
    v_mfma_f32_16x16x32_bf16 v[72:75], a[4:7], a[32:35], 0
    ds_read_b64_tr_b16 a[28:29], v11 offset:0
    s_add_u32 m0, s53, 40960
    v_mfma_f32_16x16x32_bf16 v[76:79], a[4:7], a[36:39], 0
    ds_read_b64_tr_b16 a[30:31], v11 offset:5120
    s_waitcnt lgkmcnt(8)
    v_mfma_f32_16x16x32_bf16 v[80:83], a[8:11], a[32:35], 0
    ds_read_b64_tr_b16 a[0:1], v12 offset:0
    buffer_load_dwordx4 v14, s[32:35], s55 offen offset:0 lds
    v_mfma_f32_16x16x32_bf16 v[84:87], a[8:11], a[36:39], 0
    ds_read_b64_tr_b16 a[2:3], v12 offset:5120
    buffer_load_dwordx4 v15, s[32:35], s55 offen offset:1024 lds
    v_mfma_f32_16x16x32_bf16 v[88:91], a[12:15], a[32:35], 0
    ds_read_b64_tr_b16 a[4:5], v13 offset:0
    buffer_load_dwordx4 v16, s[32:35], s55 offen offset:2048 lds
    v_mfma_f32_16x16x32_bf16 v[92:95], a[12:15], a[36:39], 0
    ds_read_b64_tr_b16 a[6:7], v13 offset:5120
    s_waitcnt lgkmcnt(8)
    v_mfma_f32_16x16x32_bf16 v[96:99], a[16:19], a[32:35], 0
    ds_read_b64_tr_b16 a[8:9], v4 offset:10240
    buffer_load_dwordx4 v17, s[32:35], s55 offen offset:3072 lds
    v_mfma_f32_16x16x32_bf16 v[100:103], a[16:19], a[36:39], 0
    ds_read_b64_tr_b16 a[10:11], v4 offset:15360
    s_add_u32 m0, s53, 45056
    v_mfma_f32_16x16x32_bf16 v[104:107], a[20:23], a[32:35], 0
    ds_read_b64_tr_b16 a[12:13], v5 offset:10240
    buffer_load_dwordx4 v18, s[32:35], s55 offen lds
    v_mfma_f32_16x16x32_bf16 v[108:111], a[20:23], a[36:39], 0
    ds_read_b64_tr_b16 a[14:15], v5 offset:15360
    s_waitcnt lgkmcnt(8)
    v_mfma_f32_16x16x32_bf16 v[112:115], a[24:27], a[32:35], 0
    ds_read_b64_tr_b16 a[16:17], v6 offset:10240
    s_add_u32 s55, s55, s52
    v_mfma_f32_16x16x32_bf16 v[116:119], a[24:27], a[36:39], 0
    ds_read_b64_tr_b16 a[18:19], v6 offset:15360
    s_cmp_eq_u32 s55, s90
    v_mfma_f32_16x16x32_bf16 v[120:123], a[28:31], a[32:35], 0
    ds_read_b64_tr_b16 a[20:21], v7 offset:10240
    s_cselect_b32 s55, s51, s55
    v_mfma_f32_16x16x32_bf16 v[124:127], a[28:31], a[36:39], 0
    ds_read_b64_tr_b16 a[22:23], v7 offset:15360
    s_waitcnt lgkmcnt(8)
    v_mfma_f32_16x16x32_bf16 v[128:131], a[0:3], a[32:35], 0
    ds_read_b64_tr_b16 a[24:25], v8 offset:10240
    s_add_u32 m0, s53, 61440
    v_mfma_f32_16x16x32_bf16 v[132:135], a[0:3], a[36:39], 0
    ds_read_b64_tr_b16 a[26:27], v8 offset:15360
    buffer_load_dwordx4 v14, s[32:35], s55 offen offset:0 lds
    v_mfma_f32_16x16x32_bf16 v[136:139], a[4:7], a[32:35], 0
    ds_read_b64_tr_b16 a[28:29], v9 offset:10240
    buffer_load_dwordx4 v15, s[32:35], s55 offen offset:1024 lds
    v_mfma_f32_16x16x32_bf16 v[140:143], a[4:7], a[36:39], 0
    ds_read_b64_tr_b16 a[30:31], v9 offset:15360
    s_waitcnt vmcnt(13) lgkmcnt(8)
    v_mfma_f32_16x16x32_bf16 v[64:67], a[8:11], a[40:43], v[64:67]
    ds_read_b64_tr_b16 a[0:1], v10 offset:10240
    buffer_load_dwordx4 a[32:35], v253, s[28:31], s56 offen sc1
    v_mfma_f32_16x16x32_bf16 v[68:71], a[8:11], a[44:47], v[68:71]
    ds_read_b64_tr_b16 a[2:3], v10 offset:15360
    buffer_load_dwordx4 a[36:39], v253, s[28:31], s56 offen offset:256 sc1
    v_mfma_f32_16x16x32_bf16 v[72:75], a[12:15], a[40:43], v[72:75]
    ds_read_b64_tr_b16 a[4:5], v11 offset:10240
    s_add_u32 s56, s56, 16384
    v_mfma_f32_16x16x32_bf16 v[76:79], a[12:15], a[44:47], v[76:79]
    ds_read_b64_tr_b16 a[6:7], v11 offset:15360
    s_waitcnt lgkmcnt(8)
    v_mfma_f32_16x16x32_bf16 v[80:83], a[16:19], a[40:43], v[80:83]
    ds_read_b64_tr_b16 a[8:9], v12 offset:10240
    s_cmp_eq_u32 s56, s89
    v_mfma_f32_16x16x32_bf16 v[84:87], a[16:19], a[44:47], v[84:87]
    ds_read_b64_tr_b16 a[10:11], v12 offset:15360
    s_cselect_b32 s56, s54, s56
    v_mfma_f32_16x16x32_bf16 v[88:91], a[20:23], a[40:43], v[88:91]
    ds_read_b64_tr_b16 a[12:13], v13 offset:10240
    buffer_load_dwordx4 v16, s[32:35], s55 offen offset:2048 lds
    v_mfma_f32_16x16x32_bf16 v[92:95], a[20:23], a[44:47], v[92:95]
    ds_read_b64_tr_b16 a[14:15], v13 offset:15360
    s_waitcnt lgkmcnt(8)
    v_mfma_f32_16x16x32_bf16 v[96:99], a[24:27], a[40:43], v[96:99]
    s_waitcnt vmcnt(24)
    s_barrier
    ds_read_b64_tr_b16 a[16:17], v4 offset:20480
    buffer_load_dwordx4 v17, s[32:35], s55 offen offset:3072 lds
    v_mfma_f32_16x16x32_bf16 v[100:103], a[24:27], a[44:47], v[100:103]
    ds_read_b64_tr_b16 a[18:19], v4 offset:25600
    s_add_u32 m0, s53, 65536
    v_mfma_f32_16x16x32_bf16 v[104:107], a[28:31], a[40:43], v[104:107]
    ds_read_b64_tr_b16 a[20:21], v5 offset:20480
    buffer_load_dwordx4 v18, s[32:35], s55 offen lds
    v_mfma_f32_16x16x32_bf16 v[108:111], a[28:31], a[44:47], v[108:111]
    ds_read_b64_tr_b16 a[22:23], v5 offset:25600
    s_waitcnt lgkmcnt(8)
    v_mfma_f32_16x16x32_bf16 v[112:115], a[0:3], a[40:43], v[112:115]
    ds_read_b64_tr_b16 a[24:25], v6 offset:20480
    s_add_u32 s55, s55, s52
    v_mfma_f32_16x16x32_bf16 v[116:119], a[0:3], a[44:47], v[116:119]
    ds_read_b64_tr_b16 a[26:27], v6 offset:25600
    s_cmp_eq_u32 s55, s90
    v_mfma_f32_16x16x32_bf16 v[120:123], a[4:7], a[40:43], v[120:123]
    ds_read_b64_tr_b16 a[28:29], v7 offset:20480
    s_cselect_b32 s55, s51, s55
    v_mfma_f32_16x16x32_bf16 v[124:127], a[4:7], a[44:47], v[124:127]
    ds_read_b64_tr_b16 a[30:31], v7 offset:25600
    s_waitcnt lgkmcnt(8)
    v_mfma_f32_16x16x32_bf16 v[128:131], a[8:11], a[40:43], v[128:131]
    ds_read_b64_tr_b16 a[0:1], v8 offset:20480
    s_add_u32 m0, s53, 81920
    v_mfma_f32_16x16x32_bf16 v[132:135], a[8:11], a[44:47], v[132:135]
    ds_read_b64_tr_b16 a[2:3], v8 offset:25600
    buffer_load_dwordx4 v14, s[32:35], s55 offen offset:0 lds
    v_mfma_f32_16x16x32_bf16 v[136:139], a[12:15], a[40:43], v[136:139]
    ds_read_b64_tr_b16 a[4:5], v9 offset:20480
    buffer_load_dwordx4 v15, s[32:35], s55 offen offset:1024 lds
    v_mfma_f32_16x16x32_bf16 v[140:143], a[12:15], a[44:47], v[140:143]
    ds_read_b64_tr_b16 a[6:7], v9 offset:25600
    s_waitcnt vmcnt(18) lgkmcnt(8)
    v_mfma_f32_16x16x32_bf16 v[64:67], a[16:19], a[48:51], v[64:67]
    ds_read_b64_tr_b16 a[8:9], v10 offset:20480
    buffer_load_dwordx4 a[40:43], v19, s[28:31], s56 offen sc1
    v_mfma_f32_16x16x32_bf16 v[68:71], a[16:19], a[52:55], v[68:71]
    ds_read_b64_tr_b16 a[10:11], v10 offset:25600
    buffer_load_dwordx4 a[44:47], v19, s[28:31], s56 offen offset:256 sc1
    v_mfma_f32_16x16x32_bf16 v[72:75], a[20:23], a[48:51], v[72:75]
    ds_read_b64_tr_b16 a[12:13], v11 offset:20480
    buffer_load_dwordx4 v16, s[32:35], s55 offen offset:2048 lds
    v_mfma_f32_16x16x32_bf16 v[76:79], a[20:23], a[52:55], v[76:79]
    ds_read_b64_tr_b16 a[14:15], v11 offset:25600
    s_waitcnt lgkmcnt(8)
    v_mfma_f32_16x16x32_bf16 v[80:83], a[24:27], a[48:51], v[80:83]
    ds_read_b64_tr_b16 a[16:17], v12 offset:20480
    buffer_load_dwordx4 v17, s[32:35], s55 offen offset:3072 lds
    v_mfma_f32_16x16x32_bf16 v[84:87], a[24:27], a[52:55], v[84:87]
    ds_read_b64_tr_b16 a[18:19], v12 offset:25600
    s_add_u32 m0, s53, 86016
    v_mfma_f32_16x16x32_bf16 v[88:91], a[28:31], a[48:51], v[88:91]
    ds_read_b64_tr_b16 a[20:21], v13 offset:20480
    buffer_load_dwordx4 v18, s[32:35], s55 offen lds
    v_mfma_f32_16x16x32_bf16 v[92:95], a[28:31], a[52:55], v[92:95]
    ds_read_b64_tr_b16 a[22:23], v13 offset:25600
    s_waitcnt lgkmcnt(8)
    v_mfma_f32_16x16x32_bf16 v[96:99], a[0:3], a[48:51], v[96:99]
    ds_read_b64_tr_b16 a[24:25], v4 offset:30720
    s_add_u32 s55, s55, s52
    v_mfma_f32_16x16x32_bf16 v[100:103], a[0:3], a[52:55], v[100:103]
    ds_read_b64_tr_b16 a[26:27], v4 offset:35840
    s_cmp_eq_u32 s55, s90
    v_mfma_f32_16x16x32_bf16 v[104:107], a[4:7], a[48:51], v[104:107]
    ds_read_b64_tr_b16 a[28:29], v5 offset:30720
    s_cselect_b32 s55, s51, s55
    v_mfma_f32_16x16x32_bf16 v[108:111], a[4:7], a[52:55], v[108:111]
    ds_read_b64_tr_b16 a[30:31], v5 offset:35840
    s_waitcnt lgkmcnt(8)
    v_mfma_f32_16x16x32_bf16 v[112:115], a[8:11], a[48:51], v[112:115]
    ds_read_b64_tr_b16 a[0:1], v6 offset:30720
    v_lshlrev_b32 v250, 4, v1
    v_mfma_f32_16x16x32_bf16 v[116:119], a[8:11], a[52:55], v[116:119]
    ds_read_b64_tr_b16 a[2:3], v6 offset:35840
    v_add_u32 v251, 1152, v250
    v_mfma_f32_16x16x32_bf16 v[120:123], a[12:15], a[48:51], v[120:123]
    ds_read_b64_tr_b16 a[4:5], v7 offset:30720
    v_add_u32 v250, 128, v250
    v_mfma_f32_16x16x32_bf16 v[124:127], a[12:15], a[52:55], v[124:127]
    ds_read_b64_tr_b16 a[6:7], v7 offset:35840
    s_waitcnt lgkmcnt(8)
    v_mfma_f32_16x16x32_bf16 v[128:131], a[16:19], a[48:51], v[128:131]
    ds_read_b64_tr_b16 a[8:9], v8 offset:30720
    v_mov_b32 v249, 1073741824
    v_mfma_f32_16x16x32_bf16 v[132:135], a[16:19], a[52:55], v[132:135]
    ds_read_b64_tr_b16 a[10:11], v8 offset:35840
    v_cmp_gt_u32 vcc, 48, v1
    v_mfma_f32_16x16x32_bf16 v[136:139], a[20:23], a[48:51], v[136:139]
    ds_read_b64_tr_b16 a[12:13], v9 offset:30720
    v_cndmask_b32 v251, v249, v251, vcc
    v_mfma_f32_16x16x32_bf16 v[140:143], a[20:23], a[52:55], v[140:143]
    ds_read_b64_tr_b16 a[14:15], v9 offset:35840
    s_waitcnt vmcnt(21) lgkmcnt(8)
    v_mfma_f32_16x16x32_bf16 v[64:67], a[24:27], a[56:59], v[64:67]
    ds_read_b64_tr_b16 a[16:17], v10 offset:30720
    buffer_load_dwordx4 a[48:51], v253, s[28:31], s56 offen sc1
    v_mfma_f32_16x16x32_bf16 v[68:71], a[24:27], a[60:63], v[68:71]
    ds_read_b64_tr_b16 a[18:19], v10 offset:35840
    buffer_load_dwordx4 a[52:55], v253, s[28:31], s56 offen offset:256 sc1
    v_mfma_f32_16x16x32_bf16 v[72:75], a[28:31], a[56:59], v[72:75]
    ds_read_b64_tr_b16 a[20:21], v11 offset:30720
    s_add_u32 s56, s56, 16384
    v_mfma_f32_16x16x32_bf16 v[76:79], a[28:31], a[60:63], v[76:79]
    ds_read_b64_tr_b16 a[22:23], v11 offset:35840
    s_waitcnt lgkmcnt(8)
    v_mfma_f32_16x16x32_bf16 v[80:83], a[0:3], a[56:59], v[80:83]
    ds_read_b64_tr_b16 a[24:25], v12 offset:30720
    s_cmp_eq_u32 s56, s89
    v_mfma_f32_16x16x32_bf16 v[84:87], a[0:3], a[60:63], v[84:87]
    ds_read_b64_tr_b16 a[26:27], v12 offset:35840
    s_cselect_b32 s56, s54, s56
    v_mfma_f32_16x16x32_bf16 v[88:91], a[4:7], a[56:59], v[88:91]
    ds_read_b64_tr_b16 a[28:29], v13 offset:30720
    s_sub_u32 s81, s43, 12
    v_mfma_f32_16x16x32_bf16 v[92:95], a[4:7], a[60:63], v[92:95]
    ds_read_b64_tr_b16 a[30:31], v13 offset:35840
    s_waitcnt lgkmcnt(8)
    v_mfma_f32_16x16x32_bf16 v[96:99], a[8:11], a[56:59], v[96:99]
    s_waitcnt vmcnt(16)
    s_barrier
    ds_read_b64_tr_b16 a[0:1], v4 offset:40960
    s_mul_i32 s81, s81, 40960
    v_mfma_f32_16x16x32_bf16 v[100:103], a[8:11], a[60:63], v[100:103]
    ds_read_b64_tr_b16 a[2:3], v4 offset:46080
    s_mul_i32 s80, s42, 163840
    v_mfma_f32_16x16x32_bf16 v[104:107], a[12:15], a[56:59], v[104:107]
    ds_read_b64_tr_b16 a[4:5], v5 offset:40960
    s_add_u32 s81, s81, s80
    v_mfma_f32_16x16x32_bf16 v[108:111], a[12:15], a[60:63], v[108:111]
    ds_read_b64_tr_b16 a[6:7], v5 offset:46080
    s_waitcnt lgkmcnt(8)
    v_mfma_f32_16x16x32_bf16 v[112:115], a[16:19], a[56:59], v[112:115]
    ds_read_b64_tr_b16 a[8:9], v6 offset:40960
    s_lshl_b32 s80, s41, 11
    v_mfma_f32_16x16x32_bf16 v[116:119], a[16:19], a[60:63], v[116:119]
    ds_read_b64_tr_b16 a[10:11], v6 offset:46080
    s_add_u32 s81, s81, s80
    v_mfma_f32_16x16x32_bf16 v[120:123], a[20:23], a[56:59], v[120:123]
    ds_read_b64_tr_b16 a[12:13], v7 offset:40960
    s_add_u32 s81, s81, 4980736
    v_mfma_f32_16x16x32_bf16 v[124:127], a[20:23], a[60:63], v[124:127]
    ds_read_b64_tr_b16 a[14:15], v7 offset:46080
    s_waitcnt lgkmcnt(8)
    v_mfma_f32_16x16x32_bf16 v[128:131], a[24:27], a[56:59], v[128:131]
    ds_read_b64_tr_b16 a[16:17], v8 offset:40960
    s_cmp_ge_u32 s43, 12
    v_mfma_f32_16x16x32_bf16 v[132:135], a[24:27], a[60:63], v[132:135]
    ds_read_b64_tr_b16 a[18:19], v8 offset:46080
    s_cselect_b32 s81, s81, 1073741824
    v_mfma_f32_16x16x32_bf16 v[136:139], a[28:31], a[56:59], v[136:139]
    ds_read_b64_tr_b16 a[20:21], v9 offset:40960
    buffer_store_dwordx4 v[244:247], v250, s[28:31], s81 offen sc1
    v_mfma_f32_16x16x32_bf16 v[140:143], a[28:31], a[60:63], v[140:143]
    ds_read_b64_tr_b16 a[22:23], v9 offset:46080
    s_waitcnt vmcnt(22) lgkmcnt(8)
    v_mfma_f32_16x16x32_bf16 v[64:67], a[0:3], a[64:67], v[64:67]
    ds_read_b64_tr_b16 a[24:25], v10 offset:40960
    buffer_load_dwordx4 a[56:59], v19, s[28:31], s56 offen sc1
    v_mfma_f32_16x16x32_bf16 v[68:71], a[0:3], a[68:71], v[68:71]
    ds_read_b64_tr_b16 a[26:27], v10 offset:46080
    buffer_load_dwordx4 a[60:63], v19, s[28:31], s56 offen offset:256 sc1
    v_mfma_f32_16x16x32_bf16 v[72:75], a[4:7], a[64:67], v[72:75]
    ds_read_b64_tr_b16 a[28:29], v11 offset:40960
    buffer_store_dwordx4 v[244:247], v251, s[28:31], s81 offen sc1
    v_mfma_f32_16x16x32_bf16 v[76:79], a[4:7], a[68:71], v[76:79]
    ds_read_b64_tr_b16 a[30:31], v11 offset:46080
    s_waitcnt lgkmcnt(8)
    v_mfma_f32_16x16x32_bf16 v[80:83], a[8:11], a[64:67], v[80:83]
    ds_read_b64_tr_b16 a[0:1], v12 offset:40960
    s_cmp_ge_u32 s43, 12
    v_mfma_f32_16x16x32_bf16 v[84:87], a[8:11], a[68:71], v[84:87]
    ds_read_b64_tr_b16 a[2:3], v12 offset:46080
    s_cselect_b32 s80, 8192, 0
    v_mfma_f32_16x16x32_bf16 v[88:91], a[12:15], a[64:67], v[88:91]
    ds_read_b64_tr_b16 a[4:5], v13 offset:40960
    s_add_u32 s81, s81, s80
    v_mfma_f32_16x16x32_bf16 v[92:95], a[12:15], a[68:71], v[92:95]
    ds_read_b64_tr_b16 a[6:7], v13 offset:46080
    s_waitcnt lgkmcnt(8)
    v_mfma_f32_16x16x32_bf16 v[96:99], a[16:19], a[64:67], v[96:99]
    ds_read_b64_tr_b16 a[8:9], v4 offset:51200
    s_add_u32 m0, s53, 102400
    v_mfma_f32_16x16x32_bf16 v[100:103], a[16:19], a[68:71], v[100:103]
    ds_read_b64_tr_b16 a[10:11], v4 offset:56320
    buffer_load_dwordx4 v14, s[32:35], s55 offen offset:0 lds
    v_mfma_f32_16x16x32_bf16 v[104:107], a[20:23], a[64:67], v[104:107]
    ds_read_b64_tr_b16 a[12:13], v5 offset:51200
    buffer_load_dwordx4 v15, s[32:35], s55 offen offset:1024 lds
    v_mfma_f32_16x16x32_bf16 v[108:111], a[20:23], a[68:71], v[108:111]
    ds_read_b64_tr_b16 a[14:15], v5 offset:56320
    s_waitcnt lgkmcnt(8)
    v_mfma_f32_16x16x32_bf16 v[112:115], a[24:27], a[64:67], v[112:115]
    ds_read_b64_tr_b16 a[16:17], v6 offset:51200
    buffer_load_dwordx4 v16, s[32:35], s55 offen offset:2048 lds
    v_mfma_f32_16x16x32_bf16 v[116:119], a[24:27], a[68:71], v[116:119]
    ds_read_b64_tr_b16 a[18:19], v6 offset:56320
    buffer_load_dwordx4 v17, s[32:35], s55 offen offset:3072 lds
    v_mfma_f32_16x16x32_bf16 v[120:123], a[28:31], a[64:67], v[120:123]
    ds_read_b64_tr_b16 a[20:21], v7 offset:51200
    s_add_u32 m0, s53, 106496
    v_mfma_f32_16x16x32_bf16 v[124:127], a[28:31], a[68:71], v[124:127]
    ds_read_b64_tr_b16 a[22:23], v7 offset:56320
    s_waitcnt lgkmcnt(8)
    v_mfma_f32_16x16x32_bf16 v[128:131], a[0:3], a[64:67], v[128:131]
    ds_read_b64_tr_b16 a[24:25], v8 offset:51200
    buffer_load_dwordx4 v18, s[32:35], s55 offen lds
    v_mfma_f32_16x16x32_bf16 v[132:135], a[0:3], a[68:71], v[132:135]
    ds_read_b64_tr_b16 a[26:27], v8 offset:56320
    s_add_u32 s55, s55, s52
    v_mfma_f32_16x16x32_bf16 v[136:139], a[4:7], a[64:67], v[136:139]
    ds_read_b64_tr_b16 a[28:29], v9 offset:51200
    s_cmp_eq_u32 s55, s90
    v_mfma_f32_16x16x32_bf16 v[140:143], a[4:7], a[68:71], v[140:143]
    ds_read_b64_tr_b16 a[30:31], v9 offset:56320
    s_waitcnt vmcnt(21) lgkmcnt(8)
    v_mfma_f32_16x16x32_bf16 v[64:67], a[8:11], a[32:35], v[64:67]
    ds_read_b64_tr_b16 a[0:1], v10 offset:51200
    s_cselect_b32 s55, s51, s55
    v_mfma_f32_16x16x32_bf16 v[68:71], a[8:11], a[36:39], v[68:71]
    ds_read_b64_tr_b16 a[2:3], v10 offset:56320
    buffer_load_dwordx4 a[64:67], v253, s[28:31], s56 offen sc1
    v_mfma_f32_16x16x32_bf16 v[72:75], a[12:15], a[32:35], v[72:75]
    ds_read_b64_tr_b16 a[4:5], v11 offset:51200
    buffer_load_dwordx4 a[68:71], v253, s[28:31], s56 offen offset:256 sc1
    v_mfma_f32_16x16x32_bf16 v[76:79], a[12:15], a[36:39], v[76:79]
    ds_read_b64_tr_b16 a[6:7], v11 offset:56320
    s_waitcnt lgkmcnt(8)
    v_mfma_f32_16x16x32_bf16 v[80:83], a[16:19], a[32:35], v[80:83]
    ds_read_b64_tr_b16 a[8:9], v12 offset:51200
    s_add_u32 s56, s56, 16384
    v_mfma_f32_16x16x32_bf16 v[84:87], a[16:19], a[36:39], v[84:87]
    ds_read_b64_tr_b16 a[10:11], v12 offset:56320
    s_cmp_eq_u32 s56, s89
    v_mfma_f32_16x16x32_bf16 v[88:91], a[20:23], a[32:35], v[88:91]
    ds_read_b64_tr_b16 a[12:13], v13 offset:51200
    s_cselect_b32 s56, s54, s56
    v_mfma_f32_16x16x32_bf16 v[92:95], a[20:23], a[36:39], v[92:95]
    ds_read_b64_tr_b16 a[14:15], v13 offset:56320
    s_waitcnt lgkmcnt(8)
    v_mfma_f32_16x16x32_bf16 v[96:99], a[24:27], a[32:35], v[96:99]
    s_waitcnt vmcnt(20)
    s_barrier
    v_add_u32 v4, 61440, v4
    v_add_u32 v5, 61440, v5
    v_add_u32 v6, 61440, v6
    v_add_u32 v7, 61440, v7
    v_add_u32 v8, 61440, v8
    v_add_u32 v9, 61440, v9
    v_add_u32 v10, 61440, v10
    v_add_u32 v11, 61440, v11
    v_add_u32 v12, 61440, v12
    v_add_u32 v13, 61440, v13
    ds_read_b64_tr_b16 a[16:17], v4 offset:0
    buffer_store_dwordx4 v[244:247], v250, s[28:31], s81 offen sc1
    v_mfma_f32_16x16x32_bf16 v[100:103], a[24:27], a[36:39], v[100:103]
    ds_read_b64_tr_b16 a[18:19], v4 offset:5120
    buffer_store_dwordx4 v[244:247], v251, s[28:31], s81 offen sc1
    v_mfma_f32_16x16x32_bf16 v[104:107], a[28:31], a[32:35], v[104:107]
    ds_read_b64_tr_b16 a[20:21], v5 offset:0
    s_cmp_ge_u32 s43, 12
    v_mfma_f32_16x16x32_bf16 v[108:111], a[28:31], a[36:39], v[108:111]
    ds_read_b64_tr_b16 a[22:23], v5 offset:5120
    s_waitcnt lgkmcnt(8)
    v_mfma_f32_16x16x32_bf16 v[112:115], a[0:3], a[32:35], v[112:115]
    ds_read_b64_tr_b16 a[24:25], v6 offset:0
    s_cselect_b32 s80, 8192, 0
    v_mfma_f32_16x16x32_bf16 v[116:119], a[0:3], a[36:39], v[116:119]
    ds_read_b64_tr_b16 a[26:27], v6 offset:5120
    s_add_u32 s81, s81, s80
    v_mfma_f32_16x16x32_bf16 v[120:123], a[4:7], a[32:35], v[120:123]
    ds_read_b64_tr_b16 a[28:29], v7 offset:0
    s_add_u32 m0, s53, 122880
    v_mfma_f32_16x16x32_bf16 v[124:127], a[4:7], a[36:39], v[124:127]
    ds_read_b64_tr_b16 a[30:31], v7 offset:5120
    s_waitcnt lgkmcnt(8)
    v_mfma_f32_16x16x32_bf16 v[128:131], a[8:11], a[32:35], v[128:131]
    ds_read_b64_tr_b16 a[0:1], v8 offset:0
    buffer_load_dwordx4 v14, s[32:35], s55 offen offset:0 lds
    v_mfma_f32_16x16x32_bf16 v[132:135], a[8:11], a[36:39], v[132:135]
    ds_read_b64_tr_b16 a[2:3], v8 offset:5120
    buffer_load_dwordx4 v15, s[32:35], s55 offen offset:1024 lds
    v_mfma_f32_16x16x32_bf16 v[136:139], a[12:15], a[32:35], v[136:139]
    ds_read_b64_tr_b16 a[4:5], v9 offset:0
    buffer_load_dwordx4 v16, s[32:35], s55 offen offset:2048 lds
    v_mfma_f32_16x16x32_bf16 v[140:143], a[12:15], a[36:39], v[140:143]
    ds_read_b64_tr_b16 a[6:7], v9 offset:5120
    s_waitcnt vmcnt(21) lgkmcnt(8)
    v_mfma_f32_16x16x32_bf16 v[64:67], a[16:19], a[40:43], v[64:67]
    ds_read_b64_tr_b16 a[8:9], v10 offset:0
    buffer_load_dwordx4 a[32:35], v19, s[28:31], s56 offen sc1
    v_mfma_f32_16x16x32_bf16 v[68:71], a[16:19], a[44:47], v[68:71]
    ds_read_b64_tr_b16 a[10:11], v10 offset:5120
    buffer_load_dwordx4 a[36:39], v19, s[28:31], s56 offen offset:256 sc1
    v_mfma_f32_16x16x32_bf16 v[72:75], a[20:23], a[40:43], v[72:75]
    ds_read_b64_tr_b16 a[12:13], v11 offset:0
    buffer_load_dwordx4 v17, s[32:35], s55 offen offset:3072 lds
    v_mfma_f32_16x16x32_bf16 v[76:79], a[20:23], a[44:47], v[76:79]
    ds_read_b64_tr_b16 a[14:15], v11 offset:5120
    s_waitcnt lgkmcnt(8)
    v_mfma_f32_16x16x32_bf16 v[80:83], a[24:27], a[40:43], v[80:83]
    ds_read_b64_tr_b16 a[16:17], v12 offset:0
    s_add_u32 m0, s53, 126976
    v_mfma_f32_16x16x32_bf16 v[84:87], a[24:27], a[44:47], v[84:87]
    ds_read_b64_tr_b16 a[18:19], v12 offset:5120
    buffer_load_dwordx4 v18, s[32:35], s55 offen lds
    v_mfma_f32_16x16x32_bf16 v[88:91], a[28:31], a[40:43], v[88:91]
    ds_read_b64_tr_b16 a[20:21], v13 offset:0
    s_add_u32 s55, s55, s52
    v_mfma_f32_16x16x32_bf16 v[92:95], a[28:31], a[44:47], v[92:95]
    ds_read_b64_tr_b16 a[22:23], v13 offset:5120
    s_waitcnt lgkmcnt(8)
    v_mfma_f32_16x16x32_bf16 v[96:99], a[0:3], a[40:43], v[96:99]
    ds_read_b64_tr_b16 a[24:25], v4 offset:10240
    s_cmp_eq_u32 s55, s90
    v_mfma_f32_16x16x32_bf16 v[100:103], a[0:3], a[44:47], v[100:103]
    ds_read_b64_tr_b16 a[26:27], v4 offset:15360
    s_cselect_b32 s55, s51, s55
    v_mfma_f32_16x16x32_bf16 v[104:107], a[4:7], a[40:43], v[104:107]
    ds_read_b64_tr_b16 a[28:29], v5 offset:10240
    buffer_store_dwordx4 v[244:247], v250, s[28:31], s81 offen sc1
    v_mfma_f32_16x16x32_bf16 v[108:111], a[4:7], a[44:47], v[108:111]
    ds_read_b64_tr_b16 a[30:31], v5 offset:15360
    s_waitcnt lgkmcnt(8)
    v_mfma_f32_16x16x32_bf16 v[112:115], a[8:11], a[40:43], v[112:115]
    ds_read_b64_tr_b16 a[0:1], v6 offset:10240
    buffer_store_dwordx4 v[244:247], v251, s[28:31], s81 offen sc1
    v_mfma_f32_16x16x32_bf16 v[116:119], a[8:11], a[44:47], v[116:119]
    ds_read_b64_tr_b16 a[2:3], v6 offset:15360
    s_cmp_ge_u32 s43, 12
    v_mfma_f32_16x16x32_bf16 v[120:123], a[12:15], a[40:43], v[120:123]
    ds_read_b64_tr_b16 a[4:5], v7 offset:10240
    s_cselect_b32 s80, 8192, 0
    v_mfma_f32_16x16x32_bf16 v[124:127], a[12:15], a[44:47], v[124:127]
    ds_read_b64_tr_b16 a[6:7], v7 offset:15360
    s_waitcnt lgkmcnt(8)
    v_mfma_f32_16x16x32_bf16 v[128:131], a[16:19], a[40:43], v[128:131]
    ds_read_b64_tr_b16 a[8:9], v8 offset:10240
    s_add_u32 s81, s81, s80
    v_mfma_f32_16x16x32_bf16 v[132:135], a[16:19], a[44:47], v[132:135]
    ds_read_b64_tr_b16 a[10:11], v8 offset:15360
    v_mfma_f32_16x16x32_bf16 v[136:139], a[20:23], a[40:43], v[136:139]
    ds_read_b64_tr_b16 a[12:13], v9 offset:10240
    v_mfma_f32_16x16x32_bf16 v[140:143], a[20:23], a[44:47], v[140:143]
    ds_read_b64_tr_b16 a[14:15], v9 offset:15360
    s_waitcnt vmcnt(22) lgkmcnt(8)
    v_mfma_f32_16x16x32_bf16 v[64:67], a[24:27], a[48:51], v[64:67]
    ds_read_b64_tr_b16 a[16:17], v10 offset:10240
    buffer_load_dwordx4 a[40:43], v253, s[28:31], s56 offen sc1
    v_mfma_f32_16x16x32_bf16 v[68:71], a[24:27], a[52:55], v[68:71]
    ds_read_b64_tr_b16 a[18:19], v10 offset:15360
    buffer_load_dwordx4 a[44:47], v253, s[28:31], s56 offen offset:256 sc1
    v_mfma_f32_16x16x32_bf16 v[72:75], a[28:31], a[48:51], v[72:75]
    ds_read_b64_tr_b16 a[20:21], v11 offset:10240
    s_add_u32 s56, s56, 16384
    v_mfma_f32_16x16x32_bf16 v[76:79], a[28:31], a[52:55], v[76:79]
    ds_read_b64_tr_b16 a[22:23], v11 offset:15360
    s_waitcnt lgkmcnt(8)
    v_mfma_f32_16x16x32_bf16 v[80:83], a[0:3], a[48:51], v[80:83]
    ds_read_b64_tr_b16 a[24:25], v12 offset:10240
    s_cmp_eq_u32 s56, s89
    v_mfma_f32_16x16x32_bf16 v[84:87], a[0:3], a[52:55], v[84:87]
    ds_read_b64_tr_b16 a[26:27], v12 offset:15360
    s_cselect_b32 s56, s54, s56
    v_mfma_f32_16x16x32_bf16 v[88:91], a[4:7], a[48:51], v[88:91]
    ds_read_b64_tr_b16 a[28:29], v13 offset:10240
    v_mfma_f32_16x16x32_bf16 v[92:95], a[4:7], a[52:55], v[92:95]
    ds_read_b64_tr_b16 a[30:31], v13 offset:15360
    s_waitcnt lgkmcnt(8)
    v_mfma_f32_16x16x32_bf16 v[96:99], a[8:11], a[48:51], v[96:99]
    s_waitcnt vmcnt(26)
    s_barrier
    ds_read_b64_tr_b16 a[0:1], v4 offset:20480
    s_add_u32 m0, s53, 0
    v_mfma_f32_16x16x32_bf16 v[100:103], a[8:11], a[52:55], v[100:103]
    ds_read_b64_tr_b16 a[2:3], v4 offset:25600
    buffer_load_dwordx4 v14, s[32:35], s55 offen offset:0 lds
    v_mfma_f32_16x16x32_bf16 v[104:107], a[12:15], a[48:51], v[104:107]
    ds_read_b64_tr_b16 a[4:5], v5 offset:20480
    buffer_load_dwordx4 v15, s[32:35], s55 offen offset:1024 lds
    v_mfma_f32_16x16x32_bf16 v[108:111], a[12:15], a[52:55], v[108:111]
    ds_read_b64_tr_b16 a[6:7], v5 offset:25600
    s_waitcnt lgkmcnt(8)
    v_mfma_f32_16x16x32_bf16 v[112:115], a[16:19], a[48:51], v[112:115]
    ds_read_b64_tr_b16 a[8:9], v6 offset:20480
    buffer_load_dwordx4 v16, s[32:35], s55 offen offset:2048 lds
    v_mfma_f32_16x16x32_bf16 v[116:119], a[16:19], a[52:55], v[116:119]
    ds_read_b64_tr_b16 a[10:11], v6 offset:25600
    buffer_load_dwordx4 v17, s[32:35], s55 offen offset:3072 lds
    v_mfma_f32_16x16x32_bf16 v[120:123], a[20:23], a[48:51], v[120:123]
    ds_read_b64_tr_b16 a[12:13], v7 offset:20480
    s_add_u32 m0, s53, 4096
    v_mfma_f32_16x16x32_bf16 v[124:127], a[20:23], a[52:55], v[124:127]
    ds_read_b64_tr_b16 a[14:15], v7 offset:25600
    s_waitcnt lgkmcnt(8)
    v_mfma_f32_16x16x32_bf16 v[128:131], a[24:27], a[48:51], v[128:131]
    ds_read_b64_tr_b16 a[16:17], v8 offset:20480
    buffer_load_dwordx4 v18, s[32:35], s55 offen lds
    v_mfma_f32_16x16x32_bf16 v[132:135], a[24:27], a[52:55], v[132:135]
    ds_read_b64_tr_b16 a[18:19], v8 offset:25600
    s_add_u32 s55, s55, s52
    v_mfma_f32_16x16x32_bf16 v[136:139], a[28:31], a[48:51], v[136:139]
    ds_read_b64_tr_b16 a[20:21], v9 offset:20480
    s_cmp_eq_u32 s55, s90
    v_mfma_f32_16x16x32_bf16 v[140:143], a[28:31], a[52:55], v[140:143]
    ds_read_b64_tr_b16 a[22:23], v9 offset:25600
    s_waitcnt vmcnt(26) lgkmcnt(8)
    v_mfma_f32_16x16x32_bf16 v[64:67], a[0:3], a[56:59], v[64:67]
    ds_read_b64_tr_b16 a[24:25], v10 offset:20480
    s_cselect_b32 s55, s51, s55
    v_mfma_f32_16x16x32_bf16 v[68:71], a[0:3], a[60:63], v[68:71]
    ds_read_b64_tr_b16 a[26:27], v10 offset:25600
    buffer_load_dwordx4 a[48:51], v19, s[28:31], s56 offen sc1
    v_mfma_f32_16x16x32_bf16 v[72:75], a[4:7], a[56:59], v[72:75]
    ds_read_b64_tr_b16 a[28:29], v11 offset:20480
    buffer_load_dwordx4 a[52:55], v19, s[28:31], s56 offen offset:256 sc1
    v_mfma_f32_16x16x32_bf16 v[76:79], a[4:7], a[60:63], v[76:79]
    ds_read_b64_tr_b16 a[30:31], v11 offset:25600
    s_waitcnt lgkmcnt(8)
    v_mfma_f32_16x16x32_bf16 v[80:83], a[8:11], a[56:59], v[80:83]
    ds_read_b64_tr_b16 a[0:1], v12 offset:20480
    buffer_store_dwordx4 v[244:247], v250, s[28:31], s81 offen sc1
    v_mfma_f32_16x16x32_bf16 v[84:87], a[8:11], a[60:63], v[84:87]
    ds_read_b64_tr_b16 a[2:3], v12 offset:25600
    buffer_store_dwordx4 v[244:247], v251, s[28:31], s81 offen sc1
    v_mfma_f32_16x16x32_bf16 v[88:91], a[12:15], a[56:59], v[88:91]
    ds_read_b64_tr_b16 a[4:5], v13 offset:20480
    s_cmp_ge_u32 s43, 12
    v_mfma_f32_16x16x32_bf16 v[92:95], a[12:15], a[60:63], v[92:95]
    ds_read_b64_tr_b16 a[6:7], v13 offset:25600
    s_waitcnt lgkmcnt(8)
    v_mfma_f32_16x16x32_bf16 v[96:99], a[16:19], a[56:59], v[96:99]
    ds_read_b64_tr_b16 a[8:9], v4 offset:30720
    s_cselect_b32 s80, 8192, 0
    v_mfma_f32_16x16x32_bf16 v[100:103], a[16:19], a[60:63], v[100:103]
    ds_read_b64_tr_b16 a[10:11], v4 offset:35840
    s_add_u32 s81, s81, s80
    v_mfma_f32_16x16x32_bf16 v[104:107], a[20:23], a[56:59], v[104:107]
    ds_read_b64_tr_b16 a[12:13], v5 offset:30720
    v_mfma_f32_16x16x32_bf16 v[108:111], a[20:23], a[60:63], v[108:111]
    ds_read_b64_tr_b16 a[14:15], v5 offset:35840
    s_waitcnt lgkmcnt(8)
    v_mfma_f32_16x16x32_bf16 v[112:115], a[24:27], a[56:59], v[112:115]
    ds_read_b64_tr_b16 a[16:17], v6 offset:30720
    v_mfma_f32_16x16x32_bf16 v[116:119], a[24:27], a[60:63], v[116:119]
    ds_read_b64_tr_b16 a[18:19], v6 offset:35840
    v_mfma_f32_16x16x32_bf16 v[120:123], a[28:31], a[56:59], v[120:123]
    ds_read_b64_tr_b16 a[20:21], v7 offset:30720
    v_mfma_f32_16x16x32_bf16 v[124:127], a[28:31], a[60:63], v[124:127]
    ds_read_b64_tr_b16 a[22:23], v7 offset:35840
    s_waitcnt lgkmcnt(8)
    v_mfma_f32_16x16x32_bf16 v[128:131], a[0:3], a[56:59], v[128:131]
    ds_read_b64_tr_b16 a[24:25], v8 offset:30720
    v_mfma_f32_16x16x32_bf16 v[132:135], a[0:3], a[60:63], v[132:135]
    ds_read_b64_tr_b16 a[26:27], v8 offset:35840
    v_mfma_f32_16x16x32_bf16 v[136:139], a[4:7], a[56:59], v[136:139]
    ds_read_b64_tr_b16 a[28:29], v9 offset:30720
    v_mfma_f32_16x16x32_bf16 v[140:143], a[4:7], a[60:63], v[140:143]
    ds_read_b64_tr_b16 a[30:31], v9 offset:35840
    s_waitcnt vmcnt(22) lgkmcnt(8)
    v_mfma_f32_16x16x32_bf16 v[64:67], a[8:11], a[64:67], v[64:67]
    ds_read_b64_tr_b16 a[0:1], v10 offset:30720
    buffer_load_dwordx4 a[56:59], v253, s[28:31], s56 offen sc1
    v_mfma_f32_16x16x32_bf16 v[68:71], a[8:11], a[68:71], v[68:71]
    ds_read_b64_tr_b16 a[2:3], v10 offset:35840
    buffer_load_dwordx4 a[60:63], v253, s[28:31], s56 offen offset:256 sc1
    v_mfma_f32_16x16x32_bf16 v[72:75], a[12:15], a[64:67], v[72:75]
    ds_read_b64_tr_b16 a[4:5], v11 offset:30720
    s_add_u32 s56, s56, 16384
    v_mfma_f32_16x16x32_bf16 v[76:79], a[12:15], a[68:71], v[76:79]
    ds_read_b64_tr_b16 a[6:7], v11 offset:35840
    s_waitcnt lgkmcnt(8)
    v_mfma_f32_16x16x32_bf16 v[80:83], a[16:19], a[64:67], v[80:83]
    ds_read_b64_tr_b16 a[8:9], v12 offset:30720
    s_cmp_eq_u32 s56, s89
    v_mfma_f32_16x16x32_bf16 v[84:87], a[16:19], a[68:71], v[84:87]
    ds_read_b64_tr_b16 a[10:11], v12 offset:35840
    s_cselect_b32 s56, s54, s56
    v_mfma_f32_16x16x32_bf16 v[88:91], a[20:23], a[64:67], v[88:91]
    ds_read_b64_tr_b16 a[12:13], v13 offset:30720
    v_mfma_f32_16x16x32_bf16 v[92:95], a[20:23], a[68:71], v[92:95]
    ds_read_b64_tr_b16 a[14:15], v13 offset:35840
    s_waitcnt lgkmcnt(8)
    v_mfma_f32_16x16x32_bf16 v[96:99], a[24:27], a[64:67], v[96:99]
    s_waitcnt vmcnt(26)
    s_barrier
    ds_read_b64_tr_b16 a[16:17], v4 offset:40960
    s_add_u32 m0, s53, 20480
    v_mfma_f32_16x16x32_bf16 v[100:103], a[24:27], a[68:71], v[100:103]
    ds_read_b64_tr_b16 a[18:19], v4 offset:46080
    buffer_load_dwordx4 v14, s[32:35], s55 offen offset:0 lds
    v_mfma_f32_16x16x32_bf16 v[104:107], a[28:31], a[64:67], v[104:107]
    ds_read_b64_tr_b16 a[20:21], v5 offset:40960
    buffer_load_dwordx4 v15, s[32:35], s55 offen offset:1024 lds
    v_mfma_f32_16x16x32_bf16 v[108:111], a[28:31], a[68:71], v[108:111]
    ds_read_b64_tr_b16 a[22:23], v5 offset:46080
    s_waitcnt lgkmcnt(8)
    v_mfma_f32_16x16x32_bf16 v[112:115], a[0:3], a[64:67], v[112:115]
    ds_read_b64_tr_b16 a[24:25], v6 offset:40960
    buffer_load_dwordx4 v16, s[32:35], s55 offen offset:2048 lds
    v_mfma_f32_16x16x32_bf16 v[116:119], a[0:3], a[68:71], v[116:119]
    ds_read_b64_tr_b16 a[26:27], v6 offset:46080
    buffer_load_dwordx4 v17, s[32:35], s55 offen offset:3072 lds
    v_mfma_f32_16x16x32_bf16 v[120:123], a[4:7], a[64:67], v[120:123]
    ds_read_b64_tr_b16 a[28:29], v7 offset:40960
    s_add_u32 m0, s53, 24576
    v_mfma_f32_16x16x32_bf16 v[124:127], a[4:7], a[68:71], v[124:127]
    ds_read_b64_tr_b16 a[30:31], v7 offset:46080
    s_waitcnt lgkmcnt(8)
    v_mfma_f32_16x16x32_bf16 v[128:131], a[8:11], a[64:67], v[128:131]
    ds_read_b64_tr_b16 a[0:1], v8 offset:40960
    buffer_load_dwordx4 v18, s[32:35], s55 offen lds
    v_mfma_f32_16x16x32_bf16 v[132:135], a[8:11], a[68:71], v[132:135]
    ds_read_b64_tr_b16 a[2:3], v8 offset:46080
    s_add_u32 s55, s55, s52
    v_mfma_f32_16x16x32_bf16 v[136:139], a[12:15], a[64:67], v[136:139]
    ds_read_b64_tr_b16 a[4:5], v9 offset:40960
    s_cmp_eq_u32 s55, s90
    v_mfma_f32_16x16x32_bf16 v[140:143], a[12:15], a[68:71], v[140:143]
    ds_read_b64_tr_b16 a[6:7], v9 offset:46080
    s_waitcnt vmcnt(22) lgkmcnt(8)
    v_mfma_f32_16x16x32_bf16 v[64:67], a[16:19], a[32:35], v[64:67]
    ds_read_b64_tr_b16 a[8:9], v10 offset:40960
    s_cselect_b32 s55, s51, s55
    v_mfma_f32_16x16x32_bf16 v[68:71], a[16:19], a[36:39], v[68:71]
    ds_read_b64_tr_b16 a[10:11], v10 offset:46080
    buffer_load_dwordx4 a[64:67], v19, s[28:31], s56 offen sc1
    v_mfma_f32_16x16x32_bf16 v[72:75], a[20:23], a[32:35], v[72:75]
    ds_read_b64_tr_b16 a[12:13], v11 offset:40960
    buffer_load_dwordx4 a[68:71], v19, s[28:31], s56 offen offset:256 sc1
    v_mfma_f32_16x16x32_bf16 v[76:79], a[20:23], a[36:39], v[76:79]
    ds_read_b64_tr_b16 a[14:15], v11 offset:46080
    s_waitcnt lgkmcnt(8)
    v_mfma_f32_16x16x32_bf16 v[80:83], a[24:27], a[32:35], v[80:83]
    ds_read_b64_tr_b16 a[16:17], v12 offset:40960
    buffer_store_dwordx4 v[244:247], v250, s[28:31], s81 offen sc1
    v_mfma_f32_16x16x32_bf16 v[84:87], a[24:27], a[36:39], v[84:87]
    ds_read_b64_tr_b16 a[18:19], v12 offset:46080
    buffer_store_dwordx4 v[244:247], v251, s[28:31], s81 offen sc1
    v_mfma_f32_16x16x32_bf16 v[88:91], a[28:31], a[32:35], v[88:91]
    ds_read_b64_tr_b16 a[20:21], v13 offset:40960
    v_mfma_f32_16x16x32_bf16 v[92:95], a[28:31], a[36:39], v[92:95]
    ds_read_b64_tr_b16 a[22:23], v13 offset:46080
    s_waitcnt lgkmcnt(8)
    v_mfma_f32_16x16x32_bf16 v[96:99], a[0:3], a[32:35], v[96:99]
    ds_read_b64_tr_b16 a[24:25], v4 offset:51200
    v_mfma_f32_16x16x32_bf16 v[100:103], a[0:3], a[36:39], v[100:103]
    ds_read_b64_tr_b16 a[26:27], v4 offset:56320
    v_mfma_f32_16x16x32_bf16 v[104:107], a[4:7], a[32:35], v[104:107]
    ds_read_b64_tr_b16 a[28:29], v5 offset:51200
    v_mfma_f32_16x16x32_bf16 v[108:111], a[4:7], a[36:39], v[108:111]
    ds_read_b64_tr_b16 a[30:31], v5 offset:56320
    s_waitcnt lgkmcnt(8)
    v_mfma_f32_16x16x32_bf16 v[112:115], a[8:11], a[32:35], v[112:115]
    ds_read_b64_tr_b16 a[0:1], v6 offset:51200
    v_mfma_f32_16x16x32_bf16 v[116:119], a[8:11], a[36:39], v[116:119]
    ds_read_b64_tr_b16 a[2:3], v6 offset:56320
    v_mfma_f32_16x16x32_bf16 v[120:123], a[12:15], a[32:35], v[120:123]
    ds_read_b64_tr_b16 a[4:5], v7 offset:51200
    v_mfma_f32_16x16x32_bf16 v[124:127], a[12:15], a[36:39], v[124:127]
    ds_read_b64_tr_b16 a[6:7], v7 offset:56320
    s_waitcnt lgkmcnt(8)
    v_mfma_f32_16x16x32_bf16 v[128:131], a[16:19], a[32:35], v[128:131]
    ds_read_b64_tr_b16 a[8:9], v8 offset:51200
    v_mfma_f32_16x16x32_bf16 v[132:135], a[16:19], a[36:39], v[132:135]
    ds_read_b64_tr_b16 a[10:11], v8 offset:56320
    v_mfma_f32_16x16x32_bf16 v[136:139], a[20:23], a[32:35], v[136:139]
    ds_read_b64_tr_b16 a[12:13], v9 offset:51200
    v_mfma_f32_16x16x32_bf16 v[140:143], a[20:23], a[36:39], v[140:143]
    ds_read_b64_tr_b16 a[14:15], v9 offset:56320
    s_waitcnt vmcnt(20) lgkmcnt(8)
    v_mfma_f32_16x16x32_bf16 v[64:67], a[24:27], a[40:43], v[64:67]
    ds_read_b64_tr_b16 a[16:17], v10 offset:51200
    buffer_load_dwordx4 a[32:35], v253, s[28:31], s56 offen sc1
    v_mfma_f32_16x16x32_bf16 v[68:71], a[24:27], a[44:47], v[68:71]
    ds_read_b64_tr_b16 a[18:19], v10 offset:56320
    buffer_load_dwordx4 a[36:39], v253, s[28:31], s56 offen offset:256 sc1
    v_mfma_f32_16x16x32_bf16 v[72:75], a[28:31], a[40:43], v[72:75]
    ds_read_b64_tr_b16 a[20:21], v11 offset:51200
    s_add_u32 s56, s56, 16384
    v_mfma_f32_16x16x32_bf16 v[76:79], a[28:31], a[44:47], v[76:79]
    ds_read_b64_tr_b16 a[22:23], v11 offset:56320
    s_waitcnt lgkmcnt(8)
    v_mfma_f32_16x16x32_bf16 v[80:83], a[0:3], a[40:43], v[80:83]
    ds_read_b64_tr_b16 a[24:25], v12 offset:51200
    s_cmp_eq_u32 s56, s89
    v_mfma_f32_16x16x32_bf16 v[84:87], a[0:3], a[44:47], v[84:87]
    ds_read_b64_tr_b16 a[26:27], v12 offset:56320
    s_cselect_b32 s56, s54, s56
    v_mfma_f32_16x16x32_bf16 v[88:91], a[4:7], a[40:43], v[88:91]
    ds_read_b64_tr_b16 a[28:29], v13 offset:51200
    v_mfma_f32_16x16x32_bf16 v[92:95], a[4:7], a[44:47], v[92:95]
    ds_read_b64_tr_b16 a[30:31], v13 offset:56320
    s_waitcnt lgkmcnt(8)
    v_mfma_f32_16x16x32_bf16 v[96:99], a[8:11], a[40:43], v[96:99]
    s_waitcnt vmcnt(26)
    s_barrier
    v_add_u32 v4, 61440, v4
    v_add_u32 v5, 61440, v5
    v_add_u32 v6, 61440, v6
    v_add_u32 v7, 61440, v7
    v_add_u32 v8, 61440, v8
    v_add_u32 v9, 61440, v9
    v_add_u32 v10, 61440, v10
    v_add_u32 v11, 61440, v11
    v_add_u32 v12, 61440, v12
    v_add_u32 v13, 61440, v13
    ds_read_b64_tr_b16 a[0:1], v4 offset:0
    s_add_u32 m0, s53, 40960
    v_mfma_f32_16x16x32_bf16 v[100:103], a[8:11], a[44:47], v[100:103]
    ds_read_b64_tr_b16 a[2:3], v4 offset:5120
    buffer_load_dwordx4 v14, s[32:35], s55 offen offset:0 lds
    v_mfma_f32_16x16x32_bf16 v[104:107], a[12:15], a[40:43], v[104:107]
    ds_read_b64_tr_b16 a[4:5], v5 offset:0
    buffer_load_dwordx4 v15, s[32:35], s55 offen offset:1024 lds
    v_mfma_f32_16x16x32_bf16 v[108:111], a[12:15], a[44:47], v[108:111]
    ds_read_b64_tr_b16 a[6:7], v5 offset:5120
    s_waitcnt lgkmcnt(8)
    v_mfma_f32_16x16x32_bf16 v[112:115], a[16:19], a[40:43], v[112:115]
    ds_read_b64_tr_b16 a[8:9], v6 offset:0
    buffer_load_dwordx4 v16, s[32:35], s55 offen offset:2048 lds
    v_mfma_f32_16x16x32_bf16 v[116:119], a[16:19], a[44:47], v[116:119]
    ds_read_b64_tr_b16 a[10:11], v6 offset:5120
    buffer_load_dwordx4 v17, s[32:35], s55 offen offset:3072 lds
    v_mfma_f32_16x16x32_bf16 v[120:123], a[20:23], a[40:43], v[120:123]
    ds_read_b64_tr_b16 a[12:13], v7 offset:0
    s_add_u32 m0, s53, 45056
    v_mfma_f32_16x16x32_bf16 v[124:127], a[20:23], a[44:47], v[124:127]
    ds_read_b64_tr_b16 a[14:15], v7 offset:5120
    s_waitcnt lgkmcnt(8)
    v_mfma_f32_16x16x32_bf16 v[128:131], a[24:27], a[40:43], v[128:131]
    ds_read_b64_tr_b16 a[16:17], v8 offset:0
    buffer_load_dwordx4 v18, s[32:35], s55 offen lds
    v_mfma_f32_16x16x32_bf16 v[132:135], a[24:27], a[44:47], v[132:135]
    ds_read_b64_tr_b16 a[18:19], v8 offset:5120
    v_mfma_f32_16x16x32_bf16 v[136:139], a[28:31], a[40:43], v[136:139]
    ds_read_b64_tr_b16 a[20:21], v9 offset:0
    v_mfma_f32_16x16x32_bf16 v[140:143], a[28:31], a[44:47], v[140:143]
    ds_read_b64_tr_b16 a[22:23], v9 offset:5120
    s_waitcnt vmcnt(20) lgkmcnt(8)
    v_mfma_f32_16x16x32_bf16 v[64:67], a[0:3], a[48:51], v[64:67]
    ds_read_b64_tr_b16 a[24:25], v10 offset:0
    buffer_load_dwordx4 a[40:43], v19, s[28:31], s56 offen sc1
    v_mfma_f32_16x16x32_bf16 v[68:71], a[0:3], a[52:55], v[68:71]
    ds_read_b64_tr_b16 a[26:27], v10 offset:5120
    buffer_load_dwordx4 a[44:47], v19, s[28:31], s56 offen offset:256 sc1
    v_mfma_f32_16x16x32_bf16 v[72:75], a[4:7], a[48:51], v[72:75]
    ds_read_b64_tr_b16 a[28:29], v11 offset:0
    v_mfma_f32_16x16x32_bf16 v[76:79], a[4:7], a[52:55], v[76:79]
    ds_read_b64_tr_b16 a[30:31], v11 offset:5120
    s_waitcnt lgkmcnt(8)
    v_mfma_f32_16x16x32_bf16 v[80:83], a[8:11], a[48:51], v[80:83]
    ds_read_b64_tr_b16 a[0:1], v12 offset:0
    v_mfma_f32_16x16x32_bf16 v[84:87], a[8:11], a[52:55], v[84:87]
    ds_read_b64_tr_b16 a[2:3], v12 offset:5120
    v_mfma_f32_16x16x32_bf16 v[88:91], a[12:15], a[48:51], v[88:91]
    ds_read_b64_tr_b16 a[4:5], v13 offset:0
    v_mfma_f32_16x16x32_bf16 v[92:95], a[12:15], a[52:55], v[92:95]
    ds_read_b64_tr_b16 a[6:7], v13 offset:5120
    s_waitcnt lgkmcnt(8)
    v_mfma_f32_16x16x32_bf16 v[96:99], a[16:19], a[48:51], v[96:99]
    ds_read_b64_tr_b16 a[8:9], v4 offset:10240
    v_mfma_f32_16x16x32_bf16 v[100:103], a[16:19], a[52:55], v[100:103]
    ds_read_b64_tr_b16 a[10:11], v4 offset:15360
    v_mfma_f32_16x16x32_bf16 v[104:107], a[20:23], a[48:51], v[104:107]
    ds_read_b64_tr_b16 a[12:13], v5 offset:10240
    v_mfma_f32_16x16x32_bf16 v[108:111], a[20:23], a[52:55], v[108:111]
    ds_read_b64_tr_b16 a[14:15], v5 offset:15360
    s_waitcnt lgkmcnt(8)
    v_mfma_f32_16x16x32_bf16 v[112:115], a[24:27], a[48:51], v[112:115]
    ds_read_b64_tr_b16 a[16:17], v6 offset:10240
    v_mfma_f32_16x16x32_bf16 v[116:119], a[24:27], a[52:55], v[116:119]
    ds_read_b64_tr_b16 a[18:19], v6 offset:15360
    v_mfma_f32_16x16x32_bf16 v[120:123], a[28:31], a[48:51], v[120:123]
    ds_read_b64_tr_b16 a[20:21], v7 offset:10240
    v_mfma_f32_16x16x32_bf16 v[124:127], a[28:31], a[52:55], v[124:127]
    ds_read_b64_tr_b16 a[22:23], v7 offset:15360
    s_waitcnt lgkmcnt(8)
    v_mfma_f32_16x16x32_bf16 v[128:131], a[0:3], a[48:51], v[128:131]
    ds_read_b64_tr_b16 a[24:25], v8 offset:10240
    v_mfma_f32_16x16x32_bf16 v[132:135], a[0:3], a[52:55], v[132:135]
    ds_read_b64_tr_b16 a[26:27], v8 offset:15360
    v_mfma_f32_16x16x32_bf16 v[136:139], a[4:7], a[48:51], v[136:139]
    ds_read_b64_tr_b16 a[28:29], v9 offset:10240
    v_mfma_f32_16x16x32_bf16 v[140:143], a[4:7], a[52:55], v[140:143]
    ds_read_b64_tr_b16 a[30:31], v9 offset:15360
    s_waitcnt vmcnt(18) lgkmcnt(8)
    v_mfma_f32_16x16x32_bf16 v[64:67], a[8:11], a[56:59], v[64:67]
    ds_read_b64_tr_b16 a[0:1], v10 offset:10240
    buffer_load_dwordx4 a[48:51], v253, s[28:31], s56 offen sc1
    v_mfma_f32_16x16x32_bf16 v[68:71], a[8:11], a[60:63], v[68:71]
    ds_read_b64_tr_b16 a[2:3], v10 offset:15360
    buffer_load_dwordx4 a[52:55], v253, s[28:31], s56 offen offset:256 sc1
    v_mfma_f32_16x16x32_bf16 v[72:75], a[12:15], a[56:59], v[72:75]
    ds_read_b64_tr_b16 a[4:5], v11 offset:10240
    s_add_u32 s56, s56, 16384
    v_mfma_f32_16x16x32_bf16 v[76:79], a[12:15], a[60:63], v[76:79]
    ds_read_b64_tr_b16 a[6:7], v11 offset:15360
    s_waitcnt lgkmcnt(8)
    v_mfma_f32_16x16x32_bf16 v[80:83], a[16:19], a[56:59], v[80:83]
    ds_read_b64_tr_b16 a[8:9], v12 offset:10240
    s_cmp_eq_u32 s56, s89
    v_mfma_f32_16x16x32_bf16 v[84:87], a[16:19], a[60:63], v[84:87]
    ds_read_b64_tr_b16 a[10:11], v12 offset:15360
    s_cselect_b32 s56, s54, s56
    v_mfma_f32_16x16x32_bf16 v[88:91], a[20:23], a[56:59], v[88:91]
    ds_read_b64_tr_b16 a[12:13], v13 offset:10240
    v_mfma_f32_16x16x32_bf16 v[92:95], a[20:23], a[60:63], v[92:95]
    ds_read_b64_tr_b16 a[14:15], v13 offset:15360
    s_waitcnt lgkmcnt(8)
    v_mfma_f32_16x16x32_bf16 v[96:99], a[24:27], a[56:59], v[96:99]
    s_waitcnt vmcnt(26)
    s_barrier
    v_add_u32 v4, 4294844416, v4
    v_add_u32 v5, 4294844416, v5
    v_add_u32 v6, 4294844416, v6
    v_add_u32 v7, 4294844416, v7
    v_add_u32 v8, 4294844416, v8
    v_add_u32 v9, 4294844416, v9
    v_add_u32 v10, 4294844416, v10
    v_add_u32 v11, 4294844416, v11
    v_add_u32 v12, 4294844416, v12
    v_add_u32 v13, 4294844416, v13
    ds_read_b64_tr_b16 a[16:17], v4 offset:0
    s_sub_u32 s83, s43, 4
    v_mfma_f32_16x16x32_bf16 v[100:103], a[24:27], a[60:63], v[100:103]
    ds_read_b64_tr_b16 a[18:19], v4 offset:5120
    s_mov_b32 s32, s16
    v_mfma_f32_16x16x32_bf16 v[104:107], a[28:31], a[56:59], v[104:107]
    ds_read_b64_tr_b16 a[20:21], v5 offset:0
    s_mov_b32 s33, s17
    v_mfma_f32_16x16x32_bf16 v[108:111], a[28:31], a[60:63], v[108:111]
    ds_read_b64_tr_b16 a[22:23], v5 offset:5120
    s_waitcnt lgkmcnt(8)
    v_mfma_f32_16x16x32_bf16 v[112:115], a[0:3], a[56:59], v[112:115]
    ds_read_b64_tr_b16 a[24:25], v6 offset:0
    s_mov_b32 s34, 819200
    v_mfma_f32_16x16x32_bf16 v[116:119], a[0:3], a[60:63], v[116:119]
    ds_read_b64_tr_b16 a[26:27], v6 offset:5120
    s_mov_b32 s35, 0x20000
    v_mfma_f32_16x16x32_bf16 v[120:123], a[4:7], a[56:59], v[120:123]
    ds_read_b64_tr_b16 a[28:29], v7 offset:0
    v_lshrrev_b32 v16, 3, v1
    v_mfma_f32_16x16x32_bf16 v[124:127], a[4:7], a[60:63], v[124:127]
    ds_read_b64_tr_b16 a[30:31], v7 offset:5120
    s_waitcnt lgkmcnt(8)
    v_mfma_f32_16x16x32_bf16 v[128:131], a[8:11], a[56:59], v[128:131]
    ds_read_b64_tr_b16 a[0:1], v8 offset:0
    v_and_b32 v17, 7, v1
    v_mfma_f32_16x16x32_bf16 v[132:135], a[8:11], a[60:63], v[132:135]
    ds_read_b64_tr_b16 a[2:3], v8 offset:5120
    v_and_b32 v18, 6, v16
    v_mfma_f32_16x16x32_bf16 v[136:139], a[12:15], a[56:59], v[136:139]
    ds_read_b64_tr_b16 a[4:5], v9 offset:0
    v_xor_b32 v17, v17, v18
    v_mfma_f32_16x16x32_bf16 v[140:143], a[12:15], a[60:63], v[140:143]
    ds_read_b64_tr_b16 a[6:7], v9 offset:5120
    s_waitcnt vmcnt(13) lgkmcnt(8)
    v_mfma_f32_16x16x32_bf16 v[64:67], a[16:19], a[64:67], v[64:67]
    ds_read_b64_tr_b16 a[8:9], v10 offset:0
    buffer_load_dwordx4 a[56:59], v19, s[28:31], s56 offen sc1
    v_mfma_f32_16x16x32_bf16 v[68:71], a[16:19], a[68:71], v[68:71]
    ds_read_b64_tr_b16 a[10:11], v10 offset:5120
    buffer_load_dwordx4 a[60:63], v19, s[28:31], s56 offen offset:256 sc1
    v_mfma_f32_16x16x32_bf16 v[72:75], a[20:23], a[64:67], v[72:75]
    ds_read_b64_tr_b16 a[12:13], v11 offset:0
    v_mul_u32_u24 v16, 1280, v16
    v_mfma_f32_16x16x32_bf16 v[76:79], a[20:23], a[68:71], v[76:79]
    ds_read_b64_tr_b16 a[14:15], v11 offset:5120
    s_waitcnt lgkmcnt(8)
    v_mfma_f32_16x16x32_bf16 v[80:83], a[24:27], a[64:67], v[80:83]
    ds_read_b64_tr_b16 a[16:17], v12 offset:0
    v_lshl_add_u32 v14, v17, 4, v16
    v_mfma_f32_16x16x32_bf16 v[84:87], a[24:27], a[68:71], v[84:87]
    ds_read_b64_tr_b16 a[18:19], v12 offset:5120
    v_add_u32 v15, 9216, v14
    v_mfma_f32_16x16x32_bf16 v[88:91], a[28:31], a[64:67], v[88:91]
    ds_read_b64_tr_b16 a[20:21], v13 offset:0
    s_lshl_b32 s53, s41, 11
    v_mfma_f32_16x16x32_bf16 v[92:95], a[28:31], a[68:71], v[92:95]
    ds_read_b64_tr_b16 a[22:23], v13 offset:5120
    s_waitcnt lgkmcnt(8)
    v_mfma_f32_16x16x32_bf16 v[96:99], a[0:3], a[64:67], v[96:99]
    ds_read_b64_tr_b16 a[24:25], v4 offset:10240
    s_lshl_b32 s78, s83, 7
    v_mfma_f32_16x16x32_bf16 v[100:103], a[0:3], a[68:71], v[100:103]
    ds_read_b64_tr_b16 a[26:27], v4 offset:15360
    s_lshl_b32 s44, s41, 4
    v_mfma_f32_16x16x32_bf16 v[104:107], a[4:7], a[64:67], v[104:107]
    ds_read_b64_tr_b16 a[28:29], v5 offset:10240
    s_mul_i32 s44, s44, 1280
    v_mfma_f32_16x16x32_bf16 v[108:111], a[4:7], a[68:71], v[108:111]
    ds_read_b64_tr_b16 a[30:31], v5 offset:15360
    s_waitcnt lgkmcnt(8)
    v_mfma_f32_16x16x32_bf16 v[112:115], a[8:11], a[64:67], v[112:115]
    ds_read_b64_tr_b16 a[0:1], v6 offset:10240
    s_add_u32 s51, s44, s78
    v_mfma_f32_16x16x32_bf16 v[116:119], a[8:11], a[68:71], v[116:119]
    ds_read_b64_tr_b16 a[2:3], v6 offset:15360
    s_mov_b32 s50, 0
    v_mfma_f32_16x16x32_bf16 v[120:123], a[12:15], a[64:67], v[120:123]
    ds_read_b64_tr_b16 a[4:5], v7 offset:10240
    s_sub_u32 s44, s43, 4
    v_mfma_f32_16x16x32_bf16 v[124:127], a[12:15], a[68:71], v[124:127]
    ds_read_b64_tr_b16 a[6:7], v7 offset:15360
    s_waitcnt lgkmcnt(8)
    v_mfma_f32_16x16x32_bf16 v[128:131], a[16:19], a[64:67], v[128:131]
    ds_read_b64_tr_b16 a[8:9], v8 offset:10240
    s_cmp_lt_u32 s44, 10
    v_mfma_f32_16x16x32_bf16 v[132:135], a[16:19], a[68:71], v[132:135]
    ds_read_b64_tr_b16 a[10:11], v8 offset:15360
    s_cselect_b32 s34, s34, 0
    v_mfma_f32_16x16x32_bf16 v[136:139], a[20:23], a[64:67], v[136:139]
    ds_read_b64_tr_b16 a[12:13], v9 offset:10240
    s_mul_i32 s55, s50, 81920
    v_mfma_f32_16x16x32_bf16 v[140:143], a[20:23], a[68:71], v[140:143]
    ds_read_b64_tr_b16 a[14:15], v9 offset:15360
    s_waitcnt vmcnt(11) lgkmcnt(8)
    v_mfma_f32_16x16x32_bf16 v[64:67], a[24:27], a[32:35], v[64:67]
    ds_read_b64_tr_b16 a[16:17], v10 offset:10240
    buffer_load_dwordx4 a[64:67], v253, s[28:31], s56 offen sc1
    v_mfma_f32_16x16x32_bf16 v[68:71], a[24:27], a[36:39], v[68:71]
    ds_read_b64_tr_b16 a[18:19], v10 offset:15360
    buffer_load_dwordx4 a[68:71], v253, s[28:31], s56 offen offset:256 sc1
    v_mfma_f32_16x16x32_bf16 v[72:75], a[28:31], a[32:35], v[72:75]
    ds_read_b64_tr_b16 a[20:21], v11 offset:10240
    s_add_u32 s55, s55, s51
    v_mfma_f32_16x16x32_bf16 v[76:79], a[28:31], a[36:39], v[76:79]
    ds_read_b64_tr_b16 a[22:23], v11 offset:15360
    s_waitcnt lgkmcnt(8)
    v_mfma_f32_16x16x32_bf16 v[80:83], a[0:3], a[32:35], v[80:83]
    ds_read_b64_tr_b16 a[24:25], v12 offset:10240
    s_mov_b32 s90, 819200
    v_mfma_f32_16x16x32_bf16 v[84:87], a[0:3], a[36:39], v[84:87]
    ds_read_b64_tr_b16 a[26:27], v12 offset:15360
    s_add_u32 s90, s90, s51
    v_mfma_f32_16x16x32_bf16 v[88:91], a[4:7], a[32:35], v[88:91]
    ds_read_b64_tr_b16 a[28:29], v13 offset:10240
    s_add_u32 m0, s53, 69632
    v_mfma_f32_16x16x32_bf16 v[92:95], a[4:7], a[36:39], v[92:95]
    ds_read_b64_tr_b16 a[30:31], v13 offset:15360
    s_waitcnt lgkmcnt(8)
    v_mfma_f32_16x16x32_bf16 v[96:99], a[8:11], a[32:35], v[96:99]
    s_waitcnt vmcnt(19)
    s_barrier
    ds_read_b64_tr_b16 a[0:1], v4 offset:20480
    buffer_load_dwordx4 v14, s[32:35], s55 offen lds
    v_mfma_f32_16x16x32_bf16 v[100:103], a[8:11], a[36:39], v[100:103]
    ds_read_b64_tr_b16 a[2:3], v4 offset:25600
    buffer_load_dwordx4 v15, s[32:35], s55 offen offset:1024 lds
    v_mfma_f32_16x16x32_bf16 v[104:107], a[12:15], a[32:35], v[104:107]
    ds_read_b64_tr_b16 a[4:5], v5 offset:20480
    s_add_u32 s55, s55, 81920
    v_mfma_f32_16x16x32_bf16 v[108:111], a[12:15], a[36:39], v[108:111]
    ds_read_b64_tr_b16 a[6:7], v5 offset:25600
    s_waitcnt lgkmcnt(8)
    v_mfma_f32_16x16x32_bf16 v[112:115], a[16:19], a[32:35], v[112:115]
    ds_read_b64_tr_b16 a[8:9], v6 offset:20480
    s_add_u32 m0, s53, 77824
    v_mfma_f32_16x16x32_bf16 v[116:119], a[16:19], a[36:39], v[116:119]
    ds_read_b64_tr_b16 a[10:11], v6 offset:25600
    buffer_load_dwordx4 v14, s[32:35], s55 offen lds
    v_mfma_f32_16x16x32_bf16 v[120:123], a[20:23], a[32:35], v[120:123]
    ds_read_b64_tr_b16 a[12:13], v7 offset:20480
    buffer_load_dwordx4 v15, s[32:35], s55 offen offset:1024 lds
    v_mfma_f32_16x16x32_bf16 v[124:127], a[20:23], a[36:39], v[124:127]
    ds_read_b64_tr_b16 a[14:15], v7 offset:25600
    s_waitcnt lgkmcnt(8)
    v_mfma_f32_16x16x32_bf16 v[128:131], a[24:27], a[32:35], v[128:131]
    ds_read_b64_tr_b16 a[16:17], v8 offset:20480
    s_add_u32 s55, s55, 81920
    v_mfma_f32_16x16x32_bf16 v[132:135], a[24:27], a[36:39], v[132:135]
    ds_read_b64_tr_b16 a[18:19], v8 offset:25600
    s_add_u32 m0, s53, 86016
    v_mfma_f32_16x16x32_bf16 v[136:139], a[28:31], a[32:35], v[136:139]
    ds_read_b64_tr_b16 a[20:21], v9 offset:20480
    buffer_load_dwordx4 v14, s[32:35], s55 offen lds
    v_mfma_f32_16x16x32_bf16 v[140:143], a[28:31], a[36:39], v[140:143]
    ds_read_b64_tr_b16 a[22:23], v9 offset:25600
    s_waitcnt vmcnt(11) lgkmcnt(8)
    v_mfma_f32_16x16x32_bf16 v[64:67], a[0:3], a[40:43], v[64:67]
    ds_read_b64_tr_b16 a[24:25], v10 offset:20480
    buffer_load_dwordx4 v15, s[32:35], s55 offen offset:1024 lds
    v_mfma_f32_16x16x32_bf16 v[68:71], a[0:3], a[44:47], v[68:71]
    ds_read_b64_tr_b16 a[26:27], v10 offset:25600
    s_add_u32 s55, s55, 81920
    v_mfma_f32_16x16x32_bf16 v[72:75], a[4:7], a[40:43], v[72:75]
    ds_read_b64_tr_b16 a[28:29], v11 offset:20480
    s_add_u32 m0, s53, 94208
    v_mfma_f32_16x16x32_bf16 v[76:79], a[4:7], a[44:47], v[76:79]
    ds_read_b64_tr_b16 a[30:31], v11 offset:25600
    s_waitcnt lgkmcnt(8)
    v_mfma_f32_16x16x32_bf16 v[80:83], a[8:11], a[40:43], v[80:83]
    ds_read_b64_tr_b16 a[0:1], v12 offset:20480
    buffer_load_dwordx4 v14, s[32:35], s55 offen lds
    v_mfma_f32_16x16x32_bf16 v[84:87], a[8:11], a[44:47], v[84:87]
    ds_read_b64_tr_b16 a[2:3], v12 offset:25600
    buffer_load_dwordx4 v15, s[32:35], s55 offen offset:1024 lds
    v_mfma_f32_16x16x32_bf16 v[88:91], a[12:15], a[40:43], v[88:91]
    ds_read_b64_tr_b16 a[4:5], v13 offset:20480
    s_add_u32 s55, s55, 81920
    v_mfma_f32_16x16x32_bf16 v[92:95], a[12:15], a[44:47], v[92:95]
    ds_read_b64_tr_b16 a[6:7], v13 offset:25600
    s_waitcnt lgkmcnt(8)
    v_mfma_f32_16x16x32_bf16 v[96:99], a[16:19], a[40:43], v[96:99]
    ds_read_b64_tr_b16 a[8:9], v4 offset:30720
    s_add_u32 m0, s53, 102400
    v_mfma_f32_16x16x32_bf16 v[100:103], a[16:19], a[44:47], v[100:103]
    ds_read_b64_tr_b16 a[10:11], v4 offset:35840
    buffer_load_dwordx4 v14, s[32:35], s55 offen lds
    v_mfma_f32_16x16x32_bf16 v[104:107], a[20:23], a[40:43], v[104:107]
    ds_read_b64_tr_b16 a[12:13], v5 offset:30720
    buffer_load_dwordx4 v15, s[32:35], s55 offen offset:1024 lds
    v_mfma_f32_16x16x32_bf16 v[108:111], a[20:23], a[44:47], v[108:111]
    ds_read_b64_tr_b16 a[14:15], v5 offset:35840
    s_waitcnt lgkmcnt(8)
    v_mfma_f32_16x16x32_bf16 v[112:115], a[24:27], a[40:43], v[112:115]
    ds_read_b64_tr_b16 a[16:17], v6 offset:30720
    s_add_u32 s55, s55, 81920
    v_mfma_f32_16x16x32_bf16 v[116:119], a[24:27], a[44:47], v[116:119]
    ds_read_b64_tr_b16 a[18:19], v6 offset:35840
    s_add_u32 m0, s53, 110592
    v_mfma_f32_16x16x32_bf16 v[120:123], a[28:31], a[40:43], v[120:123]
    ds_read_b64_tr_b16 a[20:21], v7 offset:30720
    buffer_load_dwordx4 v14, s[32:35], s55 offen lds
    v_mfma_f32_16x16x32_bf16 v[124:127], a[28:31], a[44:47], v[124:127]
    ds_read_b64_tr_b16 a[22:23], v7 offset:35840
    s_waitcnt lgkmcnt(8)
    v_mfma_f32_16x16x32_bf16 v[128:131], a[0:3], a[40:43], v[128:131]
    ds_read_b64_tr_b16 a[24:25], v8 offset:30720
    buffer_load_dwordx4 v15, s[32:35], s55 offen offset:1024 lds
    v_mfma_f32_16x16x32_bf16 v[132:135], a[0:3], a[44:47], v[132:135]
    ds_read_b64_tr_b16 a[26:27], v8 offset:35840
    s_add_u32 s55, s55, 81920
    v_mfma_f32_16x16x32_bf16 v[136:139], a[4:7], a[40:43], v[136:139]
    ds_read_b64_tr_b16 a[28:29], v9 offset:30720
    s_add_u32 m0, s53, 118784
    v_mfma_f32_16x16x32_bf16 v[140:143], a[4:7], a[44:47], v[140:143]
    ds_read_b64_tr_b16 a[30:31], v9 offset:35840
    s_waitcnt vmcnt(16) lgkmcnt(8)
    v_mfma_f32_16x16x32_bf16 v[64:67], a[8:11], a[48:51], v[64:67]
    ds_read_b64_tr_b16 a[0:1], v10 offset:30720
    buffer_load_dwordx4 v14, s[32:35], s55 offen lds
    v_mfma_f32_16x16x32_bf16 v[68:71], a[8:11], a[52:55], v[68:71]
    ds_read_b64_tr_b16 a[2:3], v10 offset:35840
    buffer_load_dwordx4 v15, s[32:35], s55 offen offset:1024 lds
    v_mfma_f32_16x16x32_bf16 v[72:75], a[12:15], a[48:51], v[72:75]
    ds_read_b64_tr_b16 a[4:5], v11 offset:30720
    s_add_u32 s55, s55, 81920
    v_mfma_f32_16x16x32_bf16 v[76:79], a[12:15], a[52:55], v[76:79]
    ds_read_b64_tr_b16 a[6:7], v11 offset:35840
    s_waitcnt lgkmcnt(8)
    v_mfma_f32_16x16x32_bf16 v[80:83], a[16:19], a[48:51], v[80:83]
    ds_read_b64_tr_b16 a[8:9], v12 offset:30720
    v_mfma_f32_16x16x32_bf16 v[84:87], a[16:19], a[52:55], v[84:87]
    ds_read_b64_tr_b16 a[10:11], v12 offset:35840
    v_mfma_f32_16x16x32_bf16 v[88:91], a[20:23], a[48:51], v[88:91]
    ds_read_b64_tr_b16 a[12:13], v13 offset:30720
    v_mfma_f32_16x16x32_bf16 v[92:95], a[20:23], a[52:55], v[92:95]
    ds_read_b64_tr_b16 a[14:15], v13 offset:35840
    s_waitcnt lgkmcnt(8)
    v_mfma_f32_16x16x32_bf16 v[96:99], a[24:27], a[48:51], v[96:99]
    s_waitcnt vmcnt(22)
    s_barrier
    ds_read_b64_tr_b16 a[16:17], v4 offset:40960
    s_add_u32 m0, s53, 126976
    v_mfma_f32_16x16x32_bf16 v[100:103], a[24:27], a[52:55], v[100:103]
    ds_read_b64_tr_b16 a[18:19], v4 offset:46080
    buffer_load_dwordx4 v14, s[32:35], s55 offen lds
    v_mfma_f32_16x16x32_bf16 v[104:107], a[28:31], a[48:51], v[104:107]
    ds_read_b64_tr_b16 a[20:21], v5 offset:40960
    buffer_load_dwordx4 v15, s[32:35], s55 offen offset:1024 lds
    v_mfma_f32_16x16x32_bf16 v[108:111], a[28:31], a[52:55], v[108:111]
    ds_read_b64_tr_b16 a[22:23], v5 offset:46080
    s_waitcnt lgkmcnt(8)
    v_mfma_f32_16x16x32_bf16 v[112:115], a[0:3], a[48:51], v[112:115]
    ds_read_b64_tr_b16 a[24:25], v6 offset:40960
    s_add_u32 s55, s55, 81920
    v_mfma_f32_16x16x32_bf16 v[116:119], a[0:3], a[52:55], v[116:119]
    ds_read_b64_tr_b16 a[26:27], v6 offset:46080
    s_add_u32 m0, s53, 135168
    v_mfma_f32_16x16x32_bf16 v[120:123], a[4:7], a[48:51], v[120:123]
    ds_read_b64_tr_b16 a[28:29], v7 offset:40960
    buffer_load_dwordx4 v14, s[32:35], s55 offen lds
    v_mfma_f32_16x16x32_bf16 v[124:127], a[4:7], a[52:55], v[124:127]
    ds_read_b64_tr_b16 a[30:31], v7 offset:46080
    s_waitcnt lgkmcnt(8)
    v_mfma_f32_16x16x32_bf16 v[128:131], a[8:11], a[48:51], v[128:131]
    ds_read_b64_tr_b16 a[0:1], v8 offset:40960
    buffer_load_dwordx4 v15, s[32:35], s55 offen offset:1024 lds
    v_mfma_f32_16x16x32_bf16 v[132:135], a[8:11], a[52:55], v[132:135]
    ds_read_b64_tr_b16 a[2:3], v8 offset:46080
    s_add_u32 s55, s55, 81920
    v_mfma_f32_16x16x32_bf16 v[136:139], a[12:15], a[48:51], v[136:139]
    ds_read_b64_tr_b16 a[4:5], v9 offset:40960
    s_add_u32 m0, s53, 143360
    v_mfma_f32_16x16x32_bf16 v[140:143], a[12:15], a[52:55], v[140:143]
    ds_read_b64_tr_b16 a[6:7], v9 offset:46080
    s_waitcnt vmcnt(20) lgkmcnt(8)
    v_mfma_f32_16x16x32_bf16 v[64:67], a[16:19], a[56:59], v[64:67]
    ds_read_b64_tr_b16 a[8:9], v10 offset:40960
    buffer_load_dwordx4 v14, s[32:35], s55 offen lds
    v_mfma_f32_16x16x32_bf16 v[68:71], a[16:19], a[60:63], v[68:71]
    ds_read_b64_tr_b16 a[10:11], v10 offset:46080
    buffer_load_dwordx4 v15, s[32:35], s55 offen offset:1024 lds
    v_mfma_f32_16x16x32_bf16 v[72:75], a[20:23], a[56:59], v[72:75]
    ds_read_b64_tr_b16 a[12:13], v11 offset:40960
    v_mfma_f32_16x16x32_bf16 v[76:79], a[20:23], a[60:63], v[76:79]
    ds_read_b64_tr_b16 a[14:15], v11 offset:46080
    s_waitcnt lgkmcnt(8)
    v_mfma_f32_16x16x32_bf16 v[80:83], a[24:27], a[56:59], v[80:83]
    ds_read_b64_tr_b16 a[16:17], v12 offset:40960
    v_mfma_f32_16x16x32_bf16 v[84:87], a[24:27], a[60:63], v[84:87]
    ds_read_b64_tr_b16 a[18:19], v12 offset:46080
    v_mfma_f32_16x16x32_bf16 v[88:91], a[28:31], a[56:59], v[88:91]
    ds_read_b64_tr_b16 a[20:21], v13 offset:40960
    v_mfma_f32_16x16x32_bf16 v[92:95], a[28:31], a[60:63], v[92:95]
    ds_read_b64_tr_b16 a[22:23], v13 offset:46080
    s_waitcnt lgkmcnt(8)
    v_mfma_f32_16x16x32_bf16 v[96:99], a[0:3], a[56:59], v[96:99]
    ds_read_b64_tr_b16 a[24:25], v4 offset:51200
    v_mfma_f32_16x16x32_bf16 v[100:103], a[0:3], a[60:63], v[100:103]
    ds_read_b64_tr_b16 a[26:27], v4 offset:56320
    v_mfma_f32_16x16x32_bf16 v[104:107], a[4:7], a[56:59], v[104:107]
    ds_read_b64_tr_b16 a[28:29], v5 offset:51200
    v_mfma_f32_16x16x32_bf16 v[108:111], a[4:7], a[60:63], v[108:111]
    ds_read_b64_tr_b16 a[30:31], v5 offset:56320
    s_waitcnt lgkmcnt(8)
    v_mfma_f32_16x16x32_bf16 v[112:115], a[8:11], a[56:59], v[112:115]
    ds_read_b64_tr_b16 a[0:1], v6 offset:51200
    v_mfma_f32_16x16x32_bf16 v[116:119], a[8:11], a[60:63], v[116:119]
    ds_read_b64_tr_b16 a[2:3], v6 offset:56320
    v_mfma_f32_16x16x32_bf16 v[120:123], a[12:15], a[56:59], v[120:123]
    ds_read_b64_tr_b16 a[4:5], v7 offset:51200
    v_mfma_f32_16x16x32_bf16 v[124:127], a[12:15], a[60:63], v[124:127]
    ds_read_b64_tr_b16 a[6:7], v7 offset:56320
    s_waitcnt lgkmcnt(8)
    v_mfma_f32_16x16x32_bf16 v[128:131], a[16:19], a[56:59], v[128:131]
    ds_read_b64_tr_b16 a[8:9], v8 offset:51200
    v_mfma_f32_16x16x32_bf16 v[132:135], a[16:19], a[60:63], v[132:135]
    ds_read_b64_tr_b16 a[10:11], v8 offset:56320
    v_mfma_f32_16x16x32_bf16 v[136:139], a[20:23], a[56:59], v[136:139]
    ds_read_b64_tr_b16 a[12:13], v9 offset:51200
    v_mfma_f32_16x16x32_bf16 v[140:143], a[20:23], a[60:63], v[140:143]
    ds_read_b64_tr_b16 a[14:15], v9 offset:56320
    s_waitcnt vmcnt(20) lgkmcnt(8)
    v_mfma_f32_16x16x32_bf16 v[64:67], a[24:27], a[64:67], v[64:67]
    ds_read_b64_tr_b16 a[16:17], v10 offset:51200
    v_mfma_f32_16x16x32_bf16 v[68:71], a[24:27], a[68:71], v[68:71]
    ds_read_b64_tr_b16 a[18:19], v10 offset:56320
    v_mfma_f32_16x16x32_bf16 v[72:75], a[28:31], a[64:67], v[72:75]
    ds_read_b64_tr_b16 a[20:21], v11 offset:51200
    v_mfma_f32_16x16x32_bf16 v[76:79], a[28:31], a[68:71], v[76:79]
    ds_read_b64_tr_b16 a[22:23], v11 offset:56320
    s_waitcnt lgkmcnt(8)
    v_mfma_f32_16x16x32_bf16 v[80:83], a[0:3], a[64:67], v[80:83]
    ds_read_b64_tr_b16 a[24:25], v12 offset:51200
    v_mfma_f32_16x16x32_bf16 v[84:87], a[0:3], a[68:71], v[84:87]
    ds_read_b64_tr_b16 a[26:27], v12 offset:56320
    v_mfma_f32_16x16x32_bf16 v[88:91], a[4:7], a[64:67], v[88:91]
    ds_read_b64_tr_b16 a[28:29], v13 offset:51200
    v_mfma_f32_16x16x32_bf16 v[92:95], a[4:7], a[68:71], v[92:95]
    ds_read_b64_tr_b16 a[30:31], v13 offset:56320
    s_waitcnt lgkmcnt(8)
    v_mfma_f32_16x16x32_bf16 v[96:99], a[8:11], a[64:67], v[96:99]
    v_mfma_f32_16x16x32_bf16 v[100:103], a[8:11], a[68:71], v[100:103]
    v_mfma_f32_16x16x32_bf16 v[104:107], a[12:15], a[64:67], v[104:107]
    v_mfma_f32_16x16x32_bf16 v[108:111], a[12:15], a[68:71], v[108:111]
    s_waitcnt lgkmcnt(4)
    v_mfma_f32_16x16x32_bf16 v[112:115], a[16:19], a[64:67], v[112:115]
    v_mfma_f32_16x16x32_bf16 v[116:119], a[16:19], a[68:71], v[116:119]
    v_mfma_f32_16x16x32_bf16 v[120:123], a[20:23], a[64:67], v[120:123]
    v_mfma_f32_16x16x32_bf16 v[124:127], a[20:23], a[68:71], v[124:127]
    s_waitcnt lgkmcnt(0)
    v_mfma_f32_16x16x32_bf16 v[128:131], a[24:27], a[64:67], v[128:131]
    v_mfma_f32_16x16x32_bf16 v[132:135], a[24:27], a[68:71], v[132:135]
    v_mfma_f32_16x16x32_bf16 v[136:139], a[28:31], a[64:67], v[136:139]
    v_mfma_f32_16x16x32_bf16 v[140:143], a[28:31], a[68:71], v[140:143]
    s_barrier
    s_mov_b32 s77, 1073741824
    s_cmp_lt_u32 s43, 4
    s_cbranch_scc1 L_q
    s_cmp_lt_u32 s43, 12
    s_cbranch_scc1 L_kv
    s_sub_u32 s58, s43, 12
    s_lshr_b32 s78, s58, 1
    s_add_u32 s78, s78, 1
    s_sub_u32 s45, 0, s78
    s_and_b32 s46, s58, 1
    s_cmp_eq_u32 s46, 1
    s_cselect_b32 s72, s45, s78
    v_mul_f32 v144, v20, v58
    v_mul_f32 v146, v58, v58
    v_rcp_f32 v148, v58
    v_mul_f32 v146, v146, v58
    v_mul_f32 v146, s62, v146
    v_mul_f32 v150, v20, v60
    v_mul_f32 v152, v60, v60
    v_rcp_f32 v154, v60
    v_mul_f32 v152, v152, v60
    v_mul_f32 v152, s62, v152
    s_lshl_b32 s44, s42, 7
    s_lshl_b32 s45, s41, 5
    s_add_u32 s44, s44, s45
    s_add_u32 s44, s44, s72
    v_and_b32 v22, 15, v1
    v_lshrrev_b32 v23, 4, v1
    v_lshlrev_b32 v23, 11, v23
    s_sub_u32 s45, s42, 1
    s_mov_b32 s46, 163840
    s_movk_i32 s47, 2048
    v_add_u32 v24, s44, v22
    v_ashrrev_i32 v25, 7, v24
    v_subrev_u32 v25, s45, v25
    v_mul_lo_u32 v25, v25, s46
    v_and_b32 v26, 127, v24
    v_lshl_add_u32 v25, v26, 4, v25
    v_add_u32 v25, v25, v23
    v_mov_b32 v26, 1073741824
    v_cmp_gt_u32 vcc, s47, v24
    s_nop 1
    v_cndmask_b32 v56, v26, v25, vcc
    v_add_u32 v24, s44, v22
    v_add_u32 v24, 16, v24
    v_ashrrev_i32 v25, 7, v24
    v_subrev_u32 v25, s45, v25
    v_mul_lo_u32 v25, v25, s46
    v_and_b32 v26, 127, v24
    v_lshl_add_u32 v25, v26, 4, v25
    v_add_u32 v25, v25, v23
    v_mov_b32 v26, 1073741824
    v_cmp_gt_u32 vcc, s47, v24
    s_nop 1
    v_cndmask_b32 v57, v26, v25, vcc
    s_mul_i32 s44, s58, 40960
    s_mul_i32 s45, s42, 163840
    s_add_u32 s44, s44, s45
    s_add_u32 s56, s44, 4816896
    v_pk_mul_f32 v[22:23], v[64:65], v[64:65]
    v_pk_mul_f32 v[24:25], v[66:67], v[66:67]
    v_pk_mul_f32 v[26:27], v[72:73], v[72:73]
    v_pk_mul_f32 v[28:29], v[74:75], v[74:75]
    v_pk_mul_f32 v[30:31], v[68:69], v[68:69]
    v_pk_mul_f32 v[32:33], v[70:71], v[70:71]
    v_pk_mul_f32 v[34:35], v[76:77], v[76:77]
    v_pk_mul_f32 v[36:37], v[78:79], v[78:79]
    v_pk_fma_f32 v[22:23], v[22:23], v[146:147], v[144:145] op_sel_hi:[1,0,0]
    v_pk_fma_f32 v[24:25], v[24:25], v[146:147], v[144:145] op_sel_hi:[1,0,0]
    v_pk_fma_f32 v[26:27], v[26:27], v[146:147], v[144:145] op_sel_hi:[1,0,0]
    v_pk_fma_f32 v[28:29], v[28:29], v[146:147], v[144:145] op_sel_hi:[1,0,0]
    v_pk_fma_f32 v[30:31], v[30:31], v[152:153], v[150:151] op_sel_hi:[1,0,0]
    v_pk_fma_f32 v[32:33], v[32:33], v[152:153], v[150:151] op_sel_hi:[1,0,0]
    v_pk_fma_f32 v[34:35], v[34:35], v[152:153], v[150:151] op_sel_hi:[1,0,0]
    v_pk_fma_f32 v[36:37], v[36:37], v[152:153], v[150:151] op_sel_hi:[1,0,0]
    v_pk_mul_f32 v[22:23], v[22:23], v[64:65]
    v_pk_mul_f32 v[24:25], v[24:25], v[66:67]
    v_pk_mul_f32 v[26:27], v[26:27], v[72:73]
    v_pk_mul_f32 v[28:29], v[28:29], v[74:75]
    v_pk_mul_f32 v[30:31], v[30:31], v[68:69]
    v_pk_mul_f32 v[32:33], v[32:33], v[70:71]
    v_pk_mul_f32 v[34:35], v[34:35], v[76:77]
    v_pk_mul_f32 v[36:37], v[36:37], v[78:79]
    v_exp_f32 v22, v22
    v_exp_f32 v23, v23
    v_exp_f32 v24, v24
    v_exp_f32 v25, v25
    v_exp_f32 v26, v26
    v_exp_f32 v27, v27
    v_exp_f32 v28, v28
    v_exp_f32 v29, v29
    v_exp_f32 v30, v30
    v_exp_f32 v31, v31
    v_exp_f32 v32, v32
    v_exp_f32 v33, v33
    v_exp_f32 v34, v34
    v_exp_f32 v35, v35
    v_exp_f32 v36, v36
    v_exp_f32 v37, v37
    v_pk_fma_f32 v[22:23], v[22:23], v[148:149], v[148:149] op_sel_hi:[1,0,0]
    v_pk_fma_f32 v[24:25], v[24:25], v[148:149], v[148:149] op_sel_hi:[1,0,0]
    v_pk_fma_f32 v[26:27], v[26:27], v[148:149], v[148:149] op_sel_hi:[1,0,0]
    v_pk_fma_f32 v[28:29], v[28:29], v[148:149], v[148:149] op_sel_hi:[1,0,0]
    v_pk_fma_f32 v[30:31], v[30:31], v[154:155], v[154:155] op_sel_hi:[1,0,0]
    v_pk_fma_f32 v[32:33], v[32:33], v[154:155], v[154:155] op_sel_hi:[1,0,0]
    v_pk_fma_f32 v[34:35], v[34:35], v[154:155], v[154:155] op_sel_hi:[1,0,0]
    v_pk_fma_f32 v[36:37], v[36:37], v[154:155], v[154:155] op_sel_hi:[1,0,0]
    v_rcp_f32 v22, v22
    v_rcp_f32 v23, v23
    v_rcp_f32 v24, v24
    v_rcp_f32 v25, v25
    v_rcp_f32 v26, v26
    v_rcp_f32 v27, v27
    v_rcp_f32 v28, v28
    v_rcp_f32 v29, v29
    v_rcp_f32 v30, v30
    v_rcp_f32 v31, v31
    v_rcp_f32 v32, v32
    v_rcp_f32 v33, v33
    v_rcp_f32 v34, v34
    v_rcp_f32 v35, v35
    v_rcp_f32 v36, v36
    v_rcp_f32 v37, v37
    v_pk_mul_f32 v[64:65], v[64:65], v[22:23]
    v_pk_mul_f32 v[66:67], v[66:67], v[24:25]
    v_pk_mul_f32 v[72:73], v[72:73], v[26:27]
    v_pk_mul_f32 v[74:75], v[74:75], v[28:29]
    v_pk_mul_f32 v[68:69], v[68:69], v[30:31]
    v_pk_mul_f32 v[70:71], v[70:71], v[32:33]
    v_pk_mul_f32 v[76:77], v[76:77], v[34:35]
    v_pk_mul_f32 v[78:79], v[78:79], v[36:37]
    v_cvt_pk_bf16_f32 v40, v64, v65
    v_cvt_pk_bf16_f32 v41, v66, v67
    v_cvt_pk_bf16_f32 v42, v72, v73
    v_cvt_pk_bf16_f32 v43, v74, v75
    v_cvt_pk_bf16_f32 v44, v68, v69
    v_cvt_pk_bf16_f32 v45, v70, v71
    v_cvt_pk_bf16_f32 v46, v76, v77
    v_cvt_pk_bf16_f32 v47, v78, v79
    buffer_store_dwordx4 v[40:43], v56, s[28:31], s56 offen sc1
    buffer_store_dwordx4 v[44:47], v57, s[28:31], s56 offen sc1
    s_add_u32 s56, s56, 8192
    v_pk_mul_f32 v[22:23], v[80:81], v[80:81]
    v_pk_mul_f32 v[24:25], v[82:83], v[82:83]
    v_pk_mul_f32 v[26:27], v[88:89], v[88:89]
    v_pk_mul_f32 v[28:29], v[90:91], v[90:91]
    v_pk_mul_f32 v[30:31], v[84:85], v[84:85]
    v_pk_mul_f32 v[32:33], v[86:87], v[86:87]
    v_pk_mul_f32 v[34:35], v[92:93], v[92:93]
    v_pk_mul_f32 v[36:37], v[94:95], v[94:95]
    v_pk_fma_f32 v[22:23], v[22:23], v[146:147], v[144:145] op_sel_hi:[1,0,0]
    v_pk_fma_f32 v[24:25], v[24:25], v[146:147], v[144:145] op_sel_hi:[1,0,0]
    v_pk_fma_f32 v[26:27], v[26:27], v[146:147], v[144:145] op_sel_hi:[1,0,0]
    v_pk_fma_f32 v[28:29], v[28:29], v[146:147], v[144:145] op_sel_hi:[1,0,0]
    v_pk_fma_f32 v[30:31], v[30:31], v[152:153], v[150:151] op_sel_hi:[1,0,0]
    v_pk_fma_f32 v[32:33], v[32:33], v[152:153], v[150:151] op_sel_hi:[1,0,0]
    v_pk_fma_f32 v[34:35], v[34:35], v[152:153], v[150:151] op_sel_hi:[1,0,0]
    v_pk_fma_f32 v[36:37], v[36:37], v[152:153], v[150:151] op_sel_hi:[1,0,0]
    v_pk_mul_f32 v[22:23], v[22:23], v[80:81]
    v_pk_mul_f32 v[24:25], v[24:25], v[82:83]
    v_pk_mul_f32 v[26:27], v[26:27], v[88:89]
    v_pk_mul_f32 v[28:29], v[28:29], v[90:91]
    v_pk_mul_f32 v[30:31], v[30:31], v[84:85]
    v_pk_mul_f32 v[32:33], v[32:33], v[86:87]
    v_pk_mul_f32 v[34:35], v[34:35], v[92:93]
    v_pk_mul_f32 v[36:37], v[36:37], v[94:95]
    v_exp_f32 v22, v22
    v_exp_f32 v23, v23
    v_exp_f32 v24, v24
    v_exp_f32 v25, v25
    v_exp_f32 v26, v26
    v_exp_f32 v27, v27
    v_exp_f32 v28, v28
    v_exp_f32 v29, v29
    v_exp_f32 v30, v30
    v_exp_f32 v31, v31
    v_exp_f32 v32, v32
    v_exp_f32 v33, v33
    v_exp_f32 v34, v34
    v_exp_f32 v35, v35
    v_exp_f32 v36, v36
    v_exp_f32 v37, v37
    v_pk_fma_f32 v[22:23], v[22:23], v[148:149], v[148:149] op_sel_hi:[1,0,0]
    v_pk_fma_f32 v[24:25], v[24:25], v[148:149], v[148:149] op_sel_hi:[1,0,0]
    v_pk_fma_f32 v[26:27], v[26:27], v[148:149], v[148:149] op_sel_hi:[1,0,0]
    v_pk_fma_f32 v[28:29], v[28:29], v[148:149], v[148:149] op_sel_hi:[1,0,0]
    v_pk_fma_f32 v[30:31], v[30:31], v[154:155], v[154:155] op_sel_hi:[1,0,0]
    v_pk_fma_f32 v[32:33], v[32:33], v[154:155], v[154:155] op_sel_hi:[1,0,0]
    v_pk_fma_f32 v[34:35], v[34:35], v[154:155], v[154:155] op_sel_hi:[1,0,0]
    v_pk_fma_f32 v[36:37], v[36:37], v[154:155], v[154:155] op_sel_hi:[1,0,0]
    v_rcp_f32 v22, v22
    v_rcp_f32 v23, v23
    v_rcp_f32 v24, v24
    v_rcp_f32 v25, v25
    v_rcp_f32 v26, v26
    v_rcp_f32 v27, v27
    v_rcp_f32 v28, v28
    v_rcp_f32 v29, v29
    v_rcp_f32 v30, v30
    v_rcp_f32 v31, v31
    v_rcp_f32 v32, v32
    v_rcp_f32 v33, v33
    v_rcp_f32 v34, v34
    v_rcp_f32 v35, v35
    v_rcp_f32 v36, v36
    v_rcp_f32 v37, v37
    v_pk_mul_f32 v[80:81], v[80:81], v[22:23]
    v_pk_mul_f32 v[82:83], v[82:83], v[24:25]
    v_pk_mul_f32 v[88:89], v[88:89], v[26:27]
    v_pk_mul_f32 v[90:91], v[90:91], v[28:29]
    v_pk_mul_f32 v[84:85], v[84:85], v[30:31]
    v_pk_mul_f32 v[86:87], v[86:87], v[32:33]
    v_pk_mul_f32 v[92:93], v[92:93], v[34:35]
    v_pk_mul_f32 v[94:95], v[94:95], v[36:37]
    v_cvt_pk_bf16_f32 v48, v80, v81
    v_cvt_pk_bf16_f32 v49, v82, v83
    v_cvt_pk_bf16_f32 v50, v88, v89
    v_cvt_pk_bf16_f32 v51, v90, v91
    v_cvt_pk_bf16_f32 v52, v84, v85
    v_cvt_pk_bf16_f32 v53, v86, v87
    v_cvt_pk_bf16_f32 v54, v92, v93
    v_cvt_pk_bf16_f32 v55, v94, v95
    buffer_store_dwordx4 v[48:51], v56, s[28:31], s56 offen sc1
    buffer_store_dwordx4 v[52:55], v57, s[28:31], s56 offen sc1
    s_add_u32 s56, s56, 8192
    v_pk_mul_f32 v[22:23], v[96:97], v[96:97]
    v_pk_mul_f32 v[24:25], v[98:99], v[98:99]
    v_pk_mul_f32 v[26:27], v[104:105], v[104:105]
    v_pk_mul_f32 v[28:29], v[106:107], v[106:107]
    v_pk_mul_f32 v[30:31], v[100:101], v[100:101]
    v_pk_mul_f32 v[32:33], v[102:103], v[102:103]
    v_pk_mul_f32 v[34:35], v[108:109], v[108:109]
    v_pk_mul_f32 v[36:37], v[110:111], v[110:111]
    v_pk_fma_f32 v[22:23], v[22:23], v[146:147], v[144:145] op_sel_hi:[1,0,0]
    v_pk_fma_f32 v[24:25], v[24:25], v[146:147], v[144:145] op_sel_hi:[1,0,0]
    v_pk_fma_f32 v[26:27], v[26:27], v[146:147], v[144:145] op_sel_hi:[1,0,0]
    v_pk_fma_f32 v[28:29], v[28:29], v[146:147], v[144:145] op_sel_hi:[1,0,0]
    v_pk_fma_f32 v[30:31], v[30:31], v[152:153], v[150:151] op_sel_hi:[1,0,0]
    v_pk_fma_f32 v[32:33], v[32:33], v[152:153], v[150:151] op_sel_hi:[1,0,0]
    v_pk_fma_f32 v[34:35], v[34:35], v[152:153], v[150:151] op_sel_hi:[1,0,0]
    v_pk_fma_f32 v[36:37], v[36:37], v[152:153], v[150:151] op_sel_hi:[1,0,0]
    v_pk_mul_f32 v[22:23], v[22:23], v[96:97]
    v_pk_mul_f32 v[24:25], v[24:25], v[98:99]
    v_pk_mul_f32 v[26:27], v[26:27], v[104:105]
    v_pk_mul_f32 v[28:29], v[28:29], v[106:107]
    v_pk_mul_f32 v[30:31], v[30:31], v[100:101]
    v_pk_mul_f32 v[32:33], v[32:33], v[102:103]
    v_pk_mul_f32 v[34:35], v[34:35], v[108:109]
    v_pk_mul_f32 v[36:37], v[36:37], v[110:111]
    v_exp_f32 v22, v22
    v_exp_f32 v23, v23
    v_exp_f32 v24, v24
    v_exp_f32 v25, v25
    v_exp_f32 v26, v26
    v_exp_f32 v27, v27
    v_exp_f32 v28, v28
    v_exp_f32 v29, v29
    v_exp_f32 v30, v30
    v_exp_f32 v31, v31
    v_exp_f32 v32, v32
    v_exp_f32 v33, v33
    v_exp_f32 v34, v34
    v_exp_f32 v35, v35
    v_exp_f32 v36, v36
    v_exp_f32 v37, v37
    v_pk_fma_f32 v[22:23], v[22:23], v[148:149], v[148:149] op_sel_hi:[1,0,0]
    v_pk_fma_f32 v[24:25], v[24:25], v[148:149], v[148:149] op_sel_hi:[1,0,0]
    v_pk_fma_f32 v[26:27], v[26:27], v[148:149], v[148:149] op_sel_hi:[1,0,0]
    v_pk_fma_f32 v[28:29], v[28:29], v[148:149], v[148:149] op_sel_hi:[1,0,0]
    v_pk_fma_f32 v[30:31], v[30:31], v[154:155], v[154:155] op_sel_hi:[1,0,0]
    v_pk_fma_f32 v[32:33], v[32:33], v[154:155], v[154:155] op_sel_hi:[1,0,0]
    v_pk_fma_f32 v[34:35], v[34:35], v[154:155], v[154:155] op_sel_hi:[1,0,0]
    v_pk_fma_f32 v[36:37], v[36:37], v[154:155], v[154:155] op_sel_hi:[1,0,0]
    v_rcp_f32 v22, v22
    v_rcp_f32 v23, v23
    v_rcp_f32 v24, v24
    v_rcp_f32 v25, v25
    v_rcp_f32 v26, v26
    v_rcp_f32 v27, v27
    v_rcp_f32 v28, v28
    v_rcp_f32 v29, v29
    v_rcp_f32 v30, v30
    v_rcp_f32 v31, v31
    v_rcp_f32 v32, v32
    v_rcp_f32 v33, v33
    v_rcp_f32 v34, v34
    v_rcp_f32 v35, v35
    v_rcp_f32 v36, v36
    v_rcp_f32 v37, v37
    v_pk_mul_f32 v[96:97], v[96:97], v[22:23]
    v_pk_mul_f32 v[98:99], v[98:99], v[24:25]
    v_pk_mul_f32 v[104:105], v[104:105], v[26:27]
    v_pk_mul_f32 v[106:107], v[106:107], v[28:29]
    v_pk_mul_f32 v[100:101], v[100:101], v[30:31]
    v_pk_mul_f32 v[102:103], v[102:103], v[32:33]
    v_pk_mul_f32 v[108:109], v[108:109], v[34:35]
    v_pk_mul_f32 v[110:111], v[110:111], v[36:37]
    v_cvt_pk_bf16_f32 v40, v96, v97
    v_cvt_pk_bf16_f32 v41, v98, v99
    v_cvt_pk_bf16_f32 v42, v104, v105
    v_cvt_pk_bf16_f32 v43, v106, v107
    v_cvt_pk_bf16_f32 v44, v100, v101
    v_cvt_pk_bf16_f32 v45, v102, v103
    v_cvt_pk_bf16_f32 v46, v108, v109
    v_cvt_pk_bf16_f32 v47, v110, v111
    buffer_store_dwordx4 v[40:43], v56, s[28:31], s56 offen sc1
    buffer_store_dwordx4 v[44:47], v57, s[28:31], s56 offen sc1
    s_add_u32 s56, s56, 8192
    v_pk_mul_f32 v[22:23], v[112:113], v[112:113]
    v_pk_mul_f32 v[24:25], v[114:115], v[114:115]
    v_pk_mul_f32 v[26:27], v[120:121], v[120:121]
    v_pk_mul_f32 v[28:29], v[122:123], v[122:123]
    v_pk_mul_f32 v[30:31], v[116:117], v[116:117]
    v_pk_mul_f32 v[32:33], v[118:119], v[118:119]
    v_pk_mul_f32 v[34:35], v[124:125], v[124:125]
    v_pk_mul_f32 v[36:37], v[126:127], v[126:127]
    v_pk_fma_f32 v[22:23], v[22:23], v[146:147], v[144:145] op_sel_hi:[1,0,0]
    v_pk_fma_f32 v[24:25], v[24:25], v[146:147], v[144:145] op_sel_hi:[1,0,0]
    v_pk_fma_f32 v[26:27], v[26:27], v[146:147], v[144:145] op_sel_hi:[1,0,0]
    v_pk_fma_f32 v[28:29], v[28:29], v[146:147], v[144:145] op_sel_hi:[1,0,0]
    v_pk_fma_f32 v[30:31], v[30:31], v[152:153], v[150:151] op_sel_hi:[1,0,0]
    v_pk_fma_f32 v[32:33], v[32:33], v[152:153], v[150:151] op_sel_hi:[1,0,0]
    v_pk_fma_f32 v[34:35], v[34:35], v[152:153], v[150:151] op_sel_hi:[1,0,0]
    v_pk_fma_f32 v[36:37], v[36:37], v[152:153], v[150:151] op_sel_hi:[1,0,0]
    v_pk_mul_f32 v[22:23], v[22:23], v[112:113]
    v_pk_mul_f32 v[24:25], v[24:25], v[114:115]
    v_pk_mul_f32 v[26:27], v[26:27], v[120:121]
    v_pk_mul_f32 v[28:29], v[28:29], v[122:123]
    v_pk_mul_f32 v[30:31], v[30:31], v[116:117]
    v_pk_mul_f32 v[32:33], v[32:33], v[118:119]
    v_pk_mul_f32 v[34:35], v[34:35], v[124:125]
    v_pk_mul_f32 v[36:37], v[36:37], v[126:127]
    v_exp_f32 v22, v22
    v_exp_f32 v23, v23
    v_exp_f32 v24, v24
    v_exp_f32 v25, v25
    v_exp_f32 v26, v26
    v_exp_f32 v27, v27
    v_exp_f32 v28, v28
    v_exp_f32 v29, v29
    v_exp_f32 v30, v30
    v_exp_f32 v31, v31
    v_exp_f32 v32, v32
    v_exp_f32 v33, v33
    v_exp_f32 v34, v34
    v_exp_f32 v35, v35
    v_exp_f32 v36, v36
    v_exp_f32 v37, v37
    v_pk_fma_f32 v[22:23], v[22:23], v[148:149], v[148:149] op_sel_hi:[1,0,0]
    v_pk_fma_f32 v[24:25], v[24:25], v[148:149], v[148:149] op_sel_hi:[1,0,0]
    v_pk_fma_f32 v[26:27], v[26:27], v[148:149], v[148:149] op_sel_hi:[1,0,0]
    v_pk_fma_f32 v[28:29], v[28:29], v[148:149], v[148:149] op_sel_hi:[1,0,0]
    v_pk_fma_f32 v[30:31], v[30:31], v[154:155], v[154:155] op_sel_hi:[1,0,0]
    v_pk_fma_f32 v[32:33], v[32:33], v[154:155], v[154:155] op_sel_hi:[1,0,0]
    v_pk_fma_f32 v[34:35], v[34:35], v[154:155], v[154:155] op_sel_hi:[1,0,0]
    v_pk_fma_f32 v[36:37], v[36:37], v[154:155], v[154:155] op_sel_hi:[1,0,0]
    v_rcp_f32 v22, v22
    v_rcp_f32 v23, v23
    v_rcp_f32 v24, v24
    v_rcp_f32 v25, v25
    v_rcp_f32 v26, v26
    v_rcp_f32 v27, v27
    v_rcp_f32 v28, v28
    v_rcp_f32 v29, v29
    v_rcp_f32 v30, v30
    v_rcp_f32 v31, v31
    v_rcp_f32 v32, v32
    v_rcp_f32 v33, v33
    v_rcp_f32 v34, v34
    v_rcp_f32 v35, v35
    v_rcp_f32 v36, v36
    v_rcp_f32 v37, v37
    v_pk_mul_f32 v[112:113], v[112:113], v[22:23]
    v_pk_mul_f32 v[114:115], v[114:115], v[24:25]
    v_pk_mul_f32 v[120:121], v[120:121], v[26:27]
    v_pk_mul_f32 v[122:123], v[122:123], v[28:29]
    v_pk_mul_f32 v[116:117], v[116:117], v[30:31]
    v_pk_mul_f32 v[118:119], v[118:119], v[32:33]
    v_pk_mul_f32 v[124:125], v[124:125], v[34:35]
    v_pk_mul_f32 v[126:127], v[126:127], v[36:37]
    v_cvt_pk_bf16_f32 v48, v112, v113
    v_cvt_pk_bf16_f32 v49, v114, v115
    v_cvt_pk_bf16_f32 v50, v120, v121
    v_cvt_pk_bf16_f32 v51, v122, v123
    v_cvt_pk_bf16_f32 v52, v116, v117
    v_cvt_pk_bf16_f32 v53, v118, v119
    v_cvt_pk_bf16_f32 v54, v124, v125
    v_cvt_pk_bf16_f32 v55, v126, v127
    buffer_store_dwordx4 v[48:51], v56, s[28:31], s56 offen sc1
    buffer_store_dwordx4 v[52:55], v57, s[28:31], s56 offen sc1
    s_add_u32 s56, s56, 8192
    v_pk_mul_f32 v[22:23], v[128:129], v[128:129]
    v_pk_mul_f32 v[24:25], v[130:131], v[130:131]
    v_pk_mul_f32 v[26:27], v[136:137], v[136:137]
    v_pk_mul_f32 v[28:29], v[138:139], v[138:139]
    v_pk_mul_f32 v[30:31], v[132:133], v[132:133]
    v_pk_mul_f32 v[32:33], v[134:135], v[134:135]
    v_pk_mul_f32 v[34:35], v[140:141], v[140:141]
    v_pk_mul_f32 v[36:37], v[142:143], v[142:143]
    v_pk_fma_f32 v[22:23], v[22:23], v[146:147], v[144:145] op_sel_hi:[1,0,0]
    v_pk_fma_f32 v[24:25], v[24:25], v[146:147], v[144:145] op_sel_hi:[1,0,0]
    v_pk_fma_f32 v[26:27], v[26:27], v[146:147], v[144:145] op_sel_hi:[1,0,0]
    v_pk_fma_f32 v[28:29], v[28:29], v[146:147], v[144:145] op_sel_hi:[1,0,0]
    v_pk_fma_f32 v[30:31], v[30:31], v[152:153], v[150:151] op_sel_hi:[1,0,0]
    v_pk_fma_f32 v[32:33], v[32:33], v[152:153], v[150:151] op_sel_hi:[1,0,0]
    v_pk_fma_f32 v[34:35], v[34:35], v[152:153], v[150:151] op_sel_hi:[1,0,0]
    v_pk_fma_f32 v[36:37], v[36:37], v[152:153], v[150:151] op_sel_hi:[1,0,0]
    v_pk_mul_f32 v[22:23], v[22:23], v[128:129]
    v_pk_mul_f32 v[24:25], v[24:25], v[130:131]
    v_pk_mul_f32 v[26:27], v[26:27], v[136:137]
    v_pk_mul_f32 v[28:29], v[28:29], v[138:139]
    v_pk_mul_f32 v[30:31], v[30:31], v[132:133]
    v_pk_mul_f32 v[32:33], v[32:33], v[134:135]
    v_pk_mul_f32 v[34:35], v[34:35], v[140:141]
    v_pk_mul_f32 v[36:37], v[36:37], v[142:143]
    v_exp_f32 v22, v22
    v_exp_f32 v23, v23
    v_exp_f32 v24, v24
    v_exp_f32 v25, v25
    v_exp_f32 v26, v26
    v_exp_f32 v27, v27
    v_exp_f32 v28, v28
    v_exp_f32 v29, v29
    v_exp_f32 v30, v30
    v_exp_f32 v31, v31
    v_exp_f32 v32, v32
    v_exp_f32 v33, v33
    v_exp_f32 v34, v34
    v_exp_f32 v35, v35
    v_exp_f32 v36, v36
    v_exp_f32 v37, v37
    v_pk_fma_f32 v[22:23], v[22:23], v[148:149], v[148:149] op_sel_hi:[1,0,0]
    v_pk_fma_f32 v[24:25], v[24:25], v[148:149], v[148:149] op_sel_hi:[1,0,0]
    v_pk_fma_f32 v[26:27], v[26:27], v[148:149], v[148:149] op_sel_hi:[1,0,0]
    v_pk_fma_f32 v[28:29], v[28:29], v[148:149], v[148:149] op_sel_hi:[1,0,0]
    v_pk_fma_f32 v[30:31], v[30:31], v[154:155], v[154:155] op_sel_hi:[1,0,0]
    v_pk_fma_f32 v[32:33], v[32:33], v[154:155], v[154:155] op_sel_hi:[1,0,0]
    v_pk_fma_f32 v[34:35], v[34:35], v[154:155], v[154:155] op_sel_hi:[1,0,0]
    v_pk_fma_f32 v[36:37], v[36:37], v[154:155], v[154:155] op_sel_hi:[1,0,0]
    v_rcp_f32 v22, v22
    v_rcp_f32 v23, v23
    v_rcp_f32 v24, v24
    v_rcp_f32 v25, v25
    v_rcp_f32 v26, v26
    v_rcp_f32 v27, v27
    v_rcp_f32 v28, v28
    v_rcp_f32 v29, v29
    v_rcp_f32 v30, v30
    v_rcp_f32 v31, v31
    v_rcp_f32 v32, v32
    v_rcp_f32 v33, v33
    v_rcp_f32 v34, v34
    v_rcp_f32 v35, v35
    v_rcp_f32 v36, v36
    v_rcp_f32 v37, v37
    v_pk_mul_f32 v[128:129], v[128:129], v[22:23]
    v_pk_mul_f32 v[130:131], v[130:131], v[24:25]
    v_pk_mul_f32 v[136:137], v[136:137], v[26:27]
    v_pk_mul_f32 v[138:139], v[138:139], v[28:29]
    v_pk_mul_f32 v[132:133], v[132:133], v[30:31]
    v_pk_mul_f32 v[134:135], v[134:135], v[32:33]
    v_pk_mul_f32 v[140:141], v[140:141], v[34:35]
    v_pk_mul_f32 v[142:143], v[142:143], v[36:37]
    v_cvt_pk_bf16_f32 v40, v128, v129
    v_cvt_pk_bf16_f32 v41, v130, v131
    v_cvt_pk_bf16_f32 v42, v136, v137
    v_cvt_pk_bf16_f32 v43, v138, v139
    v_cvt_pk_bf16_f32 v44, v132, v133
    v_cvt_pk_bf16_f32 v45, v134, v135
    v_cvt_pk_bf16_f32 v46, v140, v141
    v_cvt_pk_bf16_f32 v47, v142, v143
    buffer_store_dwordx4 v[40:43], v56, s[28:31], s56 offen sc1
    buffer_store_dwordx4 v[44:47], v57, s[28:31], s56 offen sc1
    v_lshrrev_b32 v22, 1, v0
    v_lshlrev_b32 v22, 11, v22
    v_and_b32 v23, 1, v0
    v_lshl_add_u32 v22, v23, 4, v22
    v_mov_b32 v24, 1073741824
    v_cmp_gt_u32 vcc, 40, v0
    v_cmp_gt_u32 s[48:49], s78, v23
    s_nop 0
    s_and_b64 vcc, vcc, s[48:49]
    v_cndmask_b32 v22, v24, v22, vcc
    s_add_u32 s45, s72, 128
    s_cmp_gt_i32 s72, 0
    s_cselect_b32 s45, 0, s45
    s_cselect_b32 s46, 0, 15
    s_lshl_b32 s45, s45, 4
    s_mul_i32 s44, s58, 40960
    s_add_u32 s44, s44, s45
    s_mul_i32 s45, s42, 163840
    s_add_u32 s44, s44, s45
    s_add_u32 s44, s44, 4980736
    s_cmp_eq_u32 s42, s46
    s_cselect_b32 s44, s44, 1073741824
    v_mov_b32 v28, 0
    v_mov_b32 v29, 0
    v_mov_b32 v30, 0
    v_mov_b32 v31, 0
    buffer_store_dwordx4 v[28:31], v22, s[28:31], s44 offen sc1
    s_mul_i32 s76, s42, 4
    s_add_u32 s76, s76, s58
    s_lshl_b32 s76, s76, 7
    s_add_u32 s76, s76, 27295744
    s_waitcnt vmcnt(0)
    s_barrier
    buffer_store_dwordx4 v[244:247], v243, s[28:31], s76 offen sc1
    buffer_store_dwordx4 v[244:247], v243, s[28:31], s77 offen sc1
    s_mov_b32 s77, 1073741824
    s_mov_b32 s76, 1073741824
    s_cmp_lt_u32 s43, 14
    s_cbranch_scc0 L_h23
    v_lshrrev_b32 v22, 2, v1
    v_add_u32 v22, s97, v22
    v_subrev_u32 v22, 1, v22
    v_max_i32 v22, 0, v22
    v_min_i32 v22, 15, v22
    v_and_b32 v23, 3, v1
    v_lshl_add_u32 v22, v22, 2, v23
    v_lshlrev_b32 v22, 7, v22
    v_add_u32 v22, 27295744, v22
    s_mul_i32 s44, s92, 16
    s_add_u32 s44, s44, s93
    s_lshl_b32 s44, s44, 7
    s_add_u32 s44, s44, 27262976
    v_mov_b32 v23, s44
    v_cmp_gt_u32 vcc, 12, v1
    s_nop 1
    v_cndmask_b32 v58, v23, v22, vcc
    buffer_load_dword v59, v58, s[28:31], 0 offen sc1
    s_waitcnt vmcnt(0)
    s_mov_b32 s57, 200000
L_cp_4:
    v_cmp_ne_u32 vcc, s40, v59
    s_nop 1
    s_cbranch_vccz L_cd_5
    buffer_load_dword v59, v58, s[28:31], 0 offen sc1
    s_waitcnt vmcnt(0)
    s_sub_u32 s57, s57, 1
    s_cmp_lg_u32 s57, 0
    s_cbranch_scc1 L_cp_4
L_cd_5:
    s_branch L_g2
L_h23:
    s_mov_b32 s32, s18
    s_mov_b32 s33, s19
    s_mov_b32 s34, 2211840
    s_mov_b32 s35, 0x20000
    s_lshl_b32 s72, s42, 1
    s_add_u32 s72, s72, s43
    s_sub_u32 s72, s72, 14
    v_lshrrev_b32 v26, 3, v1
    v_and_b32 v27, 7, v1
    v_mul_u32_u24 v28, 3456, v26
    v_lshl_add_u32 v28, v27, 4, v28
    s_add_u32 s44, s72, 0
    s_mul_i32 s79, s44, 2428
    s_lshr_b32 s79, s79, 16
    s_mul_i32 s45, s79, 27
    s_sub_u32 s78, s44, s45
    s_lshl_b32 s45, s79, 7
    s_lshl_b32 s46, s41, 5
    s_add_u32 s45, s45, s46
    s_mul_i32 s45, s45, 3456
    s_lshl_b32 s46, s78, 7
    s_add_u32 s45, s45, s46
    s_cmp_lt_u32 s44, 135
    s_cselect_b32 s45, s45, 1073741824
    buffer_load_dwordx4 v[64:67], v28, s[32:35], s45 offen
    s_add_u32 s45, s45, 27648
    buffer_load_dwordx4 v[68:71], v28, s[32:35], s45 offen
    s_add_u32 s45, s45, 27648
    buffer_load_dwordx4 v[72:75], v28, s[32:35], s45 offen
    s_add_u32 s45, s45, 27648
    buffer_load_dwordx4 v[76:79], v28, s[32:35], s45 offen
    s_add_u32 s44, s72, 32
    s_mul_i32 s79, s44, 2428
    s_lshr_b32 s79, s79, 16
    s_mul_i32 s45, s79, 27
    s_sub_u32 s78, s44, s45
    s_lshl_b32 s45, s79, 7
    s_lshl_b32 s46, s41, 5
    s_add_u32 s45, s45, s46
    s_mul_i32 s45, s45, 3456
    s_lshl_b32 s46, s78, 7
    s_add_u32 s45, s45, s46
    s_cmp_lt_u32 s44, 135
    s_cselect_b32 s45, s45, 1073741824
    buffer_load_dwordx4 v[80:83], v28, s[32:35], s45 offen
    s_add_u32 s45, s45, 27648
    buffer_load_dwordx4 v[84:87], v28, s[32:35], s45 offen
    s_add_u32 s45, s45, 27648
    buffer_load_dwordx4 v[88:91], v28, s[32:35], s45 offen
    s_add_u32 s45, s45, 27648
    buffer_load_dwordx4 v[92:95], v28, s[32:35], s45 offen
    s_add_u32 s44, s72, 64
    s_mul_i32 s79, s44, 2428
    s_lshr_b32 s79, s79, 16
    s_mul_i32 s45, s79, 27
    s_sub_u32 s78, s44, s45
    s_lshl_b32 s45, s79, 7
    s_lshl_b32 s46, s41, 5
    s_add_u32 s45, s45, s46
    s_mul_i32 s45, s45, 3456
    s_lshl_b32 s46, s78, 7
    s_add_u32 s45, s45, s46
    s_cmp_lt_u32 s44, 135
    s_cselect_b32 s45, s45, 1073741824
    buffer_load_dwordx4 v[96:99], v28, s[32:35], s45 offen
    s_add_u32 s45, s45, 27648
    buffer_load_dwordx4 v[100:103], v28, s[32:35], s45 offen
    s_add_u32 s45, s45, 27648
    buffer_load_dwordx4 v[104:107], v28, s[32:35], s45 offen
    s_add_u32 s45, s45, 27648
    buffer_load_dwordx4 v[108:111], v28, s[32:35], s45 offen
    s_add_u32 s44, s72, 96
    s_mul_i32 s79, s44, 2428
    s_lshr_b32 s79, s79, 16
    s_mul_i32 s45, s79, 27
    s_sub_u32 s78, s44, s45
    s_lshl_b32 s45, s79, 7
    s_lshl_b32 s46, s41, 5
    s_add_u32 s45, s45, s46
    s_mul_i32 s45, s45, 3456
    s_lshl_b32 s46, s78, 7
    s_add_u32 s45, s45, s46
    s_cmp_lt_u32 s44, 135
    s_cselect_b32 s45, s45, 1073741824
    buffer_load_dwordx4 v[112:115], v28, s[32:35], s45 offen
    s_add_u32 s45, s45, 27648
    buffer_load_dwordx4 v[116:119], v28, s[32:35], s45 offen
    s_add_u32 s45, s45, 27648
    buffer_load_dwordx4 v[120:123], v28, s[32:35], s45 offen
    s_add_u32 s45, s45, 27648
    buffer_load_dwordx4 v[124:127], v28, s[32:35], s45 offen
    s_add_u32 s44, s72, 128
    s_mul_i32 s79, s44, 2428
    s_lshr_b32 s79, s79, 16
    s_mul_i32 s45, s79, 27
    s_sub_u32 s78, s44, s45
    s_lshl_b32 s45, s79, 7
    s_lshl_b32 s46, s41, 5
    s_add_u32 s45, s45, s46
    s_mul_i32 s45, s45, 3456
    s_lshl_b32 s46, s78, 7
    s_add_u32 s45, s45, s46
    s_cmp_lt_u32 s44, 135
    s_cselect_b32 s45, s45, 1073741824
    buffer_load_dwordx4 v[128:131], v28, s[32:35], s45 offen
    s_add_u32 s45, s45, 27648
    buffer_load_dwordx4 v[132:135], v28, s[32:35], s45 offen
    s_add_u32 s45, s45, 27648
    buffer_load_dwordx4 v[136:139], v28, s[32:35], s45 offen
    s_add_u32 s45, s45, 27648
    buffer_load_dwordx4 v[140:143], v28, s[32:35], s45 offen
    v_lshlrev_b32 v22, 5, v1
    s_lshl_b32 s44, s41, 8
    s_add_u32 s44, s44, 65536
    v_add_u32 v22, s44, v22
    s_waitcnt vmcnt(16)
    v_lshlrev_b32 v144, 16, v64
    v_and_b32 v145, 0xffff0000, v64
    v_lshlrev_b32 v146, 16, v65
    v_and_b32 v147, 0xffff0000, v65
    v_lshlrev_b32 v148, 16, v66
    v_and_b32 v149, 0xffff0000, v66
    v_lshlrev_b32 v150, 16, v67
    v_and_b32 v151, 0xffff0000, v67
    v_lshlrev_b32 v152, 16, v68
    v_and_b32 v153, 0xffff0000, v68
    v_lshlrev_b32 v154, 16, v69
    v_and_b32 v155, 0xffff0000, v69
    v_lshlrev_b32 v156, 16, v70
    v_and_b32 v157, 0xffff0000, v70
    v_lshlrev_b32 v158, 16, v71
    v_and_b32 v159, 0xffff0000, v71
    v_pk_add_f32 v[144:145], v[144:145], v[152:153]
    v_pk_add_f32 v[146:147], v[146:147], v[154:155]
    v_pk_add_f32 v[148:149], v[148:149], v[156:157]
    v_pk_add_f32 v[150:151], v[150:151], v[158:159]
    v_lshlrev_b32 v152, 16, v72
    v_and_b32 v153, 0xffff0000, v72
    v_lshlrev_b32 v154, 16, v73
    v_and_b32 v155, 0xffff0000, v73
    v_lshlrev_b32 v156, 16, v74
    v_and_b32 v157, 0xffff0000, v74
    v_lshlrev_b32 v158, 16, v75
    v_and_b32 v159, 0xffff0000, v75
    v_pk_add_f32 v[144:145], v[144:145], v[152:153]
    v_pk_add_f32 v[146:147], v[146:147], v[154:155]
    v_pk_add_f32 v[148:149], v[148:149], v[156:157]
    v_pk_add_f32 v[150:151], v[150:151], v[158:159]
    v_lshlrev_b32 v152, 16, v76
    v_and_b32 v153, 0xffff0000, v76
    v_lshlrev_b32 v154, 16, v77
    v_and_b32 v155, 0xffff0000, v77
    v_lshlrev_b32 v156, 16, v78
    v_and_b32 v157, 0xffff0000, v78
    v_lshlrev_b32 v158, 16, v79
    v_and_b32 v159, 0xffff0000, v79
    v_pk_add_f32 v[144:145], v[144:145], v[152:153]
    v_pk_add_f32 v[146:147], v[146:147], v[154:155]
    v_pk_add_f32 v[148:149], v[148:149], v[156:157]
    v_pk_add_f32 v[150:151], v[150:151], v[158:159]
    v_add_f32_dpp v144, v144, v144 row_ror:8 row_mask:0xf bank_mask:0xf
    v_add_f32_dpp v145, v145, v145 row_ror:8 row_mask:0xf bank_mask:0xf
    v_add_f32_dpp v146, v146, v146 row_ror:8 row_mask:0xf bank_mask:0xf
    v_add_f32_dpp v147, v147, v147 row_ror:8 row_mask:0xf bank_mask:0xf
    v_add_f32_dpp v148, v148, v148 row_ror:8 row_mask:0xf bank_mask:0xf
    v_add_f32_dpp v149, v149, v149 row_ror:8 row_mask:0xf bank_mask:0xf
    v_add_f32_dpp v150, v150, v150 row_ror:8 row_mask:0xf bank_mask:0xf
    v_add_f32_dpp v151, v151, v151 row_ror:8 row_mask:0xf bank_mask:0xf
    v_mov_b32 v152, v144
    v_mov_b32 v153, v145
    v_mov_b32 v154, v146
    v_mov_b32 v155, v147
    v_mov_b32 v156, v148
    v_mov_b32 v157, v149
    v_mov_b32 v158, v150
    v_mov_b32 v159, v151
    v_permlane16_swap_b32 v144, v152
    v_permlane16_swap_b32 v145, v153
    v_permlane16_swap_b32 v146, v154
    v_permlane16_swap_b32 v147, v155
    v_permlane16_swap_b32 v148, v156
    v_permlane16_swap_b32 v149, v157
    v_permlane16_swap_b32 v150, v158
    v_permlane16_swap_b32 v151, v159
    v_add_f32 v144, v144, v152
    v_add_f32 v145, v145, v153
    v_add_f32 v146, v146, v154
    v_add_f32 v147, v147, v155
    v_add_f32 v148, v148, v156
    v_add_f32 v149, v149, v157
    v_add_f32 v150, v150, v158
    v_add_f32 v151, v151, v159
    v_mov_b32 v152, v144
    v_mov_b32 v153, v145
    v_mov_b32 v154, v146
    v_mov_b32 v155, v147
    v_mov_b32 v156, v148
    v_mov_b32 v157, v149
    v_mov_b32 v158, v150
    v_mov_b32 v159, v151
    v_permlane32_swap_b32 v144, v152
    v_permlane32_swap_b32 v145, v153
    v_permlane32_swap_b32 v146, v154
    v_permlane32_swap_b32 v147, v155
    v_permlane32_swap_b32 v148, v156
    v_permlane32_swap_b32 v149, v157
    v_permlane32_swap_b32 v150, v158
    v_permlane32_swap_b32 v151, v159
    v_add_f32 v144, v144, v152
    v_add_f32 v145, v145, v153
    v_add_f32 v146, v146, v154
    v_add_f32 v147, v147, v155
    v_add_f32 v148, v148, v156
    v_add_f32 v149, v149, v157
    v_add_f32 v150, v150, v158
    v_add_f32 v151, v151, v159
    s_mov_b64 exec, 0xff
    ds_write_b128 v22, v[144:147] offset:0
    ds_write_b128 v22, v[148:151] offset:16
    s_mov_b64 exec, -1
    s_waitcnt vmcnt(12)
    v_lshlrev_b32 v144, 16, v80
    v_and_b32 v145, 0xffff0000, v80
    v_lshlrev_b32 v146, 16, v81
    v_and_b32 v147, 0xffff0000, v81
    v_lshlrev_b32 v148, 16, v82
    v_and_b32 v149, 0xffff0000, v82
    v_lshlrev_b32 v150, 16, v83
    v_and_b32 v151, 0xffff0000, v83
    v_lshlrev_b32 v152, 16, v84
    v_and_b32 v153, 0xffff0000, v84
    v_lshlrev_b32 v154, 16, v85
    v_and_b32 v155, 0xffff0000, v85
    v_lshlrev_b32 v156, 16, v86
    v_and_b32 v157, 0xffff0000, v86
    v_lshlrev_b32 v158, 16, v87
    v_and_b32 v159, 0xffff0000, v87
    v_pk_add_f32 v[144:145], v[144:145], v[152:153]
    v_pk_add_f32 v[146:147], v[146:147], v[154:155]
    v_pk_add_f32 v[148:149], v[148:149], v[156:157]
    v_pk_add_f32 v[150:151], v[150:151], v[158:159]
    v_lshlrev_b32 v152, 16, v88
    v_and_b32 v153, 0xffff0000, v88
    v_lshlrev_b32 v154, 16, v89
    v_and_b32 v155, 0xffff0000, v89
    v_lshlrev_b32 v156, 16, v90
    v_and_b32 v157, 0xffff0000, v90
    v_lshlrev_b32 v158, 16, v91
    v_and_b32 v159, 0xffff0000, v91
    v_pk_add_f32 v[144:145], v[144:145], v[152:153]
    v_pk_add_f32 v[146:147], v[146:147], v[154:155]
    v_pk_add_f32 v[148:149], v[148:149], v[156:157]
    v_pk_add_f32 v[150:151], v[150:151], v[158:159]
    v_lshlrev_b32 v152, 16, v92
    v_and_b32 v153, 0xffff0000, v92
    v_lshlrev_b32 v154, 16, v93
    v_and_b32 v155, 0xffff0000, v93
    v_lshlrev_b32 v156, 16, v94
    v_and_b32 v157, 0xffff0000, v94
    v_lshlrev_b32 v158, 16, v95
    v_and_b32 v159, 0xffff0000, v95
    v_pk_add_f32 v[144:145], v[144:145], v[152:153]
    v_pk_add_f32 v[146:147], v[146:147], v[154:155]
    v_pk_add_f32 v[148:149], v[148:149], v[156:157]
    v_pk_add_f32 v[150:151], v[150:151], v[158:159]
    v_add_f32_dpp v144, v144, v144 row_ror:8 row_mask:0xf bank_mask:0xf
    v_add_f32_dpp v145, v145, v145 row_ror:8 row_mask:0xf bank_mask:0xf
    v_add_f32_dpp v146, v146, v146 row_ror:8 row_mask:0xf bank_mask:0xf
    v_add_f32_dpp v147, v147, v147 row_ror:8 row_mask:0xf bank_mask:0xf
    v_add_f32_dpp v148, v148, v148 row_ror:8 row_mask:0xf bank_mask:0xf
    v_add_f32_dpp v149, v149, v149 row_ror:8 row_mask:0xf bank_mask:0xf
    v_add_f32_dpp v150, v150, v150 row_ror:8 row_mask:0xf bank_mask:0xf
    v_add_f32_dpp v151, v151, v151 row_ror:8 row_mask:0xf bank_mask:0xf
    v_mov_b32 v152, v144
    v_mov_b32 v153, v145
    v_mov_b32 v154, v146
    v_mov_b32 v155, v147
    v_mov_b32 v156, v148
    v_mov_b32 v157, v149
    v_mov_b32 v158, v150
    v_mov_b32 v159, v151
    v_permlane16_swap_b32 v144, v152
    v_permlane16_swap_b32 v145, v153
    v_permlane16_swap_b32 v146, v154
    v_permlane16_swap_b32 v147, v155
    v_permlane16_swap_b32 v148, v156
    v_permlane16_swap_b32 v149, v157
    v_permlane16_swap_b32 v150, v158
    v_permlane16_swap_b32 v151, v159
    v_add_f32 v144, v144, v152
    v_add_f32 v145, v145, v153
    v_add_f32 v146, v146, v154
    v_add_f32 v147, v147, v155
    v_add_f32 v148, v148, v156
    v_add_f32 v149, v149, v157
    v_add_f32 v150, v150, v158
    v_add_f32 v151, v151, v159
    v_mov_b32 v152, v144
    v_mov_b32 v153, v145
    v_mov_b32 v154, v146
    v_mov_b32 v155, v147
    v_mov_b32 v156, v148
    v_mov_b32 v157, v149
    v_mov_b32 v158, v150
    v_mov_b32 v159, v151
    v_permlane32_swap_b32 v144, v152
    v_permlane32_swap_b32 v145, v153
    v_permlane32_swap_b32 v146, v154
    v_permlane32_swap_b32 v147, v155
    v_permlane32_swap_b32 v148, v156
    v_permlane32_swap_b32 v149, v157
    v_permlane32_swap_b32 v150, v158
    v_permlane32_swap_b32 v151, v159
    v_add_f32 v144, v144, v152
    v_add_f32 v145, v145, v153
    v_add_f32 v146, v146, v154
    v_add_f32 v147, v147, v155
    v_add_f32 v148, v148, v156
    v_add_f32 v149, v149, v157
    v_add_f32 v150, v150, v158
    v_add_f32 v151, v151, v159
    s_mov_b64 exec, 0xff
    ds_write_b128 v22, v[144:147] offset:1024
    ds_write_b128 v22, v[148:151] offset:1040
    s_mov_b64 exec, -1
    s_waitcnt vmcnt(8)
    v_lshlrev_b32 v144, 16, v96
    v_and_b32 v145, 0xffff0000, v96
    v_lshlrev_b32 v146, 16, v97
    v_and_b32 v147, 0xffff0000, v97
    v_lshlrev_b32 v148, 16, v98
    v_and_b32 v149, 0xffff0000, v98
    v_lshlrev_b32 v150, 16, v99
    v_and_b32 v151, 0xffff0000, v99
    v_lshlrev_b32 v152, 16, v100
    v_and_b32 v153, 0xffff0000, v100
    v_lshlrev_b32 v154, 16, v101
    v_and_b32 v155, 0xffff0000, v101
    v_lshlrev_b32 v156, 16, v102
    v_and_b32 v157, 0xffff0000, v102
    v_lshlrev_b32 v158, 16, v103
    v_and_b32 v159, 0xffff0000, v103
    v_pk_add_f32 v[144:145], v[144:145], v[152:153]
    v_pk_add_f32 v[146:147], v[146:147], v[154:155]
    v_pk_add_f32 v[148:149], v[148:149], v[156:157]
    v_pk_add_f32 v[150:151], v[150:151], v[158:159]
    v_lshlrev_b32 v152, 16, v104
    v_and_b32 v153, 0xffff0000, v104
    v_lshlrev_b32 v154, 16, v105
    v_and_b32 v155, 0xffff0000, v105
    v_lshlrev_b32 v156, 16, v106
    v_and_b32 v157, 0xffff0000, v106
    v_lshlrev_b32 v158, 16, v107
    v_and_b32 v159, 0xffff0000, v107
    v_pk_add_f32 v[144:145], v[144:145], v[152:153]
    v_pk_add_f32 v[146:147], v[146:147], v[154:155]
    v_pk_add_f32 v[148:149], v[148:149], v[156:157]
    v_pk_add_f32 v[150:151], v[150:151], v[158:159]
    v_lshlrev_b32 v152, 16, v108
    v_and_b32 v153, 0xffff0000, v108
    v_lshlrev_b32 v154, 16, v109
    v_and_b32 v155, 0xffff0000, v109
    v_lshlrev_b32 v156, 16, v110
    v_and_b32 v157, 0xffff0000, v110
    v_lshlrev_b32 v158, 16, v111
    v_and_b32 v159, 0xffff0000, v111
    v_pk_add_f32 v[144:145], v[144:145], v[152:153]
    v_pk_add_f32 v[146:147], v[146:147], v[154:155]
    v_pk_add_f32 v[148:149], v[148:149], v[156:157]
    v_pk_add_f32 v[150:151], v[150:151], v[158:159]
    v_add_f32_dpp v144, v144, v144 row_ror:8 row_mask:0xf bank_mask:0xf
    v_add_f32_dpp v145, v145, v145 row_ror:8 row_mask:0xf bank_mask:0xf
    v_add_f32_dpp v146, v146, v146 row_ror:8 row_mask:0xf bank_mask:0xf
    v_add_f32_dpp v147, v147, v147 row_ror:8 row_mask:0xf bank_mask:0xf
    v_add_f32_dpp v148, v148, v148 row_ror:8 row_mask:0xf bank_mask:0xf
    v_add_f32_dpp v149, v149, v149 row_ror:8 row_mask:0xf bank_mask:0xf
    v_add_f32_dpp v150, v150, v150 row_ror:8 row_mask:0xf bank_mask:0xf
    v_add_f32_dpp v151, v151, v151 row_ror:8 row_mask:0xf bank_mask:0xf
    v_mov_b32 v152, v144
    v_mov_b32 v153, v145
    v_mov_b32 v154, v146
    v_mov_b32 v155, v147
    v_mov_b32 v156, v148
    v_mov_b32 v157, v149
    v_mov_b32 v158, v150
    v_mov_b32 v159, v151
    v_permlane16_swap_b32 v144, v152
    v_permlane16_swap_b32 v145, v153
    v_permlane16_swap_b32 v146, v154
    v_permlane16_swap_b32 v147, v155
    v_permlane16_swap_b32 v148, v156
    v_permlane16_swap_b32 v149, v157
    v_permlane16_swap_b32 v150, v158
    v_permlane16_swap_b32 v151, v159
    v_add_f32 v144, v144, v152
    v_add_f32 v145, v145, v153
    v_add_f32 v146, v146, v154
    v_add_f32 v147, v147, v155
    v_add_f32 v148, v148, v156
    v_add_f32 v149, v149, v157
    v_add_f32 v150, v150, v158
    v_add_f32 v151, v151, v159
    v_mov_b32 v152, v144
    v_mov_b32 v153, v145
    v_mov_b32 v154, v146
    v_mov_b32 v155, v147
    v_mov_b32 v156, v148
    v_mov_b32 v157, v149
    v_mov_b32 v158, v150
    v_mov_b32 v159, v151
    v_permlane32_swap_b32 v144, v152
    v_permlane32_swap_b32 v145, v153
    v_permlane32_swap_b32 v146, v154
    v_permlane32_swap_b32 v147, v155
    v_permlane32_swap_b32 v148, v156
    v_permlane32_swap_b32 v149, v157
    v_permlane32_swap_b32 v150, v158
    v_permlane32_swap_b32 v151, v159
    v_add_f32 v144, v144, v152
    v_add_f32 v145, v145, v153
    v_add_f32 v146, v146, v154
    v_add_f32 v147, v147, v155
    v_add_f32 v148, v148, v156
    v_add_f32 v149, v149, v157
    v_add_f32 v150, v150, v158
    v_add_f32 v151, v151, v159
    s_mov_b64 exec, 0xff
    ds_write_b128 v22, v[144:147] offset:2048
    ds_write_b128 v22, v[148:151] offset:2064
    s_mov_b64 exec, -1
    s_waitcnt vmcnt(4)
    v_lshlrev_b32 v144, 16, v112
    v_and_b32 v145, 0xffff0000, v112
    v_lshlrev_b32 v146, 16, v113
    v_and_b32 v147, 0xffff0000, v113
    v_lshlrev_b32 v148, 16, v114
    v_and_b32 v149, 0xffff0000, v114
    v_lshlrev_b32 v150, 16, v115
    v_and_b32 v151, 0xffff0000, v115
    v_lshlrev_b32 v152, 16, v116
    v_and_b32 v153, 0xffff0000, v116
    v_lshlrev_b32 v154, 16, v117
    v_and_b32 v155, 0xffff0000, v117
    v_lshlrev_b32 v156, 16, v118
    v_and_b32 v157, 0xffff0000, v118
    v_lshlrev_b32 v158, 16, v119
    v_and_b32 v159, 0xffff0000, v119
    v_pk_add_f32 v[144:145], v[144:145], v[152:153]
    v_pk_add_f32 v[146:147], v[146:147], v[154:155]
    v_pk_add_f32 v[148:149], v[148:149], v[156:157]
    v_pk_add_f32 v[150:151], v[150:151], v[158:159]
    v_lshlrev_b32 v152, 16, v120
    v_and_b32 v153, 0xffff0000, v120
    v_lshlrev_b32 v154, 16, v121
    v_and_b32 v155, 0xffff0000, v121
    v_lshlrev_b32 v156, 16, v122
    v_and_b32 v157, 0xffff0000, v122
    v_lshlrev_b32 v158, 16, v123
    v_and_b32 v159, 0xffff0000, v123
    v_pk_add_f32 v[144:145], v[144:145], v[152:153]
    v_pk_add_f32 v[146:147], v[146:147], v[154:155]
    v_pk_add_f32 v[148:149], v[148:149], v[156:157]
    v_pk_add_f32 v[150:151], v[150:151], v[158:159]
    v_lshlrev_b32 v152, 16, v124
    v_and_b32 v153, 0xffff0000, v124
    v_lshlrev_b32 v154, 16, v125
    v_and_b32 v155, 0xffff0000, v125
    v_lshlrev_b32 v156, 16, v126
    v_and_b32 v157, 0xffff0000, v126
    v_lshlrev_b32 v158, 16, v127
    v_and_b32 v159, 0xffff0000, v127
    v_pk_add_f32 v[144:145], v[144:145], v[152:153]
    v_pk_add_f32 v[146:147], v[146:147], v[154:155]
    v_pk_add_f32 v[148:149], v[148:149], v[156:157]
    v_pk_add_f32 v[150:151], v[150:151], v[158:159]
    v_add_f32_dpp v144, v144, v144 row_ror:8 row_mask:0xf bank_mask:0xf
    v_add_f32_dpp v145, v145, v145 row_ror:8 row_mask:0xf bank_mask:0xf
    v_add_f32_dpp v146, v146, v146 row_ror:8 row_mask:0xf bank_mask:0xf
    v_add_f32_dpp v147, v147, v147 row_ror:8 row_mask:0xf bank_mask:0xf
    v_add_f32_dpp v148, v148, v148 row_ror:8 row_mask:0xf bank_mask:0xf
    v_add_f32_dpp v149, v149, v149 row_ror:8 row_mask:0xf bank_mask:0xf
    v_add_f32_dpp v150, v150, v150 row_ror:8 row_mask:0xf bank_mask:0xf
    v_add_f32_dpp v151, v151, v151 row_ror:8 row_mask:0xf bank_mask:0xf
    v_mov_b32 v152, v144
    v_mov_b32 v153, v145
    v_mov_b32 v154, v146
    v_mov_b32 v155, v147
    v_mov_b32 v156, v148
    v_mov_b32 v157, v149
    v_mov_b32 v158, v150
    v_mov_b32 v159, v151
    v_permlane16_swap_b32 v144, v152
    v_permlane16_swap_b32 v145, v153
    v_permlane16_swap_b32 v146, v154
    v_permlane16_swap_b32 v147, v155
    v_permlane16_swap_b32 v148, v156
    v_permlane16_swap_b32 v149, v157
    v_permlane16_swap_b32 v150, v158
    v_permlane16_swap_b32 v151, v159
    v_add_f32 v144, v144, v152
    v_add_f32 v145, v145, v153
    v_add_f32 v146, v146, v154
    v_add_f32 v147, v147, v155
    v_add_f32 v148, v148, v156
    v_add_f32 v149, v149, v157
    v_add_f32 v150, v150, v158
    v_add_f32 v151, v151, v159
    v_mov_b32 v152, v144
    v_mov_b32 v153, v145
    v_mov_b32 v154, v146
    v_mov_b32 v155, v147
    v_mov_b32 v156, v148
    v_mov_b32 v157, v149
    v_mov_b32 v158, v150
    v_mov_b32 v159, v151
    v_permlane32_swap_b32 v144, v152
    v_permlane32_swap_b32 v145, v153
    v_permlane32_swap_b32 v146, v154
    v_permlane32_swap_b32 v147, v155
    v_permlane32_swap_b32 v148, v156
    v_permlane32_swap_b32 v149, v157
    v_permlane32_swap_b32 v150, v158
    v_permlane32_swap_b32 v151, v159
    v_add_f32 v144, v144, v152
    v_add_f32 v145, v145, v153
    v_add_f32 v146, v146, v154
    v_add_f32 v147, v147, v155
    v_add_f32 v148, v148, v156
    v_add_f32 v149, v149, v157
    v_add_f32 v150, v150, v158
    v_add_f32 v151, v151, v159
    s_mov_b64 exec, 0xff
    ds_write_b128 v22, v[144:147] offset:3072
    ds_write_b128 v22, v[148:151] offset:3088
    s_mov_b64 exec, -1
    s_waitcnt vmcnt(0)
    v_lshlrev_b32 v144, 16, v128
    v_and_b32 v145, 0xffff0000, v128
    v_lshlrev_b32 v146, 16, v129
    v_and_b32 v147, 0xffff0000, v129
    v_lshlrev_b32 v148, 16, v130
    v_and_b32 v149, 0xffff0000, v130
    v_lshlrev_b32 v150, 16, v131
    v_and_b32 v151, 0xffff0000, v131
    v_lshlrev_b32 v152, 16, v132
    v_and_b32 v153, 0xffff0000, v132
    v_lshlrev_b32 v154, 16, v133
    v_and_b32 v155, 0xffff0000, v133
    v_lshlrev_b32 v156, 16, v134
    v_and_b32 v157, 0xffff0000, v134
    v_lshlrev_b32 v158, 16, v135
    v_and_b32 v159, 0xffff0000, v135
    v_pk_add_f32 v[144:145], v[144:145], v[152:153]
    v_pk_add_f32 v[146:147], v[146:147], v[154:155]
    v_pk_add_f32 v[148:149], v[148:149], v[156:157]
    v_pk_add_f32 v[150:151], v[150:151], v[158:159]
    v_lshlrev_b32 v152, 16, v136
    v_and_b32 v153, 0xffff0000, v136
    v_lshlrev_b32 v154, 16, v137
    v_and_b32 v155, 0xffff0000, v137
    v_lshlrev_b32 v156, 16, v138
    v_and_b32 v157, 0xffff0000, v138
    v_lshlrev_b32 v158, 16, v139
    v_and_b32 v159, 0xffff0000, v139
    v_pk_add_f32 v[144:145], v[144:145], v[152:153]
    v_pk_add_f32 v[146:147], v[146:147], v[154:155]
    v_pk_add_f32 v[148:149], v[148:149], v[156:157]
    v_pk_add_f32 v[150:151], v[150:151], v[158:159]
    v_lshlrev_b32 v152, 16, v140
    v_and_b32 v153, 0xffff0000, v140
    v_lshlrev_b32 v154, 16, v141
    v_and_b32 v155, 0xffff0000, v141
    v_lshlrev_b32 v156, 16, v142
    v_and_b32 v157, 0xffff0000, v142
    v_lshlrev_b32 v158, 16, v143
    v_and_b32 v159, 0xffff0000, v143
    v_pk_add_f32 v[144:145], v[144:145], v[152:153]
    v_pk_add_f32 v[146:147], v[146:147], v[154:155]
    v_pk_add_f32 v[148:149], v[148:149], v[156:157]
    v_pk_add_f32 v[150:151], v[150:151], v[158:159]
    v_add_f32_dpp v144, v144, v144 row_ror:8 row_mask:0xf bank_mask:0xf
    v_add_f32_dpp v145, v145, v145 row_ror:8 row_mask:0xf bank_mask:0xf
    v_add_f32_dpp v146, v146, v146 row_ror:8 row_mask:0xf bank_mask:0xf
    v_add_f32_dpp v147, v147, v147 row_ror:8 row_mask:0xf bank_mask:0xf
    v_add_f32_dpp v148, v148, v148 row_ror:8 row_mask:0xf bank_mask:0xf
    v_add_f32_dpp v149, v149, v149 row_ror:8 row_mask:0xf bank_mask:0xf
    v_add_f32_dpp v150, v150, v150 row_ror:8 row_mask:0xf bank_mask:0xf
    v_add_f32_dpp v151, v151, v151 row_ror:8 row_mask:0xf bank_mask:0xf
    v_mov_b32 v152, v144
    v_mov_b32 v153, v145
    v_mov_b32 v154, v146
    v_mov_b32 v155, v147
    v_mov_b32 v156, v148
    v_mov_b32 v157, v149
    v_mov_b32 v158, v150
    v_mov_b32 v159, v151
    v_permlane16_swap_b32 v144, v152
    v_permlane16_swap_b32 v145, v153
    v_permlane16_swap_b32 v146, v154
    v_permlane16_swap_b32 v147, v155
    v_permlane16_swap_b32 v148, v156
    v_permlane16_swap_b32 v149, v157
    v_permlane16_swap_b32 v150, v158
    v_permlane16_swap_b32 v151, v159
    v_add_f32 v144, v144, v152
    v_add_f32 v145, v145, v153
    v_add_f32 v146, v146, v154
    v_add_f32 v147, v147, v155
    v_add_f32 v148, v148, v156
    v_add_f32 v149, v149, v157
    v_add_f32 v150, v150, v158
    v_add_f32 v151, v151, v159
    v_mov_b32 v152, v144
    v_mov_b32 v153, v145
    v_mov_b32 v154, v146
    v_mov_b32 v155, v147
    v_mov_b32 v156, v148
    v_mov_b32 v157, v149
    v_mov_b32 v158, v150
    v_mov_b32 v159, v151
    v_permlane32_swap_b32 v144, v152
    v_permlane32_swap_b32 v145, v153
    v_permlane32_swap_b32 v146, v154
    v_permlane32_swap_b32 v147, v155
    v_permlane32_swap_b32 v148, v156
    v_permlane32_swap_b32 v149, v157
    v_permlane32_swap_b32 v150, v158
    v_permlane32_swap_b32 v151, v159
    v_add_f32 v144, v144, v152
    v_add_f32 v145, v145, v153
    v_add_f32 v146, v146, v154
    v_add_f32 v147, v147, v155
    v_add_f32 v148, v148, v156
    v_add_f32 v149, v149, v157
    v_add_f32 v150, v150, v158
    v_add_f32 v151, v151, v159
    s_mov_b64 exec, 0xff
    ds_write_b128 v22, v[144:147] offset:4096
    ds_write_b128 v22, v[148:151] offset:4112
    s_mov_b64 exec, -1
    s_waitcnt lgkmcnt(0)
    s_barrier
    v_lshlrev_b32 v23, 2, v1
    v_add_u32 v22, 65536, v23
    ds_read_b32 v64, v22 offset:0
    ds_read_b32 v65, v22 offset:256
    ds_read_b32 v66, v22 offset:512
    ds_read_b32 v67, v22 offset:768
    ds_read_b32 v68, v22 offset:1024
    ds_read_b32 v69, v22 offset:1280
    ds_read_b32 v70, v22 offset:1536
    ds_read_b32 v71, v22 offset:1792
    ds_read_b32 v72, v22 offset:2048
    ds_read_b32 v73, v22 offset:2304
    ds_read_b32 v74, v22 offset:2560
    ds_read_b32 v75, v22 offset:2816
    ds_read_b32 v76, v22 offset:3072
    ds_read_b32 v77, v22 offset:3328
    ds_read_b32 v78, v22 offset:3584
    ds_read_b32 v79, v22 offset:3840
    ds_read_b32 v80, v22 offset:4096
    ds_read_b32 v81, v22 offset:4352
    ds_read_b32 v82, v22 offset:4608
    ds_read_b32 v83, v22 offset:4864
    v_mov_b32 v25, 1073741824
    v_cmp_gt_u32 vcc, 64, v0
    s_nop 1
    v_cndmask_b32 v23, v25, v23, vcc
    s_waitcnt lgkmcnt(0)
    v_add_f32 v64, v64, v65
    v_add_f32 v66, v66, v67
    v_add_f32 v64, v64, v66
    s_add_u32 s44, s72, 0
    s_mul_i32 s79, s44, 2428
    s_lshr_b32 s79, s79, 16
    s_mul_i32 s45, s79, 27
    s_sub_u32 s78, s44, s45
    s_mul_i32 s46, s79, 6912
    s_lshl_b32 s45, s78, 8
    s_add_u32 s46, s46, s45
    s_add_u32 s46, s46, 45056
    s_cmp_lt_u32 s44, 135
    s_cselect_b32 s46, s46, 1073741824
    buffer_store_dword v64, v23, s[28:31], s46 offen sc1
    v_add_f32 v68, v68, v69
    v_add_f32 v70, v70, v71
    v_add_f32 v68, v68, v70
    s_add_u32 s44, s72, 32
    s_mul_i32 s79, s44, 2428
    s_lshr_b32 s79, s79, 16
    s_mul_i32 s45, s79, 27
    s_sub_u32 s78, s44, s45
    s_mul_i32 s46, s79, 6912
    s_lshl_b32 s45, s78, 8
    s_add_u32 s46, s46, s45
    s_add_u32 s46, s46, 45056
    s_cmp_lt_u32 s44, 135
    s_cselect_b32 s46, s46, 1073741824
    buffer_store_dword v68, v23, s[28:31], s46 offen sc1
    v_add_f32 v72, v72, v73
    v_add_f32 v74, v74, v75
    v_add_f32 v72, v72, v74
    s_add_u32 s44, s72, 64
    s_mul_i32 s79, s44, 2428
    s_lshr_b32 s79, s79, 16
    s_mul_i32 s45, s79, 27
    s_sub_u32 s78, s44, s45
    s_mul_i32 s46, s79, 6912
    s_lshl_b32 s45, s78, 8
    s_add_u32 s46, s46, s45
    s_add_u32 s46, s46, 45056
    s_cmp_lt_u32 s44, 135
    s_cselect_b32 s46, s46, 1073741824
    buffer_store_dword v72, v23, s[28:31], s46 offen sc1
    v_add_f32 v76, v76, v77
    v_add_f32 v78, v78, v79
    v_add_f32 v76, v76, v78
    s_add_u32 s44, s72, 96
    s_mul_i32 s79, s44, 2428
    s_lshr_b32 s79, s79, 16
    s_mul_i32 s45, s79, 27
    s_sub_u32 s78, s44, s45
    s_mul_i32 s46, s79, 6912
    s_lshl_b32 s45, s78, 8
    s_add_u32 s46, s46, s45
    s_add_u32 s46, s46, 45056
    s_cmp_lt_u32 s44, 135
    s_cselect_b32 s46, s46, 1073741824
    buffer_store_dword v76, v23, s[28:31], s46 offen sc1
    v_add_f32 v80, v80, v81
    v_add_f32 v82, v82, v83
    v_add_f32 v80, v80, v82
    s_add_u32 s44, s72, 128
    s_mul_i32 s79, s44, 2428
    s_lshr_b32 s79, s79, 16
    s_mul_i32 s45, s79, 27
    s_sub_u32 s78, s44, s45
    s_mul_i32 s46, s79, 6912
    s_lshl_b32 s45, s78, 8
    s_add_u32 s46, s46, s45
    s_add_u32 s46, s46, 45056
    s_cmp_lt_u32 s44, 135
    s_cselect_b32 s46, s46, 1073741824
    buffer_store_dword v80, v23, s[28:31], s46 offen sc1
    s_waitcnt vmcnt(0)
    s_barrier
    s_add_u32 s44, s72, 0
    s_mul_i32 s79, s44, 2428
    s_lshr_b32 s79, s79, 16
    s_mul_i32 s45, s79, 27
    s_sub_u32 s78, s44, s45
    s_mul_i32 s46, s78, 8
    s_add_u32 s46, s46, s79
    s_lshl_b32 s46, s46, 7
    s_add_u32 s46, s46, 27418624
    s_cmp_lt_u32 s44, 135
    s_cselect_b32 s46, s46, 1073741824
    buffer_store_dwordx4 v[244:247], v243, s[28:31], s46 offen sc1
    s_add_u32 s44, s72, 32
    s_mul_i32 s79, s44, 2428
    s_lshr_b32 s79, s79, 16
    s_mul_i32 s45, s79, 27
    s_sub_u32 s78, s44, s45
    s_mul_i32 s46, s78, 8
    s_add_u32 s46, s46, s79
    s_lshl_b32 s46, s46, 7
    s_add_u32 s46, s46, 27418624
    s_cmp_lt_u32 s44, 135
    s_cselect_b32 s46, s46, 1073741824
    buffer_store_dwordx4 v[244:247], v243, s[28:31], s46 offen sc1
    s_add_u32 s44, s72, 64
    s_mul_i32 s79, s44, 2428
    s_lshr_b32 s79, s79, 16
    s_mul_i32 s45, s79, 27
    s_sub_u32 s78, s44, s45
    s_mul_i32 s46, s78, 8
    s_add_u32 s46, s46, s79
    s_lshl_b32 s46, s46, 7
    s_add_u32 s46, s46, 27418624
    s_cmp_lt_u32 s44, 135
    s_cselect_b32 s46, s46, 1073741824
    buffer_store_dwordx4 v[244:247], v243, s[28:31], s46 offen sc1
    s_add_u32 s44, s72, 96
    s_mul_i32 s79, s44, 2428
    s_lshr_b32 s79, s79, 16
    s_mul_i32 s45, s79, 27
    s_sub_u32 s78, s44, s45
    s_mul_i32 s46, s78, 8
    s_add_u32 s46, s46, s79
    s_lshl_b32 s46, s46, 7
    s_add_u32 s46, s46, 27418624
    s_cmp_lt_u32 s44, 135
    s_cselect_b32 s46, s46, 1073741824
    buffer_store_dwordx4 v[244:247], v243, s[28:31], s46 offen sc1
    s_add_u32 s44, s72, 128
    s_mul_i32 s79, s44, 2428
    s_lshr_b32 s79, s79, 16
    s_mul_i32 s45, s79, 27
    s_sub_u32 s78, s44, s45
    s_mul_i32 s46, s78, 8
    s_add_u32 s46, s46, s79
    s_lshl_b32 s46, s46, 7
    s_add_u32 s46, s46, 27418624
    s_cmp_lt_u32 s44, 135
    s_cselect_b32 s46, s46, 1073741824
    buffer_store_dwordx4 v[244:247], v243, s[28:31], s46 offen sc1
    s_cmp_eq_u32 s43, 15
    s_cbranch_scc1 L_h15
    s_sub_u32 s83, s43, 4
    s_lshl_b32 s83, s83, 1
    s_mov_b32 s32, s18
    s_mov_b32 s33, s19
    s_mov_b32 s34, 2211840
    s_mov_b32 s35, 0x20000
    v_lshrrev_b32 v22, 4, v1
    v_and_b32 v23, 15, v1
    v_lshlrev_b32 v24, 1, v22
    v_xor_b32 v23, v23, v24
    v_mul_u32_u24 v22, 3456, v22
    v_lshl_add_u32 v14, v23, 4, v22
    v_xor_b32 v23, 8, v23
    v_lshl_add_u32 v15, v23, 4, v22
    v_add_u32 v16, 25600, v14
    v_add_u32 v17, 38400, v15
    v_add_u32 v15, 12800, v15
    s_lshl_b32 s53, s41, 12
    s_lshl_b32 s78, s83, 7
    s_lshl_b32 s44, s41, 4
    s_mul_i32 s44, s44, 3456
    s_add_u32 s51, s44, s78
    s_mov_b32 s50, 0
    s_mul_i32 s55, s50, 221184
    s_add_u32 s55, s55, s51
    s_mov_b32 s90, 2211840
    s_add_u32 s90, s90, s51
    s_add_u32 m0, s53, 0
    s_nop 0
    buffer_load_dwordx4 v14, s[32:35], s55 offen offset:0 lds
    buffer_load_dwordx4 v15, s[32:35], s55 offen offset:1024 lds
    buffer_load_dwordx4 v16, s[32:35], s55 offen offset:2048 lds
    buffer_load_dwordx4 v17, s[32:35], s55 offen offset:3072 lds
    s_add_u32 s55, s55, 221184
    s_mov_b32 s91, 1073741824
    s_branch L_p3b
L_h15:
    s_min_u32 s83, s43, 4
    s_add_u32 s83, s83, 22
    s_mov_b32 s32, s18
    s_mov_b32 s33, s19
    s_mov_b32 s34, 2211840
    s_mov_b32 s35, 0x20000
    v_lshrrev_b32 v16, 3, v1
    v_and_b32 v17, 7, v1
    v_and_b32 v18, 6, v16
    v_xor_b32 v17, v17, v18
    v_mul_u32_u24 v16, 3456, v16
    v_lshl_add_u32 v14, v17, 4, v16
    v_add_u32 v15, 26624, v14
    s_lshl_b32 s53, s41, 11
    s_lshl_b32 s78, s83, 7
    s_lshl_b32 s44, s41, 4
    s_mul_i32 s44, s44, 3456
    s_add_u32 s51, s44, s78
    s_mov_b32 s50, 0
    s_mul_i32 s55, s50, 221184
    s_add_u32 s55, s55, s51
    s_mov_b32 s90, 2211840
    s_add_u32 s90, s90, s51
    s_add_u32 m0, s53, 49152
    s_nop 0
    buffer_load_dwordx4 v14, s[32:35], s55 offen lds
    buffer_load_dwordx4 v15, s[32:35], s55 offen offset:1024 lds
    s_add_u32 s55, s55, 221184
    s_add_u32 m0, s53, 57344
    s_nop 0
    buffer_load_dwordx4 v14, s[32:35], s55 offen lds
    buffer_load_dwordx4 v15, s[32:35], s55 offen offset:1024 lds
    s_add_u32 s55, s55, 221184
    s_add_u32 m0, s53, 65536
    s_nop 0
    buffer_load_dwordx4 v14, s[32:35], s55 offen lds
    buffer_load_dwordx4 v15, s[32:35], s55 offen offset:1024 lds
    s_add_u32 s55, s55, 221184
    s_add_u32 m0, s53, 73728
    s_nop 0
    buffer_load_dwordx4 v14, s[32:35], s55 offen lds
    buffer_load_dwordx4 v15, s[32:35], s55 offen offset:1024 lds
    s_add_u32 s55, s55, 221184
    s_add_u32 m0, s53, 81920
    s_nop 0
    buffer_load_dwordx4 v14, s[32:35], s55 offen lds
    buffer_load_dwordx4 v15, s[32:35], s55 offen offset:1024 lds
    s_add_u32 s55, s55, 221184
    s_add_u32 m0, s53, 90112
    s_nop 0
    buffer_load_dwordx4 v14, s[32:35], s55 offen lds
    buffer_load_dwordx4 v15, s[32:35], s55 offen offset:1024 lds
    s_add_u32 s55, s55, 221184
    s_add_u32 m0, s53, 98304
    s_nop 0
    buffer_load_dwordx4 v14, s[32:35], s55 offen lds
    buffer_load_dwordx4 v15, s[32:35], s55 offen offset:1024 lds
    s_add_u32 s55, s55, 221184
    s_add_u32 m0, s53, 106496
    s_nop 0
    buffer_load_dwordx4 v14, s[32:35], s55 offen lds
    buffer_load_dwordx4 v15, s[32:35], s55 offen offset:1024 lds
    s_add_u32 s55, s55, 221184
    s_add_u32 m0, s53, 114688
    s_nop 0
    buffer_load_dwordx4 v14, s[32:35], s55 offen lds
    buffer_load_dwordx4 v15, s[32:35], s55 offen offset:1024 lds
    s_add_u32 s55, s55, 221184
    s_add_u32 m0, s53, 122880
    s_nop 0
    buffer_load_dwordx4 v14, s[32:35], s55 offen lds
    buffer_load_dwordx4 v15, s[32:35], s55 offen offset:1024 lds
    s_branch L_p3l
L_kv:
    v_cvt_pk_bf16_f32 v160, v64, v65
    v_cvt_pk_bf16_f32 v161, v66, v67
    v_cvt_pk_bf16_f32 v162, v72, v73
    v_cvt_pk_bf16_f32 v163, v74, v75
    v_cvt_pk_bf16_f32 v164, v80, v81
    v_cvt_pk_bf16_f32 v165, v82, v83
    v_cvt_pk_bf16_f32 v166, v88, v89
    v_cvt_pk_bf16_f32 v167, v90, v91
    v_cvt_pk_bf16_f32 v168, v96, v97
    v_cvt_pk_bf16_f32 v169, v98, v99
    v_mov_b32 v170, 0
    v_mov_b32 v171, 0
    v_cvt_pk_bf16_f32 v200, v104, v105
    v_cvt_pk_bf16_f32 v201, v106, v107
    v_cvt_pk_bf16_f32 v202, v112, v113
    v_cvt_pk_bf16_f32 v203, v114, v115
    v_cvt_pk_bf16_f32 v204, v120, v121
    v_cvt_pk_bf16_f32 v205, v122, v123
    v_cvt_pk_bf16_f32 v206, v128, v129
    v_cvt_pk_bf16_f32 v207, v130, v131
    v_cvt_pk_bf16_f32 v208, v136, v137
    v_cvt_pk_bf16_f32 v209, v138, v139
    v_mov_b32 v210, 0
    v_mov_b32 v211, 0
    v_mov_b32 v210, 0x3f80
    v_cvt_pk_bf16_f32 v180, v68, v69
    v_cvt_pk_bf16_f32 v181, v70, v71
    v_cvt_pk_bf16_f32 v182, v76, v77
    v_cvt_pk_bf16_f32 v183, v78, v79
    v_cvt_pk_bf16_f32 v184, v84, v85
    v_cvt_pk_bf16_f32 v185, v86, v87
    v_cvt_pk_bf16_f32 v186, v92, v93
    v_cvt_pk_bf16_f32 v187, v94, v95
    v_cvt_pk_bf16_f32 v188, v100, v101
    v_cvt_pk_bf16_f32 v189, v102, v103
    v_mov_b32 v190, 0
    v_mov_b32 v191, 0
    v_cvt_pk_bf16_f32 v212, v108, v109
    v_cvt_pk_bf16_f32 v213, v110, v111
    v_cvt_pk_bf16_f32 v214, v116, v117
    v_cvt_pk_bf16_f32 v215, v118, v119
    v_cvt_pk_bf16_f32 v216, v124, v125
    v_cvt_pk_bf16_f32 v217, v126, v127
    v_cvt_pk_bf16_f32 v218, v132, v133
    v_cvt_pk_bf16_f32 v219, v134, v135
    v_cvt_pk_bf16_f32 v220, v140, v141
    v_cvt_pk_bf16_f32 v221, v142, v143
    v_mov_b32 v222, 0
    v_mov_b32 v223, 0
    v_mov_b32 v222, 0x3f80
    v_and_b32 v22, 15, v1
    s_lshl_b32 s44, s41, 5
    v_add_u32 v22, s44, v22
    v_lshrrev_b32 v23, 4, v1
    v_mul_u32_u24 v24, 320, v22
    v_mul_u32_u24 v25, 80, v23
    v_add_u32 v24, v24, v25
    v_add_u32 v24, 0, v24
    v_mul_u32_u24 v26, 192, v22
    v_mul_u32_u24 v25, 48, v23
    v_add_u32 v26, v26, v25
    v_add_u32 v26, 40960, v26
    ds_write_b128 v26, v[200:203] offset:0
    ds_write_b128 v26, v[204:207] offset:16
    ds_write_b128 v26, v[208:211] offset:32
    ds_write_b128 v26, v[212:215] offset:3072
    ds_write_b128 v26, v[216:219] offset:3088
    ds_write_b128 v26, v[220:223] offset:3104
    v_mfma_f32_16x16x32_bf16 v[64:67], a[72:75], v[160:163], 0
    v_mfma_f32_16x16x32_bf16 v[68:71], a[84:87], v[160:163], 0
    v_mfma_f32_16x16x32_bf16 v[72:75], a[96:99], v[160:163], 0
    v_mfma_f32_16x16x32_bf16 v[76:79], a[108:111], v[160:163], 0
    v_mfma_f32_16x16x32_bf16 v[80:83], a[120:123], v[160:163], 0
    v_mfma_f32_16x16x32_bf16 v[64:67], a[76:79], v[164:167], v[64:67]
    v_mfma_f32_16x16x32_bf16 v[68:71], a[88:91], v[164:167], v[68:71]
    v_mfma_f32_16x16x32_bf16 v[72:75], a[100:103], v[164:167], v[72:75]
    v_mfma_f32_16x16x32_bf16 v[76:79], a[112:115], v[164:167], v[76:79]
    v_mfma_f32_16x16x32_bf16 v[80:83], a[124:127], v[164:167], v[80:83]
    v_mfma_f32_16x16x32_bf16 v[64:67], a[80:83], v[168:171], v[64:67]
    v_mfma_f32_16x16x32_bf16 v[68:71], a[92:95], v[168:171], v[68:71]
    v_mfma_f32_16x16x32_bf16 v[72:75], a[104:107], v[168:171], v[72:75]
    v_mfma_f32_16x16x32_bf16 v[76:79], a[116:119], v[168:171], v[76:79]
    v_mfma_f32_16x16x32_bf16 v[80:83], a[128:131], v[168:171], v[80:83]
    s_nop 3
    v_max3_f32 v124, v64, v65, v66
    v_min3_f32 v125, v64, v65, v66
    v_max3_f32 v124, v124, v67, v68
    v_min3_f32 v125, v125, v67, v68
    v_max3_f32 v124, v124, v69, v70
    v_min3_f32 v125, v125, v69, v70
    v_max3_f32 v124, v124, v71, v72
    v_min3_f32 v125, v125, v71, v72
    v_max3_f32 v124, v124, v73, v74
    v_min3_f32 v125, v125, v73, v74
    v_max3_f32 v124, v124, v75, v76
    v_min3_f32 v125, v125, v75, v76
    v_max3_f32 v124, v124, v77, v78
    v_min3_f32 v125, v125, v77, v78
    v_max3_f32 v124, v124, v79, v80
    v_min3_f32 v125, v125, v79, v80
    v_max3_f32 v124, v124, v81, v82
    v_min3_f32 v125, v125, v81, v82
    v_max_f32 v124, v124, v83
    v_min_f32 v125, v125, v83
    v_mul_f32 v126, s60, v124
    v_mul_f32 v128, s60, v125
    v_pk_fma_f32 v[104:105], v[64:65], s[60:61], v[126:127] op_sel_hi:[1,0,0] neg_lo:[0,0,1] neg_hi:[0,0,1]
    v_pk_fma_f32 v[106:107], v[66:67], s[60:61], v[126:127] op_sel_hi:[1,0,0] neg_lo:[0,0,1] neg_hi:[0,0,1]
    v_pk_fma_f32 v[108:109], v[68:69], s[60:61], v[126:127] op_sel_hi:[1,0,0] neg_lo:[0,0,1] neg_hi:[0,0,1]
    v_pk_fma_f32 v[110:111], v[70:71], s[60:61], v[126:127] op_sel_hi:[1,0,0] neg_lo:[0,0,1] neg_hi:[0,0,1]
    v_pk_fma_f32 v[112:113], v[72:73], s[60:61], v[126:127] op_sel_hi:[1,0,0] neg_lo:[0,0,1] neg_hi:[0,0,1]
    v_pk_fma_f32 v[114:115], v[74:75], s[60:61], v[126:127] op_sel_hi:[1,0,0] neg_lo:[0,0,1] neg_hi:[0,0,1]
    v_pk_fma_f32 v[116:117], v[76:77], s[60:61], v[126:127] op_sel_hi:[1,0,0] neg_lo:[0,0,1] neg_hi:[0,0,1]
    v_pk_fma_f32 v[118:119], v[78:79], s[60:61], v[126:127] op_sel_hi:[1,0,0] neg_lo:[0,0,1] neg_hi:[0,0,1]
    v_pk_fma_f32 v[120:121], v[80:81], s[60:61], v[126:127] op_sel_hi:[1,0,0] neg_lo:[0,0,1] neg_hi:[0,0,1]
    v_pk_fma_f32 v[122:123], v[82:83], s[60:61], v[126:127] op_sel_hi:[1,0,0] neg_lo:[0,0,1] neg_hi:[0,0,1]
    v_pk_fma_f32 v[64:65], v[64:65], s[60:61], v[128:129] op_sel_hi:[1,0,0] neg_lo:[1,0,0] neg_hi:[1,0,0]
    v_pk_fma_f32 v[66:67], v[66:67], s[60:61], v[128:129] op_sel_hi:[1,0,0] neg_lo:[1,0,0] neg_hi:[1,0,0]
    v_pk_fma_f32 v[68:69], v[68:69], s[60:61], v[128:129] op_sel_hi:[1,0,0] neg_lo:[1,0,0] neg_hi:[1,0,0]
    v_pk_fma_f32 v[70:71], v[70:71], s[60:61], v[128:129] op_sel_hi:[1,0,0] neg_lo:[1,0,0] neg_hi:[1,0,0]
    v_pk_fma_f32 v[72:73], v[72:73], s[60:61], v[128:129] op_sel_hi:[1,0,0] neg_lo:[1,0,0] neg_hi:[1,0,0]
    v_pk_fma_f32 v[74:75], v[74:75], s[60:61], v[128:129] op_sel_hi:[1,0,0] neg_lo:[1,0,0] neg_hi:[1,0,0]
    v_pk_fma_f32 v[76:77], v[76:77], s[60:61], v[128:129] op_sel_hi:[1,0,0] neg_lo:[1,0,0] neg_hi:[1,0,0]
    v_pk_fma_f32 v[78:79], v[78:79], s[60:61], v[128:129] op_sel_hi:[1,0,0] neg_lo:[1,0,0] neg_hi:[1,0,0]
    v_pk_fma_f32 v[80:81], v[80:81], s[60:61], v[128:129] op_sel_hi:[1,0,0] neg_lo:[1,0,0] neg_hi:[1,0,0]
    v_pk_fma_f32 v[82:83], v[82:83], s[60:61], v[128:129] op_sel_hi:[1,0,0] neg_lo:[1,0,0] neg_hi:[1,0,0]
    v_exp_f32 v104, v104
    v_exp_f32 v105, v105
    v_mfma_f32_16x16x32_bf16 v[84:87], a[72:75], v[180:183], 0
    v_exp_f32 v106, v106
    v_exp_f32 v107, v107
    v_mfma_f32_16x16x32_bf16 v[88:91], a[84:87], v[180:183], 0
    v_exp_f32 v108, v108
    v_exp_f32 v109, v109
    v_mfma_f32_16x16x32_bf16 v[92:95], a[96:99], v[180:183], 0
    v_exp_f32 v110, v110
    v_exp_f32 v111, v111
    v_mfma_f32_16x16x32_bf16 v[96:99], a[108:111], v[180:183], 0
    v_exp_f32 v112, v112
    v_exp_f32 v113, v113
    v_mfma_f32_16x16x32_bf16 v[100:103], a[120:123], v[180:183], 0
    v_exp_f32 v114, v114
    v_exp_f32 v115, v115
    v_mfma_f32_16x16x32_bf16 v[84:87], a[76:79], v[184:187], v[84:87]
    v_exp_f32 v116, v116
    v_exp_f32 v117, v117
    v_mfma_f32_16x16x32_bf16 v[88:91], a[88:91], v[184:187], v[88:91]
    v_exp_f32 v118, v118
    v_exp_f32 v119, v119
    v_mfma_f32_16x16x32_bf16 v[92:95], a[100:103], v[184:187], v[92:95]
    v_exp_f32 v120, v120
    v_exp_f32 v121, v121
    v_mfma_f32_16x16x32_bf16 v[96:99], a[112:115], v[184:187], v[96:99]
    v_exp_f32 v122, v122
    v_exp_f32 v123, v123
    v_mfma_f32_16x16x32_bf16 v[100:103], a[124:127], v[184:187], v[100:103]
    v_exp_f32 v64, v64
    v_exp_f32 v65, v65
    v_mfma_f32_16x16x32_bf16 v[84:87], a[80:83], v[188:191], v[84:87]
    v_exp_f32 v66, v66
    v_exp_f32 v67, v67
    v_mfma_f32_16x16x32_bf16 v[88:91], a[92:95], v[188:191], v[88:91]
    v_exp_f32 v68, v68
    v_exp_f32 v69, v69
    v_mfma_f32_16x16x32_bf16 v[92:95], a[104:107], v[188:191], v[92:95]
    v_exp_f32 v70, v70
    v_exp_f32 v71, v71
    v_mfma_f32_16x16x32_bf16 v[96:99], a[116:119], v[188:191], v[96:99]
    v_exp_f32 v72, v72
    v_exp_f32 v73, v73
    v_mfma_f32_16x16x32_bf16 v[100:103], a[128:131], v[188:191], v[100:103]
    v_exp_f32 v74, v74
    v_exp_f32 v75, v75
    v_exp_f32 v76, v76
    v_exp_f32 v77, v77
    v_exp_f32 v78, v78
    v_exp_f32 v79, v79
    v_exp_f32 v80, v80
    v_exp_f32 v81, v81
    v_exp_f32 v82, v82
    v_exp_f32 v83, v83
    v_pk_add_f32 v[126:127], v[104:105], v[106:107]
    v_pk_add_f32 v[128:129], v[64:65], v[66:67]
    v_pk_add_f32 v[126:127], v[126:127], v[108:109]
    v_pk_add_f32 v[128:129], v[128:129], v[68:69]
    v_pk_add_f32 v[126:127], v[126:127], v[110:111]
    v_pk_add_f32 v[128:129], v[128:129], v[70:71]
    v_pk_add_f32 v[126:127], v[126:127], v[112:113]
    v_pk_add_f32 v[128:129], v[128:129], v[72:73]
    v_pk_add_f32 v[126:127], v[126:127], v[114:115]
    v_pk_add_f32 v[128:129], v[128:129], v[74:75]
    v_pk_add_f32 v[126:127], v[126:127], v[116:117]
    v_pk_add_f32 v[128:129], v[128:129], v[76:77]
    v_pk_add_f32 v[126:127], v[126:127], v[118:119]
    v_pk_add_f32 v[128:129], v[128:129], v[78:79]
    v_pk_add_f32 v[126:127], v[126:127], v[120:121]
    v_pk_add_f32 v[128:129], v[128:129], v[80:81]
    v_pk_add_f32 v[126:127], v[126:127], v[122:123]
    v_pk_add_f32 v[128:129], v[128:129], v[82:83]
    v_add_f32 v126, v126, v127
    v_add_f32 v128, v128, v129
    v_rcp_f32 v126, v126
    v_rcp_f32 v128, v128
    v_pk_mul_f32 v[104:105], v[104:105], v[126:127] op_sel_hi:[1,0]
    v_pk_mul_f32 v[64:65], v[64:65], v[128:129] op_sel_hi:[1,0]
    v_pk_mul_f32 v[106:107], v[106:107], v[126:127] op_sel_hi:[1,0]
    v_pk_mul_f32 v[66:67], v[66:67], v[128:129] op_sel_hi:[1,0]
    v_pk_mul_f32 v[108:109], v[108:109], v[126:127] op_sel_hi:[1,0]
    v_pk_mul_f32 v[68:69], v[68:69], v[128:129] op_sel_hi:[1,0]
    v_pk_mul_f32 v[110:111], v[110:111], v[126:127] op_sel_hi:[1,0]
    v_pk_mul_f32 v[70:71], v[70:71], v[128:129] op_sel_hi:[1,0]
    v_pk_mul_f32 v[112:113], v[112:113], v[126:127] op_sel_hi:[1,0]
    v_pk_mul_f32 v[72:73], v[72:73], v[128:129] op_sel_hi:[1,0]
    v_pk_mul_f32 v[114:115], v[114:115], v[126:127] op_sel_hi:[1,0]
    v_pk_mul_f32 v[74:75], v[74:75], v[128:129] op_sel_hi:[1,0]
    v_pk_mul_f32 v[116:117], v[116:117], v[126:127] op_sel_hi:[1,0]
    v_pk_mul_f32 v[76:77], v[76:77], v[128:129] op_sel_hi:[1,0]
    v_pk_mul_f32 v[118:119], v[118:119], v[126:127] op_sel_hi:[1,0]
    v_pk_mul_f32 v[78:79], v[78:79], v[128:129] op_sel_hi:[1,0]
    v_pk_mul_f32 v[120:121], v[120:121], v[126:127] op_sel_hi:[1,0]
    v_pk_mul_f32 v[80:81], v[80:81], v[128:129] op_sel_hi:[1,0]
    v_pk_mul_f32 v[122:123], v[122:123], v[126:127] op_sel_hi:[1,0]
    v_pk_mul_f32 v[82:83], v[82:83], v[128:129] op_sel_hi:[1,0]
    v_cvt_pk_bf16_f32 v160, v104, v105
    v_cvt_pk_bf16_f32 v161, v106, v107
    v_cvt_pk_bf16_f32 v162, v108, v109
    v_cvt_pk_bf16_f32 v163, v110, v111
    v_cvt_pk_bf16_f32 v164, v112, v113
    v_cvt_pk_bf16_f32 v165, v114, v115
    v_cvt_pk_bf16_f32 v166, v116, v117
    v_cvt_pk_bf16_f32 v167, v118, v119
    v_cvt_pk_bf16_f32 v168, v120, v121
    v_cvt_pk_bf16_f32 v169, v122, v123
    v_cvt_pk_bf16_f32 v170, v64, v65
    v_cvt_pk_bf16_f32 v171, v66, v67
    v_cvt_pk_bf16_f32 v172, v68, v69
    v_cvt_pk_bf16_f32 v173, v70, v71
    v_cvt_pk_bf16_f32 v174, v72, v73
    v_cvt_pk_bf16_f32 v175, v74, v75
    v_cvt_pk_bf16_f32 v176, v76, v77
    v_cvt_pk_bf16_f32 v177, v78, v79
    v_cvt_pk_bf16_f32 v178, v80, v81
    v_cvt_pk_bf16_f32 v179, v82, v83
    ds_write_b128 v24, v[160:163] offset:0
    ds_write_b128 v24, v[164:167] offset:16
    ds_write_b128 v24, v[168:171] offset:32
    ds_write_b128 v24, v[172:175] offset:48
    ds_write_b128 v24, v[176:179] offset:64
    v_max3_f32 v124, v84, v85, v86
    v_min3_f32 v125, v84, v85, v86
    v_max3_f32 v124, v124, v87, v88
    v_min3_f32 v125, v125, v87, v88
    v_max3_f32 v124, v124, v89, v90
    v_min3_f32 v125, v125, v89, v90
    v_max3_f32 v124, v124, v91, v92
    v_min3_f32 v125, v125, v91, v92
    v_max3_f32 v124, v124, v93, v94
    v_min3_f32 v125, v125, v93, v94
    v_max3_f32 v124, v124, v95, v96
    v_min3_f32 v125, v125, v95, v96
    v_max3_f32 v124, v124, v97, v98
    v_min3_f32 v125, v125, v97, v98
    v_max3_f32 v124, v124, v99, v100
    v_min3_f32 v125, v125, v99, v100
    v_max3_f32 v124, v124, v101, v102
    v_min3_f32 v125, v125, v101, v102
    v_max_f32 v124, v124, v103
    v_min_f32 v125, v125, v103
    v_mul_f32 v126, s60, v124
    v_mul_f32 v128, s60, v125
    v_pk_fma_f32 v[104:105], v[84:85], s[60:61], v[126:127] op_sel_hi:[1,0,0] neg_lo:[0,0,1] neg_hi:[0,0,1]
    v_pk_fma_f32 v[106:107], v[86:87], s[60:61], v[126:127] op_sel_hi:[1,0,0] neg_lo:[0,0,1] neg_hi:[0,0,1]
    v_pk_fma_f32 v[108:109], v[88:89], s[60:61], v[126:127] op_sel_hi:[1,0,0] neg_lo:[0,0,1] neg_hi:[0,0,1]
    v_pk_fma_f32 v[110:111], v[90:91], s[60:61], v[126:127] op_sel_hi:[1,0,0] neg_lo:[0,0,1] neg_hi:[0,0,1]
    v_pk_fma_f32 v[112:113], v[92:93], s[60:61], v[126:127] op_sel_hi:[1,0,0] neg_lo:[0,0,1] neg_hi:[0,0,1]
    v_pk_fma_f32 v[114:115], v[94:95], s[60:61], v[126:127] op_sel_hi:[1,0,0] neg_lo:[0,0,1] neg_hi:[0,0,1]
    v_pk_fma_f32 v[116:117], v[96:97], s[60:61], v[126:127] op_sel_hi:[1,0,0] neg_lo:[0,0,1] neg_hi:[0,0,1]
    v_pk_fma_f32 v[118:119], v[98:99], s[60:61], v[126:127] op_sel_hi:[1,0,0] neg_lo:[0,0,1] neg_hi:[0,0,1]
    v_pk_fma_f32 v[120:121], v[100:101], s[60:61], v[126:127] op_sel_hi:[1,0,0] neg_lo:[0,0,1] neg_hi:[0,0,1]
    v_pk_fma_f32 v[122:123], v[102:103], s[60:61], v[126:127] op_sel_hi:[1,0,0] neg_lo:[0,0,1] neg_hi:[0,0,1]
    v_pk_fma_f32 v[84:85], v[84:85], s[60:61], v[128:129] op_sel_hi:[1,0,0] neg_lo:[1,0,0] neg_hi:[1,0,0]
    v_pk_fma_f32 v[86:87], v[86:87], s[60:61], v[128:129] op_sel_hi:[1,0,0] neg_lo:[1,0,0] neg_hi:[1,0,0]
    v_pk_fma_f32 v[88:89], v[88:89], s[60:61], v[128:129] op_sel_hi:[1,0,0] neg_lo:[1,0,0] neg_hi:[1,0,0]
    v_pk_fma_f32 v[90:91], v[90:91], s[60:61], v[128:129] op_sel_hi:[1,0,0] neg_lo:[1,0,0] neg_hi:[1,0,0]
    v_pk_fma_f32 v[92:93], v[92:93], s[60:61], v[128:129] op_sel_hi:[1,0,0] neg_lo:[1,0,0] neg_hi:[1,0,0]
    v_pk_fma_f32 v[94:95], v[94:95], s[60:61], v[128:129] op_sel_hi:[1,0,0] neg_lo:[1,0,0] neg_hi:[1,0,0]
    v_pk_fma_f32 v[96:97], v[96:97], s[60:61], v[128:129] op_sel_hi:[1,0,0] neg_lo:[1,0,0] neg_hi:[1,0,0]
    v_pk_fma_f32 v[98:99], v[98:99], s[60:61], v[128:129] op_sel_hi:[1,0,0] neg_lo:[1,0,0] neg_hi:[1,0,0]
    v_pk_fma_f32 v[100:101], v[100:101], s[60:61], v[128:129] op_sel_hi:[1,0,0] neg_lo:[1,0,0] neg_hi:[1,0,0]
    v_pk_fma_f32 v[102:103], v[102:103], s[60:61], v[128:129] op_sel_hi:[1,0,0] neg_lo:[1,0,0] neg_hi:[1,0,0]
    v_exp_f32 v104, v104
    v_exp_f32 v105, v105
    v_exp_f32 v106, v106
    v_exp_f32 v107, v107
    v_exp_f32 v108, v108
    v_exp_f32 v109, v109
    v_exp_f32 v110, v110
    v_exp_f32 v111, v111
    v_exp_f32 v112, v112
    v_exp_f32 v113, v113
    v_exp_f32 v114, v114
    v_exp_f32 v115, v115
    v_exp_f32 v116, v116
    v_exp_f32 v117, v117
    v_exp_f32 v118, v118
    v_exp_f32 v119, v119
    v_exp_f32 v120, v120
    v_exp_f32 v121, v121
    v_exp_f32 v122, v122
    v_exp_f32 v123, v123
    v_exp_f32 v84, v84
    v_exp_f32 v85, v85
    v_exp_f32 v86, v86
    v_exp_f32 v87, v87
    v_exp_f32 v88, v88
    v_exp_f32 v89, v89
    v_exp_f32 v90, v90
    v_exp_f32 v91, v91
    v_exp_f32 v92, v92
    v_exp_f32 v93, v93
    v_exp_f32 v94, v94
    v_exp_f32 v95, v95
    v_exp_f32 v96, v96
    v_exp_f32 v97, v97
    v_exp_f32 v98, v98
    v_exp_f32 v99, v99
    v_exp_f32 v100, v100
    v_exp_f32 v101, v101
    v_exp_f32 v102, v102
    v_exp_f32 v103, v103
    v_pk_add_f32 v[126:127], v[104:105], v[106:107]
    v_pk_add_f32 v[128:129], v[84:85], v[86:87]
    v_pk_add_f32 v[126:127], v[126:127], v[108:109]
    v_pk_add_f32 v[128:129], v[128:129], v[88:89]
    v_pk_add_f32 v[126:127], v[126:127], v[110:111]
    v_pk_add_f32 v[128:129], v[128:129], v[90:91]
    v_pk_add_f32 v[126:127], v[126:127], v[112:113]
    v_pk_add_f32 v[128:129], v[128:129], v[92:93]
    v_pk_add_f32 v[126:127], v[126:127], v[114:115]
    v_pk_add_f32 v[128:129], v[128:129], v[94:95]
    v_pk_add_f32 v[126:127], v[126:127], v[116:117]
    v_pk_add_f32 v[128:129], v[128:129], v[96:97]
    v_pk_add_f32 v[126:127], v[126:127], v[118:119]
    v_pk_add_f32 v[128:129], v[128:129], v[98:99]
    v_pk_add_f32 v[126:127], v[126:127], v[120:121]
    v_pk_add_f32 v[128:129], v[128:129], v[100:101]
    v_pk_add_f32 v[126:127], v[126:127], v[122:123]
    v_pk_add_f32 v[128:129], v[128:129], v[102:103]
    v_add_f32 v126, v126, v127
    v_add_f32 v128, v128, v129
    v_rcp_f32 v126, v126
    v_rcp_f32 v128, v128
    v_pk_mul_f32 v[104:105], v[104:105], v[126:127] op_sel_hi:[1,0]
    v_pk_mul_f32 v[84:85], v[84:85], v[128:129] op_sel_hi:[1,0]
    v_pk_mul_f32 v[106:107], v[106:107], v[126:127] op_sel_hi:[1,0]
    v_pk_mul_f32 v[86:87], v[86:87], v[128:129] op_sel_hi:[1,0]
    v_pk_mul_f32 v[108:109], v[108:109], v[126:127] op_sel_hi:[1,0]
    v_pk_mul_f32 v[88:89], v[88:89], v[128:129] op_sel_hi:[1,0]
    v_pk_mul_f32 v[110:111], v[110:111], v[126:127] op_sel_hi:[1,0]
    v_pk_mul_f32 v[90:91], v[90:91], v[128:129] op_sel_hi:[1,0]
    v_pk_mul_f32 v[112:113], v[112:113], v[126:127] op_sel_hi:[1,0]
    v_pk_mul_f32 v[92:93], v[92:93], v[128:129] op_sel_hi:[1,0]
    v_pk_mul_f32 v[114:115], v[114:115], v[126:127] op_sel_hi:[1,0]
    v_pk_mul_f32 v[94:95], v[94:95], v[128:129] op_sel_hi:[1,0]
    v_pk_mul_f32 v[116:117], v[116:117], v[126:127] op_sel_hi:[1,0]
    v_pk_mul_f32 v[96:97], v[96:97], v[128:129] op_sel_hi:[1,0]
    v_pk_mul_f32 v[118:119], v[118:119], v[126:127] op_sel_hi:[1,0]
    v_pk_mul_f32 v[98:99], v[98:99], v[128:129] op_sel_hi:[1,0]
    v_pk_mul_f32 v[120:121], v[120:121], v[126:127] op_sel_hi:[1,0]
    v_pk_mul_f32 v[100:101], v[100:101], v[128:129] op_sel_hi:[1,0]
    v_pk_mul_f32 v[122:123], v[122:123], v[126:127] op_sel_hi:[1,0]
    v_pk_mul_f32 v[102:103], v[102:103], v[128:129] op_sel_hi:[1,0]
    v_cvt_pk_bf16_f32 v180, v104, v105
    v_cvt_pk_bf16_f32 v181, v106, v107
    v_cvt_pk_bf16_f32 v182, v108, v109
    v_cvt_pk_bf16_f32 v183, v110, v111
    v_cvt_pk_bf16_f32 v184, v112, v113
    v_cvt_pk_bf16_f32 v185, v114, v115
    v_cvt_pk_bf16_f32 v186, v116, v117
    v_cvt_pk_bf16_f32 v187, v118, v119
    v_cvt_pk_bf16_f32 v188, v120, v121
    v_cvt_pk_bf16_f32 v189, v122, v123
    v_cvt_pk_bf16_f32 v190, v84, v85
    v_cvt_pk_bf16_f32 v191, v86, v87
    v_cvt_pk_bf16_f32 v192, v88, v89
    v_cvt_pk_bf16_f32 v193, v90, v91
    v_cvt_pk_bf16_f32 v194, v92, v93
    v_cvt_pk_bf16_f32 v195, v94, v95
    v_cvt_pk_bf16_f32 v196, v96, v97
    v_cvt_pk_bf16_f32 v197, v98, v99
    v_cvt_pk_bf16_f32 v198, v100, v101
    v_cvt_pk_bf16_f32 v199, v102, v103
    ds_write_b128 v24, v[180:183] offset:5120
    ds_write_b128 v24, v[184:187] offset:5136
    ds_write_b128 v24, v[188:191] offset:5152
    ds_write_b128 v24, v[192:195] offset:5168
    ds_write_b128 v24, v[196:199] offset:5184
    s_waitcnt lgkmcnt(0)
    s_barrier
    v_lshrrev_b32 v22, 2, v1
    v_add_u32 v22, s97, v22
    v_subrev_u32 v22, 1, v22
    v_max_i32 v22, 0, v22
    v_min_i32 v22, 15, v22
    v_and_b32 v23, 3, v1
    v_lshl_add_u32 v22, v22, 2, v23
    v_lshlrev_b32 v22, 7, v22
    v_add_u32 v22, 27295744, v22
    s_mul_i32 s44, s92, 16
    s_add_u32 s44, s44, s93
    s_lshl_b32 s44, s44, 7
    s_add_u32 s44, s44, 27262976
    v_mov_b32 v23, s44
    v_cmp_gt_u32 vcc, 12, v1
    s_nop 1
    v_cndmask_b32 v58, v23, v22, vcc
    buffer_load_dword v59, v58, s[28:31], 0 offen sc1
    v_lshrrev_b32 v22, 2, v1
    v_and_b32 v23, 3, v1
    v_lshlrev_b32 v23, 3, v23
    v_mul_u32_u24 v24, 320, v22
    v_add_u32 v24, v24, v23
    s_mul_i32 s44, s41, 80
    s_add_u32 s44, s44, 0
    v_add_u32 v24, s44, v24
    v_mul_u32_u24 v26, 192, v22
    v_add_u32 v26, v26, v23
    s_mul_i32 s44, s41, 48
    s_add_u32 s44, s44, 40960
    v_add_u32 v26, s44, v26
    ds_read_b64_tr_b16 a[64:65], v24 offset:0
    ds_read_b64_tr_b16 a[66:67], v24 offset:5120
    ds_read_b64_tr_b16 a[68:69], v24 offset:32
    ds_read_b64_tr_b16 a[70:71], v24 offset:5152
    ds_read_b64_tr_b16 a[72:73], v24 offset:64
    ds_read_b64_tr_b16 a[74:75], v24 offset:5184
    ds_read_b64_tr_b16 a[76:77], v26 offset:0
    ds_read_b64_tr_b16 a[78:79], v26 offset:3072
    ds_read_b64_tr_b16 a[80:81], v26 offset:32
    ds_read_b64_tr_b16 a[82:83], v26 offset:3104
    ds_read_b64_tr_b16 a[84:85], v24 offset:10240
    ds_read_b64_tr_b16 a[86:87], v24 offset:15360
    ds_read_b64_tr_b16 a[88:89], v24 offset:10272
    ds_read_b64_tr_b16 a[90:91], v24 offset:15392
    ds_read_b64_tr_b16 a[92:93], v24 offset:10304
    ds_read_b64_tr_b16 a[94:95], v24 offset:15424
    ds_read_b64_tr_b16 a[96:97], v26 offset:6144
    ds_read_b64_tr_b16 a[98:99], v26 offset:9216
    ds_read_b64_tr_b16 a[100:101], v26 offset:6176
    ds_read_b64_tr_b16 a[102:103], v26 offset:9248
    s_waitcnt lgkmcnt(10)
    v_mfma_f32_16x16x32_bf16 v[64:67], a[64:67], a[76:79], 0
    v_mfma_f32_16x16x32_bf16 v[68:71], a[64:67], a[80:83], 0
    v_mfma_f32_16x16x32_bf16 v[72:75], a[68:71], a[76:79], 0
    v_mfma_f32_16x16x32_bf16 v[76:79], a[68:71], a[80:83], 0
    v_mfma_f32_16x16x32_bf16 v[80:83], a[72:75], a[76:79], 0
    v_mfma_f32_16x16x32_bf16 v[84:87], a[72:75], a[80:83], 0
    ds_read_b64_tr_b16 a[104:105], v24 offset:20480
    ds_read_b64_tr_b16 a[106:107], v24 offset:25600
    ds_read_b64_tr_b16 a[108:109], v24 offset:20512
    ds_read_b64_tr_b16 a[110:111], v24 offset:25632
    ds_read_b64_tr_b16 a[112:113], v24 offset:20544
    ds_read_b64_tr_b16 a[114:115], v24 offset:25664
    ds_read_b64_tr_b16 a[116:117], v26 offset:12288
    ds_read_b64_tr_b16 a[118:119], v26 offset:15360
    ds_read_b64_tr_b16 a[120:121], v26 offset:12320
    ds_read_b64_tr_b16 a[122:123], v26 offset:15392
    s_waitcnt lgkmcnt(10)
    v_mfma_f32_16x16x32_bf16 v[64:67], a[84:87], a[96:99], v[64:67]
    v_mfma_f32_16x16x32_bf16 v[68:71], a[84:87], a[100:103], v[68:71]
    v_mfma_f32_16x16x32_bf16 v[72:75], a[88:91], a[96:99], v[72:75]
    v_mfma_f32_16x16x32_bf16 v[76:79], a[88:91], a[100:103], v[76:79]
    v_mfma_f32_16x16x32_bf16 v[80:83], a[92:95], a[96:99], v[80:83]
    v_mfma_f32_16x16x32_bf16 v[84:87], a[92:95], a[100:103], v[84:87]
    ds_read_b64_tr_b16 a[124:125], v24 offset:30720
    ds_read_b64_tr_b16 a[126:127], v24 offset:35840
    ds_read_b64_tr_b16 a[128:129], v24 offset:30752
    ds_read_b64_tr_b16 a[130:131], v24 offset:35872
    ds_read_b64_tr_b16 a[132:133], v24 offset:30784
    ds_read_b64_tr_b16 a[134:135], v24 offset:35904
    ds_read_b64_tr_b16 a[136:137], v26 offset:18432
    ds_read_b64_tr_b16 a[138:139], v26 offset:21504
    ds_read_b64_tr_b16 a[140:141], v26 offset:18464
    ds_read_b64_tr_b16 a[142:143], v26 offset:21536
    s_waitcnt lgkmcnt(10)
    v_mfma_f32_16x16x32_bf16 v[64:67], a[104:107], a[116:119], v[64:67]
    v_mfma_f32_16x16x32_bf16 v[68:71], a[104:107], a[120:123], v[68:71]
    v_mfma_f32_16x16x32_bf16 v[72:75], a[108:111], a[116:119], v[72:75]
    v_mfma_f32_16x16x32_bf16 v[76:79], a[108:111], a[120:123], v[76:79]
    v_mfma_f32_16x16x32_bf16 v[80:83], a[112:115], a[116:119], v[80:83]
    v_mfma_f32_16x16x32_bf16 v[84:87], a[112:115], a[120:123], v[84:87]
    s_waitcnt lgkmcnt(0)
    v_mfma_f32_16x16x32_bf16 v[64:67], a[124:127], a[136:139], v[64:67]
    v_mfma_f32_16x16x32_bf16 v[68:71], a[124:127], a[140:143], v[68:71]
    v_mfma_f32_16x16x32_bf16 v[72:75], a[128:131], a[136:139], v[72:75]
    v_mfma_f32_16x16x32_bf16 v[76:79], a[128:131], a[140:143], v[76:79]
    v_mfma_f32_16x16x32_bf16 v[80:83], a[132:135], a[136:139], v[80:83]
    v_mfma_f32_16x16x32_bf16 v[84:87], a[132:135], a[140:143], v[84:87]
    v_lshrrev_b32 v22, 4, v1
    v_and_b32 v23, 15, v1
    v_mul_u32_u24 v24, 24, v22
    v_add_u32 v24, v24, v23
    v_lshlrev_b32 v24, 4, v24
    v_mov_b32 v25, 1073741824
    v_cmp_gt_u32 vcc, 8, v23
    s_nop 1
    v_cndmask_b32 v27, v25, v24, vcc
    v_cmp_gt_u32 vcc, 2, v22
    s_nop 1
    v_cndmask_b32 v28, v25, v24, vcc
    v_cndmask_b32 v29, v25, v27, vcc
    s_sub_u32 s58, s43, 4
    s_lshl_b32 s44, s58, 2
    s_add_u32 s44, s44, s41
    s_lshl_b32 s45, s42, 5
    s_add_u32 s44, s44, s45
    s_mul_i32 s44, s44, 3840
    s_add_u32 s44, s44, 331776
    buffer_store_dwordx4 v[64:67], v24, s[28:31], s44 offen offset:0 sc1
    buffer_store_dwordx4 v[68:71], v27, s[28:31], s44 offen offset:256 sc1
    buffer_store_dwordx4 v[72:75], v24, s[28:31], s44 offen offset:1536 sc1
    buffer_store_dwordx4 v[76:79], v27, s[28:31], s44 offen offset:1792 sc1
    buffer_store_dwordx4 v[80:83], v28, s[28:31], s44 offen offset:3072 sc1
    buffer_store_dwordx4 v[84:87], v29, s[28:31], s44 offen offset:3328 sc1
    s_mul_i32 s76, s58, 16
    s_add_u32 s76, s76, s42
    s_lshl_b32 s76, s76, 7
    s_add_u32 s76, s76, 27303936
    s_waitcnt vmcnt(6)
    s_mov_b32 s57, 200000
L_cp_6:
    v_cmp_ne_u32 vcc, s40, v59
    s_nop 1
    s_cbranch_vccz L_cd_7
    buffer_load_dword v59, v58, s[28:31], 0 offen sc1
    s_waitcnt vmcnt(0)
    s_sub_u32 s57, s57, 1
    s_cmp_lg_u32 s57, 0
    s_cbranch_scc1 L_cp_6
L_cd_7:
    s_branch L_g2
L_q:
    v_cvt_pk_bf16_f32 v160, v64, v65
    v_cvt_pk_bf16_f32 v161, v66, v67
    v_cvt_pk_bf16_f32 v162, v72, v73
    v_cvt_pk_bf16_f32 v163, v74, v75
    v_cvt_pk_bf16_f32 v164, v80, v81
    v_cvt_pk_bf16_f32 v165, v82, v83
    v_cvt_pk_bf16_f32 v166, v88, v89
    v_cvt_pk_bf16_f32 v167, v90, v91
    v_cvt_pk_bf16_f32 v168, v96, v97
    v_cvt_pk_bf16_f32 v169, v98, v99
    v_mov_b32 v170, 0
    v_mov_b32 v171, 0
    v_cvt_pk_bf16_f32 v180, v68, v69
    v_cvt_pk_bf16_f32 v181, v70, v71
    v_cvt_pk_bf16_f32 v182, v76, v77
    v_cvt_pk_bf16_f32 v183, v78, v79
    v_cvt_pk_bf16_f32 v184, v84, v85
    v_cvt_pk_bf16_f32 v185, v86, v87
    v_cvt_pk_bf16_f32 v186, v92, v93
    v_cvt_pk_bf16_f32 v187, v94, v95
    v_cvt_pk_bf16_f32 v188, v100, v101
    v_cvt_pk_bf16_f32 v189, v102, v103
    v_mov_b32 v190, 0
    v_mov_b32 v191, 0
    v_cvt_pk_bf16_f32 v200, v104, v105
    v_cvt_pk_bf16_f32 v201, v106, v107
    v_cvt_pk_bf16_f32 v202, v112, v113
    v_cvt_pk_bf16_f32 v203, v114, v115
    v_cvt_pk_bf16_f32 v204, v120, v121
    v_cvt_pk_bf16_f32 v205, v122, v123
    v_cvt_pk_bf16_f32 v206, v128, v129
    v_cvt_pk_bf16_f32 v207, v130, v131
    v_cvt_pk_bf16_f32 v208, v136, v137
    v_cvt_pk_bf16_f32 v209, v138, v139
    v_mov_b32 v210, 0
    v_mov_b32 v211, 0
    v_cvt_pk_bf16_f32 v220, v108, v109
    v_cvt_pk_bf16_f32 v221, v110, v111
    v_cvt_pk_bf16_f32 v222, v116, v117
    v_cvt_pk_bf16_f32 v223, v118, v119
    v_cvt_pk_bf16_f32 v224, v124, v125
    v_cvt_pk_bf16_f32 v225, v126, v127
    v_cvt_pk_bf16_f32 v226, v132, v133
    v_cvt_pk_bf16_f32 v227, v134, v135
    v_cvt_pk_bf16_f32 v228, v140, v141
    v_cvt_pk_bf16_f32 v229, v142, v143
    v_mov_b32 v230, 0
    v_mov_b32 v231, 0
    s_lshl_b32 s72, s42, 2
    s_add_u32 s72, s72, s43
    v_lshlrev_b32 v248, 7, v0
    v_mov_b32 v251, 1073741824
    v_cmp_gt_u32 vcc, 14, v0
    s_nop 1
    v_cndmask_b32 v249, v251, v248, vcc
    v_cmp_gt_u32 vcc, 100, v0
    s_nop 1
    v_cndmask_b32 v250, v251, v248, vcc
    s_mul_i32 s79, s72, 12800
    s_mul_i32 s80, s72, 34560
    s_add_u32 s81, s80, 32768
    v_mfma_f32_16x16x32_bf16 v[112:115], a[72:75], v[160:163], 0
    v_mfma_f32_16x16x32_bf16 v[116:119], a[84:87], v[160:163], 0
    v_mfma_f32_16x16x32_bf16 v[120:123], a[96:99], v[160:163], 0
    v_mfma_f32_16x16x32_bf16 v[124:127], a[108:111], v[160:163], 0
    v_mfma_f32_16x16x32_bf16 v[128:131], a[120:123], v[160:163], 0
    v_mfma_f32_16x16x32_bf16 v[112:115], a[76:79], v[164:167], v[112:115]
    v_mfma_f32_16x16x32_bf16 v[116:119], a[88:91], v[164:167], v[116:119]
    v_mfma_f32_16x16x32_bf16 v[120:123], a[100:103], v[164:167], v[120:123]
    v_mfma_f32_16x16x32_bf16 v[124:127], a[112:115], v[164:167], v[124:127]
    v_mfma_f32_16x16x32_bf16 v[128:131], a[124:127], v[164:167], v[128:131]
    v_mfma_f32_16x16x32_bf16 v[112:115], a[80:83], v[168:171], v[112:115]
    v_mfma_f32_16x16x32_bf16 v[116:119], a[92:95], v[168:171], v[116:119]
    v_mfma_f32_16x16x32_bf16 v[120:123], a[104:107], v[168:171], v[120:123]
    v_mfma_f32_16x16x32_bf16 v[124:127], a[116:119], v[168:171], v[124:127]
    v_mfma_f32_16x16x32_bf16 v[128:131], a[128:131], v[168:171], v[128:131]
    s_nop 3
    v_max3_f32 v42, v112, v113, v114
    v_min3_f32 v43, v112, v113, v114
    v_max3_f32 v42, v42, v115, v116
    v_min3_f32 v43, v43, v115, v116
    v_max3_f32 v42, v42, v117, v118
    v_min3_f32 v43, v43, v117, v118
    v_max3_f32 v42, v42, v119, v120
    v_min3_f32 v43, v43, v119, v120
    v_max3_f32 v42, v42, v121, v122
    v_min3_f32 v43, v43, v121, v122
    v_max3_f32 v42, v42, v123, v124
    v_min3_f32 v43, v43, v123, v124
    v_max3_f32 v42, v42, v125, v126
    v_min3_f32 v43, v43, v125, v126
    v_max3_f32 v42, v42, v127, v128
    v_min3_f32 v43, v43, v127, v128
    v_max3_f32 v42, v42, v129, v130
    v_min3_f32 v43, v43, v129, v130
    v_max_f32 v42, v42, v131
    v_min_f32 v43, v43, v131
    v_mul_f32 v44, s60, v42
    v_mul_f32 v46, s60, v43
    v_pk_fma_f32 v[22:23], v[112:113], s[60:61], v[44:45] op_sel_hi:[1,0,0] neg_lo:[0,0,1] neg_hi:[0,0,1]
    v_pk_fma_f32 v[24:25], v[114:115], s[60:61], v[44:45] op_sel_hi:[1,0,0] neg_lo:[0,0,1] neg_hi:[0,0,1]
    v_pk_fma_f32 v[26:27], v[116:117], s[60:61], v[44:45] op_sel_hi:[1,0,0] neg_lo:[0,0,1] neg_hi:[0,0,1]
    v_pk_fma_f32 v[28:29], v[118:119], s[60:61], v[44:45] op_sel_hi:[1,0,0] neg_lo:[0,0,1] neg_hi:[0,0,1]
    v_pk_fma_f32 v[30:31], v[120:121], s[60:61], v[44:45] op_sel_hi:[1,0,0] neg_lo:[0,0,1] neg_hi:[0,0,1]
    v_pk_fma_f32 v[32:33], v[122:123], s[60:61], v[44:45] op_sel_hi:[1,0,0] neg_lo:[0,0,1] neg_hi:[0,0,1]
    v_pk_fma_f32 v[34:35], v[124:125], s[60:61], v[44:45] op_sel_hi:[1,0,0] neg_lo:[0,0,1] neg_hi:[0,0,1]
    v_pk_fma_f32 v[36:37], v[126:127], s[60:61], v[44:45] op_sel_hi:[1,0,0] neg_lo:[0,0,1] neg_hi:[0,0,1]
    v_pk_fma_f32 v[38:39], v[128:129], s[60:61], v[44:45] op_sel_hi:[1,0,0] neg_lo:[0,0,1] neg_hi:[0,0,1]
    v_pk_fma_f32 v[40:41], v[130:131], s[60:61], v[44:45] op_sel_hi:[1,0,0] neg_lo:[0,0,1] neg_hi:[0,0,1]
    v_pk_fma_f32 v[112:113], v[112:113], s[60:61], v[46:47] op_sel_hi:[1,0,0] neg_lo:[1,0,0] neg_hi:[1,0,0]
    v_pk_fma_f32 v[114:115], v[114:115], s[60:61], v[46:47] op_sel_hi:[1,0,0] neg_lo:[1,0,0] neg_hi:[1,0,0]
    v_pk_fma_f32 v[116:117], v[116:117], s[60:61], v[46:47] op_sel_hi:[1,0,0] neg_lo:[1,0,0] neg_hi:[1,0,0]
    v_pk_fma_f32 v[118:119], v[118:119], s[60:61], v[46:47] op_sel_hi:[1,0,0] neg_lo:[1,0,0] neg_hi:[1,0,0]
    v_pk_fma_f32 v[120:121], v[120:121], s[60:61], v[46:47] op_sel_hi:[1,0,0] neg_lo:[1,0,0] neg_hi:[1,0,0]
    v_pk_fma_f32 v[122:123], v[122:123], s[60:61], v[46:47] op_sel_hi:[1,0,0] neg_lo:[1,0,0] neg_hi:[1,0,0]
    v_pk_fma_f32 v[124:125], v[124:125], s[60:61], v[46:47] op_sel_hi:[1,0,0] neg_lo:[1,0,0] neg_hi:[1,0,0]
    v_pk_fma_f32 v[126:127], v[126:127], s[60:61], v[46:47] op_sel_hi:[1,0,0] neg_lo:[1,0,0] neg_hi:[1,0,0]
    v_pk_fma_f32 v[128:129], v[128:129], s[60:61], v[46:47] op_sel_hi:[1,0,0] neg_lo:[1,0,0] neg_hi:[1,0,0]
    v_pk_fma_f32 v[130:131], v[130:131], s[60:61], v[46:47] op_sel_hi:[1,0,0] neg_lo:[1,0,0] neg_hi:[1,0,0]
    v_exp_f32 v22, v22
    v_exp_f32 v23, v23
    v_mfma_f32_16x16x32_bf16 v[132:135], a[72:75], v[180:183], 0
    v_exp_f32 v24, v24
    v_exp_f32 v25, v25
    v_mfma_f32_16x16x32_bf16 v[136:139], a[84:87], v[180:183], 0
    v_exp_f32 v26, v26
    v_exp_f32 v27, v27
    v_mfma_f32_16x16x32_bf16 v[140:143], a[96:99], v[180:183], 0
    v_exp_f32 v28, v28
    v_exp_f32 v29, v29
    v_mfma_f32_16x16x32_bf16 v[144:147], a[108:111], v[180:183], 0
    v_exp_f32 v30, v30
    v_exp_f32 v31, v31
    v_mfma_f32_16x16x32_bf16 v[148:151], a[120:123], v[180:183], 0
    v_exp_f32 v32, v32
    v_exp_f32 v33, v33
    v_mfma_f32_16x16x32_bf16 v[132:135], a[76:79], v[184:187], v[132:135]
    v_exp_f32 v34, v34
    v_exp_f32 v35, v35
    v_mfma_f32_16x16x32_bf16 v[136:139], a[88:91], v[184:187], v[136:139]
    v_exp_f32 v36, v36
    v_exp_f32 v37, v37
    v_mfma_f32_16x16x32_bf16 v[140:143], a[100:103], v[184:187], v[140:143]
    v_exp_f32 v38, v38
    v_exp_f32 v39, v39
    v_mfma_f32_16x16x32_bf16 v[144:147], a[112:115], v[184:187], v[144:147]
    v_exp_f32 v40, v40
    v_exp_f32 v41, v41
    v_mfma_f32_16x16x32_bf16 v[148:151], a[124:127], v[184:187], v[148:151]
    v_exp_f32 v112, v112
    v_exp_f32 v113, v113
    v_mfma_f32_16x16x32_bf16 v[132:135], a[80:83], v[188:191], v[132:135]
    v_exp_f32 v114, v114
    v_exp_f32 v115, v115
    v_mfma_f32_16x16x32_bf16 v[136:139], a[92:95], v[188:191], v[136:139]
    v_exp_f32 v116, v116
    v_exp_f32 v117, v117
    v_mfma_f32_16x16x32_bf16 v[140:143], a[104:107], v[188:191], v[140:143]
    v_exp_f32 v118, v118
    v_exp_f32 v119, v119
    v_mfma_f32_16x16x32_bf16 v[144:147], a[116:119], v[188:191], v[144:147]
    v_exp_f32 v120, v120
    v_exp_f32 v121, v121
    v_mfma_f32_16x16x32_bf16 v[148:151], a[128:131], v[188:191], v[148:151]
    v_exp_f32 v122, v122
    v_exp_f32 v123, v123
    v_exp_f32 v124, v124
    v_exp_f32 v125, v125
    v_exp_f32 v126, v126
    v_exp_f32 v127, v127
    v_exp_f32 v128, v128
    v_exp_f32 v129, v129
    v_exp_f32 v130, v130
    v_exp_f32 v131, v131
    v_pk_add_f32 v[44:45], v[22:23], v[24:25]
    v_pk_add_f32 v[46:47], v[112:113], v[114:115]
    v_pk_add_f32 v[44:45], v[44:45], v[26:27]
    v_pk_add_f32 v[46:47], v[46:47], v[116:117]
    v_pk_add_f32 v[44:45], v[44:45], v[28:29]
    v_pk_add_f32 v[46:47], v[46:47], v[118:119]
    v_pk_add_f32 v[44:45], v[44:45], v[30:31]
    v_pk_add_f32 v[46:47], v[46:47], v[120:121]
    v_pk_add_f32 v[44:45], v[44:45], v[32:33]
    v_pk_add_f32 v[46:47], v[46:47], v[122:123]
    v_pk_add_f32 v[44:45], v[44:45], v[34:35]
    v_pk_add_f32 v[46:47], v[46:47], v[124:125]
    v_pk_add_f32 v[44:45], v[44:45], v[36:37]
    v_pk_add_f32 v[46:47], v[46:47], v[126:127]
    v_pk_add_f32 v[44:45], v[44:45], v[38:39]
    v_pk_add_f32 v[46:47], v[46:47], v[128:129]
    v_pk_add_f32 v[44:45], v[44:45], v[40:41]
    v_pk_add_f32 v[46:47], v[46:47], v[130:131]
    v_add_f32 v44, v44, v45
    v_add_f32 v46, v46, v47
    v_rcp_f32 v44, v44
    v_rcp_f32 v46, v46
    v_pk_mul_f32 v[22:23], v[22:23], v[44:45] op_sel_hi:[1,0]
    v_pk_mul_f32 v[112:113], v[112:113], v[46:47] op_sel_hi:[1,0]
    v_pk_mul_f32 v[24:25], v[24:25], v[44:45] op_sel_hi:[1,0]
    v_pk_mul_f32 v[114:115], v[114:115], v[46:47] op_sel_hi:[1,0]
    v_pk_mul_f32 v[26:27], v[26:27], v[44:45] op_sel_hi:[1,0]
    v_pk_mul_f32 v[116:117], v[116:117], v[46:47] op_sel_hi:[1,0]
    v_pk_mul_f32 v[28:29], v[28:29], v[44:45] op_sel_hi:[1,0]
    v_pk_mul_f32 v[118:119], v[118:119], v[46:47] op_sel_hi:[1,0]
    v_pk_mul_f32 v[30:31], v[30:31], v[44:45] op_sel_hi:[1,0]
    v_pk_mul_f32 v[120:121], v[120:121], v[46:47] op_sel_hi:[1,0]
    v_pk_mul_f32 v[32:33], v[32:33], v[44:45] op_sel_hi:[1,0]
    v_pk_mul_f32 v[122:123], v[122:123], v[46:47] op_sel_hi:[1,0]
    v_pk_mul_f32 v[34:35], v[34:35], v[44:45] op_sel_hi:[1,0]
    v_pk_mul_f32 v[124:125], v[124:125], v[46:47] op_sel_hi:[1,0]
    v_pk_mul_f32 v[36:37], v[36:37], v[44:45] op_sel_hi:[1,0]
    v_pk_mul_f32 v[126:127], v[126:127], v[46:47] op_sel_hi:[1,0]
    s_mov_b32 s36, s10
    s_mov_b32 s37, s11
    s_mov_b32 s38, 819200
    s_mov_b32 s39, 0x20000
    buffer_load_dword v254, v250, s[36:39], s79 offen
    v_pk_mul_f32 v[38:39], v[38:39], v[44:45] op_sel_hi:[1,0]
    v_pk_mul_f32 v[128:129], v[128:129], v[46:47] op_sel_hi:[1,0]
    v_pk_mul_f32 v[40:41], v[40:41], v[44:45] op_sel_hi:[1,0]
    v_pk_mul_f32 v[130:131], v[130:131], v[46:47] op_sel_hi:[1,0]
    v_cvt_pk_bf16_f32 v160, v22, v23
    v_cvt_pk_bf16_f32 v161, v24, v25
    v_cvt_pk_bf16_f32 v162, v26, v27
    v_cvt_pk_bf16_f32 v163, v28, v29
    v_cvt_pk_bf16_f32 v164, v30, v31
    v_cvt_pk_bf16_f32 v165, v32, v33
    v_cvt_pk_bf16_f32 v166, v34, v35
    v_cvt_pk_bf16_f32 v167, v36, v37
    v_cvt_pk_bf16_f32 v168, v38, v39
    v_cvt_pk_bf16_f32 v169, v40, v41
    v_cvt_pk_bf16_f32 v170, v112, v113
    v_cvt_pk_bf16_f32 v171, v114, v115
    v_cvt_pk_bf16_f32 v172, v116, v117
    v_cvt_pk_bf16_f32 v173, v118, v119
    v_cvt_pk_bf16_f32 v174, v120, v121
    v_cvt_pk_bf16_f32 v175, v122, v123
    v_cvt_pk_bf16_f32 v176, v124, v125
    v_cvt_pk_bf16_f32 v177, v126, v127
    v_cvt_pk_bf16_f32 v178, v128, v129
    v_cvt_pk_bf16_f32 v179, v130, v131
    v_max3_f32 v42, v132, v133, v134
    v_min3_f32 v43, v132, v133, v134
    v_max3_f32 v42, v42, v135, v136
    v_min3_f32 v43, v43, v135, v136
    v_max3_f32 v42, v42, v137, v138
    v_min3_f32 v43, v43, v137, v138
    v_max3_f32 v42, v42, v139, v140
    v_min3_f32 v43, v43, v139, v140
    v_max3_f32 v42, v42, v141, v142
    v_min3_f32 v43, v43, v141, v142
    v_max3_f32 v42, v42, v143, v144
    v_min3_f32 v43, v43, v143, v144
    v_max3_f32 v42, v42, v145, v146
    v_min3_f32 v43, v43, v145, v146
    v_max3_f32 v42, v42, v147, v148
    v_min3_f32 v43, v43, v147, v148
    v_max3_f32 v42, v42, v149, v150
    v_min3_f32 v43, v43, v149, v150
    v_max_f32 v42, v42, v151
    v_min_f32 v43, v43, v151
    v_mul_f32 v44, s60, v42
    v_mul_f32 v46, s60, v43
    v_pk_fma_f32 v[22:23], v[132:133], s[60:61], v[44:45] op_sel_hi:[1,0,0] neg_lo:[0,0,1] neg_hi:[0,0,1]
    v_pk_fma_f32 v[24:25], v[134:135], s[60:61], v[44:45] op_sel_hi:[1,0,0] neg_lo:[0,0,1] neg_hi:[0,0,1]
    v_pk_fma_f32 v[26:27], v[136:137], s[60:61], v[44:45] op_sel_hi:[1,0,0] neg_lo:[0,0,1] neg_hi:[0,0,1]
    v_pk_fma_f32 v[28:29], v[138:139], s[60:61], v[44:45] op_sel_hi:[1,0,0] neg_lo:[0,0,1] neg_hi:[0,0,1]
    v_pk_fma_f32 v[30:31], v[140:141], s[60:61], v[44:45] op_sel_hi:[1,0,0] neg_lo:[0,0,1] neg_hi:[0,0,1]
    v_pk_fma_f32 v[32:33], v[142:143], s[60:61], v[44:45] op_sel_hi:[1,0,0] neg_lo:[0,0,1] neg_hi:[0,0,1]
    v_pk_fma_f32 v[34:35], v[144:145], s[60:61], v[44:45] op_sel_hi:[1,0,0] neg_lo:[0,0,1] neg_hi:[0,0,1]
    v_pk_fma_f32 v[36:37], v[146:147], s[60:61], v[44:45] op_sel_hi:[1,0,0] neg_lo:[0,0,1] neg_hi:[0,0,1]
    v_pk_fma_f32 v[38:39], v[148:149], s[60:61], v[44:45] op_sel_hi:[1,0,0] neg_lo:[0,0,1] neg_hi:[0,0,1]
    v_pk_fma_f32 v[40:41], v[150:151], s[60:61], v[44:45] op_sel_hi:[1,0,0] neg_lo:[0,0,1] neg_hi:[0,0,1]
    v_pk_fma_f32 v[132:133], v[132:133], s[60:61], v[46:47] op_sel_hi:[1,0,0] neg_lo:[1,0,0] neg_hi:[1,0,0]
    v_pk_fma_f32 v[134:135], v[134:135], s[60:61], v[46:47] op_sel_hi:[1,0,0] neg_lo:[1,0,0] neg_hi:[1,0,0]
    v_pk_fma_f32 v[136:137], v[136:137], s[60:61], v[46:47] op_sel_hi:[1,0,0] neg_lo:[1,0,0] neg_hi:[1,0,0]
    v_pk_fma_f32 v[138:139], v[138:139], s[60:61], v[46:47] op_sel_hi:[1,0,0] neg_lo:[1,0,0] neg_hi:[1,0,0]
    v_pk_fma_f32 v[140:141], v[140:141], s[60:61], v[46:47] op_sel_hi:[1,0,0] neg_lo:[1,0,0] neg_hi:[1,0,0]
    v_pk_fma_f32 v[142:143], v[142:143], s[60:61], v[46:47] op_sel_hi:[1,0,0] neg_lo:[1,0,0] neg_hi:[1,0,0]
    v_pk_fma_f32 v[144:145], v[144:145], s[60:61], v[46:47] op_sel_hi:[1,0,0] neg_lo:[1,0,0] neg_hi:[1,0,0]
    v_pk_fma_f32 v[146:147], v[146:147], s[60:61], v[46:47] op_sel_hi:[1,0,0] neg_lo:[1,0,0] neg_hi:[1,0,0]
    v_pk_fma_f32 v[148:149], v[148:149], s[60:61], v[46:47] op_sel_hi:[1,0,0] neg_lo:[1,0,0] neg_hi:[1,0,0]
    v_pk_fma_f32 v[150:151], v[150:151], s[60:61], v[46:47] op_sel_hi:[1,0,0] neg_lo:[1,0,0] neg_hi:[1,0,0]
    v_exp_f32 v22, v22
    v_exp_f32 v23, v23
    v_mfma_f32_16x16x32_bf16 v[112:115], a[132:135], v[200:203], 0
    v_exp_f32 v24, v24
    v_exp_f32 v25, v25
    v_mfma_f32_16x16x32_bf16 v[116:119], a[144:147], v[200:203], 0
    v_exp_f32 v26, v26
    v_exp_f32 v27, v27
    v_mfma_f32_16x16x32_bf16 v[120:123], a[156:159], v[200:203], 0
    v_exp_f32 v28, v28
    v_exp_f32 v29, v29
    v_mfma_f32_16x16x32_bf16 v[124:127], a[168:171], v[200:203], 0
    v_exp_f32 v30, v30
    v_exp_f32 v31, v31
    v_mfma_f32_16x16x32_bf16 v[128:131], a[180:183], v[200:203], 0
    v_exp_f32 v32, v32
    v_exp_f32 v33, v33
    v_mfma_f32_16x16x32_bf16 v[112:115], a[136:139], v[204:207], v[112:115]
    v_exp_f32 v34, v34
    v_exp_f32 v35, v35
    v_mfma_f32_16x16x32_bf16 v[116:119], a[148:151], v[204:207], v[116:119]
    v_exp_f32 v36, v36
    v_exp_f32 v37, v37
    v_mfma_f32_16x16x32_bf16 v[120:123], a[160:163], v[204:207], v[120:123]
    v_exp_f32 v38, v38
    v_exp_f32 v39, v39
    v_mfma_f32_16x16x32_bf16 v[124:127], a[172:175], v[204:207], v[124:127]
    v_exp_f32 v40, v40
    v_exp_f32 v41, v41
    v_mfma_f32_16x16x32_bf16 v[128:131], a[184:187], v[204:207], v[128:131]
    v_exp_f32 v132, v132
    v_exp_f32 v133, v133
    v_mfma_f32_16x16x32_bf16 v[112:115], a[140:143], v[208:211], v[112:115]
    v_exp_f32 v134, v134
    v_exp_f32 v135, v135
    v_mfma_f32_16x16x32_bf16 v[116:119], a[152:155], v[208:211], v[116:119]
    v_exp_f32 v136, v136
    v_exp_f32 v137, v137
    v_mfma_f32_16x16x32_bf16 v[120:123], a[164:167], v[208:211], v[120:123]
    v_exp_f32 v138, v138
    v_exp_f32 v139, v139
    v_mfma_f32_16x16x32_bf16 v[124:127], a[176:179], v[208:211], v[124:127]
    v_exp_f32 v140, v140
    v_exp_f32 v141, v141
    v_mfma_f32_16x16x32_bf16 v[128:131], a[188:191], v[208:211], v[128:131]
    v_exp_f32 v142, v142
    v_exp_f32 v143, v143
    v_exp_f32 v144, v144
    v_exp_f32 v145, v145
    v_exp_f32 v146, v146
    v_exp_f32 v147, v147
    v_exp_f32 v148, v148
    v_exp_f32 v149, v149
    v_exp_f32 v150, v150
    v_exp_f32 v151, v151
    v_pk_add_f32 v[44:45], v[22:23], v[24:25]
    v_pk_add_f32 v[46:47], v[132:133], v[134:135]
    v_pk_add_f32 v[44:45], v[44:45], v[26:27]
    v_pk_add_f32 v[46:47], v[46:47], v[136:137]
    v_pk_add_f32 v[44:45], v[44:45], v[28:29]
    v_pk_add_f32 v[46:47], v[46:47], v[138:139]
    v_pk_add_f32 v[44:45], v[44:45], v[30:31]
    v_pk_add_f32 v[46:47], v[46:47], v[140:141]
    v_pk_add_f32 v[44:45], v[44:45], v[32:33]
    v_pk_add_f32 v[46:47], v[46:47], v[142:143]
    v_pk_add_f32 v[44:45], v[44:45], v[34:35]
    v_pk_add_f32 v[46:47], v[46:47], v[144:145]
    v_pk_add_f32 v[44:45], v[44:45], v[36:37]
    v_pk_add_f32 v[46:47], v[46:47], v[146:147]
    v_pk_add_f32 v[44:45], v[44:45], v[38:39]
    v_pk_add_f32 v[46:47], v[46:47], v[148:149]
    v_pk_add_f32 v[44:45], v[44:45], v[40:41]
    v_pk_add_f32 v[46:47], v[46:47], v[150:151]
    v_add_f32 v44, v44, v45
    v_add_f32 v46, v46, v47
    v_rcp_f32 v44, v44
    v_rcp_f32 v46, v46
    v_pk_mul_f32 v[22:23], v[22:23], v[44:45] op_sel_hi:[1,0]
    v_pk_mul_f32 v[132:133], v[132:133], v[46:47] op_sel_hi:[1,0]
    v_pk_mul_f32 v[24:25], v[24:25], v[44:45] op_sel_hi:[1,0]
    v_pk_mul_f32 v[134:135], v[134:135], v[46:47] op_sel_hi:[1,0]
    v_pk_mul_f32 v[26:27], v[26:27], v[44:45] op_sel_hi:[1,0]
    v_pk_mul_f32 v[136:137], v[136:137], v[46:47] op_sel_hi:[1,0]
    v_pk_mul_f32 v[28:29], v[28:29], v[44:45] op_sel_hi:[1,0]
    s_mov_b32 s36, s20
    s_mov_b32 s37, s21
    s_mov_b32 s38, 2211840
    s_mov_b32 s39, 0x20000
    buffer_load_dword v254, v248, s[36:39], s80 offen
    v_pk_mul_f32 v[138:139], v[138:139], v[46:47] op_sel_hi:[1,0]
    v_pk_mul_f32 v[30:31], v[30:31], v[44:45] op_sel_hi:[1,0]
    v_pk_mul_f32 v[140:141], v[140:141], v[46:47] op_sel_hi:[1,0]
    v_pk_mul_f32 v[32:33], v[32:33], v[44:45] op_sel_hi:[1,0]
    v_pk_mul_f32 v[142:143], v[142:143], v[46:47] op_sel_hi:[1,0]
    v_pk_mul_f32 v[34:35], v[34:35], v[44:45] op_sel_hi:[1,0]
    v_pk_mul_f32 v[144:145], v[144:145], v[46:47] op_sel_hi:[1,0]
    v_pk_mul_f32 v[36:37], v[36:37], v[44:45] op_sel_hi:[1,0]
    v_pk_mul_f32 v[146:147], v[146:147], v[46:47] op_sel_hi:[1,0]
    v_pk_mul_f32 v[38:39], v[38:39], v[44:45] op_sel_hi:[1,0]
    v_pk_mul_f32 v[148:149], v[148:149], v[46:47] op_sel_hi:[1,0]
    v_pk_mul_f32 v[40:41], v[40:41], v[44:45] op_sel_hi:[1,0]
    v_pk_mul_f32 v[150:151], v[150:151], v[46:47] op_sel_hi:[1,0]
    v_cvt_pk_bf16_f32 v180, v22, v23
    v_cvt_pk_bf16_f32 v181, v24, v25
    v_cvt_pk_bf16_f32 v182, v26, v27
    v_cvt_pk_bf16_f32 v183, v28, v29
    v_cvt_pk_bf16_f32 v184, v30, v31
    v_cvt_pk_bf16_f32 v185, v32, v33
    v_cvt_pk_bf16_f32 v186, v34, v35
    v_cvt_pk_bf16_f32 v187, v36, v37
    v_cvt_pk_bf16_f32 v188, v38, v39
    v_cvt_pk_bf16_f32 v189, v40, v41
    v_cvt_pk_bf16_f32 v190, v132, v133
    v_cvt_pk_bf16_f32 v191, v134, v135
    v_cvt_pk_bf16_f32 v192, v136, v137
    v_cvt_pk_bf16_f32 v193, v138, v139
    v_cvt_pk_bf16_f32 v194, v140, v141
    v_cvt_pk_bf16_f32 v195, v142, v143
    v_cvt_pk_bf16_f32 v196, v144, v145
    v_cvt_pk_bf16_f32 v197, v146, v147
    v_cvt_pk_bf16_f32 v198, v148, v149
    v_cvt_pk_bf16_f32 v199, v150, v151
    v_max3_f32 v42, v112, v113, v114
    v_min3_f32 v43, v112, v113, v114
    v_max3_f32 v42, v42, v115, v116
    v_min3_f32 v43, v43, v115, v116
    v_max3_f32 v42, v42, v117, v118
    v_min3_f32 v43, v43, v117, v118
    v_max3_f32 v42, v42, v119, v120
    v_min3_f32 v43, v43, v119, v120
    v_max3_f32 v42, v42, v121, v122
    v_min3_f32 v43, v43, v121, v122
    v_max3_f32 v42, v42, v123, v124
    v_min3_f32 v43, v43, v123, v124
    v_max3_f32 v42, v42, v125, v126
    v_min3_f32 v43, v43, v125, v126
    v_max3_f32 v42, v42, v127, v128
    v_min3_f32 v43, v43, v127, v128
    v_max3_f32 v42, v42, v129, v130
    v_min3_f32 v43, v43, v129, v130
    v_max_f32 v42, v42, v131
    v_min_f32 v43, v43, v131
    v_mul_f32 v44, s60, v42
    v_mul_f32 v46, s60, v43
    v_pk_fma_f32 v[22:23], v[112:113], s[60:61], v[44:45] op_sel_hi:[1,0,0] neg_lo:[0,0,1] neg_hi:[0,0,1]
    v_pk_fma_f32 v[24:25], v[114:115], s[60:61], v[44:45] op_sel_hi:[1,0,0] neg_lo:[0,0,1] neg_hi:[0,0,1]
    v_pk_fma_f32 v[26:27], v[116:117], s[60:61], v[44:45] op_sel_hi:[1,0,0] neg_lo:[0,0,1] neg_hi:[0,0,1]
    v_pk_fma_f32 v[28:29], v[118:119], s[60:61], v[44:45] op_sel_hi:[1,0,0] neg_lo:[0,0,1] neg_hi:[0,0,1]
    v_pk_fma_f32 v[30:31], v[120:121], s[60:61], v[44:45] op_sel_hi:[1,0,0] neg_lo:[0,0,1] neg_hi:[0,0,1]
    v_pk_fma_f32 v[32:33], v[122:123], s[60:61], v[44:45] op_sel_hi:[1,0,0] neg_lo:[0,0,1] neg_hi:[0,0,1]
    v_pk_fma_f32 v[34:35], v[124:125], s[60:61], v[44:45] op_sel_hi:[1,0,0] neg_lo:[0,0,1] neg_hi:[0,0,1]
    v_pk_fma_f32 v[36:37], v[126:127], s[60:61], v[44:45] op_sel_hi:[1,0,0] neg_lo:[0,0,1] neg_hi:[0,0,1]
    v_pk_fma_f32 v[38:39], v[128:129], s[60:61], v[44:45] op_sel_hi:[1,0,0] neg_lo:[0,0,1] neg_hi:[0,0,1]
    v_pk_fma_f32 v[40:41], v[130:131], s[60:61], v[44:45] op_sel_hi:[1,0,0] neg_lo:[0,0,1] neg_hi:[0,0,1]
    v_pk_fma_f32 v[112:113], v[112:113], s[60:61], v[46:47] op_sel_hi:[1,0,0] neg_lo:[1,0,0] neg_hi:[1,0,0]
    v_pk_fma_f32 v[114:115], v[114:115], s[60:61], v[46:47] op_sel_hi:[1,0,0] neg_lo:[1,0,0] neg_hi:[1,0,0]
    v_pk_fma_f32 v[116:117], v[116:117], s[60:61], v[46:47] op_sel_hi:[1,0,0] neg_lo:[1,0,0] neg_hi:[1,0,0]
    v_pk_fma_f32 v[118:119], v[118:119], s[60:61], v[46:47] op_sel_hi:[1,0,0] neg_lo:[1,0,0] neg_hi:[1,0,0]
    v_pk_fma_f32 v[120:121], v[120:121], s[60:61], v[46:47] op_sel_hi:[1,0,0] neg_lo:[1,0,0] neg_hi:[1,0,0]
    v_pk_fma_f32 v[122:123], v[122:123], s[60:61], v[46:47] op_sel_hi:[1,0,0] neg_lo:[1,0,0] neg_hi:[1,0,0]
    v_pk_fma_f32 v[124:125], v[124:125], s[60:61], v[46:47] op_sel_hi:[1,0,0] neg_lo:[1,0,0] neg_hi:[1,0,0]
    v_pk_fma_f32 v[126:127], v[126:127], s[60:61], v[46:47] op_sel_hi:[1,0,0] neg_lo:[1,0,0] neg_hi:[1,0,0]
    v_pk_fma_f32 v[128:129], v[128:129], s[60:61], v[46:47] op_sel_hi:[1,0,0] neg_lo:[1,0,0] neg_hi:[1,0,0]
    v_pk_fma_f32 v[130:131], v[130:131], s[60:61], v[46:47] op_sel_hi:[1,0,0] neg_lo:[1,0,0] neg_hi:[1,0,0]
    v_exp_f32 v22, v22
    v_exp_f32 v23, v23
    v_mfma_f32_16x16x32_bf16 v[132:135], a[132:135], v[220:223], 0
    v_exp_f32 v24, v24
    v_exp_f32 v25, v25
    v_mfma_f32_16x16x32_bf16 v[136:139], a[144:147], v[220:223], 0
    v_exp_f32 v26, v26
    v_exp_f32 v27, v27
    v_mfma_f32_16x16x32_bf16 v[140:143], a[156:159], v[220:223], 0
    v_exp_f32 v28, v28
    v_exp_f32 v29, v29
    v_mfma_f32_16x16x32_bf16 v[144:147], a[168:171], v[220:223], 0
    v_exp_f32 v30, v30
    v_exp_f32 v31, v31
    v_mfma_f32_16x16x32_bf16 v[148:151], a[180:183], v[220:223], 0
    v_exp_f32 v32, v32
    v_exp_f32 v33, v33
    v_mfma_f32_16x16x32_bf16 v[132:135], a[136:139], v[224:227], v[132:135]
    v_exp_f32 v34, v34
    v_exp_f32 v35, v35
    v_mfma_f32_16x16x32_bf16 v[136:139], a[148:151], v[224:227], v[136:139]
    v_exp_f32 v36, v36
    v_exp_f32 v37, v37
    v_mfma_f32_16x16x32_bf16 v[140:143], a[160:163], v[224:227], v[140:143]
    v_exp_f32 v38, v38
    v_exp_f32 v39, v39
    v_mfma_f32_16x16x32_bf16 v[144:147], a[172:175], v[224:227], v[144:147]
    v_exp_f32 v40, v40
    v_exp_f32 v41, v41
    v_mfma_f32_16x16x32_bf16 v[148:151], a[184:187], v[224:227], v[148:151]
    v_exp_f32 v112, v112
    v_exp_f32 v113, v113
    v_mfma_f32_16x16x32_bf16 v[132:135], a[140:143], v[228:231], v[132:135]
    v_exp_f32 v114, v114
    v_exp_f32 v115, v115
    v_mfma_f32_16x16x32_bf16 v[136:139], a[152:155], v[228:231], v[136:139]
    v_exp_f32 v116, v116
    v_exp_f32 v117, v117
    v_mfma_f32_16x16x32_bf16 v[140:143], a[164:167], v[228:231], v[140:143]
    v_exp_f32 v118, v118
    v_exp_f32 v119, v119
    v_mfma_f32_16x16x32_bf16 v[144:147], a[176:179], v[228:231], v[144:147]
    v_exp_f32 v120, v120
    v_exp_f32 v121, v121
    v_mfma_f32_16x16x32_bf16 v[148:151], a[188:191], v[228:231], v[148:151]
    v_exp_f32 v122, v122
    v_exp_f32 v123, v123
    v_exp_f32 v124, v124
    v_exp_f32 v125, v125
    v_exp_f32 v126, v126
    v_exp_f32 v127, v127
    v_exp_f32 v128, v128
    v_exp_f32 v129, v129
    v_exp_f32 v130, v130
    v_exp_f32 v131, v131
    v_pk_add_f32 v[44:45], v[22:23], v[24:25]
    v_pk_add_f32 v[46:47], v[112:113], v[114:115]
    v_pk_add_f32 v[44:45], v[44:45], v[26:27]
    v_pk_add_f32 v[46:47], v[46:47], v[116:117]
    v_pk_add_f32 v[44:45], v[44:45], v[28:29]
    v_pk_add_f32 v[46:47], v[46:47], v[118:119]
    v_pk_add_f32 v[44:45], v[44:45], v[30:31]
    v_pk_add_f32 v[46:47], v[46:47], v[120:121]
    v_pk_add_f32 v[44:45], v[44:45], v[32:33]
    v_pk_add_f32 v[46:47], v[46:47], v[122:123]
    v_pk_add_f32 v[44:45], v[44:45], v[34:35]
    v_pk_add_f32 v[46:47], v[46:47], v[124:125]
    v_pk_add_f32 v[44:45], v[44:45], v[36:37]
    v_pk_add_f32 v[46:47], v[46:47], v[126:127]
    v_pk_add_f32 v[44:45], v[44:45], v[38:39]
    v_pk_add_f32 v[46:47], v[46:47], v[128:129]
    v_pk_add_f32 v[44:45], v[44:45], v[40:41]
    v_pk_add_f32 v[46:47], v[46:47], v[130:131]
    v_add_f32 v44, v44, v45
    v_add_f32 v46, v46, v47
    buffer_load_dword v254, v249, s[36:39], s81 offen
    v_rcp_f32 v44, v44
    v_rcp_f32 v46, v46
    v_pk_mul_f32 v[22:23], v[22:23], v[44:45] op_sel_hi:[1,0]
    v_pk_mul_f32 v[112:113], v[112:113], v[46:47] op_sel_hi:[1,0]
    v_pk_mul_f32 v[24:25], v[24:25], v[44:45] op_sel_hi:[1,0]
    v_pk_mul_f32 v[114:115], v[114:115], v[46:47] op_sel_hi:[1,0]
    v_pk_mul_f32 v[26:27], v[26:27], v[44:45] op_sel_hi:[1,0]
    v_pk_mul_f32 v[116:117], v[116:117], v[46:47] op_sel_hi:[1,0]
    v_pk_mul_f32 v[28:29], v[28:29], v[44:45] op_sel_hi:[1,0]
    v_pk_mul_f32 v[118:119], v[118:119], v[46:47] op_sel_hi:[1,0]
    v_pk_mul_f32 v[30:31], v[30:31], v[44:45] op_sel_hi:[1,0]
    v_pk_mul_f32 v[120:121], v[120:121], v[46:47] op_sel_hi:[1,0]
    v_pk_mul_f32 v[32:33], v[32:33], v[44:45] op_sel_hi:[1,0]
    v_pk_mul_f32 v[122:123], v[122:123], v[46:47] op_sel_hi:[1,0]
    v_pk_mul_f32 v[34:35], v[34:35], v[44:45] op_sel_hi:[1,0]
    v_pk_mul_f32 v[124:125], v[124:125], v[46:47] op_sel_hi:[1,0]
    v_pk_mul_f32 v[36:37], v[36:37], v[44:45] op_sel_hi:[1,0]
    v_pk_mul_f32 v[126:127], v[126:127], v[46:47] op_sel_hi:[1,0]
    v_pk_mul_f32 v[38:39], v[38:39], v[44:45] op_sel_hi:[1,0]
    v_pk_mul_f32 v[128:129], v[128:129], v[46:47] op_sel_hi:[1,0]
    v_pk_mul_f32 v[40:41], v[40:41], v[44:45] op_sel_hi:[1,0]
    v_pk_mul_f32 v[130:131], v[130:131], v[46:47] op_sel_hi:[1,0]
    v_cvt_pk_bf16_f32 v200, v22, v23
    v_cvt_pk_bf16_f32 v201, v24, v25
    v_cvt_pk_bf16_f32 v202, v26, v27
    v_cvt_pk_bf16_f32 v203, v28, v29
    v_cvt_pk_bf16_f32 v204, v30, v31
    v_cvt_pk_bf16_f32 v205, v32, v33
    v_cvt_pk_bf16_f32 v206, v34, v35
    v_cvt_pk_bf16_f32 v207, v36, v37
    v_cvt_pk_bf16_f32 v208, v38, v39
    v_cvt_pk_bf16_f32 v209, v40, v41
    v_cvt_pk_bf16_f32 v210, v112, v113
    v_cvt_pk_bf16_f32 v211, v114, v115
    v_cvt_pk_bf16_f32 v212, v116, v117
    v_cvt_pk_bf16_f32 v213, v118, v119
    v_cvt_pk_bf16_f32 v214, v120, v121
    v_cvt_pk_bf16_f32 v215, v122, v123
    v_cvt_pk_bf16_f32 v216, v124, v125
    v_cvt_pk_bf16_f32 v217, v126, v127
    v_cvt_pk_bf16_f32 v218, v128, v129
    v_cvt_pk_bf16_f32 v219, v130, v131
    v_max3_f32 v42, v132, v133, v134
    v_min3_f32 v43, v132, v133, v134
    v_max3_f32 v42, v42, v135, v136
    v_min3_f32 v43, v43, v135, v136
    v_max3_f32 v42, v42, v137, v138
    v_min3_f32 v43, v43, v137, v138
    v_max3_f32 v42, v42, v139, v140
    v_min3_f32 v43, v43, v139, v140
    v_max3_f32 v42, v42, v141, v142
    v_min3_f32 v43, v43, v141, v142
    v_max3_f32 v42, v42, v143, v144
    v_min3_f32 v43, v43, v143, v144
    v_max3_f32 v42, v42, v145, v146
    v_min3_f32 v43, v43, v145, v146
    v_max3_f32 v42, v42, v147, v148
    v_min3_f32 v43, v43, v147, v148
    v_max3_f32 v42, v42, v149, v150
    v_min3_f32 v43, v43, v149, v150
    v_max_f32 v42, v42, v151
    v_min_f32 v43, v43, v151
    v_mul_f32 v44, s60, v42
    v_mul_f32 v46, s60, v43
    v_pk_fma_f32 v[22:23], v[132:133], s[60:61], v[44:45] op_sel_hi:[1,0,0] neg_lo:[0,0,1] neg_hi:[0,0,1]
    v_pk_fma_f32 v[24:25], v[134:135], s[60:61], v[44:45] op_sel_hi:[1,0,0] neg_lo:[0,0,1] neg_hi:[0,0,1]
    v_pk_fma_f32 v[26:27], v[136:137], s[60:61], v[44:45] op_sel_hi:[1,0,0] neg_lo:[0,0,1] neg_hi:[0,0,1]
    v_pk_fma_f32 v[28:29], v[138:139], s[60:61], v[44:45] op_sel_hi:[1,0,0] neg_lo:[0,0,1] neg_hi:[0,0,1]
    v_pk_fma_f32 v[30:31], v[140:141], s[60:61], v[44:45] op_sel_hi:[1,0,0] neg_lo:[0,0,1] neg_hi:[0,0,1]
    v_pk_fma_f32 v[32:33], v[142:143], s[60:61], v[44:45] op_sel_hi:[1,0,0] neg_lo:[0,0,1] neg_hi:[0,0,1]
    v_pk_fma_f32 v[34:35], v[144:145], s[60:61], v[44:45] op_sel_hi:[1,0,0] neg_lo:[0,0,1] neg_hi:[0,0,1]
    v_pk_fma_f32 v[36:37], v[146:147], s[60:61], v[44:45] op_sel_hi:[1,0,0] neg_lo:[0,0,1] neg_hi:[0,0,1]
    v_pk_fma_f32 v[38:39], v[148:149], s[60:61], v[44:45] op_sel_hi:[1,0,0] neg_lo:[0,0,1] neg_hi:[0,0,1]
    v_pk_fma_f32 v[40:41], v[150:151], s[60:61], v[44:45] op_sel_hi:[1,0,0] neg_lo:[0,0,1] neg_hi:[0,0,1]
    v_pk_fma_f32 v[132:133], v[132:133], s[60:61], v[46:47] op_sel_hi:[1,0,0] neg_lo:[1,0,0] neg_hi:[1,0,0]
    v_pk_fma_f32 v[134:135], v[134:135], s[60:61], v[46:47] op_sel_hi:[1,0,0] neg_lo:[1,0,0] neg_hi:[1,0,0]
    v_pk_fma_f32 v[136:137], v[136:137], s[60:61], v[46:47] op_sel_hi:[1,0,0] neg_lo:[1,0,0] neg_hi:[1,0,0]
    v_pk_fma_f32 v[138:139], v[138:139], s[60:61], v[46:47] op_sel_hi:[1,0,0] neg_lo:[1,0,0] neg_hi:[1,0,0]
    v_pk_fma_f32 v[140:141], v[140:141], s[60:61], v[46:47] op_sel_hi:[1,0,0] neg_lo:[1,0,0] neg_hi:[1,0,0]
    v_pk_fma_f32 v[142:143], v[142:143], s[60:61], v[46:47] op_sel_hi:[1,0,0] neg_lo:[1,0,0] neg_hi:[1,0,0]
    v_pk_fma_f32 v[144:145], v[144:145], s[60:61], v[46:47] op_sel_hi:[1,0,0] neg_lo:[1,0,0] neg_hi:[1,0,0]
    v_pk_fma_f32 v[146:147], v[146:147], s[60:61], v[46:47] op_sel_hi:[1,0,0] neg_lo:[1,0,0] neg_hi:[1,0,0]
    v_pk_fma_f32 v[148:149], v[148:149], s[60:61], v[46:47] op_sel_hi:[1,0,0] neg_lo:[1,0,0] neg_hi:[1,0,0]
    v_pk_fma_f32 v[150:151], v[150:151], s[60:61], v[46:47] op_sel_hi:[1,0,0] neg_lo:[1,0,0] neg_hi:[1,0,0]
    v_exp_f32 v22, v22
    v_exp_f32 v23, v23
    v_exp_f32 v24, v24
    v_exp_f32 v25, v25
    v_exp_f32 v26, v26
    v_exp_f32 v27, v27
    v_exp_f32 v28, v28
    v_exp_f32 v29, v29
    v_exp_f32 v30, v30
    v_exp_f32 v31, v31
    v_exp_f32 v32, v32
    v_exp_f32 v33, v33
    v_exp_f32 v34, v34
    v_exp_f32 v35, v35
    v_exp_f32 v36, v36
    v_exp_f32 v37, v37
    v_exp_f32 v38, v38
    v_exp_f32 v39, v39
    v_exp_f32 v40, v40
    v_exp_f32 v41, v41
    v_exp_f32 v132, v132
    v_exp_f32 v133, v133
    v_exp_f32 v134, v134
    v_exp_f32 v135, v135
    v_exp_f32 v136, v136
    v_exp_f32 v137, v137
    v_exp_f32 v138, v138
    v_exp_f32 v139, v139
    v_exp_f32 v140, v140
    v_exp_f32 v141, v141
    v_exp_f32 v142, v142
    v_exp_f32 v143, v143
    v_exp_f32 v144, v144
    v_exp_f32 v145, v145
    v_exp_f32 v146, v146
    v_exp_f32 v147, v147
    v_exp_f32 v148, v148
    v_exp_f32 v149, v149
    v_exp_f32 v150, v150
    v_exp_f32 v151, v151
    v_pk_add_f32 v[44:45], v[22:23], v[24:25]
    v_pk_add_f32 v[46:47], v[132:133], v[134:135]
    v_pk_add_f32 v[44:45], v[44:45], v[26:27]
    v_pk_add_f32 v[46:47], v[46:47], v[136:137]
    v_pk_add_f32 v[44:45], v[44:45], v[28:29]
    v_pk_add_f32 v[46:47], v[46:47], v[138:139]
    v_pk_add_f32 v[44:45], v[44:45], v[30:31]
    v_pk_add_f32 v[46:47], v[46:47], v[140:141]
    v_pk_add_f32 v[44:45], v[44:45], v[32:33]
    v_pk_add_f32 v[46:47], v[46:47], v[142:143]
    v_pk_add_f32 v[44:45], v[44:45], v[34:35]
    v_pk_add_f32 v[46:47], v[46:47], v[144:145]
    v_pk_add_f32 v[44:45], v[44:45], v[36:37]
    v_pk_add_f32 v[46:47], v[46:47], v[146:147]
    v_pk_add_f32 v[44:45], v[44:45], v[38:39]
    v_pk_add_f32 v[46:47], v[46:47], v[148:149]
    v_pk_add_f32 v[44:45], v[44:45], v[40:41]
    v_pk_add_f32 v[46:47], v[46:47], v[150:151]
    v_add_f32 v44, v44, v45
    v_add_f32 v46, v46, v47
    v_rcp_f32 v44, v44
    v_rcp_f32 v46, v46
    v_pk_mul_f32 v[22:23], v[22:23], v[44:45] op_sel_hi:[1,0]
    v_pk_mul_f32 v[132:133], v[132:133], v[46:47] op_sel_hi:[1,0]
    v_pk_mul_f32 v[24:25], v[24:25], v[44:45] op_sel_hi:[1,0]
    v_pk_mul_f32 v[134:135], v[134:135], v[46:47] op_sel_hi:[1,0]
    v_pk_mul_f32 v[26:27], v[26:27], v[44:45] op_sel_hi:[1,0]
    v_pk_mul_f32 v[136:137], v[136:137], v[46:47] op_sel_hi:[1,0]
    v_pk_mul_f32 v[28:29], v[28:29], v[44:45] op_sel_hi:[1,0]
    v_pk_mul_f32 v[138:139], v[138:139], v[46:47] op_sel_hi:[1,0]
    v_pk_mul_f32 v[30:31], v[30:31], v[44:45] op_sel_hi:[1,0]
    v_pk_mul_f32 v[140:141], v[140:141], v[46:47] op_sel_hi:[1,0]
    v_pk_mul_f32 v[32:33], v[32:33], v[44:45] op_sel_hi:[1,0]
    v_pk_mul_f32 v[142:143], v[142:143], v[46:47] op_sel_hi:[1,0]
    v_pk_mul_f32 v[34:35], v[34:35], v[44:45] op_sel_hi:[1,0]
    v_pk_mul_f32 v[144:145], v[144:145], v[46:47] op_sel_hi:[1,0]
    v_pk_mul_f32 v[36:37], v[36:37], v[44:45] op_sel_hi:[1,0]
    v_pk_mul_f32 v[146:147], v[146:147], v[46:47] op_sel_hi:[1,0]
    v_pk_mul_f32 v[38:39], v[38:39], v[44:45] op_sel_hi:[1,0]
    v_pk_mul_f32 v[148:149], v[148:149], v[46:47] op_sel_hi:[1,0]
    v_pk_mul_f32 v[40:41], v[40:41], v[44:45] op_sel_hi:[1,0]
    v_pk_mul_f32 v[150:151], v[150:151], v[46:47] op_sel_hi:[1,0]
    v_cvt_pk_bf16_f32 v220, v22, v23
    v_cvt_pk_bf16_f32 v221, v24, v25
    v_cvt_pk_bf16_f32 v222, v26, v27
    v_cvt_pk_bf16_f32 v223, v28, v29
    v_cvt_pk_bf16_f32 v224, v30, v31
    v_cvt_pk_bf16_f32 v225, v32, v33
    v_cvt_pk_bf16_f32 v226, v34, v35
    v_cvt_pk_bf16_f32 v227, v36, v37
    v_cvt_pk_bf16_f32 v228, v38, v39
    v_cvt_pk_bf16_f32 v229, v40, v41
    v_cvt_pk_bf16_f32 v230, v132, v133
    v_cvt_pk_bf16_f32 v231, v134, v135
    v_cvt_pk_bf16_f32 v232, v136, v137
    v_cvt_pk_bf16_f32 v233, v138, v139
    v_cvt_pk_bf16_f32 v234, v140, v141
    v_cvt_pk_bf16_f32 v235, v142, v143
    v_cvt_pk_bf16_f32 v236, v144, v145
    v_cvt_pk_bf16_f32 v237, v146, v147
    v_cvt_pk_bf16_f32 v238, v148, v149
    v_cvt_pk_bf16_f32 v239, v150, v151
    s_mov_b32 s76, 1073741824
    s_min_u32 s83, s43, 4
    s_add_u32 s83, s83, 22
    s_mov_b32 s32, s18
    s_mov_b32 s33, s19
    s_mov_b32 s34, 2211840
    s_mov_b32 s35, 0x20000
    v_lshrrev_b32 v16, 3, v1
    v_and_b32 v17, 7, v1
    v_and_b32 v18, 6, v16
    v_xor_b32 v17, v17, v18
    v_mul_u32_u24 v16, 3456, v16
    v_lshl_add_u32 v14, v17, 4, v16
    v_add_u32 v15, 26624, v14
    s_lshl_b32 s53, s41, 11
    s_lshl_b32 s78, s83, 7
    s_lshl_b32 s44, s41, 4
    s_mul_i32 s44, s44, 3456
    s_add_u32 s51, s44, s78
    s_mov_b32 s50, 0
    s_mul_i32 s55, s50, 221184
    s_add_u32 s55, s55, s51
    s_mov_b32 s90, 2211840
    s_add_u32 s90, s90, s51
    s_add_u32 m0, s53, 49152
    s_nop 0
    buffer_load_dwordx4 v14, s[32:35], s55 offen lds
    buffer_load_dwordx4 v15, s[32:35], s55 offen offset:1024 lds
    s_add_u32 s55, s55, 221184
    s_add_u32 m0, s53, 57344
    s_nop 0
    buffer_load_dwordx4 v14, s[32:35], s55 offen lds
    buffer_load_dwordx4 v15, s[32:35], s55 offen offset:1024 lds
    s_add_u32 s55, s55, 221184
    s_add_u32 m0, s53, 65536
    s_nop 0
    buffer_load_dwordx4 v14, s[32:35], s55 offen lds
    buffer_load_dwordx4 v15, s[32:35], s55 offen offset:1024 lds
    s_add_u32 s55, s55, 221184
    s_add_u32 m0, s53, 73728
    s_nop 0
    buffer_load_dwordx4 v14, s[32:35], s55 offen lds
    buffer_load_dwordx4 v15, s[32:35], s55 offen offset:1024 lds
    s_add_u32 s55, s55, 221184
    s_add_u32 m0, s53, 81920
    s_nop 0
    buffer_load_dwordx4 v14, s[32:35], s55 offen lds
    buffer_load_dwordx4 v15, s[32:35], s55 offen offset:1024 lds
    s_add_u32 s55, s55, 221184
    s_add_u32 m0, s53, 90112
    s_nop 0
    buffer_load_dwordx4 v14, s[32:35], s55 offen lds
    buffer_load_dwordx4 v15, s[32:35], s55 offen offset:1024 lds
    s_add_u32 s55, s55, 221184
    s_add_u32 m0, s53, 98304
    s_nop 0
    buffer_load_dwordx4 v14, s[32:35], s55 offen lds
    buffer_load_dwordx4 v15, s[32:35], s55 offen offset:1024 lds
    s_add_u32 s55, s55, 221184
    s_add_u32 m0, s53, 106496
    s_nop 0
    buffer_load_dwordx4 v14, s[32:35], s55 offen lds
    buffer_load_dwordx4 v15, s[32:35], s55 offen offset:1024 lds
    s_add_u32 s55, s55, 221184
    s_add_u32 m0, s53, 114688
    s_nop 0
    buffer_load_dwordx4 v14, s[32:35], s55 offen lds
    buffer_load_dwordx4 v15, s[32:35], s55 offen offset:1024 lds
    s_add_u32 s55, s55, 221184
    s_add_u32 m0, s53, 122880
    s_nop 0
    buffer_load_dwordx4 v14, s[32:35], s55 offen lds
    buffer_load_dwordx4 v15, s[32:35], s55 offen offset:1024 lds
    s_lshl_b32 s58, s43, 3
    s_lshr_b32 s44, s42, 1
    s_add_u32 s58, s58, s44
    s_lshr_b32 s45, s58, 2
    s_mul_i32 s44, s45, 16
    s_lshl_b32 s44, s44, 7
    s_add_u32 s44, s44, 27303936
    v_lshlrev_b32 v22, 7, v1
    v_add_u32 v22, s44, v22
    v_mov_b32 v25, 1073741824
    v_cmp_lt_u32 vcc, 119, v0
    s_nop 1
    v_cndmask_b32_e64 v26, 0, 1, vcc
    v_mul_u32_u24 v27, 120, v26
    v_sub_u32 v27, v0, v27
    v_mul_u32_u24 v30, 5462, v27
    v_lshrrev_b32 v30, 16, v30
    v_mul_u32_u24 v31, 12, v30
    v_sub_u32 v31, v27, v31
    s_and_b32 s44, s42, 1
    s_mul_i32 s44, s44, 12
    v_mul_u32_u24 v28, 24, v30
    v_add_u32 v28, v28, v31
    v_add_u32 v28, s44, v28
    s_mov_b32 s45, 983040
    v_mul_lo_u32 v29, v26, s45
    v_lshl_add_u32 v29, v28, 4, v29
    v_cmp_gt_u32 vcc, 240, v0
    s_nop 1
    v_cndmask_b32 v29, v25, v29, vcc
    v_mul_u32_u24 v33, 80, v31
    v_lshl_add_u32 v33, v30, 3, v33
    v_add_u32 v33, 45056, v33
    v_lshlrev_b32 v32, 4, v27
    v_add_u32 v32, 40960, v32
    s_cmp_lg_u32 s41, 0
    s_cbranch_scc1 L_pskip_10
    s_mov_b32 exec_lo, 65535
    s_mov_b32 exec_hi, 0
    s_mov_b32 s57, 200000
L_poll_8:
    buffer_load_dword v63, v22, s[28:31], 0 offen sc1
    s_waitcnt vmcnt(0)
    v_cmp_ne_u32 vcc, s40, v63
    s_nop 1
    s_cbranch_vccz L_pdone_9
    s_sub_u32 s57, s57, 1
    s_cmp_lg_u32 s57, 0
    s_cbranch_scc1 L_poll_8
L_pdone_9:
    s_mov_b64 exec, -1
L_pskip_10:
    s_barrier
    s_mul_i32 s44, s58, 3840
    s_add_u32 s44, s44, 331776
    buffer_load_dwordx4 v[64:67], v29, s[28:31], s44 offen sc1
    s_add_u32 s44, s44, 122880
    buffer_load_dwordx4 v[68:71], v29, s[28:31], s44 offen sc1
    s_add_u32 s44, s44, 122880
    buffer_load_dwordx4 v[72:75], v29, s[28:31], s44 offen sc1
    s_add_u32 s44, s44, 122880
    buffer_load_dwordx4 v[76:79], v29, s[28:31], s44 offen sc1
    s_add_u32 s44, s44, 122880
    buffer_load_dwordx4 v[80:83], v29, s[28:31], s44 offen sc1
    s_add_u32 s44, s44, 122880
    buffer_load_dwordx4 v[84:87], v29, s[28:31], s44 offen sc1
    s_add_u32 s44, s44, 122880
    buffer_load_dwordx4 v[88:91], v29, s[28:31], s44 offen sc1
    s_add_u32 s44, s44, 122880
    buffer_load_dwordx4 v[92:95], v29, s[28:31], s44 offen sc1
    s_waitcnt vmcnt(0)
    v_pk_add_f32 v[64:65], v[64:65], v[80:81]
    v_pk_add_f32 v[66:67], v[66:67], v[82:83]
    v_pk_add_f32 v[68:69], v[68:69], v[84:85]
    v_pk_add_f32 v[70:71], v[70:71], v[86:87]
    v_pk_add_f32 v[72:73], v[72:73], v[88:89]
    v_pk_add_f32 v[74:75], v[74:75], v[90:91]
    v_pk_add_f32 v[76:77], v[76:77], v[92:93]
    v_pk_add_f32 v[78:79], v[78:79], v[94:95]
    v_pk_add_f32 v[64:65], v[64:65], v[72:73]
    v_pk_add_f32 v[66:67], v[66:67], v[74:75]
    v_pk_add_f32 v[68:69], v[68:69], v[76:77]
    v_pk_add_f32 v[70:71], v[70:71], v[78:79]
    v_pk_add_f32 v[64:65], v[64:65], v[68:69]
    v_pk_add_f32 v[66:67], v[66:67], v[70:71]
    v_cmp_lt_u32 vcc, 119, v0
    s_nop 0
    s_and_saveexec_b64 s[44:45], vcc
    ds_write_b128 v32, v[64:67]
    s_mov_b64 exec, -1
    s_waitcnt lgkmcnt(0)
    s_barrier
    ds_read_b128 v[68:71], v32
    s_waitcnt lgkmcnt(0)
    v_pk_add_f32 v[64:65], v[64:65], v[68:69]
    v_pk_add_f32 v[66:67], v[66:67], v[70:71]
    v_cvt_pk_bf16_f32 v26, v64, v65
    v_cvt_pk_bf16_f32 v27, v66, v67
    v_cmp_gt_u32 vcc, 120, v0
    s_nop 0
    s_and_saveexec_b64 s[44:45], vcc
    ds_write_b64 v33, v[26:27]
    s_mov_b64 exec, -1
    s_waitcnt lgkmcnt(0)
    s_barrier
    v_lshlrev_b32 v34, 4, v0
    v_add_u32 v35, 45056, v34
    ds_read_b128 v[68:71], v35
    v_cmp_gt_u32 vcc, 64, v0
    s_nop 1
    v_cndmask_b32 v34, v25, v34, vcc
    s_lshl_b32 s44, s58, 1
    s_and_b32 s45, s42, 1
    s_add_u32 s44, s44, s45
    s_lshl_b32 s44, s44, 10
    s_add_u32 s44, s44, 266240
    s_waitcnt lgkmcnt(0)
    buffer_store_dwordx4 v[68:71], v34, s[28:31], s44 offen sc1
    s_mul_i32 s76, s43, 16
    s_add_u32 s76, s76, s42
    s_lshl_b32 s76, s76, 7
    s_add_u32 s76, s76, 27320320
    s_waitcnt vmcnt(0)
    s_barrier
    buffer_store_dwordx4 v[244:247], v243, s[28:31], s76 offen sc1
    buffer_store_dwordx4 v[244:247], v243, s[28:31], s77 offen sc1
    s_mov_b32 s77, 1073741824
    v_lshlrev_b32 v22, 3, v0
    v_add_u32 v22, 16384, v22
    v_mov_b32 v24, 0
    v_mov_b32 v25, 0
    ds_write_b64 v22, v[24:25]
    s_mul_i32 s44, s43, 16
    s_lshl_b32 s44, s44, 7
    s_add_u32 s44, s44, 27320320
    v_lshlrev_b32 v22, 7, v1
    v_add_u32 v22, s44, v22
    s_cmp_lg_u32 s41, 0
    s_cbranch_scc1 L_pskip_13
    s_mov_b32 exec_lo, 65535
    s_mov_b32 exec_hi, 0
    s_mov_b32 s57, 200000
L_poll_11:
    buffer_load_dword v63, v22, s[28:31], 0 offen sc1
    s_waitcnt vmcnt(0)
    v_cmp_ne_u32 vcc, s40, v63
    s_nop 1
    s_cbranch_vccz L_pdone_12
    s_sub_u32 s57, s57, 1
    s_cmp_lg_u32 s57, 0
    s_cbranch_scc1 L_poll_11
L_pdone_12:
    s_mov_b64 exec, -1
L_pskip_13:
    s_barrier
    v_lshlrev_b32 v22, 4, v1
    s_lshl_b32 s44, s43, 14
    s_add_u32 s44, s44, 266240
    s_lshl_b32 s45, s41, 10
    s_add_u32 s46, s45, 0
    s_add_u32 s47, s46, s44
    s_mov_b32 m0, s46
    s_nop 0
    buffer_load_dwordx4 v22, s[28:31], s47 offen sc1 lds
    s_add_u32 s46, s45, 4096
    s_add_u32 s47, s46, s44
    s_mov_b32 m0, s46
    s_nop 0
    buffer_load_dwordx4 v22, s[28:31], s47 offen sc1 lds
    s_add_u32 s46, s45, 8192
    s_add_u32 s47, s46, s44
    s_mov_b32 m0, s46
    s_nop 0
    buffer_load_dwordx4 v22, s[28:31], s47 offen sc1 lds
    s_add_u32 s46, s45, 12288
    s_add_u32 s47, s46, s44
    s_mov_b32 m0, s46
    s_nop 0
    buffer_load_dwordx4 v22, s[28:31], s47 offen sc1 lds
    v_lshrrev_b32 v23, 4, v1
    v_lshrrev_b32 v24, 2, v1
    v_and_b32 v24, 3, v24
    v_and_b32 v25, 3, v1
    v_lshlrev_b32 v26, 11, v24
    v_mul_u32_u24 v25, 80, v25
    v_add_u32 v26, v26, v25
    v_cmp_eq_u32 vcc, v23, v24
    v_mov_b32 v27, 16384
    s_nop 0
    v_cndmask_b32 v4, v27, v26, vcc
    v_add_u32 v26, 8192, v26
    v_cndmask_b32 v5, v27, v26, vcc
    s_waitcnt vmcnt(0)
    s_waitcnt lgkmcnt(0)
    s_barrier
    v_lshrrev_b32 v22, 4, v1
    v_lshlrev_b32 v22, 11, v22
    v_and_b32 v23, 15, v1
    v_lshl_add_u32 v22, v23, 4, v22
    s_lshl_b32 s44, s41, 9
    v_add_u32 v19, s44, v22
    s_mul_i32 s56, s42, 163840
    s_add_u32 s56, s56, 10289152
    s_mul_i32 s44, s43, 40960
    s_add_u32 s56, s56, s44
    v_mov_b32 v62, 897988541
    ds_read_b128 a[64:67], v4 offset:0
    ds_read_b128 a[68:71], v4 offset:16
    ds_read_b128 a[72:75], v4 offset:32
    ds_read_b128 a[76:79], v4 offset:48
    ds_read_b128 a[80:83], v4 offset:64
    ds_read_b128 a[84:87], v4 offset:320
    ds_read_b128 a[88:91], v4 offset:336
    ds_read_b128 a[92:95], v4 offset:352
    ds_read_b128 a[96:99], v4 offset:368
    ds_read_b128 a[100:103], v4 offset:384
    ds_read_b128 a[104:107], v4 offset:640
    ds_read_b128 a[108:111], v4 offset:656
    ds_read_b128 a[112:115], v4 offset:672
    ds_read_b128 a[116:119], v4 offset:688
    ds_read_b128 a[120:123], v4 offset:704
    s_waitcnt lgkmcnt(10)
    v_mfma_f32_16x16x32_bf16 v[64:67], a[64:67], v[160:163], 0
    v_mfma_f32_16x16x32_bf16 v[68:71], a[64:67], v[180:183], 0
    v_mfma_f32_16x16x32_bf16 v[64:67], a[68:71], v[164:167], v[64:67]
    v_mfma_f32_16x16x32_bf16 v[68:71], a[68:71], v[184:187], v[68:71]
    v_mfma_f32_16x16x32_bf16 v[64:67], a[72:75], v[168:171], v[64:67]
    v_mfma_f32_16x16x32_bf16 v[68:71], a[72:75], v[188:191], v[68:71]
    v_mfma_f32_16x16x32_bf16 v[64:67], a[76:79], v[172:175], v[64:67]
    v_mfma_f32_16x16x32_bf16 v[68:71], a[76:79], v[192:195], v[68:71]
    v_mfma_f32_16x16x32_bf16 v[64:67], a[80:83], v[176:179], v[64:67]
    v_mfma_f32_16x16x32_bf16 v[68:71], a[80:83], v[196:199], v[68:71]
    ds_read_b128 a[64:67], v4 offset:1024
    ds_read_b128 a[68:71], v4 offset:1040
    ds_read_b128 a[72:75], v4 offset:1056
    ds_read_b128 a[76:79], v4 offset:1072
    ds_read_b128 a[80:83], v4 offset:1088
    s_waitcnt lgkmcnt(10)
    v_mfma_f32_16x16x32_bf16 v[72:75], a[84:87], v[160:163], 0
    v_mfma_f32_16x16x32_bf16 v[76:79], a[84:87], v[180:183], 0
    v_mfma_f32_16x16x32_bf16 v[72:75], a[88:91], v[164:167], v[72:75]
    v_mfma_f32_16x16x32_bf16 v[76:79], a[88:91], v[184:187], v[76:79]
    v_mfma_f32_16x16x32_bf16 v[72:75], a[92:95], v[168:171], v[72:75]
    v_mfma_f32_16x16x32_bf16 v[76:79], a[92:95], v[188:191], v[76:79]
    v_mfma_f32_16x16x32_bf16 v[72:75], a[96:99], v[172:175], v[72:75]
    v_mfma_f32_16x16x32_bf16 v[76:79], a[96:99], v[192:195], v[76:79]
    v_mfma_f32_16x16x32_bf16 v[72:75], a[100:103], v[176:179], v[72:75]
    v_mfma_f32_16x16x32_bf16 v[76:79], a[100:103], v[196:199], v[76:79]
    ds_read_b128 a[84:87], v4 offset:1344
    ds_read_b128 a[88:91], v4 offset:1360
    ds_read_b128 a[92:95], v4 offset:1376
    ds_read_b128 a[96:99], v4 offset:1392
    ds_read_b128 a[100:103], v4 offset:1408
    s_waitcnt lgkmcnt(10)
    v_mfma_f32_16x16x32_bf16 v[80:83], a[104:107], v[160:163], 0
    v_mfma_f32_16x16x32_bf16 v[84:87], a[104:107], v[180:183], 0
    v_mfma_f32_16x16x32_bf16 v[80:83], a[108:111], v[164:167], v[80:83]
    v_mfma_f32_16x16x32_bf16 v[84:87], a[108:111], v[184:187], v[84:87]
    v_mfma_f32_16x16x32_bf16 v[80:83], a[112:115], v[168:171], v[80:83]
    v_mfma_f32_16x16x32_bf16 v[84:87], a[112:115], v[188:191], v[84:87]
    v_mfma_f32_16x16x32_bf16 v[80:83], a[116:119], v[172:175], v[80:83]
    v_mfma_f32_16x16x32_bf16 v[84:87], a[116:119], v[192:195], v[84:87]
    v_mfma_f32_16x16x32_bf16 v[80:83], a[120:123], v[176:179], v[80:83]
    v_mfma_f32_16x16x32_bf16 v[84:87], a[120:123], v[196:199], v[84:87]
    ds_read_b128 a[104:107], v4 offset:1664
    ds_read_b128 a[108:111], v4 offset:1680
    ds_read_b128 a[112:115], v4 offset:1696
    ds_read_b128 a[116:119], v4 offset:1712
    ds_read_b128 a[120:123], v4 offset:1728
    s_waitcnt lgkmcnt(10)
    v_mfma_f32_16x16x32_bf16 v[88:91], a[64:67], v[160:163], 0
    v_mfma_f32_16x16x32_bf16 v[92:95], a[64:67], v[180:183], 0
    v_mfma_f32_16x16x32_bf16 v[88:91], a[68:71], v[164:167], v[88:91]
    v_mfma_f32_16x16x32_bf16 v[92:95], a[68:71], v[184:187], v[92:95]
    v_mfma_f32_16x16x32_bf16 v[88:91], a[72:75], v[168:171], v[88:91]
    v_mfma_f32_16x16x32_bf16 v[92:95], a[72:75], v[188:191], v[92:95]
    v_mfma_f32_16x16x32_bf16 v[88:91], a[76:79], v[172:175], v[88:91]
    v_mfma_f32_16x16x32_bf16 v[92:95], a[76:79], v[192:195], v[92:95]
    v_mfma_f32_16x16x32_bf16 v[88:91], a[80:83], v[176:179], v[88:91]
    v_mfma_f32_16x16x32_bf16 v[92:95], a[80:83], v[196:199], v[92:95]
    ds_read_b128 a[64:67], v5 offset:0
    ds_read_b128 a[68:71], v5 offset:16
    ds_read_b128 a[72:75], v5 offset:32
    ds_read_b128 a[76:79], v5 offset:48
    ds_read_b128 a[80:83], v5 offset:64
    s_waitcnt lgkmcnt(10)
    v_mfma_f32_16x16x32_bf16 v[96:99], a[84:87], v[160:163], 0
    v_mfma_f32_16x16x32_bf16 v[100:103], a[84:87], v[180:183], 0
    v_mfma_f32_16x16x32_bf16 v[96:99], a[88:91], v[164:167], v[96:99]
    v_mfma_f32_16x16x32_bf16 v[100:103], a[88:91], v[184:187], v[100:103]
    v_mfma_f32_16x16x32_bf16 v[96:99], a[92:95], v[168:171], v[96:99]
    v_mfma_f32_16x16x32_bf16 v[100:103], a[92:95], v[188:191], v[100:103]
    v_mfma_f32_16x16x32_bf16 v[96:99], a[96:99], v[172:175], v[96:99]
    v_mfma_f32_16x16x32_bf16 v[100:103], a[96:99], v[192:195], v[100:103]
    v_mfma_f32_16x16x32_bf16 v[96:99], a[100:103], v[176:179], v[96:99]
    v_mfma_f32_16x16x32_bf16 v[100:103], a[100:103], v[196:199], v[100:103]
    ds_read_b128 a[84:87], v5 offset:320
    ds_read_b128 a[88:91], v5 offset:336
    ds_read_b128 a[92:95], v5 offset:352
    ds_read_b128 a[96:99], v5 offset:368
    ds_read_b128 a[100:103], v5 offset:384
    s_waitcnt lgkmcnt(10)
    v_mfma_f32_16x16x32_bf16 v[104:107], a[104:107], v[160:163], 0
    v_mfma_f32_16x16x32_bf16 v[108:111], a[104:107], v[180:183], 0
    v_mfma_f32_16x16x32_bf16 v[104:107], a[108:111], v[164:167], v[104:107]
    v_mfma_f32_16x16x32_bf16 v[108:111], a[108:111], v[184:187], v[108:111]
    v_mfma_f32_16x16x32_bf16 v[104:107], a[112:115], v[168:171], v[104:107]
    v_mfma_f32_16x16x32_bf16 v[108:111], a[112:115], v[188:191], v[108:111]
    v_mfma_f32_16x16x32_bf16 v[104:107], a[116:119], v[172:175], v[104:107]
    v_mfma_f32_16x16x32_bf16 v[108:111], a[116:119], v[192:195], v[108:111]
    v_mfma_f32_16x16x32_bf16 v[104:107], a[120:123], v[176:179], v[104:107]
    v_mfma_f32_16x16x32_bf16 v[108:111], a[120:123], v[196:199], v[108:111]
    ds_read_b128 a[104:107], v5 offset:640
    ds_read_b128 a[108:111], v5 offset:656
    ds_read_b128 a[112:115], v5 offset:672
    ds_read_b128 a[116:119], v5 offset:688
    ds_read_b128 a[120:123], v5 offset:704
    s_waitcnt lgkmcnt(10)
    v_mfma_f32_16x16x32_bf16 v[112:115], a[64:67], v[200:203], 0
    v_mfma_f32_16x16x32_bf16 v[116:119], a[64:67], v[220:223], 0
    v_mfma_f32_16x16x32_bf16 v[112:115], a[68:71], v[204:207], v[112:115]
    v_mfma_f32_16x16x32_bf16 v[116:119], a[68:71], v[224:227], v[116:119]
    v_mfma_f32_16x16x32_bf16 v[112:115], a[72:75], v[208:211], v[112:115]
    v_mfma_f32_16x16x32_bf16 v[116:119], a[72:75], v[228:231], v[116:119]
    v_mfma_f32_16x16x32_bf16 v[112:115], a[76:79], v[212:215], v[112:115]
    v_mfma_f32_16x16x32_bf16 v[116:119], a[76:79], v[232:235], v[116:119]
    v_mfma_f32_16x16x32_bf16 v[112:115], a[80:83], v[216:219], v[112:115]
    v_mfma_f32_16x16x32_bf16 v[116:119], a[80:83], v[236:239], v[116:119]
    ds_read_b128 a[64:67], v5 offset:1024
    ds_read_b128 a[68:71], v5 offset:1040
    ds_read_b128 a[72:75], v5 offset:1056
    ds_read_b128 a[76:79], v5 offset:1072
    ds_read_b128 a[80:83], v5 offset:1088
    s_waitcnt lgkmcnt(10)
    v_mfma_f32_16x16x32_bf16 v[120:123], a[84:87], v[200:203], 0
    v_mfma_f32_16x16x32_bf16 v[124:127], a[84:87], v[220:223], 0
    v_mfma_f32_16x16x32_bf16 v[120:123], a[88:91], v[204:207], v[120:123]
    v_mfma_f32_16x16x32_bf16 v[124:127], a[88:91], v[224:227], v[124:127]
    v_mfma_f32_16x16x32_bf16 v[120:123], a[92:95], v[208:211], v[120:123]
    v_mfma_f32_16x16x32_bf16 v[124:127], a[92:95], v[228:231], v[124:127]
    v_mfma_f32_16x16x32_bf16 v[120:123], a[96:99], v[212:215], v[120:123]
    v_mfma_f32_16x16x32_bf16 v[124:127], a[96:99], v[232:235], v[124:127]
    v_mfma_f32_16x16x32_bf16 v[120:123], a[100:103], v[216:219], v[120:123]
    v_mfma_f32_16x16x32_bf16 v[124:127], a[100:103], v[236:239], v[124:127]
    ds_read_b128 a[84:87], v5 offset:1344
    ds_read_b128 a[88:91], v5 offset:1360
    ds_read_b128 a[92:95], v5 offset:1376
    ds_read_b128 a[96:99], v5 offset:1392
    ds_read_b128 a[100:103], v5 offset:1408
    s_waitcnt lgkmcnt(10)
    v_mfma_f32_16x16x32_bf16 v[128:131], a[104:107], v[200:203], 0
    v_mfma_f32_16x16x32_bf16 v[132:135], a[104:107], v[220:223], 0
    v_mfma_f32_16x16x32_bf16 v[128:131], a[108:111], v[204:207], v[128:131]
    v_mfma_f32_16x16x32_bf16 v[132:135], a[108:111], v[224:227], v[132:135]
    v_mfma_f32_16x16x32_bf16 v[128:131], a[112:115], v[208:211], v[128:131]
    v_mfma_f32_16x16x32_bf16 v[132:135], a[112:115], v[228:231], v[132:135]
    v_mfma_f32_16x16x32_bf16 v[128:131], a[116:119], v[212:215], v[128:131]
    v_mfma_f32_16x16x32_bf16 v[132:135], a[116:119], v[232:235], v[132:135]
    v_mfma_f32_16x16x32_bf16 v[128:131], a[120:123], v[216:219], v[128:131]
    v_mfma_f32_16x16x32_bf16 v[132:135], a[120:123], v[236:239], v[132:135]
    v_add_f32 v240, v62, v104
    v_add_f32 v242, v62, v108
    v_rcp_f32 v240, v240
    v_rcp_f32 v242, v242
    v_pk_mul_f32 v[64:65], v[64:65], v[240:241] op_sel_hi:[1,0]
    v_pk_mul_f32 v[66:67], v[66:67], v[240:241] op_sel_hi:[1,0]
    v_cvt_pk_bf16_f32 v22, v64, v65
    v_cvt_pk_bf16_f32 v23, v66, v67
    v_pk_mul_f32 v[72:73], v[72:73], v[240:241] op_sel_hi:[1,0]
    v_pk_mul_f32 v[74:75], v[74:75], v[240:241] op_sel_hi:[1,0]
    v_cvt_pk_bf16_f32 v24, v72, v73
    v_cvt_pk_bf16_f32 v25, v74, v75
    v_pk_mul_f32 v[80:81], v[80:81], v[240:241] op_sel_hi:[1,0]
    v_pk_mul_f32 v[82:83], v[82:83], v[240:241] op_sel_hi:[1,0]
    v_cvt_pk_bf16_f32 v26, v80, v81
    v_cvt_pk_bf16_f32 v27, v82, v83
    v_pk_mul_f32 v[88:89], v[88:89], v[240:241] op_sel_hi:[1,0]
    v_pk_mul_f32 v[90:91], v[90:91], v[240:241] op_sel_hi:[1,0]
    v_cvt_pk_bf16_f32 v28, v88, v89
    v_cvt_pk_bf16_f32 v29, v90, v91
    v_pk_mul_f32 v[96:97], v[96:97], v[240:241] op_sel_hi:[1,0]
    v_pk_mul_f32 v[98:99], v[98:99], v[240:241] op_sel_hi:[1,0]
    v_cvt_pk_bf16_f32 v30, v96, v97
    v_cvt_pk_bf16_f32 v31, v98, v99
    v_pk_mul_f32 v[68:69], v[68:69], v[242:243] op_sel_hi:[1,0]
    v_pk_mul_f32 v[70:71], v[70:71], v[242:243] op_sel_hi:[1,0]
    v_cvt_pk_bf16_f32 v42, v68, v69
    v_cvt_pk_bf16_f32 v43, v70, v71
    v_pk_mul_f32 v[76:77], v[76:77], v[242:243] op_sel_hi:[1,0]
    v_pk_mul_f32 v[78:79], v[78:79], v[242:243] op_sel_hi:[1,0]
    v_cvt_pk_bf16_f32 v44, v76, v77
    v_cvt_pk_bf16_f32 v45, v78, v79
    v_pk_mul_f32 v[84:85], v[84:85], v[242:243] op_sel_hi:[1,0]
    v_pk_mul_f32 v[86:87], v[86:87], v[242:243] op_sel_hi:[1,0]
    v_cvt_pk_bf16_f32 v46, v84, v85
    v_cvt_pk_bf16_f32 v47, v86, v87
    v_pk_mul_f32 v[92:93], v[92:93], v[242:243] op_sel_hi:[1,0]
    v_pk_mul_f32 v[94:95], v[94:95], v[242:243] op_sel_hi:[1,0]
    v_cvt_pk_bf16_f32 v48, v92, v93
    v_cvt_pk_bf16_f32 v49, v94, v95
    v_pk_mul_f32 v[100:101], v[100:101], v[242:243] op_sel_hi:[1,0]
    v_pk_mul_f32 v[102:103], v[102:103], v[242:243] op_sel_hi:[1,0]
    v_cvt_pk_bf16_f32 v50, v100, v101
    v_cvt_pk_bf16_f32 v51, v102, v103
    ds_read_b128 a[104:107], v5 offset:1664
    ds_read_b128 a[108:111], v5 offset:1680
    ds_read_b128 a[112:115], v5 offset:1696
    ds_read_b128 a[116:119], v5 offset:1712
    ds_read_b128 a[120:123], v5 offset:1728
    s_waitcnt lgkmcnt(10)
    v_mfma_f32_16x16x32_bf16 v[136:139], a[64:67], v[200:203], 0
    v_mfma_f32_16x16x32_bf16 v[140:143], a[64:67], v[220:223], 0
    v_mfma_f32_16x16x32_bf16 v[136:139], a[68:71], v[204:207], v[136:139]
    v_mfma_f32_16x16x32_bf16 v[140:143], a[68:71], v[224:227], v[140:143]
    v_mfma_f32_16x16x32_bf16 v[136:139], a[72:75], v[208:211], v[136:139]
    v_mfma_f32_16x16x32_bf16 v[140:143], a[72:75], v[228:231], v[140:143]
    v_mfma_f32_16x16x32_bf16 v[136:139], a[76:79], v[212:215], v[136:139]
    v_mfma_f32_16x16x32_bf16 v[140:143], a[76:79], v[232:235], v[140:143]
    v_mfma_f32_16x16x32_bf16 v[136:139], a[80:83], v[216:219], v[136:139]
    v_mfma_f32_16x16x32_bf16 v[140:143], a[80:83], v[236:239], v[140:143]
    s_waitcnt lgkmcnt(5)
    v_mfma_f32_16x16x32_bf16 v[144:147], a[84:87], v[200:203], 0
    v_mfma_f32_16x16x32_bf16 v[148:151], a[84:87], v[220:223], 0
    v_mfma_f32_16x16x32_bf16 v[144:147], a[88:91], v[204:207], v[144:147]
    v_mfma_f32_16x16x32_bf16 v[148:151], a[88:91], v[224:227], v[148:151]
    v_mfma_f32_16x16x32_bf16 v[144:147], a[92:95], v[208:211], v[144:147]
    v_mfma_f32_16x16x32_bf16 v[148:151], a[92:95], v[228:231], v[148:151]
    v_mfma_f32_16x16x32_bf16 v[144:147], a[96:99], v[212:215], v[144:147]
    v_mfma_f32_16x16x32_bf16 v[148:151], a[96:99], v[232:235], v[148:151]
    v_mfma_f32_16x16x32_bf16 v[144:147], a[100:103], v[216:219], v[144:147]
    v_mfma_f32_16x16x32_bf16 v[148:151], a[100:103], v[236:239], v[148:151]
    s_waitcnt lgkmcnt(0)
    v_mfma_f32_16x16x32_bf16 v[152:155], a[104:107], v[200:203], 0
    v_mfma_f32_16x16x32_bf16 v[156:159], a[104:107], v[220:223], 0
    v_mfma_f32_16x16x32_bf16 v[152:155], a[108:111], v[204:207], v[152:155]
    v_mfma_f32_16x16x32_bf16 v[156:159], a[108:111], v[224:227], v[156:159]
    v_mfma_f32_16x16x32_bf16 v[152:155], a[112:115], v[208:211], v[152:155]
    v_mfma_f32_16x16x32_bf16 v[156:159], a[112:115], v[228:231], v[156:159]
    v_mfma_f32_16x16x32_bf16 v[152:155], a[116:119], v[212:215], v[152:155]
    v_mfma_f32_16x16x32_bf16 v[156:159], a[116:119], v[232:235], v[156:159]
    v_mfma_f32_16x16x32_bf16 v[152:155], a[120:123], v[216:219], v[152:155]
    v_mfma_f32_16x16x32_bf16 v[156:159], a[120:123], v[236:239], v[156:159]
    s_nop 6
    v_add_f32 v240, v62, v152
    v_add_f32 v242, v62, v156
    v_rcp_f32 v240, v240
    v_rcp_f32 v242, v242
    v_pk_mul_f32 v[112:113], v[112:113], v[240:241] op_sel_hi:[1,0]
    v_pk_mul_f32 v[114:115], v[114:115], v[240:241] op_sel_hi:[1,0]
    v_cvt_pk_bf16_f32 v32, v112, v113
    v_cvt_pk_bf16_f32 v33, v114, v115
    v_pk_mul_f32 v[120:121], v[120:121], v[240:241] op_sel_hi:[1,0]
    v_pk_mul_f32 v[122:123], v[122:123], v[240:241] op_sel_hi:[1,0]
    v_cvt_pk_bf16_f32 v34, v120, v121
    v_cvt_pk_bf16_f32 v35, v122, v123
    v_pk_mul_f32 v[128:129], v[128:129], v[240:241] op_sel_hi:[1,0]
    v_pk_mul_f32 v[130:131], v[130:131], v[240:241] op_sel_hi:[1,0]
    v_cvt_pk_bf16_f32 v36, v128, v129
    v_cvt_pk_bf16_f32 v37, v130, v131
    v_pk_mul_f32 v[136:137], v[136:137], v[240:241] op_sel_hi:[1,0]
    v_pk_mul_f32 v[138:139], v[138:139], v[240:241] op_sel_hi:[1,0]
    v_cvt_pk_bf16_f32 v38, v136, v137
    v_cvt_pk_bf16_f32 v39, v138, v139
    v_pk_mul_f32 v[144:145], v[144:145], v[240:241] op_sel_hi:[1,0]
    v_pk_mul_f32 v[146:147], v[146:147], v[240:241] op_sel_hi:[1,0]
    v_cvt_pk_bf16_f32 v40, v144, v145
    v_cvt_pk_bf16_f32 v41, v146, v147
    v_pk_mul_f32 v[116:117], v[116:117], v[242:243] op_sel_hi:[1,0]
    v_pk_mul_f32 v[118:119], v[118:119], v[242:243] op_sel_hi:[1,0]
    v_cvt_pk_bf16_f32 v52, v116, v117
    v_cvt_pk_bf16_f32 v53, v118, v119
    v_pk_mul_f32 v[124:125], v[124:125], v[242:243] op_sel_hi:[1,0]
    v_pk_mul_f32 v[126:127], v[126:127], v[242:243] op_sel_hi:[1,0]
    v_cvt_pk_bf16_f32 v54, v124, v125
    v_cvt_pk_bf16_f32 v55, v126, v127
    v_pk_mul_f32 v[132:133], v[132:133], v[242:243] op_sel_hi:[1,0]
    v_pk_mul_f32 v[134:135], v[134:135], v[242:243] op_sel_hi:[1,0]
    v_cvt_pk_bf16_f32 v56, v132, v133
    v_cvt_pk_bf16_f32 v57, v134, v135
    v_pk_mul_f32 v[140:141], v[140:141], v[242:243] op_sel_hi:[1,0]
    v_pk_mul_f32 v[142:143], v[142:143], v[242:243] op_sel_hi:[1,0]
    v_cvt_pk_bf16_f32 v58, v140, v141
    v_cvt_pk_bf16_f32 v59, v142, v143
    v_pk_mul_f32 v[148:149], v[148:149], v[242:243] op_sel_hi:[1,0]
    v_pk_mul_f32 v[150:151], v[150:151], v[242:243] op_sel_hi:[1,0]
    v_cvt_pk_bf16_f32 v60, v148, v149
    v_cvt_pk_bf16_f32 v61, v150, v151
    buffer_store_dwordx4 v[22:25], v19, s[28:31], s56 offen offset:0 sc1
    buffer_store_dwordx4 v[42:45], v19, s[28:31], s56 offen offset:256 sc1
    s_add_u32 s56, s56, 8192
    buffer_store_dwordx4 v[26:29], v19, s[28:31], s56 offen offset:0 sc1
    buffer_store_dwordx4 v[46:49], v19, s[28:31], s56 offen offset:256 sc1
    s_add_u32 s56, s56, 8192
    buffer_store_dwordx4 v[30:33], v19, s[28:31], s56 offen offset:0 sc1
    buffer_store_dwordx4 v[50:53], v19, s[28:31], s56 offen offset:256 sc1
    s_add_u32 s56, s56, 8192
    buffer_store_dwordx4 v[34:37], v19, s[28:31], s56 offen offset:0 sc1
    buffer_store_dwordx4 v[54:57], v19, s[28:31], s56 offen offset:256 sc1
    s_add_u32 s56, s56, 8192
    buffer_store_dwordx4 v[38:41], v19, s[28:31], s56 offen offset:0 sc1
    buffer_store_dwordx4 v[58:61], v19, s[28:31], s56 offen offset:256 sc1
    s_mul_i32 s76, s42, 4
    s_add_u32 s76, s76, s43
    s_lshl_b32 s76, s76, 7
    s_add_u32 s76, s76, 27394048
    s_barrier
    s_branch L_p3l
L_g2:
    s_sub_u32 s58, s43, 4
    v_lshrrev_b32 v22, 2, v1
    v_and_b32 v24, 6, v22
    v_bfe_u32 v23, v1, 1, 1
    v_xor_b32 v23, v23, v24
    v_lshlrev_b32 v22, 7, v22
    v_lshl_add_u32 v22, v23, 4, v22
    v_and_b32 v23, 1, v1
    v_lshl_add_u32 v4, v23, 3, v22
    v_xor_b32 v5, 32, v4
    v_xor_b32 v6, 64, v4
    v_xor_b32 v7, 96, v4
    v_lshrrev_b32 v22, 4, v1
    v_lshlrev_b32 v22, 11, v22
    v_and_b32 v23, 15, v1
    v_lshl_add_u32 v22, v23, 4, v22
    s_lshl_b32 s44, s41, 9
    v_add_u32 v19, s44, v22
    s_mul_i32 s54, s42, 163840
    s_add_u32 s54, s54, 4980736
    v_mov_b32 v56, v19
    s_lshl_b32 s44, s58, 14
    s_mul_i32 s45, s42, 163840
    s_add_u32 s79, s44, s45
    s_add_u32 s44, s79, 2359296
    s_add_u32 s45, s44, 8192
    s_mov_b32 s80, s44
    s_mov_b32 s81, s45
    s_lshl_b32 s56, s50, 14
    s_add_u32 s56, s56, s54
    s_add_u32 s89, s54, 163840
    v_add_u32 v253, 8192, v19
    buffer_load_dwordx4 a[32:35], v19, s[28:31], s56 offen sc1
    buffer_load_dwordx4 a[36:39], v19, s[28:31], s56 offen offset:256 sc1
    buffer_load_dwordx4 a[40:43], v253, s[28:31], s56 offen sc1
    buffer_load_dwordx4 a[44:47], v253, s[28:31], s56 offen offset:256 sc1
    s_add_u32 s56, s56, 16384
    buffer_load_dwordx4 a[48:51], v19, s[28:31], s56 offen sc1
    buffer_load_dwordx4 a[52:55], v19, s[28:31], s56 offen offset:256 sc1
    buffer_load_dwordx4 a[56:59], v253, s[28:31], s56 offen sc1
    buffer_load_dwordx4 a[60:63], v253, s[28:31], s56 offen offset:256 sc1
    s_add_u32 s56, s56, 16384
    buffer_load_dwordx4 a[64:67], v19, s[28:31], s56 offen sc1
    buffer_load_dwordx4 a[68:71], v19, s[28:31], s56 offen offset:256 sc1
    buffer_load_dwordx4 a[72:75], v253, s[28:31], s56 offen sc1
    buffer_load_dwordx4 a[76:79], v253, s[28:31], s56 offen offset:256 sc1
    s_add_u32 s56, s56, 16384
    buffer_load_dwordx4 v[40:43], v56, s[28:31], s80 offen offset:0 sc1
    buffer_load_dwordx4 v[44:47], v56, s[28:31], s80 offen offset:256 sc1
    buffer_load_dwordx4 v[48:51], v56, s[28:31], s81 offen offset:0 sc1
    buffer_load_dwordx4 v[52:55], v56, s[28:31], s81 offen offset:256 sc1
    s_waitcnt vmcnt(16)
    s_barrier
    v_add_u32 v4, 69632, v4
    v_add_u32 v5, 69632, v5
    v_add_u32 v6, 69632, v6
    v_add_u32 v7, 69632, v7
    ds_read_b64_tr_b16 a[0:1], v4 offset:0
    ds_read_b64_tr_b16 a[2:3], v4 offset:2048
    ds_read_b64_tr_b16 a[4:5], v5 offset:0
    ds_read_b64_tr_b16 a[6:7], v5 offset:2048
    ds_read_b64_tr_b16 a[8:9], v6 offset:0
    ds_read_b64_tr_b16 a[10:11], v6 offset:2048
    ds_read_b64_tr_b16 a[12:13], v7 offset:0
    ds_read_b64_tr_b16 a[14:15], v7 offset:2048
    ds_read_b64_tr_b16 a[16:17], v4 offset:4096
    ds_read_b64_tr_b16 a[18:19], v4 offset:6144
    ds_read_b64_tr_b16 a[20:21], v5 offset:4096
    ds_read_b64_tr_b16 a[22:23], v5 offset:6144
    s_waitcnt vmcnt(14) lgkmcnt(8)
    v_mfma_f32_16x16x32_bf16 v[64:67], a[0:3], a[32:35], 0
    ds_read_b64_tr_b16 a[24:25], v6 offset:4096
    buffer_load_dwordx4 a[80:83], v19, s[28:31], s56 offen sc1
    v_mfma_f32_16x16x32_bf16 v[68:71], a[0:3], a[36:39], 0
    ds_read_b64_tr_b16 a[26:27], v6 offset:6144
    buffer_load_dwordx4 a[84:87], v19, s[28:31], s56 offen offset:256 sc1
    v_mfma_f32_16x16x32_bf16 v[72:75], a[4:7], a[32:35], 0
    ds_read_b64_tr_b16 a[28:29], v7 offset:4096
    buffer_store_dwordx4 v[244:247], v243, s[28:31], s76 offen sc1
    v_mfma_f32_16x16x32_bf16 v[76:79], a[4:7], a[36:39], 0
    ds_read_b64_tr_b16 a[30:31], v7 offset:6144
    s_waitcnt lgkmcnt(8)
    v_mfma_f32_16x16x32_bf16 v[80:83], a[8:11], a[32:35], 0
    ds_read_b64_tr_b16 a[0:1], v4 offset:8192
    v_mfma_f32_16x16x32_bf16 v[84:87], a[8:11], a[36:39], 0
    ds_read_b64_tr_b16 a[2:3], v4 offset:10240
    v_mfma_f32_16x16x32_bf16 v[88:91], a[12:15], a[32:35], 0
    ds_read_b64_tr_b16 a[4:5], v5 offset:8192
    v_mfma_f32_16x16x32_bf16 v[92:95], a[12:15], a[36:39], 0
    ds_read_b64_tr_b16 a[6:7], v5 offset:10240
    s_waitcnt vmcnt(15) lgkmcnt(8)
    v_mfma_f32_16x16x32_bf16 v[64:67], a[16:19], a[40:43], v[64:67]
    ds_read_b64_tr_b16 a[8:9], v6 offset:8192
    buffer_load_dwordx4 a[32:35], v253, s[28:31], s56 offen sc1
    v_mfma_f32_16x16x32_bf16 v[68:71], a[16:19], a[44:47], v[68:71]
    ds_read_b64_tr_b16 a[10:11], v6 offset:10240
    buffer_load_dwordx4 a[36:39], v253, s[28:31], s56 offen offset:256 sc1
    v_mfma_f32_16x16x32_bf16 v[72:75], a[20:23], a[40:43], v[72:75]
    ds_read_b64_tr_b16 a[12:13], v7 offset:8192
    s_add_u32 s56, s56, 16384
    v_mfma_f32_16x16x32_bf16 v[76:79], a[20:23], a[44:47], v[76:79]
    ds_read_b64_tr_b16 a[14:15], v7 offset:10240
    s_waitcnt lgkmcnt(8)
    v_mfma_f32_16x16x32_bf16 v[80:83], a[24:27], a[40:43], v[80:83]
    ds_read_b64_tr_b16 a[16:17], v4 offset:12288
    v_mfma_f32_16x16x32_bf16 v[84:87], a[24:27], a[44:47], v[84:87]
    ds_read_b64_tr_b16 a[18:19], v4 offset:14336
    v_mfma_f32_16x16x32_bf16 v[88:91], a[28:31], a[40:43], v[88:91]
    ds_read_b64_tr_b16 a[20:21], v5 offset:12288
    v_mfma_f32_16x16x32_bf16 v[92:95], a[28:31], a[44:47], v[92:95]
    ds_read_b64_tr_b16 a[22:23], v5 offset:14336
    s_waitcnt vmcnt(15) lgkmcnt(8)
    v_mfma_f32_16x16x32_bf16 v[64:67], a[0:3], a[48:51], v[64:67]
    ds_read_b64_tr_b16 a[24:25], v6 offset:12288
    buffer_load_dwordx4 a[40:43], v19, s[28:31], s56 offen sc1
    v_mfma_f32_16x16x32_bf16 v[68:71], a[0:3], a[52:55], v[68:71]
    ds_read_b64_tr_b16 a[26:27], v6 offset:14336
    buffer_load_dwordx4 a[44:47], v19, s[28:31], s56 offen offset:256 sc1
    v_mfma_f32_16x16x32_bf16 v[72:75], a[4:7], a[48:51], v[72:75]
    ds_read_b64_tr_b16 a[28:29], v7 offset:12288
    v_mfma_f32_16x16x32_bf16 v[76:79], a[4:7], a[52:55], v[76:79]
    ds_read_b64_tr_b16 a[30:31], v7 offset:14336
    s_waitcnt lgkmcnt(8)
    v_mfma_f32_16x16x32_bf16 v[80:83], a[8:11], a[48:51], v[80:83]
    ds_read_b64_tr_b16 a[0:1], v4 offset:16384
    v_mfma_f32_16x16x32_bf16 v[84:87], a[8:11], a[52:55], v[84:87]
    ds_read_b64_tr_b16 a[2:3], v4 offset:18432
    v_mfma_f32_16x16x32_bf16 v[88:91], a[12:15], a[48:51], v[88:91]
    ds_read_b64_tr_b16 a[4:5], v5 offset:16384
    v_mfma_f32_16x16x32_bf16 v[92:95], a[12:15], a[52:55], v[92:95]
    ds_read_b64_tr_b16 a[6:7], v5 offset:18432
    s_waitcnt vmcnt(15) lgkmcnt(8)
    v_mfma_f32_16x16x32_bf16 v[64:67], a[16:19], a[56:59], v[64:67]
    ds_read_b64_tr_b16 a[8:9], v6 offset:16384
    buffer_load_dwordx4 a[48:51], v253, s[28:31], s56 offen sc1
    v_mfma_f32_16x16x32_bf16 v[68:71], a[16:19], a[60:63], v[68:71]
    ds_read_b64_tr_b16 a[10:11], v6 offset:18432
    buffer_load_dwordx4 a[52:55], v253, s[28:31], s56 offen offset:256 sc1
    v_mfma_f32_16x16x32_bf16 v[72:75], a[20:23], a[56:59], v[72:75]
    ds_read_b64_tr_b16 a[12:13], v7 offset:16384
    s_add_u32 s56, s56, 16384
    v_mfma_f32_16x16x32_bf16 v[76:79], a[20:23], a[60:63], v[76:79]
    ds_read_b64_tr_b16 a[14:15], v7 offset:18432
    s_waitcnt lgkmcnt(8)
    v_mfma_f32_16x16x32_bf16 v[80:83], a[24:27], a[56:59], v[80:83]
    ds_read_b64_tr_b16 a[16:17], v4 offset:20480
    v_mfma_f32_16x16x32_bf16 v[84:87], a[24:27], a[60:63], v[84:87]
    ds_read_b64_tr_b16 a[18:19], v4 offset:22528
    v_mfma_f32_16x16x32_bf16 v[88:91], a[28:31], a[56:59], v[88:91]
    ds_read_b64_tr_b16 a[20:21], v5 offset:20480
    v_mfma_f32_16x16x32_bf16 v[92:95], a[28:31], a[60:63], v[92:95]
    ds_read_b64_tr_b16 a[22:23], v5 offset:22528
    s_waitcnt vmcnt(15) lgkmcnt(8)
    v_mfma_f32_16x16x32_bf16 v[64:67], a[0:3], a[64:67], v[64:67]
    ds_read_b64_tr_b16 a[24:25], v6 offset:20480
    buffer_load_dwordx4 a[56:59], v19, s[28:31], s56 offen sc1
    v_mfma_f32_16x16x32_bf16 v[68:71], a[0:3], a[68:71], v[68:71]
    ds_read_b64_tr_b16 a[26:27], v6 offset:22528
    buffer_load_dwordx4 a[60:63], v19, s[28:31], s56 offen offset:256 sc1
    v_mfma_f32_16x16x32_bf16 v[72:75], a[4:7], a[64:67], v[72:75]
    ds_read_b64_tr_b16 a[28:29], v7 offset:20480
    v_mfma_f32_16x16x32_bf16 v[76:79], a[4:7], a[68:71], v[76:79]
    ds_read_b64_tr_b16 a[30:31], v7 offset:22528
    s_waitcnt lgkmcnt(8)
    v_mfma_f32_16x16x32_bf16 v[80:83], a[8:11], a[64:67], v[80:83]
    ds_read_b64_tr_b16 a[0:1], v4 offset:24576
    v_mfma_f32_16x16x32_bf16 v[84:87], a[8:11], a[68:71], v[84:87]
    ds_read_b64_tr_b16 a[2:3], v4 offset:26624
    v_mfma_f32_16x16x32_bf16 v[88:91], a[12:15], a[64:67], v[88:91]
    ds_read_b64_tr_b16 a[4:5], v5 offset:24576
    v_mfma_f32_16x16x32_bf16 v[92:95], a[12:15], a[68:71], v[92:95]
    ds_read_b64_tr_b16 a[6:7], v5 offset:26624
    s_waitcnt vmcnt(11) lgkmcnt(8)
    v_mfma_f32_16x16x32_bf16 v[64:67], a[16:19], a[72:75], v[64:67]
    ds_read_b64_tr_b16 a[8:9], v6 offset:24576
    buffer_load_dwordx4 a[64:67], v253, s[28:31], s56 offen sc1
    v_mfma_f32_16x16x32_bf16 v[68:71], a[16:19], a[76:79], v[68:71]
    ds_read_b64_tr_b16 a[10:11], v6 offset:26624
    buffer_load_dwordx4 a[68:71], v253, s[28:31], s56 offen offset:256 sc1
    v_mfma_f32_16x16x32_bf16 v[72:75], a[20:23], a[72:75], v[72:75]
    ds_read_b64_tr_b16 a[12:13], v7 offset:24576
    s_add_u32 s56, s56, 16384
    v_mfma_f32_16x16x32_bf16 v[76:79], a[20:23], a[76:79], v[76:79]
    ds_read_b64_tr_b16 a[14:15], v7 offset:26624
    s_waitcnt lgkmcnt(8)
    v_mfma_f32_16x16x32_bf16 v[80:83], a[24:27], a[72:75], v[80:83]
    ds_read_b64_tr_b16 a[16:17], v4 offset:28672
    v_mfma_f32_16x16x32_bf16 v[84:87], a[24:27], a[76:79], v[84:87]
    ds_read_b64_tr_b16 a[18:19], v4 offset:30720
    v_mfma_f32_16x16x32_bf16 v[88:91], a[28:31], a[72:75], v[88:91]
    ds_read_b64_tr_b16 a[20:21], v5 offset:28672
    v_mfma_f32_16x16x32_bf16 v[92:95], a[28:31], a[76:79], v[92:95]
    ds_read_b64_tr_b16 a[22:23], v5 offset:30720
    s_waitcnt vmcnt(11) lgkmcnt(8)
    v_mfma_f32_16x16x32_bf16 v[64:67], a[0:3], a[80:83], v[64:67]
    ds_read_b64_tr_b16 a[24:25], v6 offset:28672
    buffer_load_dwordx4 a[72:75], v19, s[28:31], s56 offen sc1
    v_mfma_f32_16x16x32_bf16 v[68:71], a[0:3], a[84:87], v[68:71]
    ds_read_b64_tr_b16 a[26:27], v6 offset:30720
    buffer_load_dwordx4 a[76:79], v19, s[28:31], s56 offen offset:256 sc1
    v_mfma_f32_16x16x32_bf16 v[72:75], a[4:7], a[80:83], v[72:75]
    ds_read_b64_tr_b16 a[28:29], v7 offset:28672
    v_mfma_f32_16x16x32_bf16 v[76:79], a[4:7], a[84:87], v[76:79]
    ds_read_b64_tr_b16 a[30:31], v7 offset:30720
    s_waitcnt lgkmcnt(8)
    v_mfma_f32_16x16x32_bf16 v[80:83], a[8:11], a[80:83], v[80:83]
    ds_read_b64_tr_b16 a[0:1], v4 offset:32768
    v_mfma_f32_16x16x32_bf16 v[84:87], a[8:11], a[84:87], v[84:87]
    ds_read_b64_tr_b16 a[2:3], v4 offset:34816
    v_mfma_f32_16x16x32_bf16 v[88:91], a[12:15], a[80:83], v[88:91]
    ds_read_b64_tr_b16 a[4:5], v5 offset:32768
    v_mfma_f32_16x16x32_bf16 v[92:95], a[12:15], a[84:87], v[92:95]
    ds_read_b64_tr_b16 a[6:7], v5 offset:34816
    s_waitcnt vmcnt(10) lgkmcnt(8)
    v_mfma_f32_16x16x32_bf16 v[64:67], a[16:19], a[32:35], v[64:67]
    ds_read_b64_tr_b16 a[8:9], v6 offset:32768
    buffer_load_dwordx4 a[80:83], v253, s[28:31], s56 offen sc1
    v_mfma_f32_16x16x32_bf16 v[68:71], a[16:19], a[36:39], v[68:71]
    ds_read_b64_tr_b16 a[10:11], v6 offset:34816
    buffer_load_dwordx4 a[84:87], v253, s[28:31], s56 offen offset:256 sc1
    v_mfma_f32_16x16x32_bf16 v[72:75], a[20:23], a[32:35], v[72:75]
    ds_read_b64_tr_b16 a[12:13], v7 offset:32768
    s_add_u32 s56, s56, 16384
    v_mfma_f32_16x16x32_bf16 v[76:79], a[20:23], a[36:39], v[76:79]
    ds_read_b64_tr_b16 a[14:15], v7 offset:34816
    s_waitcnt lgkmcnt(8)
    v_mfma_f32_16x16x32_bf16 v[80:83], a[24:27], a[32:35], v[80:83]
    ds_read_b64_tr_b16 a[16:17], v4 offset:36864
    v_mfma_f32_16x16x32_bf16 v[84:87], a[24:27], a[36:39], v[84:87]
    ds_read_b64_tr_b16 a[18:19], v4 offset:38912
    v_mfma_f32_16x16x32_bf16 v[88:91], a[28:31], a[32:35], v[88:91]
    ds_read_b64_tr_b16 a[20:21], v5 offset:36864
    v_mfma_f32_16x16x32_bf16 v[92:95], a[28:31], a[36:39], v[92:95]
    ds_read_b64_tr_b16 a[22:23], v5 offset:38912
    s_waitcnt vmcnt(10) lgkmcnt(8)
    v_mfma_f32_16x16x32_bf16 v[64:67], a[0:3], a[40:43], v[64:67]
    ds_read_b64_tr_b16 a[24:25], v6 offset:36864
    buffer_load_dwordx4 a[32:35], v19, s[28:31], s56 offen sc1
    v_mfma_f32_16x16x32_bf16 v[68:71], a[0:3], a[44:47], v[68:71]
    ds_read_b64_tr_b16 a[26:27], v6 offset:38912
    buffer_load_dwordx4 a[36:39], v19, s[28:31], s56 offen offset:256 sc1
    v_mfma_f32_16x16x32_bf16 v[72:75], a[4:7], a[40:43], v[72:75]
    ds_read_b64_tr_b16 a[28:29], v7 offset:36864
    v_mfma_f32_16x16x32_bf16 v[76:79], a[4:7], a[44:47], v[76:79]
    ds_read_b64_tr_b16 a[30:31], v7 offset:38912
    s_waitcnt lgkmcnt(8)
    v_mfma_f32_16x16x32_bf16 v[80:83], a[8:11], a[40:43], v[80:83]
    ds_read_b64_tr_b16 a[0:1], v4 offset:40960
    v_mfma_f32_16x16x32_bf16 v[84:87], a[8:11], a[44:47], v[84:87]
    ds_read_b64_tr_b16 a[2:3], v4 offset:43008
    v_mfma_f32_16x16x32_bf16 v[88:91], a[12:15], a[40:43], v[88:91]
    ds_read_b64_tr_b16 a[4:5], v5 offset:40960
    v_mfma_f32_16x16x32_bf16 v[92:95], a[12:15], a[44:47], v[92:95]
    ds_read_b64_tr_b16 a[6:7], v5 offset:43008
    s_waitcnt vmcnt(10) lgkmcnt(8)
    v_mfma_f32_16x16x32_bf16 v[64:67], a[16:19], a[48:51], v[64:67]
    ds_read_b64_tr_b16 a[8:9], v6 offset:40960
    buffer_load_dwordx4 a[40:43], v253, s[28:31], s56 offen sc1
    v_mfma_f32_16x16x32_bf16 v[68:71], a[16:19], a[52:55], v[68:71]
    ds_read_b64_tr_b16 a[10:11], v6 offset:43008
    buffer_load_dwordx4 a[44:47], v253, s[28:31], s56 offen offset:256 sc1
    v_mfma_f32_16x16x32_bf16 v[72:75], a[20:23], a[48:51], v[72:75]
    ds_read_b64_tr_b16 a[12:13], v7 offset:40960
    s_add_u32 s56, s56, 16384
    v_mfma_f32_16x16x32_bf16 v[76:79], a[20:23], a[52:55], v[76:79]
    ds_read_b64_tr_b16 a[14:15], v7 offset:43008
    s_waitcnt lgkmcnt(8)
    v_mfma_f32_16x16x32_bf16 v[80:83], a[24:27], a[48:51], v[80:83]
    ds_read_b64_tr_b16 a[16:17], v4 offset:45056
    v_mfma_f32_16x16x32_bf16 v[84:87], a[24:27], a[52:55], v[84:87]
    ds_read_b64_tr_b16 a[18:19], v4 offset:47104
    v_mfma_f32_16x16x32_bf16 v[88:91], a[28:31], a[48:51], v[88:91]
    ds_read_b64_tr_b16 a[20:21], v5 offset:45056
    v_mfma_f32_16x16x32_bf16 v[92:95], a[28:31], a[52:55], v[92:95]
    ds_read_b64_tr_b16 a[22:23], v5 offset:47104
    s_waitcnt vmcnt(10) lgkmcnt(8)
    v_mfma_f32_16x16x32_bf16 v[64:67], a[0:3], a[56:59], v[64:67]
    ds_read_b64_tr_b16 a[24:25], v6 offset:45056
    buffer_load_dwordx4 a[48:51], v19, s[28:31], s56 offen sc1
    v_mfma_f32_16x16x32_bf16 v[68:71], a[0:3], a[60:63], v[68:71]
    ds_read_b64_tr_b16 a[26:27], v6 offset:47104
    buffer_load_dwordx4 a[52:55], v19, s[28:31], s56 offen offset:256 sc1
    v_mfma_f32_16x16x32_bf16 v[72:75], a[4:7], a[56:59], v[72:75]
    ds_read_b64_tr_b16 a[28:29], v7 offset:45056
    v_mfma_f32_16x16x32_bf16 v[76:79], a[4:7], a[60:63], v[76:79]
    ds_read_b64_tr_b16 a[30:31], v7 offset:47104
    s_waitcnt lgkmcnt(8)
    v_mfma_f32_16x16x32_bf16 v[80:83], a[8:11], a[56:59], v[80:83]
    ds_read_b64_tr_b16 a[0:1], v4 offset:49152
    v_mfma_f32_16x16x32_bf16 v[84:87], a[8:11], a[60:63], v[84:87]
    ds_read_b64_tr_b16 a[2:3], v4 offset:51200
    v_mfma_f32_16x16x32_bf16 v[88:91], a[12:15], a[56:59], v[88:91]
    ds_read_b64_tr_b16 a[4:5], v5 offset:49152
    v_mfma_f32_16x16x32_bf16 v[92:95], a[12:15], a[60:63], v[92:95]
    ds_read_b64_tr_b16 a[6:7], v5 offset:51200
    s_waitcnt vmcnt(10) lgkmcnt(8)
    v_mfma_f32_16x16x32_bf16 v[64:67], a[16:19], a[64:67], v[64:67]
    ds_read_b64_tr_b16 a[8:9], v6 offset:49152
    buffer_load_dwordx4 a[56:59], v253, s[28:31], s56 offen sc1
    v_mfma_f32_16x16x32_bf16 v[68:71], a[16:19], a[68:71], v[68:71]
    ds_read_b64_tr_b16 a[10:11], v6 offset:51200
    buffer_load_dwordx4 a[60:63], v253, s[28:31], s56 offen offset:256 sc1
    v_mfma_f32_16x16x32_bf16 v[72:75], a[20:23], a[64:67], v[72:75]
    ds_read_b64_tr_b16 a[12:13], v7 offset:49152
    s_add_u32 s56, s56, 16384
    v_mfma_f32_16x16x32_bf16 v[76:79], a[20:23], a[68:71], v[76:79]
    ds_read_b64_tr_b16 a[14:15], v7 offset:51200
    s_waitcnt lgkmcnt(8)
    v_mfma_f32_16x16x32_bf16 v[80:83], a[24:27], a[64:67], v[80:83]
    ds_read_b64_tr_b16 a[16:17], v4 offset:53248
    v_mfma_f32_16x16x32_bf16 v[84:87], a[24:27], a[68:71], v[84:87]
    ds_read_b64_tr_b16 a[18:19], v4 offset:55296
    v_mfma_f32_16x16x32_bf16 v[88:91], a[28:31], a[64:67], v[88:91]
    ds_read_b64_tr_b16 a[20:21], v5 offset:53248
    v_mfma_f32_16x16x32_bf16 v[92:95], a[28:31], a[68:71], v[92:95]
    ds_read_b64_tr_b16 a[22:23], v5 offset:55296
    s_waitcnt vmcnt(10) lgkmcnt(8)
    v_mfma_f32_16x16x32_bf16 v[64:67], a[0:3], a[72:75], v[64:67]
    ds_read_b64_tr_b16 a[24:25], v6 offset:53248
    buffer_load_dwordx4 a[64:67], v19, s[28:31], s56 offen sc1
    v_mfma_f32_16x16x32_bf16 v[68:71], a[0:3], a[76:79], v[68:71]
    ds_read_b64_tr_b16 a[26:27], v6 offset:55296
    buffer_load_dwordx4 a[68:71], v19, s[28:31], s56 offen offset:256 sc1
    v_mfma_f32_16x16x32_bf16 v[72:75], a[4:7], a[72:75], v[72:75]
    ds_read_b64_tr_b16 a[28:29], v7 offset:53248
    v_mfma_f32_16x16x32_bf16 v[76:79], a[4:7], a[76:79], v[76:79]
    ds_read_b64_tr_b16 a[30:31], v7 offset:55296
    s_waitcnt lgkmcnt(8)
    v_mfma_f32_16x16x32_bf16 v[80:83], a[8:11], a[72:75], v[80:83]
    ds_read_b64_tr_b16 a[0:1], v4 offset:57344
    v_mfma_f32_16x16x32_bf16 v[84:87], a[8:11], a[76:79], v[84:87]
    ds_read_b64_tr_b16 a[2:3], v4 offset:59392
    v_mfma_f32_16x16x32_bf16 v[88:91], a[12:15], a[72:75], v[88:91]
    ds_read_b64_tr_b16 a[4:5], v5 offset:57344
    v_mfma_f32_16x16x32_bf16 v[92:95], a[12:15], a[76:79], v[92:95]
    ds_read_b64_tr_b16 a[6:7], v5 offset:59392
    s_waitcnt vmcnt(10) lgkmcnt(8)
    v_mfma_f32_16x16x32_bf16 v[64:67], a[16:19], a[80:83], v[64:67]
    ds_read_b64_tr_b16 a[8:9], v6 offset:57344
    buffer_load_dwordx4 a[72:75], v253, s[28:31], s56 offen sc1
    v_mfma_f32_16x16x32_bf16 v[68:71], a[16:19], a[84:87], v[68:71]
    ds_read_b64_tr_b16 a[10:11], v6 offset:59392
    buffer_load_dwordx4 a[76:79], v253, s[28:31], s56 offen offset:256 sc1
    v_mfma_f32_16x16x32_bf16 v[72:75], a[20:23], a[80:83], v[72:75]
    ds_read_b64_tr_b16 a[12:13], v7 offset:57344
    v_mfma_f32_16x16x32_bf16 v[76:79], a[20:23], a[84:87], v[76:79]
    ds_read_b64_tr_b16 a[14:15], v7 offset:59392
    s_waitcnt lgkmcnt(8)
    v_mfma_f32_16x16x32_bf16 v[80:83], a[24:27], a[80:83], v[80:83]
    ds_read_b64_tr_b16 a[16:17], v4 offset:61440
    v_mfma_f32_16x16x32_bf16 v[84:87], a[24:27], a[84:87], v[84:87]
    ds_read_b64_tr_b16 a[18:19], v4 offset:63488
    v_mfma_f32_16x16x32_bf16 v[88:91], a[28:31], a[80:83], v[88:91]
    ds_read_b64_tr_b16 a[20:21], v5 offset:61440
    v_mfma_f32_16x16x32_bf16 v[92:95], a[28:31], a[84:87], v[92:95]
    ds_read_b64_tr_b16 a[22:23], v5 offset:63488
    s_waitcnt vmcnt(10) lgkmcnt(8)
    v_mfma_f32_16x16x32_bf16 v[64:67], a[0:3], a[32:35], v[64:67]
    ds_read_b64_tr_b16 a[24:25], v6 offset:61440
    v_mfma_f32_16x16x32_bf16 v[68:71], a[0:3], a[36:39], v[68:71]
    ds_read_b64_tr_b16 a[26:27], v6 offset:63488
    v_mfma_f32_16x16x32_bf16 v[72:75], a[4:7], a[32:35], v[72:75]
    ds_read_b64_tr_b16 a[28:29], v7 offset:61440
    v_mfma_f32_16x16x32_bf16 v[76:79], a[4:7], a[36:39], v[76:79]
    ds_read_b64_tr_b16 a[30:31], v7 offset:63488
    s_waitcnt lgkmcnt(8)
    v_mfma_f32_16x16x32_bf16 v[80:83], a[8:11], a[32:35], v[80:83]
    v_add_u32 v4, 65536, v4
    v_add_u32 v5, 65536, v5
    v_add_u32 v6, 65536, v6
    v_add_u32 v7, 65536, v7
    ds_read_b64_tr_b16 a[0:1], v4 offset:0
    v_mfma_f32_16x16x32_bf16 v[84:87], a[8:11], a[36:39], v[84:87]
    ds_read_b64_tr_b16 a[2:3], v4 offset:2048
    v_mfma_f32_16x16x32_bf16 v[88:91], a[12:15], a[32:35], v[88:91]
    ds_read_b64_tr_b16 a[4:5], v5 offset:0
    v_mfma_f32_16x16x32_bf16 v[92:95], a[12:15], a[36:39], v[92:95]
    ds_read_b64_tr_b16 a[6:7], v5 offset:2048
    s_waitcnt vmcnt(8) lgkmcnt(8)
    v_mfma_f32_16x16x32_bf16 v[64:67], a[16:19], a[40:43], v[64:67]
    ds_read_b64_tr_b16 a[8:9], v6 offset:0
    v_mfma_f32_16x16x32_bf16 v[68:71], a[16:19], a[44:47], v[68:71]
    ds_read_b64_tr_b16 a[10:11], v6 offset:2048
    v_mfma_f32_16x16x32_bf16 v[72:75], a[20:23], a[40:43], v[72:75]
    ds_read_b64_tr_b16 a[12:13], v7 offset:0
    v_mfma_f32_16x16x32_bf16 v[76:79], a[20:23], a[44:47], v[76:79]
    ds_read_b64_tr_b16 a[14:15], v7 offset:2048
    s_waitcnt lgkmcnt(8)
    v_mfma_f32_16x16x32_bf16 v[80:83], a[24:27], a[40:43], v[80:83]
    ds_read_b64_tr_b16 a[16:17], v4 offset:4096
    v_mfma_f32_16x16x32_bf16 v[84:87], a[24:27], a[44:47], v[84:87]
    ds_read_b64_tr_b16 a[18:19], v4 offset:6144
    v_mfma_f32_16x16x32_bf16 v[88:91], a[28:31], a[40:43], v[88:91]
    ds_read_b64_tr_b16 a[20:21], v5 offset:4096
    v_mfma_f32_16x16x32_bf16 v[92:95], a[28:31], a[44:47], v[92:95]
    ds_read_b64_tr_b16 a[22:23], v5 offset:6144
    s_waitcnt vmcnt(6) lgkmcnt(8)
    v_mfma_f32_16x16x32_bf16 v[64:67], a[0:3], a[48:51], v[64:67]
    ds_read_b64_tr_b16 a[24:25], v6 offset:4096
    v_mfma_f32_16x16x32_bf16 v[68:71], a[0:3], a[52:55], v[68:71]
    ds_read_b64_tr_b16 a[26:27], v6 offset:6144
    v_mfma_f32_16x16x32_bf16 v[72:75], a[4:7], a[48:51], v[72:75]
    ds_read_b64_tr_b16 a[28:29], v7 offset:4096
    v_mfma_f32_16x16x32_bf16 v[76:79], a[4:7], a[52:55], v[76:79]
    ds_read_b64_tr_b16 a[30:31], v7 offset:6144
    s_waitcnt lgkmcnt(8)
    v_mfma_f32_16x16x32_bf16 v[80:83], a[8:11], a[48:51], v[80:83]
    ds_read_b64_tr_b16 a[0:1], v4 offset:8192
    v_mfma_f32_16x16x32_bf16 v[84:87], a[8:11], a[52:55], v[84:87]
    ds_read_b64_tr_b16 a[2:3], v4 offset:10240
    v_mfma_f32_16x16x32_bf16 v[88:91], a[12:15], a[48:51], v[88:91]
    ds_read_b64_tr_b16 a[4:5], v5 offset:8192
    v_mfma_f32_16x16x32_bf16 v[92:95], a[12:15], a[52:55], v[92:95]
    ds_read_b64_tr_b16 a[6:7], v5 offset:10240
    s_waitcnt vmcnt(4) lgkmcnt(8)
    v_mfma_f32_16x16x32_bf16 v[64:67], a[16:19], a[56:59], v[64:67]
    ds_read_b64_tr_b16 a[8:9], v6 offset:8192
    v_mfma_f32_16x16x32_bf16 v[68:71], a[16:19], a[60:63], v[68:71]
    ds_read_b64_tr_b16 a[10:11], v6 offset:10240
    v_mfma_f32_16x16x32_bf16 v[72:75], a[20:23], a[56:59], v[72:75]
    ds_read_b64_tr_b16 a[12:13], v7 offset:8192
    v_mfma_f32_16x16x32_bf16 v[76:79], a[20:23], a[60:63], v[76:79]
    ds_read_b64_tr_b16 a[14:15], v7 offset:10240
    s_waitcnt lgkmcnt(8)
    v_mfma_f32_16x16x32_bf16 v[80:83], a[24:27], a[56:59], v[80:83]
    ds_read_b64_tr_b16 a[16:17], v4 offset:12288
    v_mfma_f32_16x16x32_bf16 v[84:87], a[24:27], a[60:63], v[84:87]
    ds_read_b64_tr_b16 a[18:19], v4 offset:14336
    v_mfma_f32_16x16x32_bf16 v[88:91], a[28:31], a[56:59], v[88:91]
    ds_read_b64_tr_b16 a[20:21], v5 offset:12288
    v_mfma_f32_16x16x32_bf16 v[92:95], a[28:31], a[60:63], v[92:95]
    ds_read_b64_tr_b16 a[22:23], v5 offset:14336
    s_waitcnt vmcnt(2) lgkmcnt(8)
    v_mfma_f32_16x16x32_bf16 v[64:67], a[0:3], a[64:67], v[64:67]
    ds_read_b64_tr_b16 a[24:25], v6 offset:12288
    v_mfma_f32_16x16x32_bf16 v[68:71], a[0:3], a[68:71], v[68:71]
    ds_read_b64_tr_b16 a[26:27], v6 offset:14336
    v_mfma_f32_16x16x32_bf16 v[72:75], a[4:7], a[64:67], v[72:75]
    ds_read_b64_tr_b16 a[28:29], v7 offset:12288
    v_mfma_f32_16x16x32_bf16 v[76:79], a[4:7], a[68:71], v[76:79]
    ds_read_b64_tr_b16 a[30:31], v7 offset:14336
    s_waitcnt lgkmcnt(8)
    v_mfma_f32_16x16x32_bf16 v[80:83], a[8:11], a[64:67], v[80:83]
    v_mfma_f32_16x16x32_bf16 v[84:87], a[8:11], a[68:71], v[84:87]
    v_mfma_f32_16x16x32_bf16 v[88:91], a[12:15], a[64:67], v[88:91]
    v_mfma_f32_16x16x32_bf16 v[92:95], a[12:15], a[68:71], v[92:95]
    s_waitcnt vmcnt(0) lgkmcnt(4)
    v_mfma_f32_16x16x32_bf16 v[64:67], a[16:19], a[72:75], v[64:67]
    v_mfma_f32_16x16x32_bf16 v[68:71], a[16:19], a[76:79], v[68:71]
    v_mfma_f32_16x16x32_bf16 v[72:75], a[20:23], a[72:75], v[72:75]
    v_mfma_f32_16x16x32_bf16 v[76:79], a[20:23], a[76:79], v[76:79]
    s_waitcnt lgkmcnt(0)
    v_mfma_f32_16x16x32_bf16 v[80:83], a[24:27], a[72:75], v[80:83]
    v_mfma_f32_16x16x32_bf16 v[84:87], a[24:27], a[76:79], v[84:87]
    v_mfma_f32_16x16x32_bf16 v[88:91], a[28:31], a[72:75], v[88:91]
    v_mfma_f32_16x16x32_bf16 v[92:95], a[28:31], a[76:79], v[92:95]
    v_add_u32 v4, 4294832128, v4
    v_add_u32 v5, 4294832128, v5
    v_add_u32 v6, 4294832128, v6
    v_add_u32 v7, 4294832128, v7
    s_barrier
    s_sub_u32 s83, s43, 4
    s_lshl_b32 s83, s83, 1
    s_mov_b32 s32, s18
    s_mov_b32 s33, s19
    s_mov_b32 s34, 2211840
    s_mov_b32 s35, 0x20000
    v_lshrrev_b32 v22, 4, v1
    v_and_b32 v23, 15, v1
    v_lshlrev_b32 v24, 1, v22
    v_xor_b32 v23, v23, v24
    v_mul_u32_u24 v22, 3456, v22
    v_lshl_add_u32 v14, v23, 4, v22
    v_xor_b32 v23, 8, v23
    v_lshl_add_u32 v15, v23, 4, v22
    v_add_u32 v16, 25600, v14
    v_add_u32 v17, 38400, v15
    v_add_u32 v15, 12800, v15
    s_lshl_b32 s53, s41, 12
    s_lshl_b32 s78, s83, 7
    s_lshl_b32 s44, s41, 4
    s_mul_i32 s44, s44, 3456
    s_add_u32 s51, s44, s78
    s_mov_b32 s50, 0
    v_lshlrev_b32 v96, 16, v40
    v_and_b32 v97, 0xffff0000, v40
    v_lshlrev_b32 v98, 16, v41
    v_and_b32 v99, 0xffff0000, v41
    v_pk_add_f32 v[96:97], v[96:97], v[64:65]
    v_pk_add_f32 v[98:99], v[98:99], v[66:67]
    v_cvt_pk_bf16_f32 v40, v96, v97
    v_cvt_pk_bf16_f32 v41, v98, v99
    v_lshlrev_b32 v104, 16, v42
    v_and_b32 v105, 0xffff0000, v42
    v_lshlrev_b32 v106, 16, v43
    v_and_b32 v107, 0xffff0000, v43
    v_pk_add_f32 v[104:105], v[104:105], v[72:73]
    v_pk_add_f32 v[106:107], v[106:107], v[74:75]
    v_cvt_pk_bf16_f32 v42, v104, v105
    v_cvt_pk_bf16_f32 v43, v106, v107
    s_mul_i32 s55, s50, 221184
    s_add_u32 s55, s55, s51
    s_mov_b32 s90, 2211840
    s_add_u32 s90, s90, s51
    s_add_u32 m0, s53, 0
    s_nop 0
    buffer_load_dwordx4 v14, s[32:35], s55 offen offset:0 lds
    v_lshlrev_b32 v100, 16, v44
    v_and_b32 v101, 0xffff0000, v44
    v_lshlrev_b32 v102, 16, v45
    v_and_b32 v103, 0xffff0000, v45
    v_pk_add_f32 v[100:101], v[100:101], v[68:69]
    v_pk_add_f32 v[102:103], v[102:103], v[70:71]
    v_cvt_pk_bf16_f32 v44, v100, v101
    v_cvt_pk_bf16_f32 v45, v102, v103
    v_lshlrev_b32 v108, 16, v46
    v_and_b32 v109, 0xffff0000, v46
    v_lshlrev_b32 v110, 16, v47
    v_and_b32 v111, 0xffff0000, v47
    v_pk_add_f32 v[108:109], v[108:109], v[76:77]
    v_pk_add_f32 v[110:111], v[110:111], v[78:79]
    v_cvt_pk_bf16_f32 v46, v108, v109
    v_cvt_pk_bf16_f32 v47, v110, v111
    buffer_load_dwordx4 v15, s[32:35], s55 offen offset:1024 lds
    v_lshlrev_b32 v112, 16, v48
    v_and_b32 v113, 0xffff0000, v48
    v_lshlrev_b32 v114, 16, v49
    v_and_b32 v115, 0xffff0000, v49
    v_pk_add_f32 v[112:113], v[112:113], v[80:81]
    v_pk_add_f32 v[114:115], v[114:115], v[82:83]
    v_cvt_pk_bf16_f32 v48, v112, v113
    v_cvt_pk_bf16_f32 v49, v114, v115
    v_lshlrev_b32 v120, 16, v50
    v_and_b32 v121, 0xffff0000, v50
    v_lshlrev_b32 v122, 16, v51
    v_and_b32 v123, 0xffff0000, v51
    v_pk_add_f32 v[120:121], v[120:121], v[88:89]
    v_pk_add_f32 v[122:123], v[122:123], v[90:91]
    v_cvt_pk_bf16_f32 v50, v120, v121
    v_cvt_pk_bf16_f32 v51, v122, v123
    buffer_load_dwordx4 v16, s[32:35], s55 offen offset:2048 lds
    v_lshlrev_b32 v116, 16, v52
    v_and_b32 v117, 0xffff0000, v52
    v_lshlrev_b32 v118, 16, v53
    v_and_b32 v119, 0xffff0000, v53
    v_pk_add_f32 v[116:117], v[116:117], v[84:85]
    v_pk_add_f32 v[118:119], v[118:119], v[86:87]
    v_cvt_pk_bf16_f32 v52, v116, v117
    v_cvt_pk_bf16_f32 v53, v118, v119
    v_lshlrev_b32 v124, 16, v54
    v_and_b32 v125, 0xffff0000, v54
    v_lshlrev_b32 v126, 16, v55
    v_and_b32 v127, 0xffff0000, v55
    v_pk_add_f32 v[124:125], v[124:125], v[92:93]
    v_pk_add_f32 v[126:127], v[126:127], v[94:95]
    v_cvt_pk_bf16_f32 v54, v124, v125
    v_cvt_pk_bf16_f32 v55, v126, v127
    buffer_load_dwordx4 v17, s[32:35], s55 offen offset:3072 lds
    s_add_u32 s55, s55, 221184
    s_add_u32 s80, s79, 7667712
    s_mov_b32 s91, s80
    s_add_u32 s81, s80, 8192
    buffer_store_dwordx4 v[40:43], v56, s[28:31], s80 offen offset:0 sc1
    buffer_store_dwordx4 v[44:47], v56, s[28:31], s80 offen offset:256 sc1
    buffer_store_dwordx4 v[48:51], v56, s[28:31], s81 offen offset:0 sc1
    buffer_store_dwordx4 v[52:55], v56, s[28:31], s81 offen offset:256 sc1
    v_lshlrev_b32 v96, 16, v40
    v_and_b32 v97, 0xffff0000, v40
    v_lshlrev_b32 v98, 16, v41
    v_and_b32 v99, 0xffff0000, v41
    v_lshlrev_b32 v104, 16, v42
    v_and_b32 v105, 0xffff0000, v42
    v_lshlrev_b32 v106, 16, v43
    v_and_b32 v107, 0xffff0000, v43
    v_lshlrev_b32 v100, 16, v44
    v_and_b32 v101, 0xffff0000, v44
    v_lshlrev_b32 v102, 16, v45
    v_and_b32 v103, 0xffff0000, v45
    v_lshlrev_b32 v108, 16, v46
    v_and_b32 v109, 0xffff0000, v46
    v_lshlrev_b32 v110, 16, v47
    v_and_b32 v111, 0xffff0000, v47
    v_lshlrev_b32 v112, 16, v48
    v_and_b32 v113, 0xffff0000, v48
    v_lshlrev_b32 v114, 16, v49
    v_and_b32 v115, 0xffff0000, v49
    v_lshlrev_b32 v120, 16, v50
    v_and_b32 v121, 0xffff0000, v50
    v_lshlrev_b32 v122, 16, v51
    v_and_b32 v123, 0xffff0000, v51
    v_lshlrev_b32 v116, 16, v52
    v_and_b32 v117, 0xffff0000, v52
    v_lshlrev_b32 v118, 16, v53
    v_and_b32 v119, 0xffff0000, v53
    v_lshlrev_b32 v124, 16, v54
    v_and_b32 v125, 0xffff0000, v54
    v_lshlrev_b32 v126, 16, v55
    v_and_b32 v127, 0xffff0000, v55
    v_pk_mul_f32 v[26:27], v[96:97], v[96:97]
    v_pk_add_f32 v[22:23], v[96:97], v[98:99]
    v_pk_fma_f32 v[26:27], v[98:99], v[98:99], v[26:27]
    v_pk_fma_f32 v[26:27], v[104:105], v[104:105], v[26:27]
    v_pk_add_f32 v[22:23], v[22:23], v[104:105]
    v_pk_fma_f32 v[26:27], v[106:107], v[106:107], v[26:27]
    v_pk_add_f32 v[22:23], v[22:23], v[106:107]
    v_pk_fma_f32 v[26:27], v[112:113], v[112:113], v[26:27]
    v_pk_add_f32 v[22:23], v[22:23], v[112:113]
    v_pk_fma_f32 v[26:27], v[114:115], v[114:115], v[26:27]
    v_pk_add_f32 v[22:23], v[22:23], v[114:115]
    v_pk_fma_f32 v[26:27], v[120:121], v[120:121], v[26:27]
    v_pk_add_f32 v[22:23], v[22:23], v[120:121]
    v_pk_fma_f32 v[26:27], v[122:123], v[122:123], v[26:27]
    v_pk_add_f32 v[22:23], v[22:23], v[122:123]
    v_pk_mul_f32 v[28:29], v[100:101], v[100:101]
    v_pk_add_f32 v[24:25], v[100:101], v[102:103]
    v_pk_fma_f32 v[28:29], v[102:103], v[102:103], v[28:29]
    v_pk_fma_f32 v[28:29], v[108:109], v[108:109], v[28:29]
    v_pk_add_f32 v[24:25], v[24:25], v[108:109]
    v_pk_fma_f32 v[28:29], v[110:111], v[110:111], v[28:29]
    v_pk_add_f32 v[24:25], v[24:25], v[110:111]
    v_pk_fma_f32 v[28:29], v[116:117], v[116:117], v[28:29]
    v_pk_add_f32 v[24:25], v[24:25], v[116:117]
    v_pk_fma_f32 v[28:29], v[118:119], v[118:119], v[28:29]
    v_pk_add_f32 v[24:25], v[24:25], v[118:119]
    v_pk_fma_f32 v[28:29], v[124:125], v[124:125], v[28:29]
    v_pk_add_f32 v[24:25], v[24:25], v[124:125]
    v_pk_fma_f32 v[28:29], v[126:127], v[126:127], v[28:29]
    v_pk_add_f32 v[24:25], v[24:25], v[126:127]
    v_add_f32 v22, v22, v23
    v_add_f32 v23, v26, v27
    v_add_f32 v24, v24, v25
    v_add_f32 v25, v28, v29
    v_mov_b32 v26, v22
    v_mov_b32 v27, v23
    v_mov_b32 v28, v24
    v_mov_b32 v29, v25
    v_permlane16_swap_b32 v22, v26
    v_permlane16_swap_b32 v23, v27
    v_permlane16_swap_b32 v24, v28
    v_permlane16_swap_b32 v25, v29
    v_add_f32 v22, v22, v26
    v_add_f32 v23, v23, v27
    v_add_f32 v24, v24, v28
    v_add_f32 v25, v25, v29
    v_mov_b32 v26, v22
    v_mov_b32 v27, v23
    v_mov_b32 v28, v24
    v_mov_b32 v29, v25
    v_permlane32_swap_b32 v22, v26
    v_permlane32_swap_b32 v23, v27
    v_permlane32_swap_b32 v24, v28
    v_permlane32_swap_b32 v25, v29
    v_add_f32 v22, v22, v26
    v_add_f32 v23, v23, v27
    v_add_f32 v24, v24, v28
    v_add_f32 v25, v25, v29
    v_lshlrev_b32 v30, 3, v1
    v_mov_b32 v31, 1073741824
    v_cmp_gt_u32 vcc, 16, v1
    s_nop 1
    v_cndmask_b32 v30, v31, v30, vcc
    s_mul_i32 s44, s42, 10
    s_add_u32 s44, s44, s58
    s_lshl_b32 s44, s44, 10
    s_lshl_b32 s45, s41, 8
    s_add_u32 s44, s44, s45
    s_add_u32 s44, s44, 102400
    buffer_store_dwordx2 v[22:23], v30, s[28:31], s44 offen offset:0 sc1
    buffer_store_dwordx2 v[24:25], v30, s[28:31], s44 offen offset:128 sc1
    s_mul_i32 s76, s42, 16
    s_add_u32 s76, s76, s58
    s_lshl_b32 s76, s76, 7
    s_add_u32 s76, s76, 27328512
L_p3b:
    s_mov_b32 s58, s83
    v_lshrrev_b32 v22, 2, v1
    v_and_b32 v24, 7, v22
    v_lshlrev_b32 v24, 1, v24
    v_bfe_u32 v23, v1, 1, 1
    v_xor_b32 v23, v23, v24
    v_lshlrev_b32 v22, 8, v22
    v_lshl_add_u32 v22, v23, 4, v22
    v_and_b32 v23, 1, v1
    v_lshl_add_u32 v4, v23, 3, v22
    v_xor_b32 v5, 32, v4
    v_xor_b32 v6, 64, v4
    v_xor_b32 v7, 96, v4
    v_xor_b32 v8, 128, v4
    v_xor_b32 v9, 160, v4
    v_xor_b32 v10, 192, v4
    v_xor_b32 v11, 224, v4
    s_mul_i32 s44, s42, 16
    s_lshl_b32 s44, s44, 7
    s_add_u32 s44, s44, 27328512
    v_lshlrev_b32 v22, 7, v1
    v_add_u32 v22, s44, v22
    v_bfe_u32 v23, v1, 3, 1
    v_add_u32 v23, s58, v23
    v_and_b32 v24, 7, v1
    v_lshl_add_u32 v23, v23, 3, v24
    v_lshlrev_b32 v23, 7, v23
    v_add_u32 v23, 27418624, v23
    v_cmp_gt_u32 vcc, 16, v1
    s_nop 1
    v_cndmask_b32 v22, v23, v22, vcc
    s_waitcnt vmcnt(0)
    s_barrier
    s_cmp_lg_u32 s41, 0
    s_cbranch_scc1 L_e1_14
    s_mov_b32 exec_lo, 522126335
    s_mov_b32 exec_hi, 0
    buffer_load_dword v63, v22, s[28:31], 0 offen sc1
    s_mov_b64 exec, -1
    buffer_store_dwordx4 v[244:247], v243, s[28:31], s76 offen sc1
    buffer_store_dwordx4 v[244:247], v243, s[28:31], s77 offen sc1
L_e1_14:
    s_mov_b32 s77, 1073741824
    s_add_u32 m0, s53, 16384
    s_nop 0
    buffer_load_dwordx4 v14, s[32:35], s55 offen offset:0 lds
    buffer_load_dwordx4 v15, s[32:35], s55 offen offset:1024 lds
    buffer_load_dwordx4 v16, s[32:35], s55 offen offset:2048 lds
    buffer_load_dwordx4 v17, s[32:35], s55 offen offset:3072 lds
    s_add_u32 s55, s55, 221184
    s_add_u32 m0, s53, 32768
    s_nop 0
    buffer_load_dwordx4 v14, s[32:35], s55 offen offset:0 lds
    buffer_load_dwordx4 v15, s[32:35], s55 offen offset:1024 lds
    buffer_load_dwordx4 v16, s[32:35], s55 offen offset:2048 lds
    buffer_load_dwordx4 v17, s[32:35], s55 offen offset:3072 lds
    s_add_u32 s55, s55, 221184
    s_add_u32 m0, s53, 49152
    s_nop 0
    buffer_load_dwordx4 v14, s[32:35], s55 offen offset:0 lds
    buffer_load_dwordx4 v15, s[32:35], s55 offen offset:1024 lds
    buffer_load_dwordx4 v16, s[32:35], s55 offen offset:2048 lds
    buffer_load_dwordx4 v17, s[32:35], s55 offen offset:3072 lds
    s_add_u32 s55, s55, 221184
    s_add_u32 m0, s53, 65536
    s_nop 0
    buffer_load_dwordx4 v14, s[32:35], s55 offen offset:0 lds
    buffer_load_dwordx4 v15, s[32:35], s55 offen offset:1024 lds
    buffer_load_dwordx4 v16, s[32:35], s55 offen offset:2048 lds
    buffer_load_dwordx4 v17, s[32:35], s55 offen offset:3072 lds
    s_add_u32 s55, s55, 221184
    s_mov_b32 s36, s4
    s_mov_b32 s37, s5
    s_mov_b32 s38, 2621440
    s_mov_b32 s39, 0x20000
    v_lshrrev_b32 v24, 3, v1
    v_mul_u32_u24 v24, 1280, v24
    v_and_b32 v23, 7, v1
    v_lshl_add_u32 v24, v23, 4, v24
    s_lshl_b32 s44, s42, 7
    s_lshl_b32 s45, s41, 5
    s_add_u32 s44, s44, s45
    s_mul_i32 s44, s44, 1280
    s_sub_u32 s45, s43, 4
    s_min_u32 s45, s45, 9
    s_lshl_b32 s45, s45, 7
    s_add_u32 s44, s44, s45
    buffer_load_dwordx4 a[128:131], v24, s[36:39], s44 offen
    s_add_u32 s44, s44, 10240
    buffer_load_dwordx4 a[132:135], v24, s[36:39], s44 offen
    s_add_u32 s44, s44, 10240
    buffer_load_dwordx4 a[136:139], v24, s[36:39], s44 offen
    s_add_u32 s44, s44, 10240
    buffer_load_dwordx4 a[140:143], v24, s[36:39], s44 offen
    s_cmp_lg_u32 s41, 0
    s_cbranch_scc1 L_e2_15
    s_mov_b32 exec_lo, 522126335
    s_mov_b32 exec_hi, 0
    s_mov_b32 s57, 200000
    s_waitcnt vmcnt(22)
L_ep_16:
    v_cmp_ne_u32 vcc, s40, v63
    s_nop 1
    s_cbranch_vccz L_ed_17
    buffer_load_dword v63, v22, s[28:31], 0 offen sc1
    s_waitcnt vmcnt(0)
    s_sub_u32 s57, s57, 1
    s_cmp_lg_u32 s57, 0
    s_cbranch_scc1 L_ep_16
L_ed_17:
    s_mov_b64 exec, -1
L_e2_15:
    s_barrier
    v_lshrrev_b32 v22, 4, v1
    v_lshlrev_b32 v22, 11, v22
    v_and_b32 v23, 15, v1
    v_lshl_add_u32 v22, v23, 4, v22
    s_lshl_b32 s44, s41, 9
    v_add_u32 v19, s44, v22
    s_mul_i32 s54, s42, 163840
    s_add_u32 s54, s54, 7667712
    v_lshrrev_b32 v22, 4, v1
    v_and_b32 v23, 15, v1
    v_lshlrev_b32 v23, 3, v23
    v_lshl_add_u32 v60, v22, 10, v23
    v_mov_b32 v24, 1073741824
    v_cmp_gt_u32 vcc, 2, v22
    s_nop 1
    v_cndmask_b32 v61, v24, v60, vcc
    s_mul_i32 s79, s42, 10240
    s_lshl_b32 s45, s41, 8
    s_add_u32 s79, s79, s45
    s_add_u32 s79, s79, 102400
    v_lshlrev_b32 v62, 2, v0
    v_cmp_gt_u32 vcc, 128, v0
    s_nop 1
    v_cndmask_b32 v62, v24, v62, vcc
    s_lshl_b32 s80, s58, 8
    s_add_u32 s80, s80, 45056
    s_add_u32 s44, s79, 0
    buffer_load_dwordx2 v[40:41], v60, s[28:31], s44 offen offset:0 sc1
    s_add_u32 s44, s79, 0
    buffer_load_dwordx2 v[42:43], v60, s[28:31], s44 offen offset:128 sc1
    s_add_u32 s44, s79, 4096
    buffer_load_dwordx2 v[44:45], v60, s[28:31], s44 offen offset:0 sc1
    s_add_u32 s44, s79, 4096
    buffer_load_dwordx2 v[46:47], v60, s[28:31], s44 offen offset:128 sc1
    s_add_u32 s44, s79, 8192
    buffer_load_dwordx2 v[48:49], v61, s[28:31], s44 offen offset:0 sc1
    s_add_u32 s44, s79, 8192
    buffer_load_dwordx2 v[50:51], v61, s[28:31], s44 offen offset:128 sc1
    s_add_u32 s44, s80, 0
    buffer_load_dword v52, v62, s[28:31], s44 offen sc1
    s_add_u32 s44, s80, 6912
    buffer_load_dword v53, v62, s[28:31], s44 offen sc1
    s_add_u32 s44, s80, 13824
    buffer_load_dword v54, v62, s[28:31], s44 offen sc1
    s_add_u32 s44, s80, 20736
    buffer_load_dword v55, v62, s[28:31], s44 offen sc1
    s_add_u32 s44, s80, 27648
    buffer_load_dword v56, v62, s[28:31], s44 offen sc1
    s_lshl_b32 s56, s50, 14
    s_add_u32 s56, s56, s54
    s_add_u32 s89, s54, 163840
    v_add_u32 v253, 8192, v19
    buffer_load_dwordx4 a[32:35], v19, s[28:31], s56 offen sc1
    buffer_load_dwordx4 a[36:39], v19, s[28:31], s56 offen offset:256 sc1
    buffer_load_dwordx4 a[40:43], v253, s[28:31], s56 offen sc1
    buffer_load_dwordx4 a[44:47], v253, s[28:31], s56 offen offset:256 sc1
    s_add_u32 s56, s56, 16384
    buffer_load_dwordx4 a[48:51], v19, s[28:31], s56 offen sc1
    buffer_load_dwordx4 a[52:55], v19, s[28:31], s56 offen offset:256 sc1
    buffer_load_dwordx4 a[56:59], v253, s[28:31], s56 offen sc1
    buffer_load_dwordx4 a[60:63], v253, s[28:31], s56 offen offset:256 sc1
    s_add_u32 s56, s56, 16384
    buffer_load_dwordx4 a[64:67], v19, s[28:31], s56 offen sc1
    buffer_load_dwordx4 a[68:71], v19, s[28:31], s56 offen offset:256 sc1
    buffer_load_dwordx4 a[72:75], v253, s[28:31], s56 offen sc1
    buffer_load_dwordx4 a[76:79], v253, s[28:31], s56 offen offset:256 sc1
    s_add_u32 s56, s56, 16384
    s_waitcnt vmcnt(12)
    v_add_f32 v52, v52, v53
    v_add_f32 v54, v54, v55
    v_add_f32 v52, v52, v56
    v_add_f32 v52, v52, v54
    v_lshlrev_b32 v22, 2, v0
    v_add_u32 v22, 156160, v22
    ds_write_b32 v22, v52
    v_pk_add_f32 v[40:41], v[40:41], v[44:45]
    v_pk_add_f32 v[40:41], v[40:41], v[48:49]
    v_pk_add_f32 v[42:43], v[42:43], v[46:47]
    v_pk_add_f32 v[42:43], v[42:43], v[50:51]
    v_mov_b32 v44, v40
    v_mov_b32 v45, v41
    v_mov_b32 v46, v42
    v_mov_b32 v47, v43
    v_permlane16_swap_b32 v40, v44
    v_permlane16_swap_b32 v41, v45
    v_permlane16_swap_b32 v42, v46
    v_permlane16_swap_b32 v43, v47
    v_add_f32 v40, v40, v44
    v_add_f32 v41, v41, v45
    v_add_f32 v42, v42, v46
    v_add_f32 v43, v43, v47
    v_mov_b32 v44, v40
    v_mov_b32 v45, v41
    v_mov_b32 v46, v42
    v_mov_b32 v47, v43
    v_permlane32_swap_b32 v40, v44
    v_permlane32_swap_b32 v41, v45
    v_permlane32_swap_b32 v42, v46
    v_permlane32_swap_b32 v43, v47
    v_add_f32 v40, v40, v44
    v_add_f32 v41, v41, v45
    v_add_f32 v42, v42, v46
    v_add_f32 v43, v43, v47
    s_mov_b32 s44, 986500301
    v_mov_b32 v48, 925353388
    v_mul_f32 v40, s44, v40
    v_fma_f32 v41, v41, s44, v48
    v_fma_f32 v41, -v40, v40, v41
    v_mul_f32 v42, s44, v42
    v_fma_f32 v43, v43, s44, v48
    v_fma_f32 v43, -v42, v42, v43
    v_rsq_f32 v44, v41
    v_rsq_f32 v46, v43
    v_mul_f32 v224, v20, v44
    v_mul_f32 v226, v44, v44
    v_rcp_f32 v228, v44
    v_mul_f32 v226, v226, v44
    v_mul_f32 v226, s62, v226
    v_mul_f32 v230, v20, v46
    v_mul_f32 v232, v46, v46
    v_rcp_f32 v234, v46
    v_mul_f32 v232, v232, v46
    v_mul_f32 v232, s62, v232
    v_lshrrev_b32 v22, 4, v1
    v_lshlrev_b32 v22, 4, v22
    v_add_u32 v57, 156160, v22
    s_waitcnt lgkmcnt(0)
    s_waitcnt vmcnt(45)
    s_barrier
    ds_read_b64_tr_b16 a[0:1], v4 offset:0
    ds_read_b64_tr_b16 a[2:3], v4 offset:4096
    ds_read_b64_tr_b16 a[4:5], v5 offset:0
    ds_read_b64_tr_b16 a[6:7], v5 offset:4096
    ds_read_b64_tr_b16 a[8:9], v6 offset:0
    ds_read_b64_tr_b16 a[10:11], v6 offset:4096
    ds_read_b64_tr_b16 a[12:13], v7 offset:0
    ds_read_b64_tr_b16 a[14:15], v7 offset:4096
    ds_read_b64_tr_b16 a[16:17], v8 offset:0
    ds_read_b64_tr_b16 a[18:19], v8 offset:4096
    ds_read_b64_tr_b16 a[20:21], v9 offset:0
    ds_read_b64_tr_b16 a[22:23], v9 offset:4096
    s_waitcnt vmcnt(10) lgkmcnt(8)
    v_mfma_f32_16x16x32_bf16 v[128:131], a[0:3], a[32:35], 0
    ds_read_b64_tr_b16 a[24:25], v10 offset:0
    buffer_load_dwordx4 a[80:83], v19, s[28:31], s56 offen sc1
    v_mfma_f32_16x16x32_bf16 v[132:135], a[0:3], a[36:39], 0
    ds_read_b64_tr_b16 a[26:27], v10 offset:4096
    buffer_load_dwordx4 a[84:87], v19, s[28:31], s56 offen offset:256 sc1
    v_mfma_f32_16x16x32_bf16 v[136:139], a[4:7], a[32:35], 0
    ds_read_b64_tr_b16 a[28:29], v11 offset:0
    s_add_u32 m0, s53, 81920
    v_mfma_f32_16x16x32_bf16 v[140:143], a[4:7], a[36:39], 0
    ds_read_b64_tr_b16 a[30:31], v11 offset:4096
    s_waitcnt lgkmcnt(8)
    v_mfma_f32_16x16x32_bf16 v[144:147], a[8:11], a[32:35], 0
    ds_read_b64_tr_b16 a[0:1], v4 offset:8192
    buffer_load_dwordx4 v14, s[32:35], s55 offen offset:0 lds
    v_mfma_f32_16x16x32_bf16 v[148:151], a[8:11], a[36:39], 0
    ds_read_b64_tr_b16 a[2:3], v4 offset:12288
    buffer_load_dwordx4 v15, s[32:35], s55 offen offset:1024 lds
    v_mfma_f32_16x16x32_bf16 v[152:155], a[12:15], a[32:35], 0
    ds_read_b64_tr_b16 a[4:5], v5 offset:8192
    buffer_load_dwordx4 v16, s[32:35], s55 offen offset:2048 lds
    v_mfma_f32_16x16x32_bf16 v[156:159], a[12:15], a[36:39], 0
    ds_read_b64_tr_b16 a[6:7], v5 offset:12288
    s_waitcnt lgkmcnt(8)
    v_mfma_f32_16x16x32_bf16 v[160:163], a[16:19], a[32:35], 0
    ds_read_b64_tr_b16 a[8:9], v6 offset:8192
    buffer_load_dwordx4 v17, s[32:35], s55 offen offset:3072 lds
    v_mfma_f32_16x16x32_bf16 v[164:167], a[16:19], a[36:39], 0
    ds_read_b64_tr_b16 a[10:11], v6 offset:12288
    s_add_u32 s55, s55, 221184
    v_mfma_f32_16x16x32_bf16 v[168:171], a[20:23], a[32:35], 0
    ds_read_b64_tr_b16 a[12:13], v7 offset:8192
    s_add_u32 m0, s53, 98304
    v_mfma_f32_16x16x32_bf16 v[172:175], a[20:23], a[36:39], 0
    ds_read_b64_tr_b16 a[14:15], v7 offset:12288
    s_waitcnt lgkmcnt(8)
    v_mfma_f32_16x16x32_bf16 v[176:179], a[24:27], a[32:35], 0
    ds_read_b64_tr_b16 a[16:17], v8 offset:8192
    buffer_load_dwordx4 v14, s[32:35], s55 offen offset:0 lds
    v_mfma_f32_16x16x32_bf16 v[180:183], a[24:27], a[36:39], 0
    ds_read_b64_tr_b16 a[18:19], v8 offset:12288
    buffer_load_dwordx4 v15, s[32:35], s55 offen offset:1024 lds
    v_mfma_f32_16x16x32_bf16 v[184:187], a[28:31], a[32:35], 0
    ds_read_b64_tr_b16 a[20:21], v9 offset:8192
    buffer_load_dwordx4 v16, s[32:35], s55 offen offset:2048 lds
    v_mfma_f32_16x16x32_bf16 v[188:191], a[28:31], a[36:39], 0
    ds_read_b64_tr_b16 a[22:23], v9 offset:12288
    s_waitcnt vmcnt(17) lgkmcnt(8)
    v_mfma_f32_16x16x32_bf16 v[128:131], a[0:3], a[40:43], v[128:131]
    ds_read_b64_tr_b16 a[24:25], v10 offset:8192
    buffer_load_dwordx4 a[32:35], v253, s[28:31], s56 offen sc1
    v_mfma_f32_16x16x32_bf16 v[132:135], a[0:3], a[44:47], v[132:135]
    ds_read_b64_tr_b16 a[26:27], v10 offset:12288
    buffer_load_dwordx4 a[36:39], v253, s[28:31], s56 offen offset:256 sc1
    v_mfma_f32_16x16x32_bf16 v[136:139], a[4:7], a[40:43], v[136:139]
    ds_read_b64_tr_b16 a[28:29], v11 offset:8192
    s_add_u32 s56, s56, 16384
    v_mfma_f32_16x16x32_bf16 v[140:143], a[4:7], a[44:47], v[140:143]
    ds_read_b64_tr_b16 a[30:31], v11 offset:12288
    s_waitcnt lgkmcnt(8)
    v_mfma_f32_16x16x32_bf16 v[144:147], a[8:11], a[40:43], v[144:147]
    s_waitcnt vmcnt(50)
    s_barrier
    ds_read_b64_tr_b16 a[0:1], v4 offset:16384
    buffer_load_dwordx4 v17, s[32:35], s55 offen offset:3072 lds
    v_mfma_f32_16x16x32_bf16 v[148:151], a[8:11], a[44:47], v[148:151]
    ds_read_b64_tr_b16 a[2:3], v4 offset:20480
    s_add_u32 s55, s55, 221184
    v_mfma_f32_16x16x32_bf16 v[152:155], a[12:15], a[40:43], v[152:155]
    ds_read_b64_tr_b16 a[4:5], v5 offset:16384
    s_add_u32 m0, s53, 114688
    v_mfma_f32_16x16x32_bf16 v[156:159], a[12:15], a[44:47], v[156:159]
    ds_read_b64_tr_b16 a[6:7], v5 offset:20480
    s_waitcnt lgkmcnt(8)
    v_mfma_f32_16x16x32_bf16 v[160:163], a[16:19], a[40:43], v[160:163]
    ds_read_b64_tr_b16 a[8:9], v6 offset:16384
    buffer_load_dwordx4 v14, s[32:35], s55 offen offset:0 lds
    v_mfma_f32_16x16x32_bf16 v[164:167], a[16:19], a[44:47], v[164:167]
    ds_read_b64_tr_b16 a[10:11], v6 offset:20480
    buffer_load_dwordx4 v15, s[32:35], s55 offen offset:1024 lds
    v_mfma_f32_16x16x32_bf16 v[168:171], a[20:23], a[40:43], v[168:171]
    ds_read_b64_tr_b16 a[12:13], v7 offset:16384
    buffer_load_dwordx4 v16, s[32:35], s55 offen offset:2048 lds
    v_mfma_f32_16x16x32_bf16 v[172:175], a[20:23], a[44:47], v[172:175]
    ds_read_b64_tr_b16 a[14:15], v7 offset:20480
    s_waitcnt lgkmcnt(8)
    v_mfma_f32_16x16x32_bf16 v[176:179], a[24:27], a[40:43], v[176:179]
    ds_read_b64_tr_b16 a[16:17], v8 offset:16384
    buffer_load_dwordx4 v17, s[32:35], s55 offen offset:3072 lds
    v_mfma_f32_16x16x32_bf16 v[180:183], a[24:27], a[44:47], v[180:183]
    ds_read_b64_tr_b16 a[18:19], v8 offset:20480
    s_add_u32 s55, s55, 221184
    v_mfma_f32_16x16x32_bf16 v[184:187], a[28:31], a[40:43], v[184:187]
    ds_read_b64_tr_b16 a[20:21], v9 offset:16384
    v_mfma_f32_16x16x32_bf16 v[188:191], a[28:31], a[44:47], v[188:191]
    ds_read_b64_tr_b16 a[22:23], v9 offset:20480
    s_waitcnt vmcnt(22) lgkmcnt(8)
    v_mfma_f32_16x16x32_bf16 v[128:131], a[0:3], a[48:51], v[128:131]
    ds_read_b64_tr_b16 a[24:25], v10 offset:16384
    buffer_load_dwordx4 a[40:43], v19, s[28:31], s56 offen sc1
    v_mfma_f32_16x16x32_bf16 v[132:135], a[0:3], a[52:55], v[132:135]
    ds_read_b64_tr_b16 a[26:27], v10 offset:20480
    buffer_load_dwordx4 a[44:47], v19, s[28:31], s56 offen offset:256 sc1
    v_mfma_f32_16x16x32_bf16 v[136:139], a[4:7], a[48:51], v[136:139]
    ds_read_b64_tr_b16 a[28:29], v11 offset:16384
    v_mfma_f32_16x16x32_bf16 v[140:143], a[4:7], a[52:55], v[140:143]
    ds_read_b64_tr_b16 a[30:31], v11 offset:20480
    s_waitcnt lgkmcnt(8)
    v_mfma_f32_16x16x32_bf16 v[144:147], a[8:11], a[48:51], v[144:147]
    ds_read_b64_tr_b16 a[0:1], v4 offset:24576
    v_mfma_f32_16x16x32_bf16 v[148:151], a[8:11], a[52:55], v[148:151]
    ds_read_b64_tr_b16 a[2:3], v4 offset:28672
    v_mfma_f32_16x16x32_bf16 v[152:155], a[12:15], a[48:51], v[152:155]
    ds_read_b64_tr_b16 a[4:5], v5 offset:24576
    v_mfma_f32_16x16x32_bf16 v[156:159], a[12:15], a[52:55], v[156:159]
    ds_read_b64_tr_b16 a[6:7], v5 offset:28672
    s_waitcnt lgkmcnt(8)
    v_mfma_f32_16x16x32_bf16 v[160:163], a[16:19], a[48:51], v[160:163]
    ds_read_b64_tr_b16 a[8:9], v6 offset:24576
    v_mfma_f32_16x16x32_bf16 v[164:167], a[16:19], a[52:55], v[164:167]
    ds_read_b64_tr_b16 a[10:11], v6 offset:28672
    v_mfma_f32_16x16x32_bf16 v[168:171], a[20:23], a[48:51], v[168:171]
    ds_read_b64_tr_b16 a[12:13], v7 offset:24576
    v_mfma_f32_16x16x32_bf16 v[172:175], a[20:23], a[52:55], v[172:175]
    ds_read_b64_tr_b16 a[14:15], v7 offset:28672
    s_waitcnt lgkmcnt(8)
    v_mfma_f32_16x16x32_bf16 v[176:179], a[24:27], a[48:51], v[176:179]
    ds_read_b64_tr_b16 a[16:17], v8 offset:24576
    v_mfma_f32_16x16x32_bf16 v[180:183], a[24:27], a[52:55], v[180:183]
    ds_read_b64_tr_b16 a[18:19], v8 offset:28672
    v_mfma_f32_16x16x32_bf16 v[184:187], a[28:31], a[48:51], v[184:187]
    ds_read_b64_tr_b16 a[20:21], v9 offset:24576
    v_mfma_f32_16x16x32_bf16 v[188:191], a[28:31], a[52:55], v[188:191]
    ds_read_b64_tr_b16 a[22:23], v9 offset:28672
    s_waitcnt vmcnt(22) lgkmcnt(8)
    v_mfma_f32_16x16x32_bf16 v[128:131], a[0:3], a[56:59], v[128:131]
    ds_read_b64_tr_b16 a[24:25], v10 offset:24576
    buffer_load_dwordx4 a[48:51], v253, s[28:31], s56 offen sc1
    v_mfma_f32_16x16x32_bf16 v[132:135], a[0:3], a[60:63], v[132:135]
    ds_read_b64_tr_b16 a[26:27], v10 offset:28672
    buffer_load_dwordx4 a[52:55], v253, s[28:31], s56 offen offset:256 sc1
    v_mfma_f32_16x16x32_bf16 v[136:139], a[4:7], a[56:59], v[136:139]
    ds_read_b64_tr_b16 a[28:29], v11 offset:24576
    s_add_u32 s56, s56, 16384
    v_mfma_f32_16x16x32_bf16 v[140:143], a[4:7], a[60:63], v[140:143]
    ds_read_b64_tr_b16 a[30:31], v11 offset:28672
    s_waitcnt lgkmcnt(8)
    v_mfma_f32_16x16x32_bf16 v[144:147], a[8:11], a[56:59], v[144:147]
    s_waitcnt vmcnt(55)
    s_barrier
    ds_read_b64_tr_b16 a[0:1], v4 offset:32768
    s_add_u32 m0, s53, 131072
    v_mfma_f32_16x16x32_bf16 v[148:151], a[8:11], a[60:63], v[148:151]
    ds_read_b64_tr_b16 a[2:3], v4 offset:36864
    buffer_load_dwordx4 v14, s[32:35], s55 offen offset:0 lds
    v_mfma_f32_16x16x32_bf16 v[152:155], a[12:15], a[56:59], v[152:155]
    ds_read_b64_tr_b16 a[4:5], v5 offset:32768
    buffer_load_dwordx4 v15, s[32:35], s55 offen offset:1024 lds
    v_mfma_f32_16x16x32_bf16 v[156:159], a[12:15], a[60:63], v[156:159]
    ds_read_b64_tr_b16 a[6:7], v5 offset:36864
    s_waitcnt lgkmcnt(8)
    v_mfma_f32_16x16x32_bf16 v[160:163], a[16:19], a[56:59], v[160:163]
    ds_read_b64_tr_b16 a[8:9], v6 offset:32768
    buffer_load_dwordx4 v16, s[32:35], s55 offen offset:2048 lds
    v_mfma_f32_16x16x32_bf16 v[164:167], a[16:19], a[60:63], v[164:167]
    ds_read_b64_tr_b16 a[10:11], v6 offset:36864
    buffer_load_dwordx4 v17, s[32:35], s55 offen offset:3072 lds
    v_mfma_f32_16x16x32_bf16 v[168:171], a[20:23], a[56:59], v[168:171]
    ds_read_b64_tr_b16 a[12:13], v7 offset:32768
    s_add_u32 s55, s55, 221184
    v_mfma_f32_16x16x32_bf16 v[172:175], a[20:23], a[60:63], v[172:175]
    ds_read_b64_tr_b16 a[14:15], v7 offset:36864
    s_waitcnt lgkmcnt(8)
    v_mfma_f32_16x16x32_bf16 v[176:179], a[24:27], a[56:59], v[176:179]
    ds_read_b64_tr_b16 a[16:17], v8 offset:32768
    v_mfma_f32_16x16x32_bf16 v[180:183], a[24:27], a[60:63], v[180:183]
    ds_read_b64_tr_b16 a[18:19], v8 offset:36864
    v_mfma_f32_16x16x32_bf16 v[184:187], a[28:31], a[56:59], v[184:187]
    ds_read_b64_tr_b16 a[20:21], v9 offset:32768
    v_mfma_f32_16x16x32_bf16 v[188:191], a[28:31], a[60:63], v[188:191]
    ds_read_b64_tr_b16 a[22:23], v9 offset:36864
    s_waitcnt vmcnt(26) lgkmcnt(8)
    v_mfma_f32_16x16x32_bf16 v[128:131], a[0:3], a[64:67], v[128:131]
    ds_read_b64_tr_b16 a[24:25], v10 offset:32768
    buffer_load_dwordx4 a[56:59], v19, s[28:31], s56 offen sc1
    v_mfma_f32_16x16x32_bf16 v[132:135], a[0:3], a[68:71], v[132:135]
    ds_read_b64_tr_b16 a[26:27], v10 offset:36864
    buffer_load_dwordx4 a[60:63], v19, s[28:31], s56 offen offset:256 sc1
    v_mfma_f32_16x16x32_bf16 v[136:139], a[4:7], a[64:67], v[136:139]
    ds_read_b64_tr_b16 a[28:29], v11 offset:32768
    v_mfma_f32_16x16x32_bf16 v[140:143], a[4:7], a[68:71], v[140:143]
    ds_read_b64_tr_b16 a[30:31], v11 offset:36864
    s_waitcnt lgkmcnt(8)
    v_mfma_f32_16x16x32_bf16 v[144:147], a[8:11], a[64:67], v[144:147]
    ds_read_b64_tr_b16 a[0:1], v4 offset:40960
    v_mfma_f32_16x16x32_bf16 v[148:151], a[8:11], a[68:71], v[148:151]
    ds_read_b64_tr_b16 a[2:3], v4 offset:45056
    v_mfma_f32_16x16x32_bf16 v[152:155], a[12:15], a[64:67], v[152:155]
    ds_read_b64_tr_b16 a[4:5], v5 offset:40960
    v_mfma_f32_16x16x32_bf16 v[156:159], a[12:15], a[68:71], v[156:159]
    ds_read_b64_tr_b16 a[6:7], v5 offset:45056
    s_waitcnt lgkmcnt(8)
    v_mfma_f32_16x16x32_bf16 v[160:163], a[16:19], a[64:67], v[160:163]
    ds_read_b64_tr_b16 a[8:9], v6 offset:40960
    v_mfma_f32_16x16x32_bf16 v[164:167], a[16:19], a[68:71], v[164:167]
    ds_read_b64_tr_b16 a[10:11], v6 offset:45056
    v_mfma_f32_16x16x32_bf16 v[168:171], a[20:23], a[64:67], v[168:171]
    ds_read_b64_tr_b16 a[12:13], v7 offset:40960
    v_mfma_f32_16x16x32_bf16 v[172:175], a[20:23], a[68:71], v[172:175]
    ds_read_b64_tr_b16 a[14:15], v7 offset:45056
    s_waitcnt lgkmcnt(8)
    v_mfma_f32_16x16x32_bf16 v[176:179], a[24:27], a[64:67], v[176:179]
    ds_read_b64_tr_b16 a[16:17], v8 offset:40960
    v_mfma_f32_16x16x32_bf16 v[180:183], a[24:27], a[68:71], v[180:183]
    ds_read_b64_tr_b16 a[18:19], v8 offset:45056
    v_mfma_f32_16x16x32_bf16 v[184:187], a[28:31], a[64:67], v[184:187]
    ds_read_b64_tr_b16 a[20:21], v9 offset:40960
    v_mfma_f32_16x16x32_bf16 v[188:191], a[28:31], a[68:71], v[188:191]
    ds_read_b64_tr_b16 a[22:23], v9 offset:45056
    s_waitcnt vmcnt(26) lgkmcnt(8)
    v_mfma_f32_16x16x32_bf16 v[128:131], a[0:3], a[72:75], v[128:131]
    ds_read_b64_tr_b16 a[24:25], v10 offset:40960
    buffer_load_dwordx4 a[64:67], v253, s[28:31], s56 offen sc1
    v_mfma_f32_16x16x32_bf16 v[132:135], a[0:3], a[76:79], v[132:135]
    ds_read_b64_tr_b16 a[26:27], v10 offset:45056
    buffer_load_dwordx4 a[68:71], v253, s[28:31], s56 offen offset:256 sc1
    v_mfma_f32_16x16x32_bf16 v[136:139], a[4:7], a[72:75], v[136:139]
    ds_read_b64_tr_b16 a[28:29], v11 offset:40960
    s_add_u32 s56, s56, 16384
    v_mfma_f32_16x16x32_bf16 v[140:143], a[4:7], a[76:79], v[140:143]
    ds_read_b64_tr_b16 a[30:31], v11 offset:45056
    s_waitcnt lgkmcnt(8)
    v_mfma_f32_16x16x32_bf16 v[144:147], a[8:11], a[72:75], v[144:147]
    s_waitcnt vmcnt(59)
    s_barrier
    ds_read_b64_tr_b16 a[0:1], v4 offset:49152
    s_add_u32 m0, s53, 0
    v_mfma_f32_16x16x32_bf16 v[148:151], a[8:11], a[76:79], v[148:151]
    ds_read_b64_tr_b16 a[2:3], v4 offset:53248
    buffer_load_dwordx4 v14, s[32:35], s55 offen offset:0 lds
    v_mfma_f32_16x16x32_bf16 v[152:155], a[12:15], a[72:75], v[152:155]
    ds_read_b64_tr_b16 a[4:5], v5 offset:49152
    buffer_load_dwordx4 v15, s[32:35], s55 offen offset:1024 lds
    v_mfma_f32_16x16x32_bf16 v[156:159], a[12:15], a[76:79], v[156:159]
    ds_read_b64_tr_b16 a[6:7], v5 offset:53248
    s_waitcnt lgkmcnt(8)
    v_mfma_f32_16x16x32_bf16 v[160:163], a[16:19], a[72:75], v[160:163]
    ds_read_b64_tr_b16 a[8:9], v6 offset:49152
    buffer_load_dwordx4 v16, s[32:35], s55 offen offset:2048 lds
    v_mfma_f32_16x16x32_bf16 v[164:167], a[16:19], a[76:79], v[164:167]
    ds_read_b64_tr_b16 a[10:11], v6 offset:53248
    buffer_load_dwordx4 v17, s[32:35], s55 offen offset:3072 lds
    v_mfma_f32_16x16x32_bf16 v[168:171], a[20:23], a[72:75], v[168:171]
    ds_read_b64_tr_b16 a[12:13], v7 offset:49152
    ds_read_b128 v[192:195], v57 offset:0
    v_mfma_f32_16x16x32_bf16 v[172:175], a[20:23], a[76:79], v[172:175]
    ds_read_b64_tr_b16 a[14:15], v7 offset:53248
    s_waitcnt lgkmcnt(9)
    v_mfma_f32_16x16x32_bf16 v[176:179], a[24:27], a[72:75], v[176:179]
    ds_read_b64_tr_b16 a[16:17], v8 offset:49152
    ds_read_b128 v[196:199], v57 offset:64
    v_mfma_f32_16x16x32_bf16 v[180:183], a[24:27], a[76:79], v[180:183]
    ds_read_b64_tr_b16 a[18:19], v8 offset:53248
    ds_read_b128 v[200:203], v57 offset:128
    v_mfma_f32_16x16x32_bf16 v[184:187], a[28:31], a[72:75], v[184:187]
    ds_read_b64_tr_b16 a[20:21], v9 offset:49152
    ds_read_b128 v[204:207], v57 offset:192
    v_mfma_f32_16x16x32_bf16 v[188:191], a[28:31], a[76:79], v[188:191]
    ds_read_b64_tr_b16 a[22:23], v9 offset:53248
    s_waitcnt vmcnt(30) lgkmcnt(12)
    v_mfma_f32_16x16x32_bf16 v[128:131], a[0:3], a[80:83], v[128:131]
    ds_read_b64_tr_b16 a[24:25], v10 offset:49152
    buffer_load_dwordx4 a[72:75], v19, s[28:31], s56 offen sc1
    v_mfma_f32_16x16x32_bf16 v[132:135], a[0:3], a[84:87], v[132:135]
    ds_read_b64_tr_b16 a[26:27], v10 offset:53248
    buffer_load_dwordx4 a[76:79], v19, s[28:31], s56 offen offset:256 sc1
    v_mfma_f32_16x16x32_bf16 v[136:139], a[4:7], a[80:83], v[136:139]
    ds_read_b64_tr_b16 a[28:29], v11 offset:49152
    ds_read_b128 v[208:211], v57 offset:256
    v_mfma_f32_16x16x32_bf16 v[140:143], a[4:7], a[84:87], v[140:143]
    ds_read_b64_tr_b16 a[30:31], v11 offset:53248
    s_waitcnt lgkmcnt(12)
    v_mfma_f32_16x16x32_bf16 v[144:147], a[8:11], a[80:83], v[144:147]
    ds_read_b64_tr_b16 a[0:1], v4 offset:57344
    ds_read_b128 v[212:215], v57 offset:320
    v_mfma_f32_16x16x32_bf16 v[148:151], a[8:11], a[84:87], v[148:151]
    ds_read_b64_tr_b16 a[2:3], v4 offset:61440
    ds_read_b128 v[216:219], v57 offset:384
    v_mfma_f32_16x16x32_bf16 v[152:155], a[12:15], a[80:83], v[152:155]
    ds_read_b64_tr_b16 a[4:5], v5 offset:57344
    ds_read_b128 v[220:223], v57 offset:448
    v_mfma_f32_16x16x32_bf16 v[156:159], a[12:15], a[84:87], v[156:159]
    ds_read_b64_tr_b16 a[6:7], v5 offset:61440
    s_waitcnt lgkmcnt(12)
    v_mfma_f32_16x16x32_bf16 v[160:163], a[16:19], a[80:83], v[160:163]
    ds_read_b64_tr_b16 a[8:9], v6 offset:57344
    v_mfma_f32_16x16x32_bf16 v[164:167], a[16:19], a[84:87], v[164:167]
    ds_read_b64_tr_b16 a[10:11], v6 offset:61440
    v_mfma_f32_16x16x32_bf16 v[168:171], a[20:23], a[80:83], v[168:171]
    ds_read_b64_tr_b16 a[12:13], v7 offset:57344
    v_mfma_f32_16x16x32_bf16 v[172:175], a[20:23], a[84:87], v[172:175]
    ds_read_b64_tr_b16 a[14:15], v7 offset:61440
    s_waitcnt lgkmcnt(11)
    v_mfma_f32_16x16x32_bf16 v[176:179], a[24:27], a[80:83], v[176:179]
    ds_read_b64_tr_b16 a[16:17], v8 offset:57344
    v_mfma_f32_16x16x32_bf16 v[180:183], a[24:27], a[84:87], v[180:183]
    ds_read_b64_tr_b16 a[18:19], v8 offset:61440
    v_mfma_f32_16x16x32_bf16 v[184:187], a[28:31], a[80:83], v[184:187]
    ds_read_b64_tr_b16 a[20:21], v9 offset:57344
    v_mfma_f32_16x16x32_bf16 v[188:191], a[28:31], a[84:87], v[188:191]
    ds_read_b64_tr_b16 a[22:23], v9 offset:61440
    s_waitcnt vmcnt(23) lgkmcnt(8)
    v_mfma_f32_16x16x32_bf16 v[128:131], a[0:3], a[32:35], v[128:131]
    ds_read_b64_tr_b16 a[24:25], v10 offset:57344
    buffer_load_dwordx4 a[80:83], v253, s[28:31], s56 offen sc1
    v_mfma_f32_16x16x32_bf16 v[132:135], a[0:3], a[36:39], v[132:135]
    ds_read_b64_tr_b16 a[26:27], v10 offset:61440
    buffer_load_dwordx4 a[84:87], v253, s[28:31], s56 offen offset:256 sc1
    v_mfma_f32_16x16x32_bf16 v[136:139], a[4:7], a[32:35], v[136:139]
    ds_read_b64_tr_b16 a[28:29], v11 offset:57344
    s_add_u32 s56, s56, 16384
    v_mfma_f32_16x16x32_bf16 v[140:143], a[4:7], a[36:39], v[140:143]
    ds_read_b64_tr_b16 a[30:31], v11 offset:61440
    s_waitcnt lgkmcnt(8)
    v_mfma_f32_16x16x32_bf16 v[144:147], a[8:11], a[32:35], v[144:147]
    s_waitcnt vmcnt(63)
    s_barrier
    v_add_u32 v4, 65536, v4
    v_add_u32 v5, 65536, v5
    v_add_u32 v6, 65536, v6
    v_add_u32 v7, 65536, v7
    v_add_u32 v8, 65536, v8
    v_add_u32 v9, 65536, v9
    v_add_u32 v10, 65536, v10
    v_add_u32 v11, 65536, v11
    ds_read_b64_tr_b16 a[0:1], v4 offset:0
    v_mfma_f32_16x16x32_bf16 v[148:151], a[8:11], a[36:39], v[148:151]
    ds_read_b64_tr_b16 a[2:3], v4 offset:4096
    v_mfma_f32_16x16x32_bf16 v[152:155], a[12:15], a[32:35], v[152:155]
    ds_read_b64_tr_b16 a[4:5], v5 offset:0
    v_mfma_f32_16x16x32_bf16 v[156:159], a[12:15], a[36:39], v[156:159]
    ds_read_b64_tr_b16 a[6:7], v5 offset:4096
    s_waitcnt lgkmcnt(8)
    v_mfma_f32_16x16x32_bf16 v[160:163], a[16:19], a[32:35], v[160:163]
    ds_read_b64_tr_b16 a[8:9], v6 offset:0
    v_mfma_f32_16x16x32_bf16 v[164:167], a[16:19], a[36:39], v[164:167]
    ds_read_b64_tr_b16 a[10:11], v6 offset:4096
    v_mfma_f32_16x16x32_bf16 v[168:171], a[20:23], a[32:35], v[168:171]
    ds_read_b64_tr_b16 a[12:13], v7 offset:0
    v_mfma_f32_16x16x32_bf16 v[172:175], a[20:23], a[36:39], v[172:175]
    ds_read_b64_tr_b16 a[14:15], v7 offset:4096
    s_waitcnt lgkmcnt(8)
    v_mfma_f32_16x16x32_bf16 v[176:179], a[24:27], a[32:35], v[176:179]
    ds_read_b64_tr_b16 a[16:17], v8 offset:0
    v_mfma_f32_16x16x32_bf16 v[180:183], a[24:27], a[36:39], v[180:183]
    ds_read_b64_tr_b16 a[18:19], v8 offset:4096
    v_mfma_f32_16x16x32_bf16 v[184:187], a[28:31], a[32:35], v[184:187]
    ds_read_b64_tr_b16 a[20:21], v9 offset:0
    v_mfma_f32_16x16x32_bf16 v[188:191], a[28:31], a[36:39], v[188:191]
    ds_read_b64_tr_b16 a[22:23], v9 offset:4096
    s_waitcnt vmcnt(18) lgkmcnt(8)
    v_mfma_f32_16x16x32_bf16 v[128:131], a[0:3], a[40:43], v[128:131]
    ds_read_b64_tr_b16 a[24:25], v10 offset:0
    buffer_load_dwordx4 a[32:35], v19, s[28:31], s56 offen sc1
    v_mfma_f32_16x16x32_bf16 v[132:135], a[0:3], a[44:47], v[132:135]
    ds_read_b64_tr_b16 a[26:27], v10 offset:4096
    buffer_load_dwordx4 a[36:39], v19, s[28:31], s56 offen offset:256 sc1
    v_mfma_f32_16x16x32_bf16 v[136:139], a[4:7], a[40:43], v[136:139]
    ds_read_b64_tr_b16 a[28:29], v11 offset:0
    v_mfma_f32_16x16x32_bf16 v[140:143], a[4:7], a[44:47], v[140:143]
    ds_read_b64_tr_b16 a[30:31], v11 offset:4096
    s_waitcnt lgkmcnt(8)
    v_mfma_f32_16x16x32_bf16 v[144:147], a[8:11], a[40:43], v[144:147]
    ds_read_b64_tr_b16 a[0:1], v4 offset:8192
    v_mfma_f32_16x16x32_bf16 v[148:151], a[8:11], a[44:47], v[148:151]
    ds_read_b64_tr_b16 a[2:3], v4 offset:12288
    v_mfma_f32_16x16x32_bf16 v[152:155], a[12:15], a[40:43], v[152:155]
    ds_read_b64_tr_b16 a[4:5], v5 offset:8192
    v_mfma_f32_16x16x32_bf16 v[156:159], a[12:15], a[44:47], v[156:159]
    ds_read_b64_tr_b16 a[6:7], v5 offset:12288
    s_waitcnt lgkmcnt(8)
    v_mfma_f32_16x16x32_bf16 v[160:163], a[16:19], a[40:43], v[160:163]
    ds_read_b64_tr_b16 a[8:9], v6 offset:8192
    v_mfma_f32_16x16x32_bf16 v[164:167], a[16:19], a[44:47], v[164:167]
    ds_read_b64_tr_b16 a[10:11], v6 offset:12288
    v_mfma_f32_16x16x32_bf16 v[168:171], a[20:23], a[40:43], v[168:171]
    ds_read_b64_tr_b16 a[12:13], v7 offset:8192
    v_mfma_f32_16x16x32_bf16 v[172:175], a[20:23], a[44:47], v[172:175]
    ds_read_b64_tr_b16 a[14:15], v7 offset:12288
    s_waitcnt lgkmcnt(8)
    v_mfma_f32_16x16x32_bf16 v[176:179], a[24:27], a[40:43], v[176:179]
    ds_read_b64_tr_b16 a[16:17], v8 offset:8192
    v_mfma_f32_16x16x32_bf16 v[180:183], a[24:27], a[44:47], v[180:183]
    ds_read_b64_tr_b16 a[18:19], v8 offset:12288
    v_mfma_f32_16x16x32_bf16 v[184:187], a[28:31], a[40:43], v[184:187]
    ds_read_b64_tr_b16 a[20:21], v9 offset:8192
    v_mfma_f32_16x16x32_bf16 v[188:191], a[28:31], a[44:47], v[188:191]
    ds_read_b64_tr_b16 a[22:23], v9 offset:12288
    s_waitcnt vmcnt(18) lgkmcnt(8)
    v_mfma_f32_16x16x32_bf16 v[128:131], a[0:3], a[48:51], v[128:131]
    ds_read_b64_tr_b16 a[24:25], v10 offset:8192
    buffer_load_dwordx4 a[40:43], v253, s[28:31], s56 offen sc1
    v_mfma_f32_16x16x32_bf16 v[132:135], a[0:3], a[52:55], v[132:135]
    ds_read_b64_tr_b16 a[26:27], v10 offset:12288
    buffer_load_dwordx4 a[44:47], v253, s[28:31], s56 offen offset:256 sc1
    v_mfma_f32_16x16x32_bf16 v[136:139], a[4:7], a[48:51], v[136:139]
    ds_read_b64_tr_b16 a[28:29], v11 offset:8192
    s_add_u32 s56, s56, 16384
    v_mfma_f32_16x16x32_bf16 v[140:143], a[4:7], a[52:55], v[140:143]
    ds_read_b64_tr_b16 a[30:31], v11 offset:12288
    s_waitcnt lgkmcnt(8)
    v_mfma_f32_16x16x32_bf16 v[144:147], a[8:11], a[48:51], v[144:147]
    s_waitcnt vmcnt(34)
    s_barrier
    ds_read_b64_tr_b16 a[0:1], v4 offset:16384
    s_sub_u32 s83, s43, 4
    v_mfma_f32_16x16x32_bf16 v[148:151], a[8:11], a[52:55], v[148:151]
    ds_read_b64_tr_b16 a[2:3], v4 offset:20480
    s_mov_b32 s32, s20
    v_mfma_f32_16x16x32_bf16 v[152:155], a[12:15], a[48:51], v[152:155]
    ds_read_b64_tr_b16 a[4:5], v5 offset:16384
    s_mov_b32 s33, s21
    v_mfma_f32_16x16x32_bf16 v[156:159], a[12:15], a[52:55], v[156:159]
    ds_read_b64_tr_b16 a[6:7], v5 offset:20480
    s_waitcnt lgkmcnt(8)
    v_mfma_f32_16x16x32_bf16 v[160:163], a[16:19], a[48:51], v[160:163]
    ds_read_b64_tr_b16 a[8:9], v6 offset:16384
    s_mov_b32 s34, 2211840
    v_mfma_f32_16x16x32_bf16 v[164:167], a[16:19], a[52:55], v[164:167]
    ds_read_b64_tr_b16 a[10:11], v6 offset:20480
    s_mov_b32 s35, 0x20000
    v_mfma_f32_16x16x32_bf16 v[168:171], a[20:23], a[48:51], v[168:171]
    ds_read_b64_tr_b16 a[12:13], v7 offset:16384
    v_lshrrev_b32 v16, 3, v1
    v_mfma_f32_16x16x32_bf16 v[172:175], a[20:23], a[52:55], v[172:175]
    ds_read_b64_tr_b16 a[14:15], v7 offset:20480
    s_waitcnt lgkmcnt(8)
    v_mfma_f32_16x16x32_bf16 v[176:179], a[24:27], a[48:51], v[176:179]
    ds_read_b64_tr_b16 a[16:17], v8 offset:16384
    v_and_b32 v17, 7, v1
    v_mfma_f32_16x16x32_bf16 v[180:183], a[24:27], a[52:55], v[180:183]
    ds_read_b64_tr_b16 a[18:19], v8 offset:20480
    v_and_b32 v18, 6, v16
    v_mfma_f32_16x16x32_bf16 v[184:187], a[28:31], a[48:51], v[184:187]
    ds_read_b64_tr_b16 a[20:21], v9 offset:16384
    v_xor_b32 v17, v17, v18
    v_mfma_f32_16x16x32_bf16 v[188:191], a[28:31], a[52:55], v[188:191]
    ds_read_b64_tr_b16 a[22:23], v9 offset:20480
    s_waitcnt vmcnt(14) lgkmcnt(8)
    v_mfma_f32_16x16x32_bf16 v[128:131], a[0:3], a[56:59], v[128:131]
    ds_read_b64_tr_b16 a[24:25], v10 offset:16384
    buffer_load_dwordx4 a[48:51], v19, s[28:31], s56 offen sc1
    v_mfma_f32_16x16x32_bf16 v[132:135], a[0:3], a[60:63], v[132:135]
    ds_read_b64_tr_b16 a[26:27], v10 offset:20480
    buffer_load_dwordx4 a[52:55], v19, s[28:31], s56 offen offset:256 sc1
    v_mfma_f32_16x16x32_bf16 v[136:139], a[4:7], a[56:59], v[136:139]
    ds_read_b64_tr_b16 a[28:29], v11 offset:16384
    v_mul_u32_u24 v16, 1280, v16
    v_mfma_f32_16x16x32_bf16 v[140:143], a[4:7], a[60:63], v[140:143]
    ds_read_b64_tr_b16 a[30:31], v11 offset:20480
    s_waitcnt lgkmcnt(8)
    v_mfma_f32_16x16x32_bf16 v[144:147], a[8:11], a[56:59], v[144:147]
    ds_read_b64_tr_b16 a[0:1], v4 offset:24576
    v_lshl_add_u32 v14, v17, 4, v16
    v_mfma_f32_16x16x32_bf16 v[148:151], a[8:11], a[60:63], v[148:151]
    ds_read_b64_tr_b16 a[2:3], v4 offset:28672
    v_add_u32 v15, 9216, v14
    v_mfma_f32_16x16x32_bf16 v[152:155], a[12:15], a[56:59], v[152:155]
    ds_read_b64_tr_b16 a[4:5], v5 offset:24576
    s_lshl_b32 s53, s41, 11
    v_mfma_f32_16x16x32_bf16 v[156:159], a[12:15], a[60:63], v[156:159]
    ds_read_b64_tr_b16 a[6:7], v5 offset:28672
    s_waitcnt lgkmcnt(8)
    v_mfma_f32_16x16x32_bf16 v[160:163], a[16:19], a[56:59], v[160:163]
    ds_read_b64_tr_b16 a[8:9], v6 offset:24576
    s_lshl_b32 s78, s83, 7
    v_mfma_f32_16x16x32_bf16 v[164:167], a[16:19], a[60:63], v[164:167]
    ds_read_b64_tr_b16 a[10:11], v6 offset:28672
    s_mov_b32 s50, 0
    v_mfma_f32_16x16x32_bf16 v[168:171], a[20:23], a[56:59], v[168:171]
    ds_read_b64_tr_b16 a[12:13], v7 offset:24576
    s_sub_u32 s44, s43, 4
    v_mfma_f32_16x16x32_bf16 v[172:175], a[20:23], a[60:63], v[172:175]
    ds_read_b64_tr_b16 a[14:15], v7 offset:28672
    s_waitcnt lgkmcnt(8)
    v_mfma_f32_16x16x32_bf16 v[176:179], a[24:27], a[56:59], v[176:179]
    ds_read_b64_tr_b16 a[16:17], v8 offset:24576
    s_cmp_lt_u32 s44, 10
    v_mfma_f32_16x16x32_bf16 v[180:183], a[24:27], a[60:63], v[180:183]
    ds_read_b64_tr_b16 a[18:19], v8 offset:28672
    s_cselect_b32 s34, s34, 0
    v_mfma_f32_16x16x32_bf16 v[184:187], a[28:31], a[56:59], v[184:187]
    ds_read_b64_tr_b16 a[20:21], v9 offset:24576
    s_add_u32 s51, s78, 0
    v_mfma_f32_16x16x32_bf16 v[188:191], a[28:31], a[60:63], v[188:191]
    ds_read_b64_tr_b16 a[22:23], v9 offset:28672
    s_waitcnt vmcnt(14) lgkmcnt(8)
    v_mfma_f32_16x16x32_bf16 v[128:131], a[0:3], a[64:67], v[128:131]
    ds_read_b64_tr_b16 a[24:25], v10 offset:24576
    buffer_load_dwordx4 a[56:59], v253, s[28:31], s56 offen sc1
    v_mfma_f32_16x16x32_bf16 v[132:135], a[0:3], a[68:71], v[132:135]
    ds_read_b64_tr_b16 a[26:27], v10 offset:28672
    buffer_load_dwordx4 a[60:63], v253, s[28:31], s56 offen offset:256 sc1
    v_mfma_f32_16x16x32_bf16 v[136:139], a[4:7], a[64:67], v[136:139]
    ds_read_b64_tr_b16 a[28:29], v11 offset:24576
    s_add_u32 s56, s56, 16384
    v_mfma_f32_16x16x32_bf16 v[140:143], a[4:7], a[68:71], v[140:143]
    ds_read_b64_tr_b16 a[30:31], v11 offset:28672
    s_waitcnt lgkmcnt(8)
    v_mfma_f32_16x16x32_bf16 v[144:147], a[8:11], a[64:67], v[144:147]
    s_waitcnt vmcnt(32)
    s_barrier
    ds_read_b64_tr_b16 a[0:1], v4 offset:32768
    s_lshl_b32 s82, s41, 4
    v_mfma_f32_16x16x32_bf16 v[148:151], a[8:11], a[68:71], v[148:151]
    ds_read_b64_tr_b16 a[2:3], v4 offset:36864
    s_mul_i32 s82, s82, 1280
    v_mfma_f32_16x16x32_bf16 v[152:155], a[12:15], a[64:67], v[152:155]
    ds_read_b64_tr_b16 a[4:5], v5 offset:32768
    s_add_u32 s51, s51, s82
    v_mfma_f32_16x16x32_bf16 v[156:159], a[12:15], a[68:71], v[156:159]
    ds_read_b64_tr_b16 a[6:7], v5 offset:36864
    s_waitcnt lgkmcnt(8)
    v_mfma_f32_16x16x32_bf16 v[160:163], a[16:19], a[64:67], v[160:163]
    ds_read_b64_tr_b16 a[8:9], v6 offset:32768
    s_mul_i32 s55, s50, 163840
    v_mfma_f32_16x16x32_bf16 v[164:167], a[16:19], a[68:71], v[164:167]
    ds_read_b64_tr_b16 a[10:11], v6 offset:36864
    s_add_u32 s55, s55, s51
    v_mfma_f32_16x16x32_bf16 v[168:171], a[20:23], a[64:67], v[168:171]
    ds_read_b64_tr_b16 a[12:13], v7 offset:32768
    s_mov_b32 s90, 1802240
    v_mfma_f32_16x16x32_bf16 v[172:175], a[20:23], a[68:71], v[172:175]
    ds_read_b64_tr_b16 a[14:15], v7 offset:36864
    s_waitcnt lgkmcnt(8)
    v_mfma_f32_16x16x32_bf16 v[176:179], a[24:27], a[64:67], v[176:179]
    ds_read_b64_tr_b16 a[16:17], v8 offset:32768
    s_add_u32 s90, s90, s51
    v_mfma_f32_16x16x32_bf16 v[180:183], a[24:27], a[68:71], v[180:183]
    ds_read_b64_tr_b16 a[18:19], v8 offset:36864
    s_add_u32 m0, s53, 16384
    v_mfma_f32_16x16x32_bf16 v[184:187], a[28:31], a[64:67], v[184:187]
    ds_read_b64_tr_b16 a[20:21], v9 offset:32768
    buffer_load_dwordx4 v14, s[32:35], s55 offen lds
    v_mfma_f32_16x16x32_bf16 v[188:191], a[28:31], a[68:71], v[188:191]
    ds_read_b64_tr_b16 a[22:23], v9 offset:36864
    s_waitcnt vmcnt(11) lgkmcnt(8)
    v_mfma_f32_16x16x32_bf16 v[128:131], a[0:3], a[72:75], v[128:131]
    ds_read_b64_tr_b16 a[24:25], v10 offset:32768
    buffer_load_dwordx4 a[64:67], v19, s[28:31], s56 offen sc1
    v_mfma_f32_16x16x32_bf16 v[132:135], a[0:3], a[76:79], v[132:135]
    ds_read_b64_tr_b16 a[26:27], v10 offset:36864
    buffer_load_dwordx4 a[68:71], v19, s[28:31], s56 offen offset:256 sc1
    v_mfma_f32_16x16x32_bf16 v[136:139], a[4:7], a[72:75], v[136:139]
    ds_read_b64_tr_b16 a[28:29], v11 offset:32768
    buffer_load_dwordx4 v15, s[32:35], s55 offen offset:1024 lds
    v_mfma_f32_16x16x32_bf16 v[140:143], a[4:7], a[76:79], v[140:143]
    ds_read_b64_tr_b16 a[30:31], v11 offset:36864
    s_waitcnt lgkmcnt(8)
    v_mfma_f32_16x16x32_bf16 v[144:147], a[8:11], a[72:75], v[144:147]
    ds_read_b64_tr_b16 a[0:1], v4 offset:40960
    s_add_u32 s55, s55, 163840
    v_mfma_f32_16x16x32_bf16 v[148:151], a[8:11], a[76:79], v[148:151]
    ds_read_b64_tr_b16 a[2:3], v4 offset:45056
    s_add_u32 m0, s53, 24576
    v_mfma_f32_16x16x32_bf16 v[152:155], a[12:15], a[72:75], v[152:155]
    ds_read_b64_tr_b16 a[4:5], v5 offset:40960
    buffer_load_dwordx4 v14, s[32:35], s55 offen lds
    v_mfma_f32_16x16x32_bf16 v[156:159], a[12:15], a[76:79], v[156:159]
    ds_read_b64_tr_b16 a[6:7], v5 offset:45056
    s_waitcnt lgkmcnt(8)
    v_mfma_f32_16x16x32_bf16 v[160:163], a[16:19], a[72:75], v[160:163]
    ds_read_b64_tr_b16 a[8:9], v6 offset:40960
    buffer_load_dwordx4 v15, s[32:35], s55 offen offset:1024 lds
    v_mfma_f32_16x16x32_bf16 v[164:167], a[16:19], a[76:79], v[164:167]
    ds_read_b64_tr_b16 a[10:11], v6 offset:45056
    s_add_u32 s55, s55, 163840
    v_mfma_f32_16x16x32_bf16 v[168:171], a[20:23], a[72:75], v[168:171]
    ds_read_b64_tr_b16 a[12:13], v7 offset:40960
    s_add_u32 m0, s53, 32768
    v_mfma_f32_16x16x32_bf16 v[172:175], a[20:23], a[76:79], v[172:175]
    ds_read_b64_tr_b16 a[14:15], v7 offset:45056
    s_waitcnt lgkmcnt(8)
    v_mfma_f32_16x16x32_bf16 v[176:179], a[24:27], a[72:75], v[176:179]
    ds_read_b64_tr_b16 a[16:17], v8 offset:40960
    buffer_load_dwordx4 v14, s[32:35], s55 offen lds
    v_mfma_f32_16x16x32_bf16 v[180:183], a[24:27], a[76:79], v[180:183]
    ds_read_b64_tr_b16 a[18:19], v8 offset:45056
    buffer_load_dwordx4 v15, s[32:35], s55 offen offset:1024 lds
    v_mfma_f32_16x16x32_bf16 v[184:187], a[28:31], a[72:75], v[184:187]
    ds_read_b64_tr_b16 a[20:21], v9 offset:40960
    s_add_u32 s55, s55, 163840
    v_mfma_f32_16x16x32_bf16 v[188:191], a[28:31], a[76:79], v[188:191]
    ds_read_b64_tr_b16 a[22:23], v9 offset:45056
    s_waitcnt vmcnt(16) lgkmcnt(8)
    v_mfma_f32_16x16x32_bf16 v[128:131], a[0:3], a[80:83], v[128:131]
    ds_read_b64_tr_b16 a[24:25], v10 offset:40960
    buffer_load_dwordx4 a[72:75], v253, s[28:31], s56 offen sc1
    v_mfma_f32_16x16x32_bf16 v[132:135], a[0:3], a[84:87], v[132:135]
    ds_read_b64_tr_b16 a[26:27], v10 offset:45056
    buffer_load_dwordx4 a[76:79], v253, s[28:31], s56 offen offset:256 sc1
    v_mfma_f32_16x16x32_bf16 v[136:139], a[4:7], a[80:83], v[136:139]
    ds_read_b64_tr_b16 a[28:29], v11 offset:40960
    s_add_u32 m0, s53, 40960
    v_mfma_f32_16x16x32_bf16 v[140:143], a[4:7], a[84:87], v[140:143]
    ds_read_b64_tr_b16 a[30:31], v11 offset:45056
    s_waitcnt lgkmcnt(8)
    v_mfma_f32_16x16x32_bf16 v[144:147], a[8:11], a[80:83], v[144:147]
    s_waitcnt vmcnt(38)
    s_barrier
    ds_read_b64_tr_b16 a[0:1], v4 offset:49152
    buffer_load_dwordx4 v14, s[32:35], s55 offen lds
    v_mfma_f32_16x16x32_bf16 v[148:151], a[8:11], a[84:87], v[148:151]
    ds_read_b64_tr_b16 a[2:3], v4 offset:53248
    buffer_load_dwordx4 v15, s[32:35], s55 offen offset:1024 lds
    v_mfma_f32_16x16x32_bf16 v[152:155], a[12:15], a[80:83], v[152:155]
    ds_read_b64_tr_b16 a[4:5], v5 offset:49152
    s_add_u32 s55, s55, 163840
    v_mfma_f32_16x16x32_bf16 v[156:159], a[12:15], a[84:87], v[156:159]
    ds_read_b64_tr_b16 a[6:7], v5 offset:53248
    s_waitcnt lgkmcnt(8)
    v_mfma_f32_16x16x32_bf16 v[160:163], a[16:19], a[80:83], v[160:163]
    ds_read_b64_tr_b16 a[8:9], v6 offset:49152
    s_add_u32 m0, s53, 49152
    v_mfma_f32_16x16x32_bf16 v[164:167], a[16:19], a[84:87], v[164:167]
    ds_read_b64_tr_b16 a[10:11], v6 offset:53248
    buffer_load_dwordx4 v14, s[32:35], s55 offen lds
    v_mfma_f32_16x16x32_bf16 v[168:171], a[20:23], a[80:83], v[168:171]
    ds_read_b64_tr_b16 a[12:13], v7 offset:49152
    buffer_load_dwordx4 v15, s[32:35], s55 offen offset:1024 lds
    v_mfma_f32_16x16x32_bf16 v[172:175], a[20:23], a[84:87], v[172:175]
    ds_read_b64_tr_b16 a[14:15], v7 offset:53248
    s_waitcnt lgkmcnt(8)
    v_mfma_f32_16x16x32_bf16 v[176:179], a[24:27], a[80:83], v[176:179]
    ds_read_b64_tr_b16 a[16:17], v8 offset:49152
    s_add_u32 s55, s55, 163840
    v_mfma_f32_16x16x32_bf16 v[180:183], a[24:27], a[84:87], v[180:183]
    ds_read_b64_tr_b16 a[18:19], v8 offset:53248
    s_add_u32 m0, s53, 57344
    v_mfma_f32_16x16x32_bf16 v[184:187], a[28:31], a[80:83], v[184:187]
    ds_read_b64_tr_b16 a[20:21], v9 offset:49152
    buffer_load_dwordx4 v14, s[32:35], s55 offen lds
    v_mfma_f32_16x16x32_bf16 v[188:191], a[28:31], a[84:87], v[188:191]
    ds_read_b64_tr_b16 a[22:23], v9 offset:53248
    s_waitcnt vmcnt(21) lgkmcnt(8)
    v_mfma_f32_16x16x32_bf16 v[128:131], a[0:3], a[32:35], v[128:131]
    ds_read_b64_tr_b16 a[24:25], v10 offset:49152
    buffer_load_dwordx4 v15, s[32:35], s55 offen offset:1024 lds
    v_mfma_f32_16x16x32_bf16 v[132:135], a[0:3], a[36:39], v[132:135]
    ds_read_b64_tr_b16 a[26:27], v10 offset:53248
    s_add_u32 s55, s55, 163840
    v_mfma_f32_16x16x32_bf16 v[136:139], a[4:7], a[32:35], v[136:139]
    ds_read_b64_tr_b16 a[28:29], v11 offset:49152
    s_add_u32 m0, s53, 65536
    v_mfma_f32_16x16x32_bf16 v[140:143], a[4:7], a[36:39], v[140:143]
    ds_read_b64_tr_b16 a[30:31], v11 offset:53248
    s_waitcnt lgkmcnt(8)
    v_mfma_f32_16x16x32_bf16 v[144:147], a[8:11], a[32:35], v[144:147]
    ds_read_b64_tr_b16 a[0:1], v4 offset:57344
    buffer_load_dwordx4 v14, s[32:35], s55 offen lds
    v_mfma_f32_16x16x32_bf16 v[148:151], a[8:11], a[36:39], v[148:151]
    ds_read_b64_tr_b16 a[2:3], v4 offset:61440
    buffer_load_dwordx4 v15, s[32:35], s55 offen offset:1024 lds
    v_mfma_f32_16x16x32_bf16 v[152:155], a[12:15], a[32:35], v[152:155]
    ds_read_b64_tr_b16 a[4:5], v5 offset:57344
    s_add_u32 s55, s55, 163840
    v_mfma_f32_16x16x32_bf16 v[156:159], a[12:15], a[36:39], v[156:159]
    ds_read_b64_tr_b16 a[6:7], v5 offset:61440
    s_waitcnt lgkmcnt(8)
    v_mfma_f32_16x16x32_bf16 v[160:163], a[16:19], a[32:35], v[160:163]
    ds_read_b64_tr_b16 a[8:9], v6 offset:57344
    s_add_u32 m0, s53, 73728
    v_mfma_f32_16x16x32_bf16 v[164:167], a[16:19], a[36:39], v[164:167]
    ds_read_b64_tr_b16 a[10:11], v6 offset:61440
    buffer_load_dwordx4 v14, s[32:35], s55 offen lds
    v_mfma_f32_16x16x32_bf16 v[168:171], a[20:23], a[32:35], v[168:171]
    ds_read_b64_tr_b16 a[12:13], v7 offset:57344
    buffer_load_dwordx4 v15, s[32:35], s55 offen offset:1024 lds
    v_mfma_f32_16x16x32_bf16 v[172:175], a[20:23], a[36:39], v[172:175]
    ds_read_b64_tr_b16 a[14:15], v7 offset:61440
    s_waitcnt lgkmcnt(8)
    v_mfma_f32_16x16x32_bf16 v[176:179], a[24:27], a[32:35], v[176:179]
    ds_read_b64_tr_b16 a[16:17], v8 offset:57344
    s_add_u32 s55, s55, 163840
    v_mfma_f32_16x16x32_bf16 v[180:183], a[24:27], a[36:39], v[180:183]
    ds_read_b64_tr_b16 a[18:19], v8 offset:61440
    v_mfma_f32_16x16x32_bf16 v[184:187], a[28:31], a[32:35], v[184:187]
    ds_read_b64_tr_b16 a[20:21], v9 offset:57344
    v_mfma_f32_16x16x32_bf16 v[188:191], a[28:31], a[36:39], v[188:191]
    ds_read_b64_tr_b16 a[22:23], v9 offset:61440
    s_waitcnt vmcnt(24) lgkmcnt(8)
    v_mfma_f32_16x16x32_bf16 v[128:131], a[0:3], a[40:43], v[128:131]
    ds_read_b64_tr_b16 a[24:25], v10 offset:57344
    v_mfma_f32_16x16x32_bf16 v[132:135], a[0:3], a[44:47], v[132:135]
    ds_read_b64_tr_b16 a[26:27], v10 offset:61440
    v_mfma_f32_16x16x32_bf16 v[136:139], a[4:7], a[40:43], v[136:139]
    ds_read_b64_tr_b16 a[28:29], v11 offset:57344
    v_mfma_f32_16x16x32_bf16 v[140:143], a[4:7], a[44:47], v[140:143]
    ds_read_b64_tr_b16 a[30:31], v11 offset:61440
    s_waitcnt lgkmcnt(8)
    v_mfma_f32_16x16x32_bf16 v[144:147], a[8:11], a[40:43], v[144:147]
    s_waitcnt vmcnt(40)
    s_barrier
    v_add_u32 v4, 65536, v4
    v_add_u32 v5, 65536, v5
    v_add_u32 v6, 65536, v6
    v_add_u32 v7, 65536, v7
    v_add_u32 v8, 65536, v8
    v_add_u32 v9, 65536, v9
    v_add_u32 v10, 65536, v10
    v_add_u32 v11, 65536, v11
    ds_read_b64_tr_b16 a[0:1], v4 offset:0
    s_add_u32 m0, s53, 81920
    v_mfma_f32_16x16x32_bf16 v[148:151], a[8:11], a[44:47], v[148:151]
    ds_read_b64_tr_b16 a[2:3], v4 offset:4096
    buffer_load_dwordx4 v14, s[32:35], s55 offen lds
    v_mfma_f32_16x16x32_bf16 v[152:155], a[12:15], a[40:43], v[152:155]
    ds_read_b64_tr_b16 a[4:5], v5 offset:0
    buffer_load_dwordx4 v15, s[32:35], s55 offen offset:1024 lds
    v_mfma_f32_16x16x32_bf16 v[156:159], a[12:15], a[44:47], v[156:159]
    ds_read_b64_tr_b16 a[6:7], v5 offset:4096
    s_waitcnt lgkmcnt(8)
    v_mfma_f32_16x16x32_bf16 v[160:163], a[16:19], a[40:43], v[160:163]
    ds_read_b64_tr_b16 a[8:9], v6 offset:0
    s_add_u32 s55, s55, 163840
    v_mfma_f32_16x16x32_bf16 v[164:167], a[16:19], a[44:47], v[164:167]
    ds_read_b64_tr_b16 a[10:11], v6 offset:4096
    s_add_u32 m0, s53, 90112
    v_mfma_f32_16x16x32_bf16 v[168:171], a[20:23], a[40:43], v[168:171]
    ds_read_b64_tr_b16 a[12:13], v7 offset:0
    buffer_load_dwordx4 v14, s[32:35], s55 offen lds
    v_mfma_f32_16x16x32_bf16 v[172:175], a[20:23], a[44:47], v[172:175]
    ds_read_b64_tr_b16 a[14:15], v7 offset:4096
    s_waitcnt lgkmcnt(8)
    v_mfma_f32_16x16x32_bf16 v[176:179], a[24:27], a[40:43], v[176:179]
    ds_read_b64_tr_b16 a[16:17], v8 offset:0
    buffer_load_dwordx4 v15, s[32:35], s55 offen offset:1024 lds
    v_mfma_f32_16x16x32_bf16 v[180:183], a[24:27], a[44:47], v[180:183]
    ds_read_b64_tr_b16 a[18:19], v8 offset:4096
    s_add_u32 s55, s55, 163840
    v_mfma_f32_16x16x32_bf16 v[184:187], a[28:31], a[40:43], v[184:187]
    ds_read_b64_tr_b16 a[20:21], v9 offset:0
    v_mfma_f32_16x16x32_bf16 v[188:191], a[28:31], a[44:47], v[188:191]
    ds_read_b64_tr_b16 a[22:23], v9 offset:4096
    s_waitcnt vmcnt(26) lgkmcnt(8)
    v_mfma_f32_16x16x32_bf16 v[128:131], a[0:3], a[48:51], v[128:131]
    ds_read_b64_tr_b16 a[24:25], v10 offset:0
    v_mfma_f32_16x16x32_bf16 v[132:135], a[0:3], a[52:55], v[132:135]
    ds_read_b64_tr_b16 a[26:27], v10 offset:4096
    v_mfma_f32_16x16x32_bf16 v[136:139], a[4:7], a[48:51], v[136:139]
    ds_read_b64_tr_b16 a[28:29], v11 offset:0
    v_mfma_f32_16x16x32_bf16 v[140:143], a[4:7], a[52:55], v[140:143]
    ds_read_b64_tr_b16 a[30:31], v11 offset:4096
    s_waitcnt lgkmcnt(8)
    v_mfma_f32_16x16x32_bf16 v[144:147], a[8:11], a[48:51], v[144:147]
    ds_read_b64_tr_b16 a[0:1], v4 offset:8192
    v_mfma_f32_16x16x32_bf16 v[148:151], a[8:11], a[52:55], v[148:151]
    ds_read_b64_tr_b16 a[2:3], v4 offset:12288
    v_mfma_f32_16x16x32_bf16 v[152:155], a[12:15], a[48:51], v[152:155]
    ds_read_b64_tr_b16 a[4:5], v5 offset:8192
    v_mfma_f32_16x16x32_bf16 v[156:159], a[12:15], a[52:55], v[156:159]
    ds_read_b64_tr_b16 a[6:7], v5 offset:12288
    s_waitcnt lgkmcnt(8)
    v_mfma_f32_16x16x32_bf16 v[160:163], a[16:19], a[48:51], v[160:163]
    ds_read_b64_tr_b16 a[8:9], v6 offset:8192
    v_mfma_f32_16x16x32_bf16 v[164:167], a[16:19], a[52:55], v[164:167]
    ds_read_b64_tr_b16 a[10:11], v6 offset:12288
    v_mfma_f32_16x16x32_bf16 v[168:171], a[20:23], a[48:51], v[168:171]
    ds_read_b64_tr_b16 a[12:13], v7 offset:8192
    v_mfma_f32_16x16x32_bf16 v[172:175], a[20:23], a[52:55], v[172:175]
    ds_read_b64_tr_b16 a[14:15], v7 offset:12288
    s_waitcnt lgkmcnt(8)
    v_mfma_f32_16x16x32_bf16 v[176:179], a[24:27], a[48:51], v[176:179]
    ds_read_b64_tr_b16 a[16:17], v8 offset:8192
    v_mfma_f32_16x16x32_bf16 v[180:183], a[24:27], a[52:55], v[180:183]
    ds_read_b64_tr_b16 a[18:19], v8 offset:12288
    v_mfma_f32_16x16x32_bf16 v[184:187], a[28:31], a[48:51], v[184:187]
    ds_read_b64_tr_b16 a[20:21], v9 offset:8192
    v_mfma_f32_16x16x32_bf16 v[188:191], a[28:31], a[52:55], v[188:191]
    ds_read_b64_tr_b16 a[22:23], v9 offset:12288
    s_waitcnt vmcnt(24) lgkmcnt(8)
    v_mfma_f32_16x16x32_bf16 v[128:131], a[0:3], a[56:59], v[128:131]
    ds_read_b64_tr_b16 a[24:25], v10 offset:8192
    v_mfma_f32_16x16x32_bf16 v[132:135], a[0:3], a[60:63], v[132:135]
    ds_read_b64_tr_b16 a[26:27], v10 offset:12288
    v_mfma_f32_16x16x32_bf16 v[136:139], a[4:7], a[56:59], v[136:139]
    ds_read_b64_tr_b16 a[28:29], v11 offset:8192
    v_mfma_f32_16x16x32_bf16 v[140:143], a[4:7], a[60:63], v[140:143]
    ds_read_b64_tr_b16 a[30:31], v11 offset:12288
    s_waitcnt lgkmcnt(8)
    v_mfma_f32_16x16x32_bf16 v[144:147], a[8:11], a[56:59], v[144:147]
    s_waitcnt vmcnt(36)
    s_barrier
    v_add_u32 v4, 4294836224, v4
    v_add_u32 v5, 4294836224, v5
    v_add_u32 v6, 4294836224, v6
    v_add_u32 v7, 4294836224, v7
    v_add_u32 v8, 4294836224, v8
    v_add_u32 v9, 4294836224, v9
    v_add_u32 v10, 4294836224, v10
    v_add_u32 v11, 4294836224, v11
    ds_read_b64_tr_b16 a[0:1], v4 offset:0
    s_add_u32 m0, s53, 98304
    v_mfma_f32_16x16x32_bf16 v[148:151], a[8:11], a[60:63], v[148:151]
    ds_read_b64_tr_b16 a[2:3], v4 offset:4096
    buffer_load_dwordx4 v14, s[32:35], s55 offen lds
    v_mfma_f32_16x16x32_bf16 v[152:155], a[12:15], a[56:59], v[152:155]
    ds_read_b64_tr_b16 a[4:5], v5 offset:0
    buffer_load_dwordx4 v15, s[32:35], s55 offen offset:1024 lds
    v_mfma_f32_16x16x32_bf16 v[156:159], a[12:15], a[60:63], v[156:159]
    ds_read_b64_tr_b16 a[6:7], v5 offset:4096
    s_waitcnt lgkmcnt(8)
    v_mfma_f32_16x16x32_bf16 v[160:163], a[16:19], a[56:59], v[160:163]
    ds_read_b64_tr_b16 a[8:9], v6 offset:0
    s_add_u32 s51, s78, 81920
    v_mfma_f32_16x16x32_bf16 v[164:167], a[16:19], a[60:63], v[164:167]
    ds_read_b64_tr_b16 a[10:11], v6 offset:4096
    s_lshl_b32 s82, s41, 4
    v_mfma_f32_16x16x32_bf16 v[168:171], a[20:23], a[56:59], v[168:171]
    ds_read_b64_tr_b16 a[12:13], v7 offset:0
    s_mul_i32 s82, s82, 1280
    v_mfma_f32_16x16x32_bf16 v[172:175], a[20:23], a[60:63], v[172:175]
    ds_read_b64_tr_b16 a[14:15], v7 offset:4096
    s_waitcnt lgkmcnt(8)
    v_mfma_f32_16x16x32_bf16 v[176:179], a[24:27], a[56:59], v[176:179]
    ds_read_b64_tr_b16 a[16:17], v8 offset:0
    s_add_u32 s51, s51, s82
    v_mfma_f32_16x16x32_bf16 v[180:183], a[24:27], a[60:63], v[180:183]
    ds_read_b64_tr_b16 a[18:19], v8 offset:4096
    s_mul_i32 s55, s50, 163840
    v_mfma_f32_16x16x32_bf16 v[184:187], a[28:31], a[56:59], v[184:187]
    ds_read_b64_tr_b16 a[20:21], v9 offset:0
    s_add_u32 s55, s55, s51
    v_mfma_f32_16x16x32_bf16 v[188:191], a[28:31], a[60:63], v[188:191]
    ds_read_b64_tr_b16 a[22:23], v9 offset:4096
    s_waitcnt vmcnt(23) lgkmcnt(8)
    v_mfma_f32_16x16x32_bf16 v[128:131], a[0:3], a[64:67], v[128:131]
    ds_read_b64_tr_b16 a[24:25], v10 offset:0
    s_mov_b32 s90, 1802240
    v_mfma_f32_16x16x32_bf16 v[132:135], a[0:3], a[68:71], v[132:135]
    ds_read_b64_tr_b16 a[26:27], v10 offset:4096
    s_add_u32 s90, s90, s51
    v_mfma_f32_16x16x32_bf16 v[136:139], a[4:7], a[64:67], v[136:139]
    ds_read_b64_tr_b16 a[28:29], v11 offset:0
    s_add_u32 m0, s53, 106496
    v_mfma_f32_16x16x32_bf16 v[140:143], a[4:7], a[68:71], v[140:143]
    ds_read_b64_tr_b16 a[30:31], v11 offset:4096
    s_waitcnt lgkmcnt(8)
    v_mfma_f32_16x16x32_bf16 v[144:147], a[8:11], a[64:67], v[144:147]
    ds_read_b64_tr_b16 a[0:1], v4 offset:8192
    buffer_load_dwordx4 v14, s[32:35], s55 offen lds
    v_mfma_f32_16x16x32_bf16 v[148:151], a[8:11], a[68:71], v[148:151]
    ds_read_b64_tr_b16 a[2:3], v4 offset:12288
    buffer_load_dwordx4 v15, s[32:35], s55 offen offset:1024 lds
    v_mfma_f32_16x16x32_bf16 v[152:155], a[12:15], a[64:67], v[152:155]
    ds_read_b64_tr_b16 a[4:5], v5 offset:8192
    s_add_u32 s55, s55, 163840
    v_mfma_f32_16x16x32_bf16 v[156:159], a[12:15], a[68:71], v[156:159]
    ds_read_b64_tr_b16 a[6:7], v5 offset:12288
    s_waitcnt lgkmcnt(8)
    v_mfma_f32_16x16x32_bf16 v[160:163], a[16:19], a[64:67], v[160:163]
    ds_read_b64_tr_b16 a[8:9], v6 offset:8192
    v_mfma_f32_16x16x32_bf16 v[164:167], a[16:19], a[68:71], v[164:167]
    ds_read_b64_tr_b16 a[10:11], v6 offset:12288
    v_mfma_f32_16x16x32_bf16 v[168:171], a[20:23], a[64:67], v[168:171]
    ds_read_b64_tr_b16 a[12:13], v7 offset:8192
    v_mfma_f32_16x16x32_bf16 v[172:175], a[20:23], a[68:71], v[172:175]
    ds_read_b64_tr_b16 a[14:15], v7 offset:12288
    s_waitcnt lgkmcnt(8)
    v_mfma_f32_16x16x32_bf16 v[176:179], a[24:27], a[64:67], v[176:179]
    ds_read_b64_tr_b16 a[16:17], v8 offset:8192
    v_mfma_f32_16x16x32_bf16 v[180:183], a[24:27], a[68:71], v[180:183]
    ds_read_b64_tr_b16 a[18:19], v8 offset:12288
    v_mfma_f32_16x16x32_bf16 v[184:187], a[28:31], a[64:67], v[184:187]
    ds_read_b64_tr_b16 a[20:21], v9 offset:8192
    v_mfma_f32_16x16x32_bf16 v[188:191], a[28:31], a[68:71], v[188:191]
    ds_read_b64_tr_b16 a[22:23], v9 offset:12288
    s_waitcnt vmcnt(18) lgkmcnt(8)
    v_mfma_f32_16x16x32_bf16 v[128:131], a[0:3], a[72:75], v[128:131]
    ds_read_b64_tr_b16 a[24:25], v10 offset:8192
    v_mfma_f32_16x16x32_bf16 v[132:135], a[0:3], a[76:79], v[132:135]
    ds_read_b64_tr_b16 a[26:27], v10 offset:12288
    v_mfma_f32_16x16x32_bf16 v[136:139], a[4:7], a[72:75], v[136:139]
    ds_read_b64_tr_b16 a[28:29], v11 offset:8192
    v_mfma_f32_16x16x32_bf16 v[140:143], a[4:7], a[76:79], v[140:143]
    ds_read_b64_tr_b16 a[30:31], v11 offset:12288
    s_waitcnt lgkmcnt(8)
    v_mfma_f32_16x16x32_bf16 v[144:147], a[8:11], a[72:75], v[144:147]
    v_mfma_f32_16x16x32_bf16 v[148:151], a[8:11], a[76:79], v[148:151]
    v_mfma_f32_16x16x32_bf16 v[152:155], a[12:15], a[72:75], v[152:155]
    v_mfma_f32_16x16x32_bf16 v[156:159], a[12:15], a[76:79], v[156:159]
    s_waitcnt lgkmcnt(4)
    v_mfma_f32_16x16x32_bf16 v[160:163], a[16:19], a[72:75], v[160:163]
    v_mfma_f32_16x16x32_bf16 v[164:167], a[16:19], a[76:79], v[164:167]
    v_mfma_f32_16x16x32_bf16 v[168:171], a[20:23], a[72:75], v[168:171]
    v_mfma_f32_16x16x32_bf16 v[172:175], a[20:23], a[76:79], v[172:175]
    s_waitcnt lgkmcnt(0)
    v_mfma_f32_16x16x32_bf16 v[176:179], a[24:27], a[72:75], v[176:179]
    v_mfma_f32_16x16x32_bf16 v[180:183], a[24:27], a[76:79], v[180:183]
    v_mfma_f32_16x16x32_bf16 v[184:187], a[28:31], a[72:75], v[184:187]
    v_mfma_f32_16x16x32_bf16 v[188:191], a[28:31], a[76:79], v[188:191]
    s_barrier
    s_mul_i32 s56, s42, 442368
    s_add_u32 s56, s56, 12910592
    s_lshl_b32 s44, s58, 14
    s_add_u32 s56, s56, s44
    s_mov_b32 s91, s56
    v_pk_fma_f32 v[128:129], v[192:193], v[40:41], v[128:129] op_sel_hi:[1,0,1] neg_lo:[0,1,0] neg_hi:[0,1,0]
    v_pk_fma_f32 v[130:131], v[194:195], v[40:41], v[130:131] op_sel_hi:[1,0,1] neg_lo:[0,1,0] neg_hi:[0,1,0]
    v_pk_fma_f32 v[136:137], v[196:197], v[40:41], v[136:137] op_sel_hi:[1,0,1] neg_lo:[0,1,0] neg_hi:[0,1,0]
    v_pk_fma_f32 v[138:139], v[198:199], v[40:41], v[138:139] op_sel_hi:[1,0,1] neg_lo:[0,1,0] neg_hi:[0,1,0]
    v_pk_fma_f32 v[132:133], v[192:193], v[42:43], v[132:133] op_sel_hi:[1,0,1] neg_lo:[0,1,0] neg_hi:[0,1,0]
    v_pk_fma_f32 v[134:135], v[194:195], v[42:43], v[134:135] op_sel_hi:[1,0,1] neg_lo:[0,1,0] neg_hi:[0,1,0]
    v_pk_fma_f32 v[140:141], v[196:197], v[42:43], v[140:141] op_sel_hi:[1,0,1] neg_lo:[0,1,0] neg_hi:[0,1,0]
    v_pk_fma_f32 v[142:143], v[198:199], v[42:43], v[142:143] op_sel_hi:[1,0,1] neg_lo:[0,1,0] neg_hi:[0,1,0]
    v_pk_mul_f32 v[22:23], v[128:129], v[128:129]
    v_pk_mul_f32 v[24:25], v[130:131], v[130:131]
    v_pk_mul_f32 v[26:27], v[136:137], v[136:137]
    v_pk_mul_f32 v[28:29], v[138:139], v[138:139]
    v_pk_mul_f32 v[30:31], v[132:133], v[132:133]
    v_pk_mul_f32 v[32:33], v[134:135], v[134:135]
    v_pk_mul_f32 v[34:35], v[140:141], v[140:141]
    v_pk_mul_f32 v[36:37], v[142:143], v[142:143]
    v_pk_fma_f32 v[22:23], v[22:23], v[226:227], v[224:225] op_sel_hi:[1,0,0]
    v_pk_fma_f32 v[24:25], v[24:25], v[226:227], v[224:225] op_sel_hi:[1,0,0]
    v_pk_fma_f32 v[26:27], v[26:27], v[226:227], v[224:225] op_sel_hi:[1,0,0]
    v_pk_fma_f32 v[28:29], v[28:29], v[226:227], v[224:225] op_sel_hi:[1,0,0]
    v_pk_fma_f32 v[30:31], v[30:31], v[232:233], v[230:231] op_sel_hi:[1,0,0]
    v_pk_fma_f32 v[32:33], v[32:33], v[232:233], v[230:231] op_sel_hi:[1,0,0]
    v_pk_fma_f32 v[34:35], v[34:35], v[232:233], v[230:231] op_sel_hi:[1,0,0]
    v_pk_fma_f32 v[36:37], v[36:37], v[232:233], v[230:231] op_sel_hi:[1,0,0]
    s_add_u32 m0, s53, 114688
    s_nop 0
    buffer_load_dwordx4 v14, s[32:35], s55 offen lds
    v_pk_mul_f32 v[22:23], v[22:23], v[128:129]
    v_pk_mul_f32 v[24:25], v[24:25], v[130:131]
    v_pk_mul_f32 v[26:27], v[26:27], v[136:137]
    v_pk_mul_f32 v[28:29], v[28:29], v[138:139]
    v_pk_mul_f32 v[30:31], v[30:31], v[132:133]
    v_pk_mul_f32 v[32:33], v[32:33], v[134:135]
    v_pk_mul_f32 v[34:35], v[34:35], v[140:141]
    v_pk_mul_f32 v[36:37], v[36:37], v[142:143]
    v_exp_f32 v22, v22
    v_exp_f32 v23, v23
    v_exp_f32 v24, v24
    v_exp_f32 v25, v25
    v_exp_f32 v26, v26
    v_exp_f32 v27, v27
    v_exp_f32 v28, v28
    v_exp_f32 v29, v29
    v_exp_f32 v30, v30
    v_exp_f32 v31, v31
    v_exp_f32 v32, v32
    v_exp_f32 v33, v33
    v_exp_f32 v34, v34
    v_exp_f32 v35, v35
    v_exp_f32 v36, v36
    v_exp_f32 v37, v37
    buffer_load_dwordx4 v15, s[32:35], s55 offen offset:1024 lds
    s_add_u32 s55, s55, 163840
    v_pk_fma_f32 v[22:23], v[22:23], v[228:229], v[228:229] op_sel_hi:[1,0,0]
    v_pk_fma_f32 v[24:25], v[24:25], v[228:229], v[228:229] op_sel_hi:[1,0,0]
    v_pk_fma_f32 v[26:27], v[26:27], v[228:229], v[228:229] op_sel_hi:[1,0,0]
    v_pk_fma_f32 v[28:29], v[28:29], v[228:229], v[228:229] op_sel_hi:[1,0,0]
    v_pk_fma_f32 v[30:31], v[30:31], v[234:235], v[234:235] op_sel_hi:[1,0,0]
    v_pk_fma_f32 v[32:33], v[32:33], v[234:235], v[234:235] op_sel_hi:[1,0,0]
    v_pk_fma_f32 v[34:35], v[34:35], v[234:235], v[234:235] op_sel_hi:[1,0,0]
    v_pk_fma_f32 v[36:37], v[36:37], v[234:235], v[234:235] op_sel_hi:[1,0,0]
    v_rcp_f32 v22, v22
    v_rcp_f32 v23, v23
    v_rcp_f32 v24, v24
    v_rcp_f32 v25, v25
    v_rcp_f32 v26, v26
    v_rcp_f32 v27, v27
    v_rcp_f32 v28, v28
    v_rcp_f32 v29, v29
    v_rcp_f32 v30, v30
    v_rcp_f32 v31, v31
    v_rcp_f32 v32, v32
    v_rcp_f32 v33, v33
    v_rcp_f32 v34, v34
    v_rcp_f32 v35, v35
    v_rcp_f32 v36, v36
    v_rcp_f32 v37, v37
    s_add_u32 m0, s53, 122880
    s_nop 0
    buffer_load_dwordx4 v14, s[32:35], s55 offen lds
    v_pk_mul_f32 v[128:129], v[128:129], v[22:23]
    v_pk_mul_f32 v[130:131], v[130:131], v[24:25]
    v_pk_mul_f32 v[136:137], v[136:137], v[26:27]
    v_pk_mul_f32 v[138:139], v[138:139], v[28:29]
    v_pk_mul_f32 v[132:133], v[132:133], v[30:31]
    v_pk_mul_f32 v[134:135], v[134:135], v[32:33]
    v_pk_mul_f32 v[140:141], v[140:141], v[34:35]
    v_pk_mul_f32 v[142:143], v[142:143], v[36:37]
    v_cvt_pk_bf16_f32 v48, v128, v129
    v_cvt_pk_bf16_f32 v49, v130, v131
    v_cvt_pk_bf16_f32 v50, v136, v137
    v_cvt_pk_bf16_f32 v51, v138, v139
    v_cvt_pk_bf16_f32 v52, v132, v133
    v_cvt_pk_bf16_f32 v53, v134, v135
    v_cvt_pk_bf16_f32 v54, v140, v141
    v_cvt_pk_bf16_f32 v55, v142, v143
    buffer_store_dwordx4 v[48:51], v19, s[28:31], s56 offen sc1
    buffer_store_dwordx4 v[52:55], v19, s[28:31], s56 offen offset:256 sc1
    s_add_u32 s56, s56, 8192
    v_pk_fma_f32 v[144:145], v[200:201], v[40:41], v[144:145] op_sel_hi:[1,0,1] neg_lo:[0,1,0] neg_hi:[0,1,0]
    v_pk_fma_f32 v[146:147], v[202:203], v[40:41], v[146:147] op_sel_hi:[1,0,1] neg_lo:[0,1,0] neg_hi:[0,1,0]
    v_pk_fma_f32 v[152:153], v[204:205], v[40:41], v[152:153] op_sel_hi:[1,0,1] neg_lo:[0,1,0] neg_hi:[0,1,0]
    v_pk_fma_f32 v[154:155], v[206:207], v[40:41], v[154:155] op_sel_hi:[1,0,1] neg_lo:[0,1,0] neg_hi:[0,1,0]
    v_pk_fma_f32 v[148:149], v[200:201], v[42:43], v[148:149] op_sel_hi:[1,0,1] neg_lo:[0,1,0] neg_hi:[0,1,0]
    v_pk_fma_f32 v[150:151], v[202:203], v[42:43], v[150:151] op_sel_hi:[1,0,1] neg_lo:[0,1,0] neg_hi:[0,1,0]
    v_pk_fma_f32 v[156:157], v[204:205], v[42:43], v[156:157] op_sel_hi:[1,0,1] neg_lo:[0,1,0] neg_hi:[0,1,0]
    v_pk_fma_f32 v[158:159], v[206:207], v[42:43], v[158:159] op_sel_hi:[1,0,1] neg_lo:[0,1,0] neg_hi:[0,1,0]
    buffer_load_dwordx4 v15, s[32:35], s55 offen offset:1024 lds
    s_add_u32 s55, s55, 163840
    v_pk_mul_f32 v[22:23], v[144:145], v[144:145]
    v_pk_mul_f32 v[24:25], v[146:147], v[146:147]
    v_pk_mul_f32 v[26:27], v[152:153], v[152:153]
    v_pk_mul_f32 v[28:29], v[154:155], v[154:155]
    v_pk_mul_f32 v[30:31], v[148:149], v[148:149]
    v_pk_mul_f32 v[32:33], v[150:151], v[150:151]
    v_pk_mul_f32 v[34:35], v[156:157], v[156:157]
    v_pk_mul_f32 v[36:37], v[158:159], v[158:159]
    v_pk_fma_f32 v[22:23], v[22:23], v[226:227], v[224:225] op_sel_hi:[1,0,0]
    v_pk_fma_f32 v[24:25], v[24:25], v[226:227], v[224:225] op_sel_hi:[1,0,0]
    v_pk_fma_f32 v[26:27], v[26:27], v[226:227], v[224:225] op_sel_hi:[1,0,0]
    v_pk_fma_f32 v[28:29], v[28:29], v[226:227], v[224:225] op_sel_hi:[1,0,0]
    v_pk_fma_f32 v[30:31], v[30:31], v[232:233], v[230:231] op_sel_hi:[1,0,0]
    v_pk_fma_f32 v[32:33], v[32:33], v[232:233], v[230:231] op_sel_hi:[1,0,0]
    v_pk_fma_f32 v[34:35], v[34:35], v[232:233], v[230:231] op_sel_hi:[1,0,0]
    v_pk_fma_f32 v[36:37], v[36:37], v[232:233], v[230:231] op_sel_hi:[1,0,0]
    v_pk_mul_f32 v[22:23], v[22:23], v[144:145]
    v_pk_mul_f32 v[24:25], v[24:25], v[146:147]
    v_pk_mul_f32 v[26:27], v[26:27], v[152:153]
    v_pk_mul_f32 v[28:29], v[28:29], v[154:155]
    v_pk_mul_f32 v[30:31], v[30:31], v[148:149]
    v_pk_mul_f32 v[32:33], v[32:33], v[150:151]
    v_pk_mul_f32 v[34:35], v[34:35], v[156:157]
    v_pk_mul_f32 v[36:37], v[36:37], v[158:159]
    s_add_u32 m0, s53, 131072
    s_nop 0
    buffer_load_dwordx4 v14, s[32:35], s55 offen lds
    v_exp_f32 v22, v22
    v_exp_f32 v23, v23
    v_exp_f32 v24, v24
    v_exp_f32 v25, v25
    v_exp_f32 v26, v26
    v_exp_f32 v27, v27
    v_exp_f32 v28, v28
    v_exp_f32 v29, v29
    v_exp_f32 v30, v30
    v_exp_f32 v31, v31
    v_exp_f32 v32, v32
    v_exp_f32 v33, v33
    v_exp_f32 v34, v34
    v_exp_f32 v35, v35
    v_exp_f32 v36, v36
    v_exp_f32 v37, v37
    v_pk_fma_f32 v[22:23], v[22:23], v[228:229], v[228:229] op_sel_hi:[1,0,0]
    v_pk_fma_f32 v[24:25], v[24:25], v[228:229], v[228:229] op_sel_hi:[1,0,0]
    v_pk_fma_f32 v[26:27], v[26:27], v[228:229], v[228:229] op_sel_hi:[1,0,0]
    v_pk_fma_f32 v[28:29], v[28:29], v[228:229], v[228:229] op_sel_hi:[1,0,0]
    v_pk_fma_f32 v[30:31], v[30:31], v[234:235], v[234:235] op_sel_hi:[1,0,0]
    v_pk_fma_f32 v[32:33], v[32:33], v[234:235], v[234:235] op_sel_hi:[1,0,0]
    v_pk_fma_f32 v[34:35], v[34:35], v[234:235], v[234:235] op_sel_hi:[1,0,0]
    v_pk_fma_f32 v[36:37], v[36:37], v[234:235], v[234:235] op_sel_hi:[1,0,0]
    buffer_load_dwordx4 v15, s[32:35], s55 offen offset:1024 lds
    s_add_u32 s55, s55, 163840
    v_rcp_f32 v22, v22
    v_rcp_f32 v23, v23
    v_rcp_f32 v24, v24
    v_rcp_f32 v25, v25
    v_rcp_f32 v26, v26
    v_rcp_f32 v27, v27
    v_rcp_f32 v28, v28
    v_rcp_f32 v29, v29
    v_rcp_f32 v30, v30
    v_rcp_f32 v31, v31
    v_rcp_f32 v32, v32
    v_rcp_f32 v33, v33
    v_rcp_f32 v34, v34
    v_rcp_f32 v35, v35
    v_rcp_f32 v36, v36
    v_rcp_f32 v37, v37
    v_pk_mul_f32 v[144:145], v[144:145], v[22:23]
    v_pk_mul_f32 v[146:147], v[146:147], v[24:25]
    v_pk_mul_f32 v[152:153], v[152:153], v[26:27]
    v_pk_mul_f32 v[154:155], v[154:155], v[28:29]
    v_pk_mul_f32 v[148:149], v[148:149], v[30:31]
    v_pk_mul_f32 v[150:151], v[150:151], v[32:33]
    v_pk_mul_f32 v[156:157], v[156:157], v[34:35]
    v_pk_mul_f32 v[158:159], v[158:159], v[36:37]
    s_add_u32 m0, s53, 139264
    s_nop 0
    buffer_load_dwordx4 v14, s[32:35], s55 offen lds
    v_cvt_pk_bf16_f32 v56, v144, v145
    v_cvt_pk_bf16_f32 v57, v146, v147
    v_cvt_pk_bf16_f32 v58, v152, v153
    v_cvt_pk_bf16_f32 v59, v154, v155
    v_cvt_pk_bf16_f32 v60, v148, v149
    v_cvt_pk_bf16_f32 v61, v150, v151
    v_cvt_pk_bf16_f32 v62, v156, v157
    v_cvt_pk_bf16_f32 v63, v158, v159
    buffer_store_dwordx4 v[56:59], v19, s[28:31], s56 offen sc1
    buffer_store_dwordx4 v[60:63], v19, s[28:31], s56 offen offset:256 sc1
    s_add_u32 s56, s56, 8192
    v_pk_fma_f32 v[160:161], v[208:209], v[40:41], v[160:161] op_sel_hi:[1,0,1] neg_lo:[0,1,0] neg_hi:[0,1,0]
    v_pk_fma_f32 v[162:163], v[210:211], v[40:41], v[162:163] op_sel_hi:[1,0,1] neg_lo:[0,1,0] neg_hi:[0,1,0]
    v_pk_fma_f32 v[168:169], v[212:213], v[40:41], v[168:169] op_sel_hi:[1,0,1] neg_lo:[0,1,0] neg_hi:[0,1,0]
    v_pk_fma_f32 v[170:171], v[214:215], v[40:41], v[170:171] op_sel_hi:[1,0,1] neg_lo:[0,1,0] neg_hi:[0,1,0]
    v_pk_fma_f32 v[164:165], v[208:209], v[42:43], v[164:165] op_sel_hi:[1,0,1] neg_lo:[0,1,0] neg_hi:[0,1,0]
    v_pk_fma_f32 v[166:167], v[210:211], v[42:43], v[166:167] op_sel_hi:[1,0,1] neg_lo:[0,1,0] neg_hi:[0,1,0]
    v_pk_fma_f32 v[172:173], v[212:213], v[42:43], v[172:173] op_sel_hi:[1,0,1] neg_lo:[0,1,0] neg_hi:[0,1,0]
    v_pk_fma_f32 v[174:175], v[214:215], v[42:43], v[174:175] op_sel_hi:[1,0,1] neg_lo:[0,1,0] neg_hi:[0,1,0]
    v_pk_mul_f32 v[22:23], v[160:161], v[160:161]
    v_pk_mul_f32 v[24:25], v[162:163], v[162:163]
    v_pk_mul_f32 v[26:27], v[168:169], v[168:169]
    v_pk_mul_f32 v[28:29], v[170:171], v[170:171]
    v_pk_mul_f32 v[30:31], v[164:165], v[164:165]
    v_pk_mul_f32 v[32:33], v[166:167], v[166:167]
    v_pk_mul_f32 v[34:35], v[172:173], v[172:173]
    v_pk_mul_f32 v[36:37], v[174:175], v[174:175]
    buffer_load_dwordx4 v15, s[32:35], s55 offen offset:1024 lds
    s_add_u32 s55, s55, 163840
    v_pk_fma_f32 v[22:23], v[22:23], v[226:227], v[224:225] op_sel_hi:[1,0,0]
    v_pk_fma_f32 v[24:25], v[24:25], v[226:227], v[224:225] op_sel_hi:[1,0,0]
    v_pk_fma_f32 v[26:27], v[26:27], v[226:227], v[224:225] op_sel_hi:[1,0,0]
    v_pk_fma_f32 v[28:29], v[28:29], v[226:227], v[224:225] op_sel_hi:[1,0,0]
    v_pk_fma_f32 v[30:31], v[30:31], v[232:233], v[230:231] op_sel_hi:[1,0,0]
    v_pk_fma_f32 v[32:33], v[32:33], v[232:233], v[230:231] op_sel_hi:[1,0,0]
    v_pk_fma_f32 v[34:35], v[34:35], v[232:233], v[230:231] op_sel_hi:[1,0,0]
    v_pk_fma_f32 v[36:37], v[36:37], v[232:233], v[230:231] op_sel_hi:[1,0,0]
    v_pk_mul_f32 v[22:23], v[22:23], v[160:161]
    v_pk_mul_f32 v[24:25], v[24:25], v[162:163]
    v_pk_mul_f32 v[26:27], v[26:27], v[168:169]
    v_pk_mul_f32 v[28:29], v[28:29], v[170:171]
    v_pk_mul_f32 v[30:31], v[30:31], v[164:165]
    v_pk_mul_f32 v[32:33], v[32:33], v[166:167]
    v_pk_mul_f32 v[34:35], v[34:35], v[172:173]
    v_pk_mul_f32 v[36:37], v[36:37], v[174:175]
    v_exp_f32 v22, v22
    v_exp_f32 v23, v23
    v_exp_f32 v24, v24
    v_exp_f32 v25, v25
    v_exp_f32 v26, v26
    v_exp_f32 v27, v27
    v_exp_f32 v28, v28
    v_exp_f32 v29, v29
    v_exp_f32 v30, v30
    v_exp_f32 v31, v31
    v_exp_f32 v32, v32
    v_exp_f32 v33, v33
    v_exp_f32 v34, v34
    v_exp_f32 v35, v35
    v_exp_f32 v36, v36
    v_exp_f32 v37, v37
    v_pk_fma_f32 v[22:23], v[22:23], v[228:229], v[228:229] op_sel_hi:[1,0,0]
    v_pk_fma_f32 v[24:25], v[24:25], v[228:229], v[228:229] op_sel_hi:[1,0,0]
    v_pk_fma_f32 v[26:27], v[26:27], v[228:229], v[228:229] op_sel_hi:[1,0,0]
    v_pk_fma_f32 v[28:29], v[28:29], v[228:229], v[228:229] op_sel_hi:[1,0,0]
    v_pk_fma_f32 v[30:31], v[30:31], v[234:235], v[234:235] op_sel_hi:[1,0,0]
    v_pk_fma_f32 v[32:33], v[32:33], v[234:235], v[234:235] op_sel_hi:[1,0,0]
    v_pk_fma_f32 v[34:35], v[34:35], v[234:235], v[234:235] op_sel_hi:[1,0,0]
    v_pk_fma_f32 v[36:37], v[36:37], v[234:235], v[234:235] op_sel_hi:[1,0,0]
    v_rcp_f32 v22, v22
    v_rcp_f32 v23, v23
    v_rcp_f32 v24, v24
    v_rcp_f32 v25, v25
    v_rcp_f32 v26, v26
    v_rcp_f32 v27, v27
    v_rcp_f32 v28, v28
    v_rcp_f32 v29, v29
    v_rcp_f32 v30, v30
    v_rcp_f32 v31, v31
    v_rcp_f32 v32, v32
    v_rcp_f32 v33, v33
    v_rcp_f32 v34, v34
    v_rcp_f32 v35, v35
    v_rcp_f32 v36, v36
    v_rcp_f32 v37, v37
    v_pk_mul_f32 v[160:161], v[160:161], v[22:23]
    v_pk_mul_f32 v[162:163], v[162:163], v[24:25]
    v_pk_mul_f32 v[168:169], v[168:169], v[26:27]
    v_pk_mul_f32 v[170:171], v[170:171], v[28:29]
    v_pk_mul_f32 v[164:165], v[164:165], v[30:31]
    v_pk_mul_f32 v[166:167], v[166:167], v[32:33]
    v_pk_mul_f32 v[172:173], v[172:173], v[34:35]
    v_pk_mul_f32 v[174:175], v[174:175], v[36:37]
    v_cvt_pk_bf16_f32 v48, v160, v161
    v_cvt_pk_bf16_f32 v49, v162, v163
    v_cvt_pk_bf16_f32 v50, v168, v169
    v_cvt_pk_bf16_f32 v51, v170, v171
    v_cvt_pk_bf16_f32 v52, v164, v165
    v_cvt_pk_bf16_f32 v53, v166, v167
    v_cvt_pk_bf16_f32 v54, v172, v173
    v_cvt_pk_bf16_f32 v55, v174, v175
    s_waitcnt vmcnt(1)
    s_barrier
    s_mul_i32 s44, s42, 16
    s_add_u32 s44, s44, s43
    s_lshl_b32 s44, s44, 7
    s_add_u32 s44, s44, 27446272
    buffer_store_dwordx4 v[244:247], v243, s[28:31], s44 offen sc1
    buffer_store_dwordx4 v[48:51], v19, s[28:31], s56 offen sc1
    buffer_store_dwordx4 v[52:55], v19, s[28:31], s56 offen offset:256 sc1
    s_add_u32 s56, s56, 8192
    v_pk_fma_f32 v[176:177], v[216:217], v[40:41], v[176:177] op_sel_hi:[1,0,1] neg_lo:[0,1,0] neg_hi:[0,1,0]
    v_pk_fma_f32 v[178:179], v[218:219], v[40:41], v[178:179] op_sel_hi:[1,0,1] neg_lo:[0,1,0] neg_hi:[0,1,0]
    v_pk_fma_f32 v[184:185], v[220:221], v[40:41], v[184:185] op_sel_hi:[1,0,1] neg_lo:[0,1,0] neg_hi:[0,1,0]
    v_pk_fma_f32 v[186:187], v[222:223], v[40:41], v[186:187] op_sel_hi:[1,0,1] neg_lo:[0,1,0] neg_hi:[0,1,0]
    v_pk_fma_f32 v[180:181], v[216:217], v[42:43], v[180:181] op_sel_hi:[1,0,1] neg_lo:[0,1,0] neg_hi:[0,1,0]
    v_pk_fma_f32 v[182:183], v[218:219], v[42:43], v[182:183] op_sel_hi:[1,0,1] neg_lo:[0,1,0] neg_hi:[0,1,0]
    v_pk_fma_f32 v[188:189], v[220:221], v[42:43], v[188:189] op_sel_hi:[1,0,1] neg_lo:[0,1,0] neg_hi:[0,1,0]
    v_pk_fma_f32 v[190:191], v[222:223], v[42:43], v[190:191] op_sel_hi:[1,0,1] neg_lo:[0,1,0] neg_hi:[0,1,0]
    v_pk_mul_f32 v[22:23], v[176:177], v[176:177]
    v_pk_mul_f32 v[24:25], v[178:179], v[178:179]
    v_pk_mul_f32 v[26:27], v[184:185], v[184:185]
    v_pk_mul_f32 v[28:29], v[186:187], v[186:187]
    v_pk_mul_f32 v[30:31], v[180:181], v[180:181]
    v_pk_mul_f32 v[32:33], v[182:183], v[182:183]
    v_pk_mul_f32 v[34:35], v[188:189], v[188:189]
    v_pk_mul_f32 v[36:37], v[190:191], v[190:191]
    v_pk_fma_f32 v[22:23], v[22:23], v[226:227], v[224:225] op_sel_hi:[1,0,0]
    v_pk_fma_f32 v[24:25], v[24:25], v[226:227], v[224:225] op_sel_hi:[1,0,0]
    v_pk_fma_f32 v[26:27], v[26:27], v[226:227], v[224:225] op_sel_hi:[1,0,0]
    v_pk_fma_f32 v[28:29], v[28:29], v[226:227], v[224:225] op_sel_hi:[1,0,0]
    v_pk_fma_f32 v[30:31], v[30:31], v[232:233], v[230:231] op_sel_hi:[1,0,0]
    v_pk_fma_f32 v[32:33], v[32:33], v[232:233], v[230:231] op_sel_hi:[1,0,0]
    v_pk_fma_f32 v[34:35], v[34:35], v[232:233], v[230:231] op_sel_hi:[1,0,0]
    v_pk_fma_f32 v[36:37], v[36:37], v[232:233], v[230:231] op_sel_hi:[1,0,0]
    v_pk_mul_f32 v[22:23], v[22:23], v[176:177]
    v_pk_mul_f32 v[24:25], v[24:25], v[178:179]
    v_pk_mul_f32 v[26:27], v[26:27], v[184:185]
    v_pk_mul_f32 v[28:29], v[28:29], v[186:187]
    v_pk_mul_f32 v[30:31], v[30:31], v[180:181]
    v_pk_mul_f32 v[32:33], v[32:33], v[182:183]
    v_pk_mul_f32 v[34:35], v[34:35], v[188:189]
    v_pk_mul_f32 v[36:37], v[36:37], v[190:191]
    v_exp_f32 v22, v22
    v_exp_f32 v23, v23
    v_exp_f32 v24, v24
    v_exp_f32 v25, v25
    v_exp_f32 v26, v26
    v_exp_f32 v27, v27
    v_exp_f32 v28, v28
    v_exp_f32 v29, v29
    v_exp_f32 v30, v30
    v_exp_f32 v31, v31
    v_exp_f32 v32, v32
    v_exp_f32 v33, v33
    v_exp_f32 v34, v34
    v_exp_f32 v35, v35
    v_exp_f32 v36, v36
    v_exp_f32 v37, v37
    v_pk_fma_f32 v[22:23], v[22:23], v[228:229], v[228:229] op_sel_hi:[1,0,0]
    v_pk_fma_f32 v[24:25], v[24:25], v[228:229], v[228:229] op_sel_hi:[1,0,0]
    v_pk_fma_f32 v[26:27], v[26:27], v[228:229], v[228:229] op_sel_hi:[1,0,0]
    v_pk_fma_f32 v[28:29], v[28:29], v[228:229], v[228:229] op_sel_hi:[1,0,0]
    v_pk_fma_f32 v[30:31], v[30:31], v[234:235], v[234:235] op_sel_hi:[1,0,0]
    v_pk_fma_f32 v[32:33], v[32:33], v[234:235], v[234:235] op_sel_hi:[1,0,0]
    v_pk_fma_f32 v[34:35], v[34:35], v[234:235], v[234:235] op_sel_hi:[1,0,0]
    v_pk_fma_f32 v[36:37], v[36:37], v[234:235], v[234:235] op_sel_hi:[1,0,0]
    v_rcp_f32 v22, v22
    v_rcp_f32 v23, v23
    v_rcp_f32 v24, v24
    v_rcp_f32 v25, v25
    v_rcp_f32 v26, v26
    v_rcp_f32 v27, v27
    v_rcp_f32 v28, v28
    v_rcp_f32 v29, v29
    v_rcp_f32 v30, v30
    v_rcp_f32 v31, v31
    v_rcp_f32 v32, v32
    v_rcp_f32 v33, v33
    v_rcp_f32 v34, v34
    v_rcp_f32 v35, v35
    v_rcp_f32 v36, v36
    v_rcp_f32 v37, v37
    v_pk_mul_f32 v[176:177], v[176:177], v[22:23]
    v_pk_mul_f32 v[178:179], v[178:179], v[24:25]
    v_pk_mul_f32 v[184:185], v[184:185], v[26:27]
    v_pk_mul_f32 v[186:187], v[186:187], v[28:29]
    v_pk_mul_f32 v[180:181], v[180:181], v[30:31]
    v_pk_mul_f32 v[182:183], v[182:183], v[32:33]
    v_pk_mul_f32 v[188:189], v[188:189], v[34:35]
    v_pk_mul_f32 v[190:191], v[190:191], v[36:37]
    v_cvt_pk_bf16_f32 v56, v176, v177
    v_cvt_pk_bf16_f32 v57, v178, v179
    v_cvt_pk_bf16_f32 v58, v184, v185
    v_cvt_pk_bf16_f32 v59, v186, v187
    v_cvt_pk_bf16_f32 v60, v180, v181
    v_cvt_pk_bf16_f32 v61, v182, v183
    v_cvt_pk_bf16_f32 v62, v188, v189
    v_cvt_pk_bf16_f32 v63, v190, v191
    buffer_store_dwordx4 v[56:59], v19, s[28:31], s56 offen sc1
    buffer_store_dwordx4 v[60:63], v19, s[28:31], s56 offen offset:256 sc1
    s_mul_i32 s76, s42, 16
    s_add_u32 s76, s76, s43
    s_lshl_b32 s76, s76, 7
    s_add_u32 s76, s76, 27361280
    s_cmp_eq_u32 s43, 14
    s_cbranch_scc0 L_g4
    s_waitcnt vmcnt(0)
    s_barrier
    buffer_store_dwordx4 v[244:247], v243, s[28:31], s76 offen sc1
    buffer_store_dwordx4 v[244:247], v243, s[28:31], s77 offen sc1
    s_mov_b32 s77, 1073741824
    s_branch L_fin
L_p3l:
    s_mov_b32 s58, s83
    v_lshrrev_b32 v22, 2, v1
    v_and_b32 v24, 6, v22
    v_bfe_u32 v23, v1, 1, 1
    v_xor_b32 v23, v23, v24
    v_lshlrev_b32 v22, 7, v22
    v_lshl_add_u32 v22, v23, 4, v22
    v_and_b32 v23, 1, v1
    v_lshl_add_u32 v4, v23, 3, v22
    v_xor_b32 v5, 32, v4
    v_xor_b32 v6, 64, v4
    v_xor_b32 v7, 96, v4
    s_mul_i32 s44, s42, 16
    s_lshl_b32 s44, s44, 7
    s_add_u32 s44, s44, 27328512
    v_lshlrev_b32 v22, 7, v1
    v_add_u32 v22, s44, v22
    v_bfe_u32 v23, v1, 3, 1
    v_add_u32 v23, s58, v23
    v_and_b32 v24, 7, v1
    v_lshl_add_u32 v23, v23, 3, v24
    v_lshlrev_b32 v23, 7, v23
    v_add_u32 v23, 27418624, v23
    v_cmp_gt_u32 vcc, 16, v1
    s_nop 1
    v_cndmask_b32 v22, v23, v22, vcc
    s_cmp_lg_u32 s41, 0
    s_cbranch_scc1 L_f1_18
    s_mov_b32 exec_lo, 2032639
    s_mov_b32 exec_hi, 0
    buffer_load_dword v63, v22, s[28:31], 0 offen sc1
    s_mov_b64 exec, -1
L_f1_18:
    s_waitcnt vmcnt(0)
    s_waitcnt vmcnt(0)
    s_cmp_lg_u32 s41, 0
    s_cbranch_scc1 L_f2_19
    s_mov_b32 exec_lo, 2032639
    s_mov_b32 exec_hi, 0
    s_mov_b32 s57, 200000
L_fp_20:
    v_cmp_ne_u32 vcc, s40, v63
    s_nop 1
    s_cbranch_vccz L_fd_21
    buffer_load_dword v63, v22, s[28:31], 0 offen sc1
    s_waitcnt vmcnt(0)
    s_sub_u32 s57, s57, 1
    s_cmp_lg_u32 s57, 0
    s_cbranch_scc1 L_fp_20
L_fd_21:
    s_mov_b64 exec, -1
L_f2_19:
    s_barrier
    buffer_store_dwordx4 v[244:247], v243, s[28:31], s76 offen sc1
    v_lshrrev_b32 v22, 4, v1
    v_lshlrev_b32 v22, 11, v22
    v_and_b32 v23, 15, v1
    v_lshl_add_u32 v22, v23, 4, v22
    s_lshl_b32 s44, s41, 9
    v_add_u32 v19, s44, v22
    s_mul_i32 s54, s42, 163840
    s_add_u32 s54, s54, 7667712
    v_lshrrev_b32 v22, 4, v1
    v_and_b32 v23, 15, v1
    v_lshlrev_b32 v23, 3, v23
    v_lshl_add_u32 v60, v22, 10, v23
    v_mov_b32 v24, 1073741824
    v_cmp_gt_u32 vcc, 2, v22
    s_nop 1
    v_cndmask_b32 v61, v24, v60, vcc
    s_mul_i32 s79, s42, 10240
    s_lshl_b32 s45, s41, 8
    s_add_u32 s79, s79, s45
    s_add_u32 s79, s79, 102400
    v_lshlrev_b32 v62, 2, v0
    v_cmp_gt_u32 vcc, 64, v0
    s_nop 1
    v_cndmask_b32 v62, v24, v62, vcc
    s_lshl_b32 s80, s58, 8
    s_add_u32 s80, s80, 45056
    s_add_u32 s44, s79, 0
    buffer_load_dwordx2 v[40:41], v60, s[28:31], s44 offen offset:0 sc1
    s_add_u32 s44, s79, 0
    buffer_load_dwordx2 v[42:43], v60, s[28:31], s44 offen offset:128 sc1
    s_add_u32 s44, s79, 4096
    buffer_load_dwordx2 v[44:45], v60, s[28:31], s44 offen offset:0 sc1
    s_add_u32 s44, s79, 4096
    buffer_load_dwordx2 v[46:47], v60, s[28:31], s44 offen offset:128 sc1
    s_add_u32 s44, s79, 8192
    buffer_load_dwordx2 v[48:49], v61, s[28:31], s44 offen offset:0 sc1
    s_add_u32 s44, s79, 8192
    buffer_load_dwordx2 v[50:51], v61, s[28:31], s44 offen offset:128 sc1
    s_add_u32 s44, s80, 0
    buffer_load_dword v52, v62, s[28:31], s44 offen sc1
    s_add_u32 s44, s80, 6912
    buffer_load_dword v53, v62, s[28:31], s44 offen sc1
    s_add_u32 s44, s80, 13824
    buffer_load_dword v54, v62, s[28:31], s44 offen sc1
    s_add_u32 s44, s80, 20736
    buffer_load_dword v55, v62, s[28:31], s44 offen sc1
    s_add_u32 s44, s80, 27648
    buffer_load_dword v56, v62, s[28:31], s44 offen sc1
    s_lshl_b32 s56, s50, 14
    s_add_u32 s56, s56, s54
    s_add_u32 s89, s54, 163840
    v_add_u32 v253, 8192, v19
    buffer_load_dwordx4 a[32:35], v19, s[28:31], s56 offen sc1
    buffer_load_dwordx4 a[36:39], v19, s[28:31], s56 offen offset:256 sc1
    buffer_load_dwordx4 a[40:43], v253, s[28:31], s56 offen sc1
    buffer_load_dwordx4 a[44:47], v253, s[28:31], s56 offen offset:256 sc1
    s_add_u32 s56, s56, 16384
    buffer_load_dwordx4 a[48:51], v19, s[28:31], s56 offen sc1
    buffer_load_dwordx4 a[52:55], v19, s[28:31], s56 offen offset:256 sc1
    buffer_load_dwordx4 a[56:59], v253, s[28:31], s56 offen sc1
    buffer_load_dwordx4 a[60:63], v253, s[28:31], s56 offen offset:256 sc1
    s_add_u32 s56, s56, 16384
    buffer_load_dwordx4 a[64:67], v19, s[28:31], s56 offen sc1
    buffer_load_dwordx4 a[68:71], v19, s[28:31], s56 offen offset:256 sc1
    buffer_load_dwordx4 a[72:75], v253, s[28:31], s56 offen sc1
    buffer_load_dwordx4 a[76:79], v253, s[28:31], s56 offen offset:256 sc1
    s_add_u32 s56, s56, 16384
    s_waitcnt vmcnt(12)
    v_add_f32 v52, v52, v53
    v_add_f32 v54, v54, v55
    v_add_f32 v52, v52, v56
    v_add_f32 v52, v52, v54
    v_lshlrev_b32 v22, 2, v0
    v_add_u32 v22, 156160, v22
    ds_write_b32 v22, v52
    v_pk_add_f32 v[40:41], v[40:41], v[44:45]
    v_pk_add_f32 v[40:41], v[40:41], v[48:49]
    v_pk_add_f32 v[42:43], v[42:43], v[46:47]
    v_pk_add_f32 v[42:43], v[42:43], v[50:51]
    v_mov_b32 v44, v40
    v_mov_b32 v45, v41
    v_mov_b32 v46, v42
    v_mov_b32 v47, v43
    v_permlane16_swap_b32 v40, v44
    v_permlane16_swap_b32 v41, v45
    v_permlane16_swap_b32 v42, v46
    v_permlane16_swap_b32 v43, v47
    v_add_f32 v40, v40, v44
    v_add_f32 v41, v41, v45
    v_add_f32 v42, v42, v46
    v_add_f32 v43, v43, v47
    v_mov_b32 v44, v40
    v_mov_b32 v45, v41
    v_mov_b32 v46, v42
    v_mov_b32 v47, v43
    v_permlane32_swap_b32 v40, v44
    v_permlane32_swap_b32 v41, v45
    v_permlane32_swap_b32 v42, v46
    v_permlane32_swap_b32 v43, v47
    v_add_f32 v40, v40, v44
    v_add_f32 v41, v41, v45
    v_add_f32 v42, v42, v46
    v_add_f32 v43, v43, v47
    s_mov_b32 s44, 986500301
    v_mov_b32 v48, 925353388
    v_mul_f32 v40, s44, v40
    v_fma_f32 v41, v41, s44, v48
    v_fma_f32 v41, -v40, v40, v41
    v_mul_f32 v42, s44, v42
    v_fma_f32 v43, v43, s44, v48
    v_fma_f32 v43, -v42, v42, v43
    v_rsq_f32 v44, v41
    v_rsq_f32 v46, v43
    v_mul_f32 v224, v20, v44
    v_mul_f32 v226, v44, v44
    v_rcp_f32 v228, v44
    v_mul_f32 v226, v226, v44
    v_mul_f32 v226, s62, v226
    v_mul_f32 v230, v20, v46
    v_mul_f32 v232, v46, v46
    v_rcp_f32 v234, v46
    v_mul_f32 v232, v232, v46
    v_mul_f32 v232, s62, v232
    v_lshrrev_b32 v22, 4, v1
    v_lshlrev_b32 v22, 4, v22
    v_add_u32 v57, 156160, v22
    s_waitcnt lgkmcnt(0)
    s_waitcnt vmcnt(23)
    s_barrier
    ds_read_b64_tr_b16 a[0:1], v4 offset:49152
    ds_read_b64_tr_b16 a[2:3], v4 offset:51200
    ds_read_b64_tr_b16 a[4:5], v5 offset:49152
    ds_read_b64_tr_b16 a[6:7], v5 offset:51200
    ds_read_b64_tr_b16 a[8:9], v6 offset:49152
    ds_read_b64_tr_b16 a[10:11], v6 offset:51200
    ds_read_b64_tr_b16 a[12:13], v7 offset:49152
    ds_read_b64_tr_b16 a[14:15], v7 offset:51200
    ds_read_b64_tr_b16 a[16:17], v4 offset:53248
    ds_read_b64_tr_b16 a[18:19], v4 offset:55296
    ds_read_b64_tr_b16 a[20:21], v5 offset:53248
    ds_read_b64_tr_b16 a[22:23], v5 offset:55296
    s_waitcnt vmcnt(10) lgkmcnt(8)
    v_mfma_f32_16x16x32_bf16 v[64:67], a[0:3], a[32:35], 0
    ds_read_b64_tr_b16 a[24:25], v6 offset:53248
    buffer_load_dwordx4 a[80:83], v19, s[28:31], s56 offen sc1
    v_mfma_f32_16x16x32_bf16 v[68:71], a[0:3], a[36:39], 0
    ds_read_b64_tr_b16 a[26:27], v6 offset:55296
    buffer_load_dwordx4 a[84:87], v19, s[28:31], s56 offen offset:256 sc1
    v_mfma_f32_16x16x32_bf16 v[72:75], a[4:7], a[32:35], 0
    ds_read_b64_tr_b16 a[28:29], v7 offset:53248
    v_mfma_f32_16x16x32_bf16 v[76:79], a[4:7], a[36:39], 0
    ds_read_b64_tr_b16 a[30:31], v7 offset:55296
    s_waitcnt lgkmcnt(8)
    v_mfma_f32_16x16x32_bf16 v[80:83], a[8:11], a[32:35], 0
    ds_read_b64_tr_b16 a[0:1], v4 offset:57344
    v_mfma_f32_16x16x32_bf16 v[84:87], a[8:11], a[36:39], 0
    ds_read_b64_tr_b16 a[2:3], v4 offset:59392
    v_mfma_f32_16x16x32_bf16 v[88:91], a[12:15], a[32:35], 0
    ds_read_b64_tr_b16 a[4:5], v5 offset:57344
    v_mfma_f32_16x16x32_bf16 v[92:95], a[12:15], a[36:39], 0
    ds_read_b64_tr_b16 a[6:7], v5 offset:59392
    s_waitcnt vmcnt(10) lgkmcnt(8)
    v_mfma_f32_16x16x32_bf16 v[64:67], a[16:19], a[40:43], v[64:67]
    ds_read_b64_tr_b16 a[8:9], v6 offset:57344
    buffer_load_dwordx4 a[32:35], v253, s[28:31], s56 offen sc1
    v_mfma_f32_16x16x32_bf16 v[68:71], a[16:19], a[44:47], v[68:71]
    ds_read_b64_tr_b16 a[10:11], v6 offset:59392
    buffer_load_dwordx4 a[36:39], v253, s[28:31], s56 offen offset:256 sc1
    v_mfma_f32_16x16x32_bf16 v[72:75], a[20:23], a[40:43], v[72:75]
    ds_read_b64_tr_b16 a[12:13], v7 offset:57344
    s_add_u32 s56, s56, 16384
    v_mfma_f32_16x16x32_bf16 v[76:79], a[20:23], a[44:47], v[76:79]
    ds_read_b64_tr_b16 a[14:15], v7 offset:59392
    s_waitcnt lgkmcnt(8)
    v_mfma_f32_16x16x32_bf16 v[80:83], a[24:27], a[40:43], v[80:83]
    ds_read_b64_tr_b16 a[16:17], v4 offset:61440
    v_mfma_f32_16x16x32_bf16 v[84:87], a[24:27], a[44:47], v[84:87]
    ds_read_b64_tr_b16 a[18:19], v4 offset:63488
    v_mfma_f32_16x16x32_bf16 v[88:91], a[28:31], a[40:43], v[88:91]
    ds_read_b64_tr_b16 a[20:21], v5 offset:61440
    v_mfma_f32_16x16x32_bf16 v[92:95], a[28:31], a[44:47], v[92:95]
    ds_read_b64_tr_b16 a[22:23], v5 offset:63488
    s_waitcnt vmcnt(10) lgkmcnt(8)
    v_mfma_f32_16x16x32_bf16 v[64:67], a[0:3], a[48:51], v[64:67]
    ds_read_b64_tr_b16 a[24:25], v6 offset:61440
    buffer_load_dwordx4 a[40:43], v19, s[28:31], s56 offen sc1
    v_mfma_f32_16x16x32_bf16 v[68:71], a[0:3], a[52:55], v[68:71]
    ds_read_b64_tr_b16 a[26:27], v6 offset:63488
    buffer_load_dwordx4 a[44:47], v19, s[28:31], s56 offen offset:256 sc1
    v_mfma_f32_16x16x32_bf16 v[72:75], a[4:7], a[48:51], v[72:75]
    ds_read_b64_tr_b16 a[28:29], v7 offset:61440
    v_mfma_f32_16x16x32_bf16 v[76:79], a[4:7], a[52:55], v[76:79]
    ds_read_b64_tr_b16 a[30:31], v7 offset:63488
    s_waitcnt lgkmcnt(8)
    v_mfma_f32_16x16x32_bf16 v[80:83], a[8:11], a[48:51], v[80:83]
    v_add_u32 v4, 65536, v4
    v_add_u32 v5, 65536, v5
    v_add_u32 v6, 65536, v6
    v_add_u32 v7, 65536, v7
    ds_read_b64_tr_b16 a[0:1], v4 offset:0
    s_min_u32 s83, s43, 4
    v_mfma_f32_16x16x32_bf16 v[84:87], a[8:11], a[52:55], v[84:87]
    ds_read_b64_tr_b16 a[2:3], v4 offset:2048
    s_mov_b32 s32, s10
    v_mfma_f32_16x16x32_bf16 v[88:91], a[12:15], a[48:51], v[88:91]
    ds_read_b64_tr_b16 a[4:5], v5 offset:0
    s_mov_b32 s33, s11
    v_mfma_f32_16x16x32_bf16 v[92:95], a[12:15], a[52:55], v[92:95]
    ds_read_b64_tr_b16 a[6:7], v5 offset:2048
    s_waitcnt vmcnt(10) lgkmcnt(8)
    v_mfma_f32_16x16x32_bf16 v[64:67], a[16:19], a[56:59], v[64:67]
    ds_read_b64_tr_b16 a[8:9], v6 offset:0
    buffer_load_dwordx4 a[48:51], v253, s[28:31], s56 offen sc1
    v_mfma_f32_16x16x32_bf16 v[68:71], a[16:19], a[60:63], v[68:71]
    ds_read_b64_tr_b16 a[10:11], v6 offset:2048
    buffer_load_dwordx4 a[52:55], v253, s[28:31], s56 offen offset:256 sc1
    v_mfma_f32_16x16x32_bf16 v[72:75], a[20:23], a[56:59], v[72:75]
    ds_read_b64_tr_b16 a[12:13], v7 offset:0
    s_add_u32 s56, s56, 16384
    v_mfma_f32_16x16x32_bf16 v[76:79], a[20:23], a[60:63], v[76:79]
    ds_read_b64_tr_b16 a[14:15], v7 offset:2048
    s_waitcnt lgkmcnt(8)
    v_mfma_f32_16x16x32_bf16 v[80:83], a[24:27], a[56:59], v[80:83]
    ds_read_b64_tr_b16 a[16:17], v4 offset:4096
    s_mov_b32 s34, 819200
    v_mfma_f32_16x16x32_bf16 v[84:87], a[24:27], a[60:63], v[84:87]
    ds_read_b64_tr_b16 a[18:19], v4 offset:6144
    s_mov_b32 s35, 0x20000
    v_mfma_f32_16x16x32_bf16 v[88:91], a[28:31], a[56:59], v[88:91]
    ds_read_b64_tr_b16 a[20:21], v5 offset:4096
    v_lshrrev_b32 v22, 4, v1
    v_mfma_f32_16x16x32_bf16 v[92:95], a[28:31], a[60:63], v[92:95]
    ds_read_b64_tr_b16 a[22:23], v5 offset:6144
    s_waitcnt vmcnt(10) lgkmcnt(8)
    v_mfma_f32_16x16x32_bf16 v[64:67], a[0:3], a[64:67], v[64:67]
    ds_read_b64_tr_b16 a[24:25], v6 offset:4096
    buffer_load_dwordx4 a[56:59], v19, s[28:31], s56 offen sc1
    v_mfma_f32_16x16x32_bf16 v[68:71], a[0:3], a[68:71], v[68:71]
    ds_read_b64_tr_b16 a[26:27], v6 offset:6144
    buffer_load_dwordx4 a[60:63], v19, s[28:31], s56 offen offset:256 sc1
    v_mfma_f32_16x16x32_bf16 v[72:75], a[4:7], a[64:67], v[72:75]
    ds_read_b64_tr_b16 a[28:29], v7 offset:4096
    v_and_b32 v23, 15, v1
    v_mfma_f32_16x16x32_bf16 v[76:79], a[4:7], a[68:71], v[76:79]
    ds_read_b64_tr_b16 a[30:31], v7 offset:6144
    s_waitcnt lgkmcnt(8)
    v_mfma_f32_16x16x32_bf16 v[80:83], a[8:11], a[64:67], v[80:83]
    ds_read_b64_tr_b16 a[0:1], v4 offset:8192
    v_lshlrev_b32 v24, 1, v22
    v_mfma_f32_16x16x32_bf16 v[84:87], a[8:11], a[68:71], v[84:87]
    ds_read_b64_tr_b16 a[2:3], v4 offset:10240
    v_xor_b32 v23, v23, v24
    v_mfma_f32_16x16x32_bf16 v[88:91], a[12:15], a[64:67], v[88:91]
    ds_read_b64_tr_b16 a[4:5], v5 offset:8192
    v_mul_u32_u24 v22, 1280, v22
    v_mfma_f32_16x16x32_bf16 v[92:95], a[12:15], a[68:71], v[92:95]
    ds_read_b64_tr_b16 a[6:7], v5 offset:10240
    s_waitcnt vmcnt(10) lgkmcnt(8)
    v_mfma_f32_16x16x32_bf16 v[64:67], a[16:19], a[72:75], v[64:67]
    ds_read_b64_tr_b16 a[8:9], v6 offset:8192
    buffer_load_dwordx4 a[64:67], v253, s[28:31], s56 offen sc1
    v_mfma_f32_16x16x32_bf16 v[68:71], a[16:19], a[76:79], v[68:71]
    ds_read_b64_tr_b16 a[10:11], v6 offset:10240
    buffer_load_dwordx4 a[68:71], v253, s[28:31], s56 offen offset:256 sc1
    v_mfma_f32_16x16x32_bf16 v[72:75], a[20:23], a[72:75], v[72:75]
    ds_read_b64_tr_b16 a[12:13], v7 offset:8192
    s_add_u32 s56, s56, 16384
    v_mfma_f32_16x16x32_bf16 v[76:79], a[20:23], a[76:79], v[76:79]
    ds_read_b64_tr_b16 a[14:15], v7 offset:10240
    s_waitcnt lgkmcnt(8)
    v_mfma_f32_16x16x32_bf16 v[80:83], a[24:27], a[72:75], v[80:83]
    ds_read_b64_tr_b16 a[16:17], v4 offset:12288
    v_lshl_add_u32 v14, v23, 4, v22
    v_mfma_f32_16x16x32_bf16 v[84:87], a[24:27], a[76:79], v[84:87]
    ds_read_b64_tr_b16 a[18:19], v4 offset:14336
    v_xor_b32 v23, 8, v23
    v_mfma_f32_16x16x32_bf16 v[88:91], a[28:31], a[72:75], v[88:91]
    ds_read_b64_tr_b16 a[20:21], v5 offset:12288
    v_lshl_add_u32 v15, v23, 4, v22
    v_mfma_f32_16x16x32_bf16 v[92:95], a[28:31], a[76:79], v[92:95]
    ds_read_b64_tr_b16 a[22:23], v5 offset:14336
    s_waitcnt vmcnt(10) lgkmcnt(8)
    v_mfma_f32_16x16x32_bf16 v[64:67], a[0:3], a[80:83], v[64:67]
    ds_read_b64_tr_b16 a[24:25], v6 offset:12288
    buffer_load_dwordx4 a[72:75], v19, s[28:31], s56 offen sc1
    v_mfma_f32_16x16x32_bf16 v[68:71], a[0:3], a[84:87], v[68:71]
    ds_read_b64_tr_b16 a[26:27], v6 offset:14336
    buffer_load_dwordx4 a[76:79], v19, s[28:31], s56 offen offset:256 sc1
    v_mfma_f32_16x16x32_bf16 v[72:75], a[4:7], a[80:83], v[72:75]
    ds_read_b64_tr_b16 a[28:29], v7 offset:12288
    v_add_u32 v16, 49152, v14
    v_mfma_f32_16x16x32_bf16 v[76:79], a[4:7], a[84:87], v[76:79]
    ds_read_b64_tr_b16 a[30:31], v7 offset:14336
    s_waitcnt lgkmcnt(8)
    v_mfma_f32_16x16x32_bf16 v[80:83], a[8:11], a[80:83], v[80:83]
    ds_read_b64_tr_b16 a[0:1], v4 offset:16384
    v_add_u32 v17, 73728, v15
    v_mfma_f32_16x16x32_bf16 v[84:87], a[8:11], a[84:87], v[84:87]
    ds_read_b64_tr_b16 a[2:3], v4 offset:18432
    v_add_u32 v15, 24576, v15
    v_mfma_f32_16x16x32_bf16 v[88:91], a[12:15], a[80:83], v[88:91]
    ds_read_b64_tr_b16 a[4:5], v5 offset:16384
    s_lshl_b32 s53, s41, 12
    v_mfma_f32_16x16x32_bf16 v[92:95], a[12:15], a[84:87], v[92:95]
    ds_read_b64_tr_b16 a[6:7], v5 offset:18432
    s_waitcnt vmcnt(10) lgkmcnt(8)
    v_mfma_f32_16x16x32_bf16 v[64:67], a[16:19], a[32:35], v[64:67]
    ds_read_b64_tr_b16 a[8:9], v6 offset:16384
    buffer_load_dwordx4 a[80:83], v253, s[28:31], s56 offen sc1
    v_mfma_f32_16x16x32_bf16 v[68:71], a[16:19], a[36:39], v[68:71]
    ds_read_b64_tr_b16 a[10:11], v6 offset:18432
    buffer_load_dwordx4 a[84:87], v253, s[28:31], s56 offen offset:256 sc1
    v_mfma_f32_16x16x32_bf16 v[72:75], a[20:23], a[32:35], v[72:75]
    ds_read_b64_tr_b16 a[12:13], v7 offset:16384
    s_add_u32 s56, s56, 16384
    v_mfma_f32_16x16x32_bf16 v[76:79], a[20:23], a[36:39], v[76:79]
    ds_read_b64_tr_b16 a[14:15], v7 offset:18432
    s_waitcnt lgkmcnt(8)
    v_mfma_f32_16x16x32_bf16 v[80:83], a[24:27], a[32:35], v[80:83]
    ds_read_b64_tr_b16 a[16:17], v4 offset:20480
    s_lshl_b32 s78, s83, 8
    v_mfma_f32_16x16x32_bf16 v[84:87], a[24:27], a[36:39], v[84:87]
    ds_read_b64_tr_b16 a[18:19], v4 offset:22528
    s_mov_b32 s50, 0
    v_mfma_f32_16x16x32_bf16 v[88:91], a[28:31], a[32:35], v[88:91]
    ds_read_b64_tr_b16 a[20:21], v5 offset:20480
    s_mov_b32 s71, 0
    v_mfma_f32_16x16x32_bf16 v[92:95], a[28:31], a[36:39], v[92:95]
    ds_read_b64_tr_b16 a[22:23], v5 offset:22528
    s_waitcnt vmcnt(10) lgkmcnt(8)
    v_mfma_f32_16x16x32_bf16 v[64:67], a[0:3], a[40:43], v[64:67]
    ds_read_b64_tr_b16 a[24:25], v6 offset:20480
    buffer_load_dwordx4 a[32:35], v19, s[28:31], s56 offen sc1
    v_mfma_f32_16x16x32_bf16 v[68:71], a[0:3], a[44:47], v[68:71]
    ds_read_b64_tr_b16 a[26:27], v6 offset:22528
    buffer_load_dwordx4 a[36:39], v19, s[28:31], s56 offen offset:256 sc1
    v_mfma_f32_16x16x32_bf16 v[72:75], a[4:7], a[40:43], v[72:75]
    ds_read_b64_tr_b16 a[28:29], v7 offset:20480
    s_add_u32 s55, s50, 0
    v_mfma_f32_16x16x32_bf16 v[76:79], a[4:7], a[44:47], v[76:79]
    ds_read_b64_tr_b16 a[30:31], v7 offset:22528
    s_waitcnt lgkmcnt(8)
    v_mfma_f32_16x16x32_bf16 v[80:83], a[8:11], a[40:43], v[80:83]
    ds_read_b64_tr_b16 a[0:1], v4 offset:24576
    s_cmp_ge_u32 s55, 10
    v_mfma_f32_16x16x32_bf16 v[84:87], a[8:11], a[44:47], v[84:87]
    ds_read_b64_tr_b16 a[2:3], v4 offset:26624
    s_cselect_b32 s82, 10, 0
    v_mfma_f32_16x16x32_bf16 v[88:91], a[12:15], a[40:43], v[88:91]
    ds_read_b64_tr_b16 a[4:5], v5 offset:24576
    s_sub_u32 s55, s55, s82
    v_mfma_f32_16x16x32_bf16 v[92:95], a[12:15], a[44:47], v[92:95]
    ds_read_b64_tr_b16 a[6:7], v5 offset:26624
    s_waitcnt vmcnt(10) lgkmcnt(8)
    v_mfma_f32_16x16x32_bf16 v[64:67], a[16:19], a[48:51], v[64:67]
    ds_read_b64_tr_b16 a[8:9], v6 offset:24576
    buffer_load_dwordx4 a[40:43], v253, s[28:31], s56 offen sc1
    v_mfma_f32_16x16x32_bf16 v[68:71], a[16:19], a[52:55], v[68:71]
    ds_read_b64_tr_b16 a[10:11], v6 offset:26624
    buffer_load_dwordx4 a[44:47], v253, s[28:31], s56 offen offset:256 sc1
    v_mfma_f32_16x16x32_bf16 v[72:75], a[20:23], a[48:51], v[72:75]
    ds_read_b64_tr_b16 a[12:13], v7 offset:24576
    s_add_u32 s56, s56, 16384
    v_mfma_f32_16x16x32_bf16 v[76:79], a[20:23], a[52:55], v[76:79]
    ds_read_b64_tr_b16 a[14:15], v7 offset:26624
    s_waitcnt lgkmcnt(8)
    v_mfma_f32_16x16x32_bf16 v[80:83], a[24:27], a[48:51], v[80:83]
    ds_read_b64_tr_b16 a[16:17], v4 offset:28672
    s_lshl_b32 s55, s55, 1
    v_mfma_f32_16x16x32_bf16 v[84:87], a[24:27], a[52:55], v[84:87]
    ds_read_b64_tr_b16 a[18:19], v4 offset:30720
    s_lshr_b32 s82, s41, 1
    v_mfma_f32_16x16x32_bf16 v[88:91], a[28:31], a[48:51], v[88:91]
    ds_read_b64_tr_b16 a[20:21], v5 offset:28672
    s_add_u32 s55, s55, s82
    v_mfma_f32_16x16x32_bf16 v[92:95], a[28:31], a[52:55], v[92:95]
    ds_read_b64_tr_b16 a[22:23], v5 offset:30720
    s_waitcnt vmcnt(10) lgkmcnt(8)
    v_mfma_f32_16x16x32_bf16 v[64:67], a[0:3], a[56:59], v[64:67]
    ds_read_b64_tr_b16 a[24:25], v6 offset:28672
    buffer_load_dwordx4 a[48:51], v19, s[28:31], s56 offen sc1
    v_mfma_f32_16x16x32_bf16 v[68:71], a[0:3], a[60:63], v[68:71]
    ds_read_b64_tr_b16 a[26:27], v6 offset:30720
    buffer_load_dwordx4 a[52:55], v19, s[28:31], s56 offen offset:256 sc1
    v_mfma_f32_16x16x32_bf16 v[72:75], a[4:7], a[56:59], v[72:75]
    ds_read_b64_tr_b16 a[28:29], v7 offset:28672
    s_mul_i32 s82, s55, 13
    v_mfma_f32_16x16x32_bf16 v[76:79], a[4:7], a[60:63], v[76:79]
    ds_read_b64_tr_b16 a[30:31], v7 offset:30720
    s_waitcnt lgkmcnt(8)
    v_mfma_f32_16x16x32_bf16 v[80:83], a[8:11], a[56:59], v[80:83]
    ds_read_b64_tr_b16 a[0:1], v4 offset:32768
    s_lshr_b32 s82, s82, 6
    v_mfma_f32_16x16x32_bf16 v[84:87], a[8:11], a[60:63], v[84:87]
    ds_read_b64_tr_b16 a[2:3], v4 offset:34816
    s_mul_i32 s84, s82, 5
    v_mfma_f32_16x16x32_bf16 v[88:91], a[12:15], a[56:59], v[88:91]
    ds_read_b64_tr_b16 a[4:5], v5 offset:32768
    s_sub_u32 s84, s55, s84
    v_mfma_f32_16x16x32_bf16 v[92:95], a[12:15], a[60:63], v[92:95]
    ds_read_b64_tr_b16 a[6:7], v5 offset:34816
    s_waitcnt vmcnt(10) lgkmcnt(8)
    v_mfma_f32_16x16x32_bf16 v[64:67], a[16:19], a[64:67], v[64:67]
    ds_read_b64_tr_b16 a[8:9], v6 offset:32768
    buffer_load_dwordx4 a[56:59], v253, s[28:31], s56 offen sc1
    v_mfma_f32_16x16x32_bf16 v[68:71], a[16:19], a[68:71], v[68:71]
    ds_read_b64_tr_b16 a[10:11], v6 offset:34816
    buffer_load_dwordx4 a[60:63], v253, s[28:31], s56 offen offset:256 sc1
    v_mfma_f32_16x16x32_bf16 v[72:75], a[20:23], a[64:67], v[72:75]
    ds_read_b64_tr_b16 a[12:13], v7 offset:32768
    s_add_u32 s56, s56, 16384
    v_mfma_f32_16x16x32_bf16 v[76:79], a[20:23], a[68:71], v[76:79]
    ds_read_b64_tr_b16 a[14:15], v7 offset:34816
    s_waitcnt lgkmcnt(8)
    v_mfma_f32_16x16x32_bf16 v[80:83], a[24:27], a[64:67], v[80:83]
    ds_read_b64_tr_b16 a[16:17], v4 offset:36864
    s_lshl_b32 s84, s84, 3
    v_mfma_f32_16x16x32_bf16 v[84:87], a[24:27], a[68:71], v[84:87]
    ds_read_b64_tr_b16 a[18:19], v4 offset:38912
    s_and_b32 s85, s41, 1
    v_mfma_f32_16x16x32_bf16 v[88:91], a[28:31], a[64:67], v[88:91]
    ds_read_b64_tr_b16 a[20:21], v5 offset:36864
    s_lshl_b32 s85, s85, 2
    v_mfma_f32_16x16x32_bf16 v[92:95], a[28:31], a[68:71], v[92:95]
    ds_read_b64_tr_b16 a[22:23], v5 offset:38912
    s_waitcnt vmcnt(10) lgkmcnt(8)
    v_mfma_f32_16x16x32_bf16 v[64:67], a[0:3], a[72:75], v[64:67]
    ds_read_b64_tr_b16 a[24:25], v6 offset:36864
    buffer_load_dwordx4 a[64:67], v19, s[28:31], s56 offen sc1
    v_mfma_f32_16x16x32_bf16 v[68:71], a[0:3], a[76:79], v[68:71]
    ds_read_b64_tr_b16 a[26:27], v6 offset:38912
    buffer_load_dwordx4 a[68:71], v19, s[28:31], s56 offen offset:256 sc1
    v_mfma_f32_16x16x32_bf16 v[72:75], a[4:7], a[72:75], v[72:75]
    ds_read_b64_tr_b16 a[28:29], v7 offset:36864
    s_add_u32 s84, s84, s85
    v_mfma_f32_16x16x32_bf16 v[76:79], a[4:7], a[76:79], v[76:79]
    ds_read_b64_tr_b16 a[30:31], v7 offset:38912
    s_waitcnt lgkmcnt(8)
    v_mfma_f32_16x16x32_bf16 v[80:83], a[8:11], a[72:75], v[80:83]
    ds_read_b64_tr_b16 a[0:1], v4 offset:40960
    s_cmp_ge_u32 s84, 20
    v_mfma_f32_16x16x32_bf16 v[84:87], a[8:11], a[76:79], v[84:87]
    ds_read_b64_tr_b16 a[2:3], v4 offset:43008
    s_cselect_b32 s85, 60, 0
    v_mfma_f32_16x16x32_bf16 v[88:91], a[12:15], a[72:75], v[88:91]
    ds_read_b64_tr_b16 a[4:5], v5 offset:40960
    s_add_u32 s84, s84, s85
    v_mfma_f32_16x16x32_bf16 v[92:95], a[12:15], a[76:79], v[92:95]
    ds_read_b64_tr_b16 a[6:7], v5 offset:43008
    s_waitcnt vmcnt(10) lgkmcnt(8)
    v_mfma_f32_16x16x32_bf16 v[64:67], a[16:19], a[80:83], v[64:67]
    ds_read_b64_tr_b16 a[8:9], v6 offset:40960
    buffer_load_dwordx4 a[72:75], v253, s[28:31], s56 offen sc1
    v_mfma_f32_16x16x32_bf16 v[68:71], a[16:19], a[84:87], v[68:71]
    ds_read_b64_tr_b16 a[10:11], v6 offset:43008
    buffer_load_dwordx4 a[76:79], v253, s[28:31], s56 offen offset:256 sc1
    v_mfma_f32_16x16x32_bf16 v[72:75], a[20:23], a[80:83], v[72:75]
    ds_read_b64_tr_b16 a[12:13], v7 offset:40960
    s_mul_i32 s82, s82, 160
    v_mfma_f32_16x16x32_bf16 v[76:79], a[20:23], a[84:87], v[76:79]
    ds_read_b64_tr_b16 a[14:15], v7 offset:43008
    s_waitcnt lgkmcnt(8)
    v_mfma_f32_16x16x32_bf16 v[80:83], a[24:27], a[80:83], v[80:83]
    ds_read_b64_tr_b16 a[16:17], v4 offset:45056
    s_add_u32 s82, s82, s84
    v_mfma_f32_16x16x32_bf16 v[84:87], a[24:27], a[84:87], v[84:87]
    ds_read_b64_tr_b16 a[18:19], v4 offset:47104
    s_mul_i32 s82, s82, 1280
    v_mfma_f32_16x16x32_bf16 v[88:91], a[28:31], a[80:83], v[88:91]
    ds_read_b64_tr_b16 a[20:21], v5 offset:45056
    s_add_u32 s55, s82, s78
    v_mfma_f32_16x16x32_bf16 v[92:95], a[28:31], a[84:87], v[92:95]
    ds_read_b64_tr_b16 a[22:23], v5 offset:47104
    s_waitcnt vmcnt(10) lgkmcnt(8)
    v_mfma_f32_16x16x32_bf16 v[64:67], a[0:3], a[32:35], v[64:67]
    ds_read_b64_tr_b16 a[24:25], v6 offset:45056
    s_add_u32 m0, s53, 0
    v_mfma_f32_16x16x32_bf16 v[68:71], a[0:3], a[36:39], v[68:71]
    ds_read_b64_tr_b16 a[26:27], v6 offset:47104
    buffer_load_dwordx4 v14, s[32:35], s55 offen offset:0 lds
    v_mfma_f32_16x16x32_bf16 v[72:75], a[4:7], a[32:35], v[72:75]
    ds_read_b64_tr_b16 a[28:29], v7 offset:45056
    buffer_load_dwordx4 v15, s[32:35], s55 offen offset:1024 lds
    v_mfma_f32_16x16x32_bf16 v[76:79], a[4:7], a[36:39], v[76:79]
    ds_read_b64_tr_b16 a[30:31], v7 offset:47104
    s_waitcnt lgkmcnt(8)
    v_mfma_f32_16x16x32_bf16 v[80:83], a[8:11], a[32:35], v[80:83]
    ds_read_b64_tr_b16 a[0:1], v4 offset:49152
    buffer_load_dwordx4 v16, s[32:35], s55 offen offset:2048 lds
    v_mfma_f32_16x16x32_bf16 v[84:87], a[8:11], a[36:39], v[84:87]
    ds_read_b64_tr_b16 a[2:3], v4 offset:51200
    buffer_load_dwordx4 v17, s[32:35], s55 offen offset:3072 lds
    v_mfma_f32_16x16x32_bf16 v[88:91], a[12:15], a[32:35], v[88:91]
    ds_read_b64_tr_b16 a[4:5], v5 offset:49152
    ds_read_b128 v[192:195], v57 offset:0
    v_mfma_f32_16x16x32_bf16 v[92:95], a[12:15], a[36:39], v[92:95]
    ds_read_b64_tr_b16 a[6:7], v5 offset:51200
    s_waitcnt vmcnt(12) lgkmcnt(9)
    v_mfma_f32_16x16x32_bf16 v[64:67], a[16:19], a[40:43], v[64:67]
    ds_read_b64_tr_b16 a[8:9], v6 offset:49152
    ds_read_b128 v[196:199], v57 offset:64
    v_mfma_f32_16x16x32_bf16 v[68:71], a[16:19], a[44:47], v[68:71]
    ds_read_b64_tr_b16 a[10:11], v6 offset:51200
    ds_read_b128 v[200:203], v57 offset:128
    v_mfma_f32_16x16x32_bf16 v[72:75], a[20:23], a[40:43], v[72:75]
    ds_read_b64_tr_b16 a[12:13], v7 offset:49152
    ds_read_b128 v[204:207], v57 offset:192
    v_mfma_f32_16x16x32_bf16 v[76:79], a[20:23], a[44:47], v[76:79]
    ds_read_b64_tr_b16 a[14:15], v7 offset:51200
    s_waitcnt lgkmcnt(12)
    v_mfma_f32_16x16x32_bf16 v[80:83], a[24:27], a[40:43], v[80:83]
    ds_read_b64_tr_b16 a[16:17], v4 offset:53248
    s_add_u32 s55, s50, 1
    v_mfma_f32_16x16x32_bf16 v[84:87], a[24:27], a[44:47], v[84:87]
    ds_read_b64_tr_b16 a[18:19], v4 offset:55296
    s_cmp_ge_u32 s55, 10
    v_mfma_f32_16x16x32_bf16 v[88:91], a[28:31], a[40:43], v[88:91]
    ds_read_b64_tr_b16 a[20:21], v5 offset:53248
    s_cselect_b32 s82, 10, 0
    v_mfma_f32_16x16x32_bf16 v[92:95], a[28:31], a[44:47], v[92:95]
    ds_read_b64_tr_b16 a[22:23], v5 offset:55296
    s_waitcnt vmcnt(10) lgkmcnt(11)
    v_mfma_f32_16x16x32_bf16 v[64:67], a[0:3], a[48:51], v[64:67]
    ds_read_b64_tr_b16 a[24:25], v6 offset:53248
    s_sub_u32 s55, s55, s82
    v_mfma_f32_16x16x32_bf16 v[68:71], a[0:3], a[52:55], v[68:71]
    ds_read_b64_tr_b16 a[26:27], v6 offset:55296
    s_lshl_b32 s55, s55, 1
    v_mfma_f32_16x16x32_bf16 v[72:75], a[4:7], a[48:51], v[72:75]
    ds_read_b64_tr_b16 a[28:29], v7 offset:53248
    s_lshr_b32 s82, s41, 1
    v_mfma_f32_16x16x32_bf16 v[76:79], a[4:7], a[52:55], v[76:79]
    ds_read_b64_tr_b16 a[30:31], v7 offset:55296
    s_waitcnt lgkmcnt(8)
    v_mfma_f32_16x16x32_bf16 v[80:83], a[8:11], a[48:51], v[80:83]
    ds_read_b64_tr_b16 a[0:1], v4 offset:57344
    s_add_u32 s55, s55, s82
    v_mfma_f32_16x16x32_bf16 v[84:87], a[8:11], a[52:55], v[84:87]
    ds_read_b64_tr_b16 a[2:3], v4 offset:59392
    s_mul_i32 s82, s55, 13
    v_mfma_f32_16x16x32_bf16 v[88:91], a[12:15], a[48:51], v[88:91]
    ds_read_b64_tr_b16 a[4:5], v5 offset:57344
    s_lshr_b32 s82, s82, 6
    v_mfma_f32_16x16x32_bf16 v[92:95], a[12:15], a[52:55], v[92:95]
    ds_read_b64_tr_b16 a[6:7], v5 offset:59392
    s_waitcnt vmcnt(8) lgkmcnt(8)
    v_mfma_f32_16x16x32_bf16 v[64:67], a[16:19], a[56:59], v[64:67]
    ds_read_b64_tr_b16 a[8:9], v6 offset:57344
    s_mul_i32 s84, s82, 5
    v_mfma_f32_16x16x32_bf16 v[68:71], a[16:19], a[60:63], v[68:71]
    ds_read_b64_tr_b16 a[10:11], v6 offset:59392
    s_sub_u32 s84, s55, s84
    v_mfma_f32_16x16x32_bf16 v[72:75], a[20:23], a[56:59], v[72:75]
    ds_read_b64_tr_b16 a[12:13], v7 offset:57344
    s_lshl_b32 s84, s84, 3
    v_mfma_f32_16x16x32_bf16 v[76:79], a[20:23], a[60:63], v[76:79]
    ds_read_b64_tr_b16 a[14:15], v7 offset:59392
    s_waitcnt lgkmcnt(8)
    v_mfma_f32_16x16x32_bf16 v[80:83], a[24:27], a[56:59], v[80:83]
    ds_read_b64_tr_b16 a[16:17], v4 offset:61440
    s_and_b32 s85, s41, 1
    v_mfma_f32_16x16x32_bf16 v[84:87], a[24:27], a[60:63], v[84:87]
    ds_read_b64_tr_b16 a[18:19], v4 offset:63488
    s_lshl_b32 s85, s85, 2
    v_mfma_f32_16x16x32_bf16 v[88:91], a[28:31], a[56:59], v[88:91]
    ds_read_b64_tr_b16 a[20:21], v5 offset:61440
    s_add_u32 s84, s84, s85
    v_mfma_f32_16x16x32_bf16 v[92:95], a[28:31], a[60:63], v[92:95]
    ds_read_b64_tr_b16 a[22:23], v5 offset:63488
    s_waitcnt vmcnt(6) lgkmcnt(8)
    v_mfma_f32_16x16x32_bf16 v[64:67], a[0:3], a[64:67], v[64:67]
    ds_read_b64_tr_b16 a[24:25], v6 offset:61440
    s_cmp_ge_u32 s84, 20
    v_mfma_f32_16x16x32_bf16 v[68:71], a[0:3], a[68:71], v[68:71]
    ds_read_b64_tr_b16 a[26:27], v6 offset:63488
    s_cselect_b32 s85, 60, 0
    v_mfma_f32_16x16x32_bf16 v[72:75], a[4:7], a[64:67], v[72:75]
    ds_read_b64_tr_b16 a[28:29], v7 offset:61440
    s_add_u32 s84, s84, s85
    v_mfma_f32_16x16x32_bf16 v[76:79], a[4:7], a[68:71], v[76:79]
    ds_read_b64_tr_b16 a[30:31], v7 offset:63488
    s_waitcnt lgkmcnt(8)
    v_mfma_f32_16x16x32_bf16 v[80:83], a[8:11], a[64:67], v[80:83]
    s_mul_i32 s82, s82, 160
    v_mfma_f32_16x16x32_bf16 v[84:87], a[8:11], a[68:71], v[84:87]
    s_add_u32 s82, s82, s84
    v_mfma_f32_16x16x32_bf16 v[88:91], a[12:15], a[64:67], v[88:91]
    s_mul_i32 s82, s82, 1280
    v_mfma_f32_16x16x32_bf16 v[92:95], a[12:15], a[68:71], v[92:95]
    s_waitcnt vmcnt(4) lgkmcnt(4)
    v_mfma_f32_16x16x32_bf16 v[64:67], a[16:19], a[72:75], v[64:67]
    s_add_u32 s55, s82, s78
    v_mfma_f32_16x16x32_bf16 v[68:71], a[16:19], a[76:79], v[68:71]
    s_add_u32 m0, s53, 16384
    v_mfma_f32_16x16x32_bf16 v[72:75], a[20:23], a[72:75], v[72:75]
    buffer_load_dwordx4 v14, s[32:35], s55 offen offset:0 lds
    v_mfma_f32_16x16x32_bf16 v[76:79], a[20:23], a[76:79], v[76:79]
    s_waitcnt lgkmcnt(0)
    v_mfma_f32_16x16x32_bf16 v[80:83], a[24:27], a[72:75], v[80:83]
    buffer_load_dwordx4 v15, s[32:35], s55 offen offset:1024 lds
    v_mfma_f32_16x16x32_bf16 v[84:87], a[24:27], a[76:79], v[84:87]
    buffer_load_dwordx4 v16, s[32:35], s55 offen offset:2048 lds
    v_mfma_f32_16x16x32_bf16 v[88:91], a[28:31], a[72:75], v[88:91]
    buffer_load_dwordx4 v17, s[32:35], s55 offen offset:3072 lds
    v_mfma_f32_16x16x32_bf16 v[92:95], a[28:31], a[76:79], v[92:95]
    s_add_u32 s55, s50, 2
    s_cmp_ge_u32 s55, 10
    s_cselect_b32 s82, 10, 0
    s_sub_u32 s55, s55, s82
    s_lshl_b32 s55, s55, 1
    s_lshr_b32 s82, s41, 1
    s_add_u32 s55, s55, s82
    s_mul_i32 s82, s55, 13
    s_lshr_b32 s82, s82, 6
    s_mul_i32 s84, s82, 5
    s_sub_u32 s84, s55, s84
    s_lshl_b32 s84, s84, 3
    s_and_b32 s85, s41, 1
    s_lshl_b32 s85, s85, 2
    s_add_u32 s84, s84, s85
    s_cmp_ge_u32 s84, 20
    s_cselect_b32 s85, 60, 0
    s_add_u32 s84, s84, s85
    s_mul_i32 s82, s82, 160
    s_add_u32 s82, s82, s84
    s_mul_i32 s82, s82, 1280
    s_add_u32 s55, s82, s78
    s_add_u32 m0, s53, 32768
    s_nop 0
    buffer_load_dwordx4 v14, s[32:35], s55 offen offset:0 lds
    buffer_load_dwordx4 v15, s[32:35], s55 offen offset:1024 lds
    buffer_load_dwordx4 v16, s[32:35], s55 offen offset:2048 lds
    buffer_load_dwordx4 v17, s[32:35], s55 offen offset:3072 lds
    v_add_u32 v4, 4294901760, v4
    v_add_u32 v5, 4294901760, v5
    v_add_u32 v6, 4294901760, v6
    v_add_u32 v7, 4294901760, v7
    s_barrier
    s_mul_i32 s56, s42, 442368
    s_add_u32 s56, s56, 12910592
    s_lshl_b32 s44, s58, 14
    s_add_u32 s56, s56, s44
    s_mov_b32 s91, s56
    v_pk_fma_f32 v[64:65], v[192:193], v[40:41], v[64:65] op_sel_hi:[1,0,1] neg_lo:[0,1,0] neg_hi:[0,1,0]
    v_pk_fma_f32 v[66:67], v[194:195], v[40:41], v[66:67] op_sel_hi:[1,0,1] neg_lo:[0,1,0] neg_hi:[0,1,0]
    v_pk_fma_f32 v[72:73], v[196:197], v[40:41], v[72:73] op_sel_hi:[1,0,1] neg_lo:[0,1,0] neg_hi:[0,1,0]
    v_pk_fma_f32 v[74:75], v[198:199], v[40:41], v[74:75] op_sel_hi:[1,0,1] neg_lo:[0,1,0] neg_hi:[0,1,0]
    v_pk_fma_f32 v[68:69], v[192:193], v[42:43], v[68:69] op_sel_hi:[1,0,1] neg_lo:[0,1,0] neg_hi:[0,1,0]
    v_pk_fma_f32 v[70:71], v[194:195], v[42:43], v[70:71] op_sel_hi:[1,0,1] neg_lo:[0,1,0] neg_hi:[0,1,0]
    v_pk_fma_f32 v[76:77], v[196:197], v[42:43], v[76:77] op_sel_hi:[1,0,1] neg_lo:[0,1,0] neg_hi:[0,1,0]
    v_pk_fma_f32 v[78:79], v[198:199], v[42:43], v[78:79] op_sel_hi:[1,0,1] neg_lo:[0,1,0] neg_hi:[0,1,0]
    v_pk_mul_f32 v[22:23], v[64:65], v[64:65]
    v_pk_mul_f32 v[24:25], v[66:67], v[66:67]
    v_pk_mul_f32 v[26:27], v[72:73], v[72:73]
    v_pk_mul_f32 v[28:29], v[74:75], v[74:75]
    v_pk_mul_f32 v[30:31], v[68:69], v[68:69]
    v_pk_mul_f32 v[32:33], v[70:71], v[70:71]
    v_pk_mul_f32 v[34:35], v[76:77], v[76:77]
    v_pk_mul_f32 v[36:37], v[78:79], v[78:79]
    v_pk_fma_f32 v[22:23], v[22:23], v[226:227], v[224:225] op_sel_hi:[1,0,0]
    v_pk_fma_f32 v[24:25], v[24:25], v[226:227], v[224:225] op_sel_hi:[1,0,0]
    v_pk_fma_f32 v[26:27], v[26:27], v[226:227], v[224:225] op_sel_hi:[1,0,0]
    v_pk_fma_f32 v[28:29], v[28:29], v[226:227], v[224:225] op_sel_hi:[1,0,0]
    s_add_u32 s55, s50, 3
    s_cmp_ge_u32 s55, 10
    s_cselect_b32 s82, 10, 0
    s_sub_u32 s55, s55, s82
    s_lshl_b32 s55, s55, 1
    s_lshr_b32 s82, s41, 1
    s_add_u32 s55, s55, s82
    s_mul_i32 s82, s55, 13
    s_lshr_b32 s82, s82, 6
    s_mul_i32 s84, s82, 5
    s_sub_u32 s84, s55, s84
    s_lshl_b32 s84, s84, 3
    s_and_b32 s85, s41, 1
    s_lshl_b32 s85, s85, 2
    s_add_u32 s84, s84, s85
    s_cmp_ge_u32 s84, 20
    s_cselect_b32 s85, 60, 0
    s_add_u32 s84, s84, s85
    s_mul_i32 s82, s82, 160
    s_add_u32 s82, s82, s84
    s_mul_i32 s82, s82, 1280
    s_add_u32 s55, s82, s78
    s_add_u32 m0, s53, 49152
    s_nop 0
    buffer_load_dwordx4 v14, s[32:35], s55 offen offset:0 lds
    v_pk_fma_f32 v[30:31], v[30:31], v[232:233], v[230:231] op_sel_hi:[1,0,0]
    v_pk_fma_f32 v[32:33], v[32:33], v[232:233], v[230:231] op_sel_hi:[1,0,0]
    v_pk_fma_f32 v[34:35], v[34:35], v[232:233], v[230:231] op_sel_hi:[1,0,0]
    v_pk_fma_f32 v[36:37], v[36:37], v[232:233], v[230:231] op_sel_hi:[1,0,0]
    v_pk_mul_f32 v[22:23], v[22:23], v[64:65]
    v_pk_mul_f32 v[24:25], v[24:25], v[66:67]
    v_pk_mul_f32 v[26:27], v[26:27], v[72:73]
    v_pk_mul_f32 v[28:29], v[28:29], v[74:75]
    v_pk_mul_f32 v[30:31], v[30:31], v[68:69]
    v_pk_mul_f32 v[32:33], v[32:33], v[70:71]
    v_pk_mul_f32 v[34:35], v[34:35], v[76:77]
    v_pk_mul_f32 v[36:37], v[36:37], v[78:79]
    v_exp_f32 v22, v22
    v_exp_f32 v23, v23
    v_exp_f32 v24, v24
    v_exp_f32 v25, v25
    v_exp_f32 v26, v26
    v_exp_f32 v27, v27
    v_exp_f32 v28, v28
    v_exp_f32 v29, v29
    buffer_load_dwordx4 v15, s[32:35], s55 offen offset:1024 lds
    v_exp_f32 v30, v30
    v_exp_f32 v31, v31
    v_exp_f32 v32, v32
    v_exp_f32 v33, v33
    v_exp_f32 v34, v34
    v_exp_f32 v35, v35
    v_exp_f32 v36, v36
    v_exp_f32 v37, v37
    v_pk_fma_f32 v[22:23], v[22:23], v[228:229], v[228:229] op_sel_hi:[1,0,0]
    v_pk_fma_f32 v[24:25], v[24:25], v[228:229], v[228:229] op_sel_hi:[1,0,0]
    v_pk_fma_f32 v[26:27], v[26:27], v[228:229], v[228:229] op_sel_hi:[1,0,0]
    v_pk_fma_f32 v[28:29], v[28:29], v[228:229], v[228:229] op_sel_hi:[1,0,0]
    v_pk_fma_f32 v[30:31], v[30:31], v[234:235], v[234:235] op_sel_hi:[1,0,0]
    v_pk_fma_f32 v[32:33], v[32:33], v[234:235], v[234:235] op_sel_hi:[1,0,0]
    v_pk_fma_f32 v[34:35], v[34:35], v[234:235], v[234:235] op_sel_hi:[1,0,0]
    v_pk_fma_f32 v[36:37], v[36:37], v[234:235], v[234:235] op_sel_hi:[1,0,0]
    v_rcp_f32 v22, v22
    v_rcp_f32 v23, v23
    v_rcp_f32 v24, v24
    v_rcp_f32 v25, v25
    buffer_load_dwordx4 v16, s[32:35], s55 offen offset:2048 lds
    v_rcp_f32 v26, v26
    v_rcp_f32 v27, v27
    v_rcp_f32 v28, v28
    v_rcp_f32 v29, v29
    v_rcp_f32 v30, v30
    v_rcp_f32 v31, v31
    v_rcp_f32 v32, v32
    v_rcp_f32 v33, v33
    v_rcp_f32 v34, v34
    v_rcp_f32 v35, v35
    v_rcp_f32 v36, v36
    v_rcp_f32 v37, v37
    v_pk_mul_f32 v[64:65], v[64:65], v[22:23]
    v_pk_mul_f32 v[66:67], v[66:67], v[24:25]
    v_pk_mul_f32 v[72:73], v[72:73], v[26:27]
    v_pk_mul_f32 v[74:75], v[74:75], v[28:29]
    v_pk_mul_f32 v[68:69], v[68:69], v[30:31]
    v_pk_mul_f32 v[70:71], v[70:71], v[32:33]
    v_pk_mul_f32 v[76:77], v[76:77], v[34:35]
    v_pk_mul_f32 v[78:79], v[78:79], v[36:37]
    buffer_load_dwordx4 v17, s[32:35], s55 offen offset:3072 lds
    v_cvt_pk_bf16_f32 v48, v64, v65
    v_cvt_pk_bf16_f32 v49, v66, v67
    v_cvt_pk_bf16_f32 v50, v72, v73
    v_cvt_pk_bf16_f32 v51, v74, v75
    v_cvt_pk_bf16_f32 v52, v68, v69
    v_cvt_pk_bf16_f32 v53, v70, v71
    v_cvt_pk_bf16_f32 v54, v76, v77
    v_cvt_pk_bf16_f32 v55, v78, v79
    buffer_store_dwordx4 v[48:51], v19, s[28:31], s56 offen sc1
    buffer_store_dwordx4 v[52:55], v19, s[28:31], s56 offen offset:256 sc1
    s_add_u32 s56, s56, 8192
    v_pk_fma_f32 v[80:81], v[200:201], v[40:41], v[80:81] op_sel_hi:[1,0,1] neg_lo:[0,1,0] neg_hi:[0,1,0]
    v_pk_fma_f32 v[82:83], v[202:203], v[40:41], v[82:83] op_sel_hi:[1,0,1] neg_lo:[0,1,0] neg_hi:[0,1,0]
    v_pk_fma_f32 v[88:89], v[204:205], v[40:41], v[88:89] op_sel_hi:[1,0,1] neg_lo:[0,1,0] neg_hi:[0,1,0]
    v_pk_fma_f32 v[90:91], v[206:207], v[40:41], v[90:91] op_sel_hi:[1,0,1] neg_lo:[0,1,0] neg_hi:[0,1,0]
    v_pk_fma_f32 v[84:85], v[200:201], v[42:43], v[84:85] op_sel_hi:[1,0,1] neg_lo:[0,1,0] neg_hi:[0,1,0]
    v_pk_fma_f32 v[86:87], v[202:203], v[42:43], v[86:87] op_sel_hi:[1,0,1] neg_lo:[0,1,0] neg_hi:[0,1,0]
    v_pk_fma_f32 v[92:93], v[204:205], v[42:43], v[92:93] op_sel_hi:[1,0,1] neg_lo:[0,1,0] neg_hi:[0,1,0]
    v_pk_fma_f32 v[94:95], v[206:207], v[42:43], v[94:95] op_sel_hi:[1,0,1] neg_lo:[0,1,0] neg_hi:[0,1,0]
    v_pk_mul_f32 v[22:23], v[80:81], v[80:81]
    v_pk_mul_f32 v[24:25], v[82:83], v[82:83]
    v_pk_mul_f32 v[26:27], v[88:89], v[88:89]
    v_pk_mul_f32 v[28:29], v[90:91], v[90:91]
    s_add_u32 s55, s50, 4
    s_cmp_ge_u32 s55, 10
    s_cselect_b32 s82, 10, 0
    s_sub_u32 s55, s55, s82
    s_lshl_b32 s55, s55, 1
    s_lshr_b32 s82, s41, 1
    s_add_u32 s55, s55, s82
    s_mul_i32 s82, s55, 13
    s_lshr_b32 s82, s82, 6
    s_mul_i32 s84, s82, 5
    s_sub_u32 s84, s55, s84
    s_lshl_b32 s84, s84, 3
    s_and_b32 s85, s41, 1
    s_lshl_b32 s85, s85, 2
    s_add_u32 s84, s84, s85
    s_cmp_ge_u32 s84, 20
    s_cselect_b32 s85, 60, 0
    s_add_u32 s84, s84, s85
    s_mul_i32 s82, s82, 160
    s_add_u32 s82, s82, s84
    s_mul_i32 s82, s82, 1280
    s_add_u32 s55, s82, s78
    s_add_u32 m0, s53, 65536
    s_nop 0
    buffer_load_dwordx4 v14, s[32:35], s55 offen offset:0 lds
    v_pk_mul_f32 v[30:31], v[84:85], v[84:85]
    v_pk_mul_f32 v[32:33], v[86:87], v[86:87]
    v_pk_mul_f32 v[34:35], v[92:93], v[92:93]
    v_pk_mul_f32 v[36:37], v[94:95], v[94:95]
    v_pk_fma_f32 v[22:23], v[22:23], v[226:227], v[224:225] op_sel_hi:[1,0,0]
    v_pk_fma_f32 v[24:25], v[24:25], v[226:227], v[224:225] op_sel_hi:[1,0,0]
    v_pk_fma_f32 v[26:27], v[26:27], v[226:227], v[224:225] op_sel_hi:[1,0,0]
    v_pk_fma_f32 v[28:29], v[28:29], v[226:227], v[224:225] op_sel_hi:[1,0,0]
    v_pk_fma_f32 v[30:31], v[30:31], v[232:233], v[230:231] op_sel_hi:[1,0,0]
    v_pk_fma_f32 v[32:33], v[32:33], v[232:233], v[230:231] op_sel_hi:[1,0,0]
    v_pk_fma_f32 v[34:35], v[34:35], v[232:233], v[230:231] op_sel_hi:[1,0,0]
    v_pk_fma_f32 v[36:37], v[36:37], v[232:233], v[230:231] op_sel_hi:[1,0,0]
    v_pk_mul_f32 v[22:23], v[22:23], v[80:81]
    v_pk_mul_f32 v[24:25], v[24:25], v[82:83]
    v_pk_mul_f32 v[26:27], v[26:27], v[88:89]
    v_pk_mul_f32 v[28:29], v[28:29], v[90:91]
    v_pk_mul_f32 v[30:31], v[30:31], v[84:85]
    v_pk_mul_f32 v[32:33], v[32:33], v[86:87]
    v_pk_mul_f32 v[34:35], v[34:35], v[92:93]
    v_pk_mul_f32 v[36:37], v[36:37], v[94:95]
    buffer_load_dwordx4 v15, s[32:35], s55 offen offset:1024 lds
    v_exp_f32 v22, v22
    v_exp_f32 v23, v23
    v_exp_f32 v24, v24
    v_exp_f32 v25, v25
    v_exp_f32 v26, v26
    v_exp_f32 v27, v27
    v_exp_f32 v28, v28
    v_exp_f32 v29, v29
    v_exp_f32 v30, v30
    v_exp_f32 v31, v31
    v_exp_f32 v32, v32
    v_exp_f32 v33, v33
    v_exp_f32 v34, v34
    v_exp_f32 v35, v35
    v_exp_f32 v36, v36
    v_exp_f32 v37, v37
    v_pk_fma_f32 v[22:23], v[22:23], v[228:229], v[228:229] op_sel_hi:[1,0,0]
    v_pk_fma_f32 v[24:25], v[24:25], v[228:229], v[228:229] op_sel_hi:[1,0,0]
    v_pk_fma_f32 v[26:27], v[26:27], v[228:229], v[228:229] op_sel_hi:[1,0,0]
    v_pk_fma_f32 v[28:29], v[28:29], v[228:229], v[228:229] op_sel_hi:[1,0,0]
    buffer_load_dwordx4 v16, s[32:35], s55 offen offset:2048 lds
    v_pk_fma_f32 v[30:31], v[30:31], v[234:235], v[234:235] op_sel_hi:[1,0,0]
    v_pk_fma_f32 v[32:33], v[32:33], v[234:235], v[234:235] op_sel_hi:[1,0,0]
    v_pk_fma_f32 v[34:35], v[34:35], v[234:235], v[234:235] op_sel_hi:[1,0,0]
    v_pk_fma_f32 v[36:37], v[36:37], v[234:235], v[234:235] op_sel_hi:[1,0,0]
    v_rcp_f32 v22, v22
    v_rcp_f32 v23, v23
    v_rcp_f32 v24, v24
    v_rcp_f32 v25, v25
    v_rcp_f32 v26, v26
    v_rcp_f32 v27, v27
    v_rcp_f32 v28, v28
    v_rcp_f32 v29, v29
    v_rcp_f32 v30, v30
    v_rcp_f32 v31, v31
    v_rcp_f32 v32, v32
    v_rcp_f32 v33, v33
    v_rcp_f32 v34, v34
    v_rcp_f32 v35, v35
    v_rcp_f32 v36, v36
    v_rcp_f32 v37, v37
    buffer_load_dwordx4 v17, s[32:35], s55 offen offset:3072 lds
    v_pk_mul_f32 v[80:81], v[80:81], v[22:23]
    v_pk_mul_f32 v[82:83], v[82:83], v[24:25]
    v_pk_mul_f32 v[88:89], v[88:89], v[26:27]
    v_pk_mul_f32 v[90:91], v[90:91], v[28:29]
    v_pk_mul_f32 v[84:85], v[84:85], v[30:31]
    v_pk_mul_f32 v[86:87], v[86:87], v[32:33]
    v_pk_mul_f32 v[92:93], v[92:93], v[34:35]
    v_pk_mul_f32 v[94:95], v[94:95], v[36:37]
    v_cvt_pk_bf16_f32 v56, v80, v81
    v_cvt_pk_bf16_f32 v57, v82, v83
    v_cvt_pk_bf16_f32 v58, v88, v89
    v_cvt_pk_bf16_f32 v59, v90, v91
    v_cvt_pk_bf16_f32 v60, v84, v85
    v_cvt_pk_bf16_f32 v61, v86, v87
    v_cvt_pk_bf16_f32 v62, v92, v93
    v_cvt_pk_bf16_f32 v63, v94, v95
    buffer_store_dwordx4 v[56:59], v19, s[28:31], s56 offen sc1
    buffer_store_dwordx4 v[60:63], v19, s[28:31], s56 offen offset:256 sc1
    s_mul_i32 s76, s42, 16
    s_add_u32 s76, s76, s43
    s_lshl_b32 s76, s76, 7
    s_add_u32 s76, s76, 27361280
    s_barrier
    s_mov_b32 s58, s83
    v_lshrrev_b32 v22, 2, v1
    v_and_b32 v24, 7, v22
    v_lshlrev_b32 v24, 1, v24
    v_bfe_u32 v23, v1, 1, 1
    v_xor_b32 v23, v23, v24
    v_lshlrev_b32 v22, 8, v22
    v_lshl_add_u32 v22, v23, 4, v22
    v_and_b32 v23, 1, v1
    v_lshl_add_u32 v4, v23, 3, v22
    v_xor_b32 v5, 32, v4
    v_xor_b32 v6, 64, v4
    v_xor_b32 v7, 96, v4
    v_xor_b32 v8, 128, v4
    v_xor_b32 v9, 160, v4
    v_xor_b32 v10, 192, v4
    v_xor_b32 v11, 224, v4
    v_lshrrev_b32 v22, 4, v1
    v_lshlrev_b32 v22, 11, v22
    v_and_b32 v23, 15, v1
    v_lshl_add_u32 v22, v23, 4, v22
    s_lshl_b32 s44, s41, 9
    v_add_u32 v19, s44, v22
    s_mul_i32 s44, s42, 4
    s_lshl_b32 s44, s44, 7
    s_add_u32 s44, s44, 27394048
    v_lshlrev_b32 v22, 7, v1
    v_add_u32 v22, s44, v22
    s_cmp_lg_u32 s41, 0
    s_cbranch_scc1 L_f1_22
    s_mov_b32 exec_lo, 15
    s_mov_b32 exec_hi, 0
    buffer_load_dword v63, v22, s[28:31], 0 offen sc1
    s_mov_b64 exec, -1
L_f1_22:
    s_waitcnt vmcnt(0)
    s_waitcnt vmcnt(0)
    s_cmp_lg_u32 s41, 0
    s_cbranch_scc1 L_f2_23
    s_mov_b32 exec_lo, 15
    s_mov_b32 exec_hi, 0
    s_mov_b32 s57, 200000
L_fp_24:
    v_cmp_ne_u32 vcc, s40, v63
    s_nop 1
    s_cbranch_vccz L_fd_25
    buffer_load_dword v63, v22, s[28:31], 0 offen sc1
    s_waitcnt vmcnt(0)
    s_sub_u32 s57, s57, 1
    s_cmp_lg_u32 s57, 0
    s_cbranch_scc1 L_fp_24
L_fd_25:
    s_mov_b64 exec, -1
L_f2_23:
    s_barrier
    buffer_store_dwordx4 v[244:247], v243, s[28:31], s76 offen sc1
    s_mul_i32 s54, s42, 163840
    s_add_u32 s54, s54, 10289152
    s_lshl_b32 s56, s50, 14
    s_add_u32 s56, s56, s54
    s_add_u32 s89, s54, 163840
    v_add_u32 v253, 8192, v19
    buffer_load_dwordx4 a[32:35], v19, s[28:31], s56 offen sc1
    buffer_load_dwordx4 a[36:39], v19, s[28:31], s56 offen offset:256 sc1
    buffer_load_dwordx4 a[40:43], v253, s[28:31], s56 offen sc1
    buffer_load_dwordx4 a[44:47], v253, s[28:31], s56 offen offset:256 sc1
    s_add_u32 s56, s56, 16384
    buffer_load_dwordx4 a[48:51], v19, s[28:31], s56 offen sc1
    buffer_load_dwordx4 a[52:55], v19, s[28:31], s56 offen offset:256 sc1
    buffer_load_dwordx4 a[56:59], v253, s[28:31], s56 offen sc1
    buffer_load_dwordx4 a[60:63], v253, s[28:31], s56 offen offset:256 sc1
    s_add_u32 s56, s56, 16384
    buffer_load_dwordx4 a[64:67], v19, s[28:31], s56 offen sc1
    buffer_load_dwordx4 a[68:71], v19, s[28:31], s56 offen offset:256 sc1
    buffer_load_dwordx4 a[72:75], v253, s[28:31], s56 offen sc1
    buffer_load_dwordx4 a[76:79], v253, s[28:31], s56 offen offset:256 sc1
    s_add_u32 s56, s56, 16384
    s_waitcnt vmcnt(13)
    s_barrier
    ds_read_b64_tr_b16 a[0:1], v4 offset:0
    ds_read_b64_tr_b16 a[2:3], v4 offset:4096
    ds_read_b64_tr_b16 a[4:5], v5 offset:0
    ds_read_b64_tr_b16 a[6:7], v5 offset:4096
    ds_read_b64_tr_b16 a[8:9], v6 offset:0
    ds_read_b64_tr_b16 a[10:11], v6 offset:4096
    ds_read_b64_tr_b16 a[12:13], v7 offset:0
    ds_read_b64_tr_b16 a[14:15], v7 offset:4096
    ds_read_b64_tr_b16 a[16:17], v8 offset:0
    ds_read_b64_tr_b16 a[18:19], v8 offset:4096
    ds_read_b64_tr_b16 a[20:21], v9 offset:0
    ds_read_b64_tr_b16 a[22:23], v9 offset:4096
    s_waitcnt vmcnt(10) lgkmcnt(8)
    v_mfma_f32_16x16x32_bf16 v[128:131], a[0:3], a[32:35], 0
    ds_read_b64_tr_b16 a[24:25], v10 offset:0
    buffer_load_dwordx4 a[80:83], v19, s[28:31], s56 offen sc1
    v_mfma_f32_16x16x32_bf16 v[132:135], a[0:3], a[36:39], 0
    ds_read_b64_tr_b16 a[26:27], v10 offset:4096
    buffer_load_dwordx4 a[84:87], v19, s[28:31], s56 offen offset:256 sc1
    v_mfma_f32_16x16x32_bf16 v[136:139], a[4:7], a[32:35], 0
    ds_read_b64_tr_b16 a[28:29], v11 offset:0
    s_add_u32 s55, s50, 5
    v_mfma_f32_16x16x32_bf16 v[140:143], a[4:7], a[36:39], 0
    ds_read_b64_tr_b16 a[30:31], v11 offset:4096
    s_waitcnt lgkmcnt(8)
    v_mfma_f32_16x16x32_bf16 v[144:147], a[8:11], a[32:35], 0
    ds_read_b64_tr_b16 a[0:1], v4 offset:8192
    s_cmp_ge_u32 s55, 10
    v_mfma_f32_16x16x32_bf16 v[148:151], a[8:11], a[36:39], 0
    ds_read_b64_tr_b16 a[2:3], v4 offset:12288
    s_cselect_b32 s82, 10, 0
    v_mfma_f32_16x16x32_bf16 v[152:155], a[12:15], a[32:35], 0
    ds_read_b64_tr_b16 a[4:5], v5 offset:8192
    s_sub_u32 s55, s55, s82
    v_mfma_f32_16x16x32_bf16 v[156:159], a[12:15], a[36:39], 0
    ds_read_b64_tr_b16 a[6:7], v5 offset:12288
    s_waitcnt lgkmcnt(8)
    v_mfma_f32_16x16x32_bf16 v[160:163], a[16:19], a[32:35], 0
    ds_read_b64_tr_b16 a[8:9], v6 offset:8192
    s_lshl_b32 s55, s55, 1
    v_mfma_f32_16x16x32_bf16 v[164:167], a[16:19], a[36:39], 0
    ds_read_b64_tr_b16 a[10:11], v6 offset:12288
    s_lshr_b32 s82, s41, 1
    v_mfma_f32_16x16x32_bf16 v[168:171], a[20:23], a[32:35], 0
    ds_read_b64_tr_b16 a[12:13], v7 offset:8192
    s_add_u32 s55, s55, s82
    v_mfma_f32_16x16x32_bf16 v[172:175], a[20:23], a[36:39], 0
    ds_read_b64_tr_b16 a[14:15], v7 offset:12288
    s_waitcnt lgkmcnt(8)
    v_mfma_f32_16x16x32_bf16 v[176:179], a[24:27], a[32:35], 0
    ds_read_b64_tr_b16 a[16:17], v8 offset:8192
    s_mul_i32 s82, s55, 13
    v_mfma_f32_16x16x32_bf16 v[180:183], a[24:27], a[36:39], 0
    ds_read_b64_tr_b16 a[18:19], v8 offset:12288
    s_lshr_b32 s82, s82, 6
    v_mfma_f32_16x16x32_bf16 v[184:187], a[28:31], a[32:35], 0
    ds_read_b64_tr_b16 a[20:21], v9 offset:8192
    s_mul_i32 s84, s82, 5
    v_mfma_f32_16x16x32_bf16 v[188:191], a[28:31], a[36:39], 0
    ds_read_b64_tr_b16 a[22:23], v9 offset:12288
    s_waitcnt vmcnt(10) lgkmcnt(8)
    v_mfma_f32_16x16x32_bf16 v[128:131], a[0:3], a[40:43], v[128:131]
    ds_read_b64_tr_b16 a[24:25], v10 offset:8192
    buffer_load_dwordx4 a[32:35], v253, s[28:31], s56 offen sc1
    v_mfma_f32_16x16x32_bf16 v[132:135], a[0:3], a[44:47], v[132:135]
    ds_read_b64_tr_b16 a[26:27], v10 offset:12288
    buffer_load_dwordx4 a[36:39], v253, s[28:31], s56 offen offset:256 sc1
    v_mfma_f32_16x16x32_bf16 v[136:139], a[4:7], a[40:43], v[136:139]
    ds_read_b64_tr_b16 a[28:29], v11 offset:8192
    s_add_u32 s56, s56, 16384
    v_mfma_f32_16x16x32_bf16 v[140:143], a[4:7], a[44:47], v[140:143]
    ds_read_b64_tr_b16 a[30:31], v11 offset:12288
    s_waitcnt lgkmcnt(8)
    v_mfma_f32_16x16x32_bf16 v[144:147], a[8:11], a[40:43], v[144:147]
    s_waitcnt vmcnt(17)
    s_barrier
    ds_read_b64_tr_b16 a[0:1], v4 offset:16384
    s_sub_u32 s84, s55, s84
    v_mfma_f32_16x16x32_bf16 v[148:151], a[8:11], a[44:47], v[148:151]
    ds_read_b64_tr_b16 a[2:3], v4 offset:20480
    s_lshl_b32 s84, s84, 3
    v_mfma_f32_16x16x32_bf16 v[152:155], a[12:15], a[40:43], v[152:155]
    ds_read_b64_tr_b16 a[4:5], v5 offset:16384
    s_and_b32 s85, s41, 1
    v_mfma_f32_16x16x32_bf16 v[156:159], a[12:15], a[44:47], v[156:159]
    ds_read_b64_tr_b16 a[6:7], v5 offset:20480
    s_waitcnt lgkmcnt(8)
    v_mfma_f32_16x16x32_bf16 v[160:163], a[16:19], a[40:43], v[160:163]
    ds_read_b64_tr_b16 a[8:9], v6 offset:16384
    s_lshl_b32 s85, s85, 2
    v_mfma_f32_16x16x32_bf16 v[164:167], a[16:19], a[44:47], v[164:167]
    ds_read_b64_tr_b16 a[10:11], v6 offset:20480
    s_add_u32 s84, s84, s85
    v_mfma_f32_16x16x32_bf16 v[168:171], a[20:23], a[40:43], v[168:171]
    ds_read_b64_tr_b16 a[12:13], v7 offset:16384
    s_cmp_ge_u32 s84, 20
    v_mfma_f32_16x16x32_bf16 v[172:175], a[20:23], a[44:47], v[172:175]
    ds_read_b64_tr_b16 a[14:15], v7 offset:20480
    s_waitcnt lgkmcnt(8)
    v_mfma_f32_16x16x32_bf16 v[176:179], a[24:27], a[40:43], v[176:179]
    ds_read_b64_tr_b16 a[16:17], v8 offset:16384
    s_cselect_b32 s85, 60, 0
    v_mfma_f32_16x16x32_bf16 v[180:183], a[24:27], a[44:47], v[180:183]
    ds_read_b64_tr_b16 a[18:19], v8 offset:20480
    s_add_u32 s84, s84, s85
    v_mfma_f32_16x16x32_bf16 v[184:187], a[28:31], a[40:43], v[184:187]
    ds_read_b64_tr_b16 a[20:21], v9 offset:16384
    s_mul_i32 s82, s82, 160
    v_mfma_f32_16x16x32_bf16 v[188:191], a[28:31], a[44:47], v[188:191]
    ds_read_b64_tr_b16 a[22:23], v9 offset:20480
    s_waitcnt vmcnt(10) lgkmcnt(8)
    v_mfma_f32_16x16x32_bf16 v[128:131], a[0:3], a[48:51], v[128:131]
    ds_read_b64_tr_b16 a[24:25], v10 offset:16384
    buffer_load_dwordx4 a[40:43], v19, s[28:31], s56 offen sc1
    v_mfma_f32_16x16x32_bf16 v[132:135], a[0:3], a[52:55], v[132:135]
    ds_read_b64_tr_b16 a[26:27], v10 offset:20480
    buffer_load_dwordx4 a[44:47], v19, s[28:31], s56 offen offset:256 sc1
    v_mfma_f32_16x16x32_bf16 v[136:139], a[4:7], a[48:51], v[136:139]
    ds_read_b64_tr_b16 a[28:29], v11 offset:16384
    s_add_u32 s82, s82, s84
    v_mfma_f32_16x16x32_bf16 v[140:143], a[4:7], a[52:55], v[140:143]
    ds_read_b64_tr_b16 a[30:31], v11 offset:20480
    s_waitcnt lgkmcnt(8)
    v_mfma_f32_16x16x32_bf16 v[144:147], a[8:11], a[48:51], v[144:147]
    ds_read_b64_tr_b16 a[0:1], v4 offset:24576
    s_mul_i32 s82, s82, 1280
    v_mfma_f32_16x16x32_bf16 v[148:151], a[8:11], a[52:55], v[148:151]
    ds_read_b64_tr_b16 a[2:3], v4 offset:28672
    s_add_u32 s55, s82, s78
    v_mfma_f32_16x16x32_bf16 v[152:155], a[12:15], a[48:51], v[152:155]
    ds_read_b64_tr_b16 a[4:5], v5 offset:24576
    s_add_u32 m0, s53, 81920
    v_mfma_f32_16x16x32_bf16 v[156:159], a[12:15], a[52:55], v[156:159]
    ds_read_b64_tr_b16 a[6:7], v5 offset:28672
    s_waitcnt lgkmcnt(8)
    v_mfma_f32_16x16x32_bf16 v[160:163], a[16:19], a[48:51], v[160:163]
    ds_read_b64_tr_b16 a[8:9], v6 offset:24576
    buffer_load_dwordx4 v14, s[32:35], s55 offen offset:0 lds
    v_mfma_f32_16x16x32_bf16 v[164:167], a[16:19], a[52:55], v[164:167]
    ds_read_b64_tr_b16 a[10:11], v6 offset:28672
    buffer_load_dwordx4 v15, s[32:35], s55 offen offset:1024 lds
    v_mfma_f32_16x16x32_bf16 v[168:171], a[20:23], a[48:51], v[168:171]
    ds_read_b64_tr_b16 a[12:13], v7 offset:24576
    buffer_load_dwordx4 v16, s[32:35], s55 offen offset:2048 lds
    v_mfma_f32_16x16x32_bf16 v[172:175], a[20:23], a[52:55], v[172:175]
    ds_read_b64_tr_b16 a[14:15], v7 offset:28672
    s_waitcnt lgkmcnt(8)
    v_mfma_f32_16x16x32_bf16 v[176:179], a[24:27], a[48:51], v[176:179]
    ds_read_b64_tr_b16 a[16:17], v8 offset:24576
    buffer_load_dwordx4 v17, s[32:35], s55 offen offset:3072 lds
    v_mfma_f32_16x16x32_bf16 v[180:183], a[24:27], a[52:55], v[180:183]
    ds_read_b64_tr_b16 a[18:19], v8 offset:28672
    s_add_u32 s55, s50, 6
    v_mfma_f32_16x16x32_bf16 v[184:187], a[28:31], a[48:51], v[184:187]
    ds_read_b64_tr_b16 a[20:21], v9 offset:24576
    s_cmp_ge_u32 s55, 10
    v_mfma_f32_16x16x32_bf16 v[188:191], a[28:31], a[52:55], v[188:191]
    ds_read_b64_tr_b16 a[22:23], v9 offset:28672
    s_waitcnt vmcnt(14) lgkmcnt(8)
    v_mfma_f32_16x16x32_bf16 v[128:131], a[0:3], a[56:59], v[128:131]
    ds_read_b64_tr_b16 a[24:25], v10 offset:24576
    s_cselect_b32 s82, 10, 0
    v_mfma_f32_16x16x32_bf16 v[132:135], a[0:3], a[60:63], v[132:135]
    ds_read_b64_tr_b16 a[26:27], v10 offset:28672
    buffer_load_dwordx4 a[48:51], v253, s[28:31], s56 offen sc1
    v_mfma_f32_16x16x32_bf16 v[136:139], a[4:7], a[56:59], v[136:139]
    ds_read_b64_tr_b16 a[28:29], v11 offset:24576
    buffer_load_dwordx4 a[52:55], v253, s[28:31], s56 offen offset:256 sc1
    v_mfma_f32_16x16x32_bf16 v[140:143], a[4:7], a[60:63], v[140:143]
    ds_read_b64_tr_b16 a[30:31], v11 offset:28672
    s_waitcnt lgkmcnt(8)
    v_mfma_f32_16x16x32_bf16 v[144:147], a[8:11], a[56:59], v[144:147]
    s_waitcnt vmcnt(25)
    s_barrier
    ds_read_b64_tr_b16 a[0:1], v4 offset:32768
    s_add_u32 s56, s56, 16384
    v_mfma_f32_16x16x32_bf16 v[148:151], a[8:11], a[60:63], v[148:151]
    ds_read_b64_tr_b16 a[2:3], v4 offset:36864
    s_sub_u32 s55, s55, s82
    v_mfma_f32_16x16x32_bf16 v[152:155], a[12:15], a[56:59], v[152:155]
    ds_read_b64_tr_b16 a[4:5], v5 offset:32768
    s_lshl_b32 s55, s55, 1
    v_mfma_f32_16x16x32_bf16 v[156:159], a[12:15], a[60:63], v[156:159]
    ds_read_b64_tr_b16 a[6:7], v5 offset:36864
    s_waitcnt lgkmcnt(8)
    v_mfma_f32_16x16x32_bf16 v[160:163], a[16:19], a[56:59], v[160:163]
    ds_read_b64_tr_b16 a[8:9], v6 offset:32768
    s_lshr_b32 s82, s41, 1
    v_mfma_f32_16x16x32_bf16 v[164:167], a[16:19], a[60:63], v[164:167]
    ds_read_b64_tr_b16 a[10:11], v6 offset:36864
    s_add_u32 s55, s55, s82
    v_mfma_f32_16x16x32_bf16 v[168:171], a[20:23], a[56:59], v[168:171]
    ds_read_b64_tr_b16 a[12:13], v7 offset:32768
    s_mul_i32 s82, s55, 13
    v_mfma_f32_16x16x32_bf16 v[172:175], a[20:23], a[60:63], v[172:175]
    ds_read_b64_tr_b16 a[14:15], v7 offset:36864
    s_waitcnt lgkmcnt(8)
    v_mfma_f32_16x16x32_bf16 v[176:179], a[24:27], a[56:59], v[176:179]
    ds_read_b64_tr_b16 a[16:17], v8 offset:32768
    s_lshr_b32 s82, s82, 6
    v_mfma_f32_16x16x32_bf16 v[180:183], a[24:27], a[60:63], v[180:183]
    ds_read_b64_tr_b16 a[18:19], v8 offset:36864
    s_mul_i32 s84, s82, 5
    v_mfma_f32_16x16x32_bf16 v[184:187], a[28:31], a[56:59], v[184:187]
    ds_read_b64_tr_b16 a[20:21], v9 offset:32768
    s_sub_u32 s84, s55, s84
    v_mfma_f32_16x16x32_bf16 v[188:191], a[28:31], a[60:63], v[188:191]
    ds_read_b64_tr_b16 a[22:23], v9 offset:36864
    s_waitcnt vmcnt(14) lgkmcnt(8)
    v_mfma_f32_16x16x32_bf16 v[128:131], a[0:3], a[64:67], v[128:131]
    ds_read_b64_tr_b16 a[24:25], v10 offset:32768
    buffer_load_dwordx4 a[56:59], v19, s[28:31], s56 offen sc1
    v_mfma_f32_16x16x32_bf16 v[132:135], a[0:3], a[68:71], v[132:135]
    ds_read_b64_tr_b16 a[26:27], v10 offset:36864
    buffer_load_dwordx4 a[60:63], v19, s[28:31], s56 offen offset:256 sc1
    v_mfma_f32_16x16x32_bf16 v[136:139], a[4:7], a[64:67], v[136:139]
    ds_read_b64_tr_b16 a[28:29], v11 offset:32768
    s_lshl_b32 s84, s84, 3
    v_mfma_f32_16x16x32_bf16 v[140:143], a[4:7], a[68:71], v[140:143]
    ds_read_b64_tr_b16 a[30:31], v11 offset:36864
    s_waitcnt lgkmcnt(8)
    v_mfma_f32_16x16x32_bf16 v[144:147], a[8:11], a[64:67], v[144:147]
    ds_read_b64_tr_b16 a[0:1], v4 offset:40960
    s_and_b32 s85, s41, 1
    v_mfma_f32_16x16x32_bf16 v[148:151], a[8:11], a[68:71], v[148:151]
    ds_read_b64_tr_b16 a[2:3], v4 offset:45056
    s_lshl_b32 s85, s85, 2
    v_mfma_f32_16x16x32_bf16 v[152:155], a[12:15], a[64:67], v[152:155]
    ds_read_b64_tr_b16 a[4:5], v5 offset:40960
    s_add_u32 s84, s84, s85
    v_mfma_f32_16x16x32_bf16 v[156:159], a[12:15], a[68:71], v[156:159]
    ds_read_b64_tr_b16 a[6:7], v5 offset:45056
    s_waitcnt lgkmcnt(8)
    v_mfma_f32_16x16x32_bf16 v[160:163], a[16:19], a[64:67], v[160:163]
    ds_read_b64_tr_b16 a[8:9], v6 offset:40960
    s_cmp_ge_u32 s84, 20
    v_mfma_f32_16x16x32_bf16 v[164:167], a[16:19], a[68:71], v[164:167]
    ds_read_b64_tr_b16 a[10:11], v6 offset:45056
    s_cselect_b32 s85, 60, 0
    v_mfma_f32_16x16x32_bf16 v[168:171], a[20:23], a[64:67], v[168:171]
    ds_read_b64_tr_b16 a[12:13], v7 offset:40960
    s_add_u32 s84, s84, s85
    v_mfma_f32_16x16x32_bf16 v[172:175], a[20:23], a[68:71], v[172:175]
    ds_read_b64_tr_b16 a[14:15], v7 offset:45056
    s_waitcnt lgkmcnt(8)
    v_mfma_f32_16x16x32_bf16 v[176:179], a[24:27], a[64:67], v[176:179]
    ds_read_b64_tr_b16 a[16:17], v8 offset:40960
    s_mul_i32 s82, s82, 160
    v_mfma_f32_16x16x32_bf16 v[180:183], a[24:27], a[68:71], v[180:183]
    ds_read_b64_tr_b16 a[18:19], v8 offset:45056
    s_add_u32 s82, s82, s84
    v_mfma_f32_16x16x32_bf16 v[184:187], a[28:31], a[64:67], v[184:187]
    ds_read_b64_tr_b16 a[20:21], v9 offset:40960
    s_mul_i32 s82, s82, 1280
    v_mfma_f32_16x16x32_bf16 v[188:191], a[28:31], a[68:71], v[188:191]
    ds_read_b64_tr_b16 a[22:23], v9 offset:45056
    s_waitcnt vmcnt(14) lgkmcnt(8)
    v_mfma_f32_16x16x32_bf16 v[128:131], a[0:3], a[72:75], v[128:131]
    ds_read_b64_tr_b16 a[24:25], v10 offset:40960
    buffer_load_dwordx4 a[64:67], v253, s[28:31], s56 offen sc1
    v_mfma_f32_16x16x32_bf16 v[132:135], a[0:3], a[76:79], v[132:135]
    ds_read_b64_tr_b16 a[26:27], v10 offset:45056
    buffer_load_dwordx4 a[68:71], v253, s[28:31], s56 offen offset:256 sc1
    v_mfma_f32_16x16x32_bf16 v[136:139], a[4:7], a[72:75], v[136:139]
    ds_read_b64_tr_b16 a[28:29], v11 offset:40960
    s_add_u32 s56, s56, 16384
    v_mfma_f32_16x16x32_bf16 v[140:143], a[4:7], a[76:79], v[140:143]
    ds_read_b64_tr_b16 a[30:31], v11 offset:45056
    s_waitcnt lgkmcnt(8)
    v_mfma_f32_16x16x32_bf16 v[144:147], a[8:11], a[72:75], v[144:147]
    s_waitcnt vmcnt(29)
    s_barrier
    ds_read_b64_tr_b16 a[0:1], v4 offset:49152
    s_add_u32 s55, s82, s78
    v_mfma_f32_16x16x32_bf16 v[148:151], a[8:11], a[76:79], v[148:151]
    ds_read_b64_tr_b16 a[2:3], v4 offset:53248
    s_add_u32 m0, s53, 98304
    v_mfma_f32_16x16x32_bf16 v[152:155], a[12:15], a[72:75], v[152:155]
    ds_read_b64_tr_b16 a[4:5], v5 offset:49152
    buffer_load_dwordx4 v14, s[32:35], s55 offen offset:0 lds
    v_mfma_f32_16x16x32_bf16 v[156:159], a[12:15], a[76:79], v[156:159]
    ds_read_b64_tr_b16 a[6:7], v5 offset:53248
    s_waitcnt lgkmcnt(8)
    v_mfma_f32_16x16x32_bf16 v[160:163], a[16:19], a[72:75], v[160:163]
    ds_read_b64_tr_b16 a[8:9], v6 offset:49152
    buffer_load_dwordx4 v15, s[32:35], s55 offen offset:1024 lds
    v_mfma_f32_16x16x32_bf16 v[164:167], a[16:19], a[76:79], v[164:167]
    ds_read_b64_tr_b16 a[10:11], v6 offset:53248
    buffer_load_dwordx4 v16, s[32:35], s55 offen offset:2048 lds
    v_mfma_f32_16x16x32_bf16 v[168:171], a[20:23], a[72:75], v[168:171]
    ds_read_b64_tr_b16 a[12:13], v7 offset:49152
    buffer_load_dwordx4 v17, s[32:35], s55 offen offset:3072 lds
    v_mfma_f32_16x16x32_bf16 v[172:175], a[20:23], a[76:79], v[172:175]
    ds_read_b64_tr_b16 a[14:15], v7 offset:53248
    s_waitcnt lgkmcnt(8)
    v_mfma_f32_16x16x32_bf16 v[176:179], a[24:27], a[72:75], v[176:179]
    ds_read_b64_tr_b16 a[16:17], v8 offset:49152
    s_add_u32 s55, s50, 7
    v_mfma_f32_16x16x32_bf16 v[180:183], a[24:27], a[76:79], v[180:183]
    ds_read_b64_tr_b16 a[18:19], v8 offset:53248
    s_cmp_ge_u32 s55, 10
    v_mfma_f32_16x16x32_bf16 v[184:187], a[28:31], a[72:75], v[184:187]
    ds_read_b64_tr_b16 a[20:21], v9 offset:49152
    s_cselect_b32 s82, 10, 0
    v_mfma_f32_16x16x32_bf16 v[188:191], a[28:31], a[76:79], v[188:191]
    ds_read_b64_tr_b16 a[22:23], v9 offset:53248
    s_waitcnt vmcnt(18) lgkmcnt(8)
    v_mfma_f32_16x16x32_bf16 v[128:131], a[0:3], a[80:83], v[128:131]
    ds_read_b64_tr_b16 a[24:25], v10 offset:49152
    buffer_load_dwordx4 a[72:75], v19, s[28:31], s56 offen sc1
    v_mfma_f32_16x16x32_bf16 v[132:135], a[0:3], a[84:87], v[132:135]
    ds_read_b64_tr_b16 a[26:27], v10 offset:53248
    buffer_load_dwordx4 a[76:79], v19, s[28:31], s56 offen offset:256 sc1
    v_mfma_f32_16x16x32_bf16 v[136:139], a[4:7], a[80:83], v[136:139]
    ds_read_b64_tr_b16 a[28:29], v11 offset:49152
    s_sub_u32 s55, s55, s82
    v_mfma_f32_16x16x32_bf16 v[140:143], a[4:7], a[84:87], v[140:143]
    ds_read_b64_tr_b16 a[30:31], v11 offset:53248
    s_waitcnt lgkmcnt(8)
    v_mfma_f32_16x16x32_bf16 v[144:147], a[8:11], a[80:83], v[144:147]
    ds_read_b64_tr_b16 a[0:1], v4 offset:57344
    s_lshl_b32 s55, s55, 1
    v_mfma_f32_16x16x32_bf16 v[148:151], a[8:11], a[84:87], v[148:151]
    ds_read_b64_tr_b16 a[2:3], v4 offset:61440
    s_lshr_b32 s82, s41, 1
    v_mfma_f32_16x16x32_bf16 v[152:155], a[12:15], a[80:83], v[152:155]
    ds_read_b64_tr_b16 a[4:5], v5 offset:57344
    s_add_u32 s55, s55, s82
    v_mfma_f32_16x16x32_bf16 v[156:159], a[12:15], a[84:87], v[156:159]
    ds_read_b64_tr_b16 a[6:7], v5 offset:61440
    s_waitcnt lgkmcnt(8)
    v_mfma_f32_16x16x32_bf16 v[160:163], a[16:19], a[80:83], v[160:163]
    ds_read_b64_tr_b16 a[8:9], v6 offset:57344
    s_mul_i32 s82, s55, 13
    v_mfma_f32_16x16x32_bf16 v[164:167], a[16:19], a[84:87], v[164:167]
    ds_read_b64_tr_b16 a[10:11], v6 offset:61440
    s_lshr_b32 s82, s82, 6
    v_mfma_f32_16x16x32_bf16 v[168:171], a[20:23], a[80:83], v[168:171]
    ds_read_b64_tr_b16 a[12:13], v7 offset:57344
    s_mul_i32 s84, s82, 5
    v_mfma_f32_16x16x32_bf16 v[172:175], a[20:23], a[84:87], v[172:175]
    ds_read_b64_tr_b16 a[14:15], v7 offset:61440
    s_waitcnt lgkmcnt(8)
    v_mfma_f32_16x16x32_bf16 v[176:179], a[24:27], a[80:83], v[176:179]
    ds_read_b64_tr_b16 a[16:17], v8 offset:57344
    s_sub_u32 s84, s55, s84
    v_mfma_f32_16x16x32_bf16 v[180:183], a[24:27], a[84:87], v[180:183]
    ds_read_b64_tr_b16 a[18:19], v8 offset:61440
    s_lshl_b32 s84, s84, 3
    v_mfma_f32_16x16x32_bf16 v[184:187], a[28:31], a[80:83], v[184:187]
    ds_read_b64_tr_b16 a[20:21], v9 offset:57344
    s_and_b32 s85, s41, 1
    v_mfma_f32_16x16x32_bf16 v[188:191], a[28:31], a[84:87], v[188:191]
    ds_read_b64_tr_b16 a[22:23], v9 offset:61440
    s_waitcnt vmcnt(18) lgkmcnt(8)
    v_mfma_f32_16x16x32_bf16 v[128:131], a[0:3], a[32:35], v[128:131]
    ds_read_b64_tr_b16 a[24:25], v10 offset:57344
    buffer_load_dwordx4 a[80:83], v253, s[28:31], s56 offen sc1
    v_mfma_f32_16x16x32_bf16 v[132:135], a[0:3], a[36:39], v[132:135]
    ds_read_b64_tr_b16 a[26:27], v10 offset:61440
    buffer_load_dwordx4 a[84:87], v253, s[28:31], s56 offen offset:256 sc1
    v_mfma_f32_16x16x32_bf16 v[136:139], a[4:7], a[32:35], v[136:139]
    ds_read_b64_tr_b16 a[28:29], v11 offset:57344
    s_add_u32 s56, s56, 16384
    v_mfma_f32_16x16x32_bf16 v[140:143], a[4:7], a[36:39], v[140:143]
    ds_read_b64_tr_b16 a[30:31], v11 offset:61440
    s_waitcnt lgkmcnt(8)
    v_mfma_f32_16x16x32_bf16 v[144:147], a[8:11], a[32:35], v[144:147]
    s_waitcnt vmcnt(37)
    s_barrier
    v_add_u32 v4, 65536, v4
    v_add_u32 v5, 65536, v5
    v_add_u32 v6, 65536, v6
    v_add_u32 v7, 65536, v7
    v_add_u32 v8, 65536, v8
    v_add_u32 v9, 65536, v9
    v_add_u32 v10, 65536, v10
    v_add_u32 v11, 65536, v11
    ds_read_b64_tr_b16 a[0:1], v4 offset:0
    s_lshl_b32 s85, s85, 2
    v_mfma_f32_16x16x32_bf16 v[148:151], a[8:11], a[36:39], v[148:151]
    ds_read_b64_tr_b16 a[2:3], v4 offset:4096
    s_add_u32 s84, s84, s85
    v_mfma_f32_16x16x32_bf16 v[152:155], a[12:15], a[32:35], v[152:155]
    ds_read_b64_tr_b16 a[4:5], v5 offset:0
    s_cmp_ge_u32 s84, 20
    v_mfma_f32_16x16x32_bf16 v[156:159], a[12:15], a[36:39], v[156:159]
    ds_read_b64_tr_b16 a[6:7], v5 offset:4096
    s_waitcnt lgkmcnt(8)
    v_mfma_f32_16x16x32_bf16 v[160:163], a[16:19], a[32:35], v[160:163]
    ds_read_b64_tr_b16 a[8:9], v6 offset:0
    s_cselect_b32 s85, 60, 0
    v_mfma_f32_16x16x32_bf16 v[164:167], a[16:19], a[36:39], v[164:167]
    ds_read_b64_tr_b16 a[10:11], v6 offset:4096
    s_add_u32 s84, s84, s85
    v_mfma_f32_16x16x32_bf16 v[168:171], a[20:23], a[32:35], v[168:171]
    ds_read_b64_tr_b16 a[12:13], v7 offset:0
    s_mul_i32 s82, s82, 160
    v_mfma_f32_16x16x32_bf16 v[172:175], a[20:23], a[36:39], v[172:175]
    ds_read_b64_tr_b16 a[14:15], v7 offset:4096
    s_waitcnt lgkmcnt(8)
    v_mfma_f32_16x16x32_bf16 v[176:179], a[24:27], a[32:35], v[176:179]
    ds_read_b64_tr_b16 a[16:17], v8 offset:0
    s_add_u32 s82, s82, s84
    v_mfma_f32_16x16x32_bf16 v[180:183], a[24:27], a[36:39], v[180:183]
    ds_read_b64_tr_b16 a[18:19], v8 offset:4096
    s_mul_i32 s82, s82, 1280
    v_mfma_f32_16x16x32_bf16 v[184:187], a[28:31], a[32:35], v[184:187]
    ds_read_b64_tr_b16 a[20:21], v9 offset:0
    s_add_u32 s55, s82, s78
    v_mfma_f32_16x16x32_bf16 v[188:191], a[28:31], a[36:39], v[188:191]
    ds_read_b64_tr_b16 a[22:23], v9 offset:4096
    s_waitcnt vmcnt(18) lgkmcnt(8)
    v_mfma_f32_16x16x32_bf16 v[128:131], a[0:3], a[40:43], v[128:131]
    ds_read_b64_tr_b16 a[24:25], v10 offset:0
    buffer_load_dwordx4 a[32:35], v19, s[28:31], s56 offen sc1
    v_mfma_f32_16x16x32_bf16 v[132:135], a[0:3], a[44:47], v[132:135]
    ds_read_b64_tr_b16 a[26:27], v10 offset:4096
    buffer_load_dwordx4 a[36:39], v19, s[28:31], s56 offen offset:256 sc1
    v_mfma_f32_16x16x32_bf16 v[136:139], a[4:7], a[40:43], v[136:139]
    ds_read_b64_tr_b16 a[28:29], v11 offset:0
    s_add_u32 m0, s53, 114688
    v_mfma_f32_16x16x32_bf16 v[140:143], a[4:7], a[44:47], v[140:143]
    ds_read_b64_tr_b16 a[30:31], v11 offset:4096
    s_waitcnt lgkmcnt(8)
    v_mfma_f32_16x16x32_bf16 v[144:147], a[8:11], a[40:43], v[144:147]
    ds_read_b64_tr_b16 a[0:1], v4 offset:8192
    buffer_load_dwordx4 v14, s[32:35], s55 offen offset:0 lds
    v_mfma_f32_16x16x32_bf16 v[148:151], a[8:11], a[44:47], v[148:151]
    ds_read_b64_tr_b16 a[2:3], v4 offset:12288
    buffer_load_dwordx4 v15, s[32:35], s55 offen offset:1024 lds
    v_mfma_f32_16x16x32_bf16 v[152:155], a[12:15], a[40:43], v[152:155]
    ds_read_b64_tr_b16 a[4:5], v5 offset:8192
    buffer_load_dwordx4 v16, s[32:35], s55 offen offset:2048 lds
    v_mfma_f32_16x16x32_bf16 v[156:159], a[12:15], a[44:47], v[156:159]
    ds_read_b64_tr_b16 a[6:7], v5 offset:12288
    s_waitcnt lgkmcnt(8)
    v_mfma_f32_16x16x32_bf16 v[160:163], a[16:19], a[40:43], v[160:163]
    ds_read_b64_tr_b16 a[8:9], v6 offset:8192
    buffer_load_dwordx4 v17, s[32:35], s55 offen offset:3072 lds
    v_mfma_f32_16x16x32_bf16 v[164:167], a[16:19], a[44:47], v[164:167]
    ds_read_b64_tr_b16 a[10:11], v6 offset:12288
    s_add_u32 s55, s50, 8
    v_mfma_f32_16x16x32_bf16 v[168:171], a[20:23], a[40:43], v[168:171]
    ds_read_b64_tr_b16 a[12:13], v7 offset:8192
    s_cmp_ge_u32 s55, 10
    v_mfma_f32_16x16x32_bf16 v[172:175], a[20:23], a[44:47], v[172:175]
    ds_read_b64_tr_b16 a[14:15], v7 offset:12288
    s_waitcnt lgkmcnt(8)
    v_mfma_f32_16x16x32_bf16 v[176:179], a[24:27], a[40:43], v[176:179]
    ds_read_b64_tr_b16 a[16:17], v8 offset:8192
    s_cselect_b32 s82, 10, 0
    v_mfma_f32_16x16x32_bf16 v[180:183], a[24:27], a[44:47], v[180:183]
    ds_read_b64_tr_b16 a[18:19], v8 offset:12288
    s_sub_u32 s55, s55, s82
    v_mfma_f32_16x16x32_bf16 v[184:187], a[28:31], a[40:43], v[184:187]
    ds_read_b64_tr_b16 a[20:21], v9 offset:8192
    s_lshl_b32 s55, s55, 1
    v_mfma_f32_16x16x32_bf16 v[188:191], a[28:31], a[44:47], v[188:191]
    ds_read_b64_tr_b16 a[22:23], v9 offset:12288
    s_waitcnt vmcnt(18) lgkmcnt(8)
    v_mfma_f32_16x16x32_bf16 v[128:131], a[0:3], a[48:51], v[128:131]
    ds_read_b64_tr_b16 a[24:25], v10 offset:8192
    buffer_load_dwordx4 a[40:43], v253, s[28:31], s56 offen sc1
    v_mfma_f32_16x16x32_bf16 v[132:135], a[0:3], a[52:55], v[132:135]
    ds_read_b64_tr_b16 a[26:27], v10 offset:12288
    buffer_load_dwordx4 a[44:47], v253, s[28:31], s56 offen offset:256 sc1
    v_mfma_f32_16x16x32_bf16 v[136:139], a[4:7], a[48:51], v[136:139]
    ds_read_b64_tr_b16 a[28:29], v11 offset:8192
    s_add_u32 s56, s56, 16384
    v_mfma_f32_16x16x32_bf16 v[140:143], a[4:7], a[52:55], v[140:143]
    ds_read_b64_tr_b16 a[30:31], v11 offset:12288
    s_waitcnt lgkmcnt(8)
    v_mfma_f32_16x16x32_bf16 v[144:147], a[8:11], a[48:51], v[144:147]
    s_waitcnt vmcnt(22)
    s_barrier
    ds_read_b64_tr_b16 a[0:1], v4 offset:16384
    s_lshr_b32 s82, s41, 1
    v_mfma_f32_16x16x32_bf16 v[148:151], a[8:11], a[52:55], v[148:151]
    ds_read_b64_tr_b16 a[2:3], v4 offset:20480
    s_add_u32 s55, s55, s82
    v_mfma_f32_16x16x32_bf16 v[152:155], a[12:15], a[48:51], v[152:155]
    ds_read_b64_tr_b16 a[4:5], v5 offset:16384
    s_mul_i32 s82, s55, 13
    v_mfma_f32_16x16x32_bf16 v[156:159], a[12:15], a[52:55], v[156:159]
    ds_read_b64_tr_b16 a[6:7], v5 offset:20480
    s_waitcnt lgkmcnt(8)
    v_mfma_f32_16x16x32_bf16 v[160:163], a[16:19], a[48:51], v[160:163]
    ds_read_b64_tr_b16 a[8:9], v6 offset:16384
    s_lshr_b32 s82, s82, 6
    v_mfma_f32_16x16x32_bf16 v[164:167], a[16:19], a[52:55], v[164:167]
    ds_read_b64_tr_b16 a[10:11], v6 offset:20480
    s_mul_i32 s84, s82, 5
    v_mfma_f32_16x16x32_bf16 v[168:171], a[20:23], a[48:51], v[168:171]
    ds_read_b64_tr_b16 a[12:13], v7 offset:16384
    s_sub_u32 s84, s55, s84
    v_mfma_f32_16x16x32_bf16 v[172:175], a[20:23], a[52:55], v[172:175]
    ds_read_b64_tr_b16 a[14:15], v7 offset:20480
    s_waitcnt lgkmcnt(8)
    v_mfma_f32_16x16x32_bf16 v[176:179], a[24:27], a[48:51], v[176:179]
    ds_read_b64_tr_b16 a[16:17], v8 offset:16384
    s_lshl_b32 s84, s84, 3
    v_mfma_f32_16x16x32_bf16 v[180:183], a[24:27], a[52:55], v[180:183]
    ds_read_b64_tr_b16 a[18:19], v8 offset:20480
    s_and_b32 s85, s41, 1
    v_mfma_f32_16x16x32_bf16 v[184:187], a[28:31], a[48:51], v[184:187]
    ds_read_b64_tr_b16 a[20:21], v9 offset:16384
    s_lshl_b32 s85, s85, 2
    v_mfma_f32_16x16x32_bf16 v[188:191], a[28:31], a[52:55], v[188:191]
    ds_read_b64_tr_b16 a[22:23], v9 offset:20480
    s_waitcnt vmcnt(18) lgkmcnt(8)
    v_mfma_f32_16x16x32_bf16 v[128:131], a[0:3], a[56:59], v[128:131]
    ds_read_b64_tr_b16 a[24:25], v10 offset:16384
    buffer_load_dwordx4 a[48:51], v19, s[28:31], s56 offen sc1
    v_mfma_f32_16x16x32_bf16 v[132:135], a[0:3], a[60:63], v[132:135]
    ds_read_b64_tr_b16 a[26:27], v10 offset:20480
    buffer_load_dwordx4 a[52:55], v19, s[28:31], s56 offen offset:256 sc1
    v_mfma_f32_16x16x32_bf16 v[136:139], a[4:7], a[56:59], v[136:139]
    ds_read_b64_tr_b16 a[28:29], v11 offset:16384
    s_add_u32 s84, s84, s85
    v_mfma_f32_16x16x32_bf16 v[140:143], a[4:7], a[60:63], v[140:143]
    ds_read_b64_tr_b16 a[30:31], v11 offset:20480
    s_waitcnt lgkmcnt(8)
    v_mfma_f32_16x16x32_bf16 v[144:147], a[8:11], a[56:59], v[144:147]
    ds_read_b64_tr_b16 a[0:1], v4 offset:24576
    s_cmp_ge_u32 s84, 20
    v_mfma_f32_16x16x32_bf16 v[148:151], a[8:11], a[60:63], v[148:151]
    ds_read_b64_tr_b16 a[2:3], v4 offset:28672
    s_cselect_b32 s85, 60, 0
    v_mfma_f32_16x16x32_bf16 v[152:155], a[12:15], a[56:59], v[152:155]
    ds_read_b64_tr_b16 a[4:5], v5 offset:24576
    s_add_u32 s84, s84, s85
    v_mfma_f32_16x16x32_bf16 v[156:159], a[12:15], a[60:63], v[156:159]
    ds_read_b64_tr_b16 a[6:7], v5 offset:28672
    s_waitcnt lgkmcnt(8)
    v_mfma_f32_16x16x32_bf16 v[160:163], a[16:19], a[56:59], v[160:163]
    ds_read_b64_tr_b16 a[8:9], v6 offset:24576
    s_mul_i32 s82, s82, 160
    v_mfma_f32_16x16x32_bf16 v[164:167], a[16:19], a[60:63], v[164:167]
    ds_read_b64_tr_b16 a[10:11], v6 offset:28672
    s_add_u32 s82, s82, s84
    v_mfma_f32_16x16x32_bf16 v[168:171], a[20:23], a[56:59], v[168:171]
    ds_read_b64_tr_b16 a[12:13], v7 offset:24576
    s_mul_i32 s82, s82, 1280
    v_mfma_f32_16x16x32_bf16 v[172:175], a[20:23], a[60:63], v[172:175]
    ds_read_b64_tr_b16 a[14:15], v7 offset:28672
    s_waitcnt lgkmcnt(8)
    v_mfma_f32_16x16x32_bf16 v[176:179], a[24:27], a[56:59], v[176:179]
    ds_read_b64_tr_b16 a[16:17], v8 offset:24576
    s_add_u32 s55, s82, s78
    v_mfma_f32_16x16x32_bf16 v[180:183], a[24:27], a[60:63], v[180:183]
    ds_read_b64_tr_b16 a[18:19], v8 offset:28672
    s_add_u32 m0, s53, 131072
    v_mfma_f32_16x16x32_bf16 v[184:187], a[28:31], a[56:59], v[184:187]
    ds_read_b64_tr_b16 a[20:21], v9 offset:24576
    buffer_load_dwordx4 v14, s[32:35], s55 offen offset:0 lds
    v_mfma_f32_16x16x32_bf16 v[188:191], a[28:31], a[60:63], v[188:191]
    ds_read_b64_tr_b16 a[22:23], v9 offset:28672
    s_waitcnt vmcnt(19) lgkmcnt(8)
    v_mfma_f32_16x16x32_bf16 v[128:131], a[0:3], a[64:67], v[128:131]
    ds_read_b64_tr_b16 a[24:25], v10 offset:24576
    buffer_load_dwordx4 a[56:59], v253, s[28:31], s56 offen sc1
    v_mfma_f32_16x16x32_bf16 v[132:135], a[0:3], a[68:71], v[132:135]
    ds_read_b64_tr_b16 a[26:27], v10 offset:28672
    buffer_load_dwordx4 a[60:63], v253, s[28:31], s56 offen offset:256 sc1
    v_mfma_f32_16x16x32_bf16 v[136:139], a[4:7], a[64:67], v[136:139]
    ds_read_b64_tr_b16 a[28:29], v11 offset:24576
    s_add_u32 s56, s56, 16384
    v_mfma_f32_16x16x32_bf16 v[140:143], a[4:7], a[68:71], v[140:143]
    ds_read_b64_tr_b16 a[30:31], v11 offset:28672
    s_waitcnt lgkmcnt(8)
    v_mfma_f32_16x16x32_bf16 v[144:147], a[8:11], a[64:67], v[144:147]
    s_waitcnt vmcnt(17)
    s_barrier
    ds_read_b64_tr_b16 a[0:1], v4 offset:32768
    buffer_load_dwordx4 v15, s[32:35], s55 offen offset:1024 lds
    v_mfma_f32_16x16x32_bf16 v[148:151], a[8:11], a[68:71], v[148:151]
    ds_read_b64_tr_b16 a[2:3], v4 offset:36864
    buffer_load_dwordx4 v16, s[32:35], s55 offen offset:2048 lds
    v_mfma_f32_16x16x32_bf16 v[152:155], a[12:15], a[64:67], v[152:155]
    ds_read_b64_tr_b16 a[4:5], v5 offset:32768
    buffer_load_dwordx4 v17, s[32:35], s55 offen offset:3072 lds
    v_mfma_f32_16x16x32_bf16 v[156:159], a[12:15], a[68:71], v[156:159]
    ds_read_b64_tr_b16 a[6:7], v5 offset:36864
    s_waitcnt lgkmcnt(8)
    v_mfma_f32_16x16x32_bf16 v[160:163], a[16:19], a[64:67], v[160:163]
    ds_read_b64_tr_b16 a[8:9], v6 offset:32768
    s_add_u32 s55, s50, 9
    v_mfma_f32_16x16x32_bf16 v[164:167], a[16:19], a[68:71], v[164:167]
    ds_read_b64_tr_b16 a[10:11], v6 offset:36864
    s_cmp_ge_u32 s55, 10
    v_mfma_f32_16x16x32_bf16 v[168:171], a[20:23], a[64:67], v[168:171]
    ds_read_b64_tr_b16 a[12:13], v7 offset:32768
    s_cselect_b32 s82, 10, 0
    v_mfma_f32_16x16x32_bf16 v[172:175], a[20:23], a[68:71], v[172:175]
    ds_read_b64_tr_b16 a[14:15], v7 offset:36864
    s_waitcnt lgkmcnt(8)
    v_mfma_f32_16x16x32_bf16 v[176:179], a[24:27], a[64:67], v[176:179]
    ds_read_b64_tr_b16 a[16:17], v8 offset:32768
    s_sub_u32 s55, s55, s82
    v_mfma_f32_16x16x32_bf16 v[180:183], a[24:27], a[68:71], v[180:183]
    ds_read_b64_tr_b16 a[18:19], v8 offset:36864
    s_lshl_b32 s55, s55, 1
    v_mfma_f32_16x16x32_bf16 v[184:187], a[28:31], a[64:67], v[184:187]
    ds_read_b64_tr_b16 a[20:21], v9 offset:32768
    s_lshr_b32 s82, s41, 1
    v_mfma_f32_16x16x32_bf16 v[188:191], a[28:31], a[68:71], v[188:191]
    ds_read_b64_tr_b16 a[22:23], v9 offset:36864
    s_waitcnt vmcnt(18) lgkmcnt(8)
    v_mfma_f32_16x16x32_bf16 v[128:131], a[0:3], a[72:75], v[128:131]
    ds_read_b64_tr_b16 a[24:25], v10 offset:32768
    buffer_load_dwordx4 a[64:67], v19, s[28:31], s56 offen sc1
    v_mfma_f32_16x16x32_bf16 v[132:135], a[0:3], a[76:79], v[132:135]
    ds_read_b64_tr_b16 a[26:27], v10 offset:36864
    buffer_load_dwordx4 a[68:71], v19, s[28:31], s56 offen offset:256 sc1
    v_mfma_f32_16x16x32_bf16 v[136:139], a[4:7], a[72:75], v[136:139]
    ds_read_b64_tr_b16 a[28:29], v11 offset:32768
    s_add_u32 s55, s55, s82
    v_mfma_f32_16x16x32_bf16 v[140:143], a[4:7], a[76:79], v[140:143]
    ds_read_b64_tr_b16 a[30:31], v11 offset:36864
    s_waitcnt lgkmcnt(8)
    v_mfma_f32_16x16x32_bf16 v[144:147], a[8:11], a[72:75], v[144:147]
    ds_read_b64_tr_b16 a[0:1], v4 offset:40960
    s_mul_i32 s82, s55, 13
    v_mfma_f32_16x16x32_bf16 v[148:151], a[8:11], a[76:79], v[148:151]
    ds_read_b64_tr_b16 a[2:3], v4 offset:45056
    s_lshr_b32 s82, s82, 6
    v_mfma_f32_16x16x32_bf16 v[152:155], a[12:15], a[72:75], v[152:155]
    ds_read_b64_tr_b16 a[4:5], v5 offset:40960
    s_mul_i32 s84, s82, 5
    v_mfma_f32_16x16x32_bf16 v[156:159], a[12:15], a[76:79], v[156:159]
    ds_read_b64_tr_b16 a[6:7], v5 offset:45056
    s_waitcnt lgkmcnt(8)
    v_mfma_f32_16x16x32_bf16 v[160:163], a[16:19], a[72:75], v[160:163]
    ds_read_b64_tr_b16 a[8:9], v6 offset:40960
    s_sub_u32 s84, s55, s84
    v_mfma_f32_16x16x32_bf16 v[164:167], a[16:19], a[76:79], v[164:167]
    ds_read_b64_tr_b16 a[10:11], v6 offset:45056
    s_lshl_b32 s84, s84, 3
    v_mfma_f32_16x16x32_bf16 v[168:171], a[20:23], a[72:75], v[168:171]
    ds_read_b64_tr_b16 a[12:13], v7 offset:40960
    s_and_b32 s85, s41, 1
    v_mfma_f32_16x16x32_bf16 v[172:175], a[20:23], a[76:79], v[172:175]
    ds_read_b64_tr_b16 a[14:15], v7 offset:45056
    s_waitcnt lgkmcnt(8)
    v_mfma_f32_16x16x32_bf16 v[176:179], a[24:27], a[72:75], v[176:179]
    ds_read_b64_tr_b16 a[16:17], v8 offset:40960
    s_lshl_b32 s85, s85, 2
    v_mfma_f32_16x16x32_bf16 v[180:183], a[24:27], a[76:79], v[180:183]
    ds_read_b64_tr_b16 a[18:19], v8 offset:45056
    s_add_u32 s84, s84, s85
    v_mfma_f32_16x16x32_bf16 v[184:187], a[28:31], a[72:75], v[184:187]
    ds_read_b64_tr_b16 a[20:21], v9 offset:40960
    s_cmp_ge_u32 s84, 20
    v_mfma_f32_16x16x32_bf16 v[188:191], a[28:31], a[76:79], v[188:191]
    ds_read_b64_tr_b16 a[22:23], v9 offset:45056
    s_waitcnt vmcnt(18) lgkmcnt(8)
    v_mfma_f32_16x16x32_bf16 v[128:131], a[0:3], a[80:83], v[128:131]
    ds_read_b64_tr_b16 a[24:25], v10 offset:40960
    s_cselect_b32 s85, 60, 0
    v_mfma_f32_16x16x32_bf16 v[132:135], a[0:3], a[84:87], v[132:135]
    ds_read_b64_tr_b16 a[26:27], v10 offset:45056
    buffer_load_dwordx4 a[72:75], v253, s[28:31], s56 offen sc1
    v_mfma_f32_16x16x32_bf16 v[136:139], a[4:7], a[80:83], v[136:139]
    ds_read_b64_tr_b16 a[28:29], v11 offset:40960
    buffer_load_dwordx4 a[76:79], v253, s[28:31], s56 offen offset:256 sc1
    v_mfma_f32_16x16x32_bf16 v[140:143], a[4:7], a[84:87], v[140:143]
    ds_read_b64_tr_b16 a[30:31], v11 offset:45056
    s_waitcnt lgkmcnt(8)
    v_mfma_f32_16x16x32_bf16 v[144:147], a[8:11], a[80:83], v[144:147]
    s_waitcnt vmcnt(14)
    s_barrier
    ds_read_b64_tr_b16 a[0:1], v4 offset:49152
    s_add_u32 s84, s84, s85
    v_mfma_f32_16x16x32_bf16 v[148:151], a[8:11], a[84:87], v[148:151]
    ds_read_b64_tr_b16 a[2:3], v4 offset:53248
    s_mul_i32 s82, s82, 160
    v_mfma_f32_16x16x32_bf16 v[152:155], a[12:15], a[80:83], v[152:155]
    ds_read_b64_tr_b16 a[4:5], v5 offset:49152
    s_add_u32 s82, s82, s84
    v_mfma_f32_16x16x32_bf16 v[156:159], a[12:15], a[84:87], v[156:159]
    ds_read_b64_tr_b16 a[6:7], v5 offset:53248
    s_waitcnt lgkmcnt(8)
    v_mfma_f32_16x16x32_bf16 v[160:163], a[16:19], a[80:83], v[160:163]
    ds_read_b64_tr_b16 a[8:9], v6 offset:49152
    s_mul_i32 s82, s82, 1280
    v_mfma_f32_16x16x32_bf16 v[164:167], a[16:19], a[84:87], v[164:167]
    ds_read_b64_tr_b16 a[10:11], v6 offset:53248
    s_add_u32 s55, s82, s78
    v_mfma_f32_16x16x32_bf16 v[168:171], a[20:23], a[80:83], v[168:171]
    ds_read_b64_tr_b16 a[12:13], v7 offset:49152
    s_add_u32 m0, s53, 0
    v_mfma_f32_16x16x32_bf16 v[172:175], a[20:23], a[84:87], v[172:175]
    ds_read_b64_tr_b16 a[14:15], v7 offset:53248
    s_waitcnt lgkmcnt(8)
    v_mfma_f32_16x16x32_bf16 v[176:179], a[24:27], a[80:83], v[176:179]
    ds_read_b64_tr_b16 a[16:17], v8 offset:49152
    buffer_load_dwordx4 v14, s[32:35], s55 offen offset:0 lds
    v_mfma_f32_16x16x32_bf16 v[180:183], a[24:27], a[84:87], v[180:183]
    ds_read_b64_tr_b16 a[18:19], v8 offset:53248
    buffer_load_dwordx4 v15, s[32:35], s55 offen offset:1024 lds
    v_mfma_f32_16x16x32_bf16 v[184:187], a[28:31], a[80:83], v[184:187]
    ds_read_b64_tr_b16 a[20:21], v9 offset:49152
    buffer_load_dwordx4 v16, s[32:35], s55 offen offset:2048 lds
    v_mfma_f32_16x16x32_bf16 v[188:191], a[28:31], a[84:87], v[188:191]
    ds_read_b64_tr_b16 a[22:23], v9 offset:53248
    s_waitcnt vmcnt(21) lgkmcnt(8)
    buffer_load_dwordx4 v17, s[32:35], s55 offen offset:3072 lds
    s_mov_b32 s32, s20
    s_mov_b32 s33, s21
    s_mov_b32 s34, 2211840
    s_mov_b32 s35, 0x20000
    s_lshl_b32 s82, s41, 4
    s_add_u32 s82, s82, 1664
    s_mul_i32 s82, s82, 1280
    s_add_u32 s51, s82, s78
    v_subrev_u32 v15, 20480, v15
    v_subrev_u32 v16, 40960, v16
    v_subrev_u32 v17, 61440, v17
    s_mul_i32 s55, s71, 81920
    s_add_u32 s55, s55, s51
    s_mov_b32 s90, 81920
    s_add_u32 s90, s90, s51
    s_add_u32 m0, s53, 16384
    s_nop 0
    buffer_load_dwordx4 v14, s[32:35], s55 offen offset:0 lds
    buffer_load_dwordx4 v15, s[32:35], s55 offen offset:1024 lds
    buffer_load_dwordx4 v16, s[32:35], s55 offen offset:2048 lds
    buffer_load_dwordx4 v17, s[32:35], s55 offen offset:3072 lds
    s_mul_i32 s44, s42, 16
    s_lshl_b32 s44, s44, 7
    s_add_u32 s44, s44, 27361280
    v_lshlrev_b32 v22, 7, v1
    v_add_u32 v22, s44, v22
    s_cmp_lg_u32 s41, 0
    s_cbranch_scc1 L_pskip_28
    s_mov_b32 exec_lo, 32768
    s_mov_b32 exec_hi, 0
    s_mov_b32 s57, 200000
L_poll_26:
    buffer_load_dword v63, v22, s[28:31], 0 offen sc1
    s_waitcnt vmcnt(0)
    v_cmp_ne_u32 vcc, s40, v63
    s_nop 1
    s_cbranch_vccz L_pdone_27
    s_sub_u32 s57, s57, 1
    s_cmp_lg_u32 s57, 0
    s_cbranch_scc1 L_poll_26
L_pdone_27:
    s_mov_b64 exec, -1
L_pskip_28:
    s_barrier
    s_mul_i32 s54, s42, 442368
    s_add_u32 s54, s54, 13336576
    v_mfma_f32_16x16x32_bf16 v[128:131], a[0:3], a[32:35], v[128:131]
    ds_read_b64_tr_b16 a[24:25], v10 offset:49152
    s_lshl_b32 s56, s71, 14
    v_mfma_f32_16x16x32_bf16 v[132:135], a[0:3], a[36:39], v[132:135]
    ds_read_b64_tr_b16 a[26:27], v10 offset:53248
    s_add_u32 s56, s56, s54
    v_mfma_f32_16x16x32_bf16 v[136:139], a[4:7], a[32:35], v[136:139]
    ds_read_b64_tr_b16 a[28:29], v11 offset:49152
    s_add_u32 s89, s54, 16384
    v_mfma_f32_16x16x32_bf16 v[140:143], a[4:7], a[36:39], v[140:143]
    ds_read_b64_tr_b16 a[30:31], v11 offset:53248
    s_waitcnt lgkmcnt(8)
    v_mfma_f32_16x16x32_bf16 v[144:147], a[8:11], a[32:35], v[144:147]
    ds_read_b64_tr_b16 a[0:1], v4 offset:57344
    v_add_u32 v253, 8192, v19
    v_mfma_f32_16x16x32_bf16 v[148:151], a[8:11], a[36:39], v[148:151]
    ds_read_b64_tr_b16 a[2:3], v4 offset:61440
    buffer_load_dwordx4 a[80:83], v19, s[28:31], s56 offen sc1
    v_mfma_f32_16x16x32_bf16 v[152:155], a[12:15], a[32:35], v[152:155]
    ds_read_b64_tr_b16 a[4:5], v5 offset:57344
    buffer_load_dwordx4 a[84:87], v19, s[28:31], s56 offen offset:256 sc1
    v_mfma_f32_16x16x32_bf16 v[156:159], a[12:15], a[36:39], v[156:159]
    ds_read_b64_tr_b16 a[6:7], v5 offset:61440
    s_waitcnt lgkmcnt(8)
    v_mfma_f32_16x16x32_bf16 v[160:163], a[16:19], a[32:35], v[160:163]
    ds_read_b64_tr_b16 a[8:9], v6 offset:57344
    v_mfma_f32_16x16x32_bf16 v[164:167], a[16:19], a[36:39], v[164:167]
    ds_read_b64_tr_b16 a[10:11], v6 offset:61440
    v_mfma_f32_16x16x32_bf16 v[168:171], a[20:23], a[32:35], v[168:171]
    ds_read_b64_tr_b16 a[12:13], v7 offset:57344
    v_mfma_f32_16x16x32_bf16 v[172:175], a[20:23], a[36:39], v[172:175]
    ds_read_b64_tr_b16 a[14:15], v7 offset:61440
    s_waitcnt lgkmcnt(8)
    v_mfma_f32_16x16x32_bf16 v[176:179], a[24:27], a[32:35], v[176:179]
    ds_read_b64_tr_b16 a[16:17], v8 offset:57344
    v_mfma_f32_16x16x32_bf16 v[180:183], a[24:27], a[36:39], v[180:183]
    ds_read_b64_tr_b16 a[18:19], v8 offset:61440
    v_mfma_f32_16x16x32_bf16 v[184:187], a[28:31], a[32:35], v[184:187]
    ds_read_b64_tr_b16 a[20:21], v9 offset:57344
    v_mfma_f32_16x16x32_bf16 v[188:191], a[28:31], a[36:39], v[188:191]
    ds_read_b64_tr_b16 a[22:23], v9 offset:61440
    s_waitcnt vmcnt(22) lgkmcnt(8)
    v_mfma_f32_16x16x32_bf16 v[128:131], a[0:3], a[40:43], v[128:131]
    ds_read_b64_tr_b16 a[24:25], v10 offset:57344
    buffer_load_dwordx4 a[32:35], v253, s[28:31], s56 offen sc1
    v_mfma_f32_16x16x32_bf16 v[132:135], a[0:3], a[44:47], v[132:135]
    ds_read_b64_tr_b16 a[26:27], v10 offset:61440
    buffer_load_dwordx4 a[36:39], v253, s[28:31], s56 offen offset:256 sc1
    v_mfma_f32_16x16x32_bf16 v[136:139], a[4:7], a[40:43], v[136:139]
    ds_read_b64_tr_b16 a[28:29], v11 offset:57344
    v_mfma_f32_16x16x32_bf16 v[140:143], a[4:7], a[44:47], v[140:143]
    ds_read_b64_tr_b16 a[30:31], v11 offset:61440
    s_waitcnt lgkmcnt(8)
    v_mfma_f32_16x16x32_bf16 v[144:147], a[8:11], a[40:43], v[144:147]
    s_waitcnt vmcnt(16)
    s_barrier
    v_add_u32 v4, 65536, v4
    v_add_u32 v5, 65536, v5
    v_add_u32 v6, 65536, v6
    v_add_u32 v7, 65536, v7
    v_add_u32 v8, 65536, v8
    v_add_u32 v9, 65536, v9
    v_add_u32 v10, 65536, v10
    v_add_u32 v11, 65536, v11
    ds_read_b64_tr_b16 a[0:1], v4 offset:0
    v_mfma_f32_16x16x32_bf16 v[148:151], a[8:11], a[44:47], v[148:151]
    ds_read_b64_tr_b16 a[2:3], v4 offset:4096
    v_mfma_f32_16x16x32_bf16 v[152:155], a[12:15], a[40:43], v[152:155]
    ds_read_b64_tr_b16 a[4:5], v5 offset:0
    v_mfma_f32_16x16x32_bf16 v[156:159], a[12:15], a[44:47], v[156:159]
    ds_read_b64_tr_b16 a[6:7], v5 offset:4096
    s_waitcnt lgkmcnt(8)
    v_mfma_f32_16x16x32_bf16 v[160:163], a[16:19], a[40:43], v[160:163]
    ds_read_b64_tr_b16 a[8:9], v6 offset:0
    v_mfma_f32_16x16x32_bf16 v[164:167], a[16:19], a[44:47], v[164:167]
    ds_read_b64_tr_b16 a[10:11], v6 offset:4096
    v_mfma_f32_16x16x32_bf16 v[168:171], a[20:23], a[40:43], v[168:171]
    ds_read_b64_tr_b16 a[12:13], v7 offset:0
    v_mfma_f32_16x16x32_bf16 v[172:175], a[20:23], a[44:47], v[172:175]
    ds_read_b64_tr_b16 a[14:15], v7 offset:4096
    s_waitcnt lgkmcnt(8)
    v_mfma_f32_16x16x32_bf16 v[176:179], a[24:27], a[40:43], v[176:179]
    ds_read_b64_tr_b16 a[16:17], v8 offset:0
    v_mfma_f32_16x16x32_bf16 v[180:183], a[24:27], a[44:47], v[180:183]
    ds_read_b64_tr_b16 a[18:19], v8 offset:4096
    v_mfma_f32_16x16x32_bf16 v[184:187], a[28:31], a[40:43], v[184:187]
    ds_read_b64_tr_b16 a[20:21], v9 offset:0
    v_mfma_f32_16x16x32_bf16 v[188:191], a[28:31], a[44:47], v[188:191]
    ds_read_b64_tr_b16 a[22:23], v9 offset:4096
    s_waitcnt vmcnt(22) lgkmcnt(8)
    v_mfma_f32_16x16x32_bf16 v[128:131], a[0:3], a[48:51], v[128:131]
    ds_read_b64_tr_b16 a[24:25], v10 offset:0
    v_mfma_f32_16x16x32_bf16 v[132:135], a[0:3], a[52:55], v[132:135]
    ds_read_b64_tr_b16 a[26:27], v10 offset:4096
    v_mfma_f32_16x16x32_bf16 v[136:139], a[4:7], a[48:51], v[136:139]
    ds_read_b64_tr_b16 a[28:29], v11 offset:0
    v_mfma_f32_16x16x32_bf16 v[140:143], a[4:7], a[52:55], v[140:143]
    ds_read_b64_tr_b16 a[30:31], v11 offset:4096
    s_waitcnt lgkmcnt(8)
    v_mfma_f32_16x16x32_bf16 v[144:147], a[8:11], a[48:51], v[144:147]
    ds_read_b64_tr_b16 a[0:1], v4 offset:8192
    v_mfma_f32_16x16x32_bf16 v[148:151], a[8:11], a[52:55], v[148:151]
    ds_read_b64_tr_b16 a[2:3], v4 offset:12288
    v_mfma_f32_16x16x32_bf16 v[152:155], a[12:15], a[48:51], v[152:155]
    ds_read_b64_tr_b16 a[4:5], v5 offset:8192
    v_mfma_f32_16x16x32_bf16 v[156:159], a[12:15], a[52:55], v[156:159]
    ds_read_b64_tr_b16 a[6:7], v5 offset:12288
    s_waitcnt lgkmcnt(8)
    v_mfma_f32_16x16x32_bf16 v[160:163], a[16:19], a[48:51], v[160:163]
    ds_read_b64_tr_b16 a[8:9], v6 offset:8192
    v_mfma_f32_16x16x32_bf16 v[164:167], a[16:19], a[52:55], v[164:167]
    ds_read_b64_tr_b16 a[10:11], v6 offset:12288
    v_mfma_f32_16x16x32_bf16 v[168:171], a[20:23], a[48:51], v[168:171]
    ds_read_b64_tr_b16 a[12:13], v7 offset:8192
    v_mfma_f32_16x16x32_bf16 v[172:175], a[20:23], a[52:55], v[172:175]
    ds_read_b64_tr_b16 a[14:15], v7 offset:12288
    s_waitcnt lgkmcnt(8)
    v_mfma_f32_16x16x32_bf16 v[176:179], a[24:27], a[48:51], v[176:179]
    ds_read_b64_tr_b16 a[16:17], v8 offset:8192
    v_mfma_f32_16x16x32_bf16 v[180:183], a[24:27], a[52:55], v[180:183]
    ds_read_b64_tr_b16 a[18:19], v8 offset:12288
    v_mfma_f32_16x16x32_bf16 v[184:187], a[28:31], a[48:51], v[184:187]
    ds_read_b64_tr_b16 a[20:21], v9 offset:8192
    v_mfma_f32_16x16x32_bf16 v[188:191], a[28:31], a[52:55], v[188:191]
    ds_read_b64_tr_b16 a[22:23], v9 offset:12288
    s_waitcnt vmcnt(19) lgkmcnt(8)
    v_mfma_f32_16x16x32_bf16 v[128:131], a[0:3], a[56:59], v[128:131]
    ds_read_b64_tr_b16 a[24:25], v10 offset:8192
    v_mfma_f32_16x16x32_bf16 v[132:135], a[0:3], a[60:63], v[132:135]
    ds_read_b64_tr_b16 a[26:27], v10 offset:12288
    v_mfma_f32_16x16x32_bf16 v[136:139], a[4:7], a[56:59], v[136:139]
    ds_read_b64_tr_b16 a[28:29], v11 offset:8192
    v_mfma_f32_16x16x32_bf16 v[140:143], a[4:7], a[60:63], v[140:143]
    ds_read_b64_tr_b16 a[30:31], v11 offset:12288
    s_waitcnt lgkmcnt(8)
    v_mfma_f32_16x16x32_bf16 v[144:147], a[8:11], a[56:59], v[144:147]
    s_waitcnt vmcnt(8)
    s_barrier
    v_add_u32 v4, 4294836224, v4
    v_add_u32 v5, 4294836224, v5
    v_add_u32 v6, 4294836224, v6
    v_add_u32 v7, 4294836224, v7
    v_add_u32 v8, 4294836224, v8
    v_add_u32 v9, 4294836224, v9
    v_add_u32 v10, 4294836224, v10
    v_add_u32 v11, 4294836224, v11
    ds_read_b64_tr_b16 a[0:1], v4 offset:0
    v_mfma_f32_16x16x32_bf16 v[148:151], a[8:11], a[60:63], v[148:151]
    ds_read_b64_tr_b16 a[2:3], v4 offset:4096
    v_mfma_f32_16x16x32_bf16 v[152:155], a[12:15], a[56:59], v[152:155]
    ds_read_b64_tr_b16 a[4:5], v5 offset:0
    v_mfma_f32_16x16x32_bf16 v[156:159], a[12:15], a[60:63], v[156:159]
    ds_read_b64_tr_b16 a[6:7], v5 offset:4096
    s_waitcnt lgkmcnt(8)
    v_mfma_f32_16x16x32_bf16 v[160:163], a[16:19], a[56:59], v[160:163]
    ds_read_b64_tr_b16 a[8:9], v6 offset:0
    v_mfma_f32_16x16x32_bf16 v[164:167], a[16:19], a[60:63], v[164:167]
    ds_read_b64_tr_b16 a[10:11], v6 offset:4096
    v_mfma_f32_16x16x32_bf16 v[168:171], a[20:23], a[56:59], v[168:171]
    ds_read_b64_tr_b16 a[12:13], v7 offset:0
    v_mfma_f32_16x16x32_bf16 v[172:175], a[20:23], a[60:63], v[172:175]
    ds_read_b64_tr_b16 a[14:15], v7 offset:4096
    s_waitcnt lgkmcnt(8)
    v_mfma_f32_16x16x32_bf16 v[176:179], a[24:27], a[56:59], v[176:179]
    ds_read_b64_tr_b16 a[16:17], v8 offset:0
    v_mfma_f32_16x16x32_bf16 v[180:183], a[24:27], a[60:63], v[180:183]
    ds_read_b64_tr_b16 a[18:19], v8 offset:4096
    v_mfma_f32_16x16x32_bf16 v[184:187], a[28:31], a[56:59], v[184:187]
    ds_read_b64_tr_b16 a[20:21], v9 offset:0
    v_mfma_f32_16x16x32_bf16 v[188:191], a[28:31], a[60:63], v[188:191]
    ds_read_b64_tr_b16 a[22:23], v9 offset:4096
    s_waitcnt vmcnt(14) lgkmcnt(8)
    v_mfma_f32_16x16x32_bf16 v[128:131], a[0:3], a[64:67], v[128:131]
    ds_read_b64_tr_b16 a[24:25], v10 offset:0
    v_mfma_f32_16x16x32_bf16 v[132:135], a[0:3], a[68:71], v[132:135]
    ds_read_b64_tr_b16 a[26:27], v10 offset:4096
    v_mfma_f32_16x16x32_bf16 v[136:139], a[4:7], a[64:67], v[136:139]
    ds_read_b64_tr_b16 a[28:29], v11 offset:0
    v_mfma_f32_16x16x32_bf16 v[140:143], a[4:7], a[68:71], v[140:143]
    ds_read_b64_tr_b16 a[30:31], v11 offset:4096
    s_waitcnt lgkmcnt(8)
    v_mfma_f32_16x16x32_bf16 v[144:147], a[8:11], a[64:67], v[144:147]
    ds_read_b64_tr_b16 a[0:1], v4 offset:8192
    v_mfma_f32_16x16x32_bf16 v[148:151], a[8:11], a[68:71], v[148:151]
    ds_read_b64_tr_b16 a[2:3], v4 offset:12288
    v_mfma_f32_16x16x32_bf16 v[152:155], a[12:15], a[64:67], v[152:155]
    ds_read_b64_tr_b16 a[4:5], v5 offset:8192
    v_mfma_f32_16x16x32_bf16 v[156:159], a[12:15], a[68:71], v[156:159]
    ds_read_b64_tr_b16 a[6:7], v5 offset:12288
    s_waitcnt lgkmcnt(8)
    v_mfma_f32_16x16x32_bf16 v[160:163], a[16:19], a[64:67], v[160:163]
    ds_read_b64_tr_b16 a[8:9], v6 offset:8192
    v_mfma_f32_16x16x32_bf16 v[164:167], a[16:19], a[68:71], v[164:167]
    ds_read_b64_tr_b16 a[10:11], v6 offset:12288
    v_mfma_f32_16x16x32_bf16 v[168:171], a[20:23], a[64:67], v[168:171]
    ds_read_b64_tr_b16 a[12:13], v7 offset:8192
    v_mfma_f32_16x16x32_bf16 v[172:175], a[20:23], a[68:71], v[172:175]
    ds_read_b64_tr_b16 a[14:15], v7 offset:12288
    s_waitcnt lgkmcnt(8)
    v_mfma_f32_16x16x32_bf16 v[176:179], a[24:27], a[64:67], v[176:179]
    ds_read_b64_tr_b16 a[16:17], v8 offset:8192
    v_mfma_f32_16x16x32_bf16 v[180:183], a[24:27], a[68:71], v[180:183]
    ds_read_b64_tr_b16 a[18:19], v8 offset:12288
    v_mfma_f32_16x16x32_bf16 v[184:187], a[28:31], a[64:67], v[184:187]
    ds_read_b64_tr_b16 a[20:21], v9 offset:8192
    v_mfma_f32_16x16x32_bf16 v[188:191], a[28:31], a[68:71], v[188:191]
    ds_read_b64_tr_b16 a[22:23], v9 offset:12288
    s_waitcnt vmcnt(12) lgkmcnt(8)
    v_mfma_f32_16x16x32_bf16 v[128:131], a[0:3], a[72:75], v[128:131]
    ds_read_b64_tr_b16 a[24:25], v10 offset:8192
    v_mfma_f32_16x16x32_bf16 v[132:135], a[0:3], a[76:79], v[132:135]
    ds_read_b64_tr_b16 a[26:27], v10 offset:12288
    v_mfma_f32_16x16x32_bf16 v[136:139], a[4:7], a[72:75], v[136:139]
    ds_read_b64_tr_b16 a[28:29], v11 offset:8192
    v_mfma_f32_16x16x32_bf16 v[140:143], a[4:7], a[76:79], v[140:143]
    ds_read_b64_tr_b16 a[30:31], v11 offset:12288
    s_waitcnt lgkmcnt(8)
    v_mfma_f32_16x16x32_bf16 v[144:147], a[8:11], a[72:75], v[144:147]
    s_waitcnt vmcnt(4)
    s_barrier
    ds_read_b64_tr_b16 a[0:1], v4 offset:16384
    v_mfma_f32_16x16x32_bf16 v[148:151], a[8:11], a[76:79], v[148:151]
    ds_read_b64_tr_b16 a[2:3], v4 offset:20480
    v_mfma_f32_16x16x32_bf16 v[152:155], a[12:15], a[72:75], v[152:155]
    ds_read_b64_tr_b16 a[4:5], v5 offset:16384
    v_mfma_f32_16x16x32_bf16 v[156:159], a[12:15], a[76:79], v[156:159]
    ds_read_b64_tr_b16 a[6:7], v5 offset:20480
    s_waitcnt lgkmcnt(8)
    v_mfma_f32_16x16x32_bf16 v[160:163], a[16:19], a[72:75], v[160:163]
    ds_read_b64_tr_b16 a[8:9], v6 offset:16384
    v_mfma_f32_16x16x32_bf16 v[164:167], a[16:19], a[76:79], v[164:167]
    ds_read_b64_tr_b16 a[10:11], v6 offset:20480
    v_mfma_f32_16x16x32_bf16 v[168:171], a[20:23], a[72:75], v[168:171]
    ds_read_b64_tr_b16 a[12:13], v7 offset:16384
    v_mfma_f32_16x16x32_bf16 v[172:175], a[20:23], a[76:79], v[172:175]
    ds_read_b64_tr_b16 a[14:15], v7 offset:20480
    s_waitcnt lgkmcnt(8)
    v_mfma_f32_16x16x32_bf16 v[176:179], a[24:27], a[72:75], v[176:179]
    ds_read_b64_tr_b16 a[16:17], v8 offset:16384
    v_mfma_f32_16x16x32_bf16 v[180:183], a[24:27], a[76:79], v[180:183]
    ds_read_b64_tr_b16 a[18:19], v8 offset:20480
    v_mfma_f32_16x16x32_bf16 v[184:187], a[28:31], a[72:75], v[184:187]
    ds_read_b64_tr_b16 a[20:21], v9 offset:16384
    v_mfma_f32_16x16x32_bf16 v[188:191], a[28:31], a[76:79], v[188:191]
    ds_read_b64_tr_b16 a[22:23], v9 offset:20480
    s_waitcnt vmcnt(2) lgkmcnt(8)
    v_mfma_f32_16x16x32_bf16 v[128:131], a[0:3], a[80:83], v[128:131]
    ds_read_b64_tr_b16 a[24:25], v10 offset:16384
    v_mfma_f32_16x16x32_bf16 v[132:135], a[0:3], a[84:87], v[132:135]
    ds_read_b64_tr_b16 a[26:27], v10 offset:20480
    v_mfma_f32_16x16x32_bf16 v[136:139], a[4:7], a[80:83], v[136:139]
    ds_read_b64_tr_b16 a[28:29], v11 offset:16384
    v_mfma_f32_16x16x32_bf16 v[140:143], a[4:7], a[84:87], v[140:143]
    ds_read_b64_tr_b16 a[30:31], v11 offset:20480
    s_waitcnt lgkmcnt(8)
    v_mfma_f32_16x16x32_bf16 v[144:147], a[8:11], a[80:83], v[144:147]
    ds_read_b64_tr_b16 a[0:1], v4 offset:24576
    v_mfma_f32_16x16x32_bf16 v[148:151], a[8:11], a[84:87], v[148:151]
    ds_read_b64_tr_b16 a[2:3], v4 offset:28672
    v_mfma_f32_16x16x32_bf16 v[152:155], a[12:15], a[80:83], v[152:155]
    ds_read_b64_tr_b16 a[4:5], v5 offset:24576
    v_mfma_f32_16x16x32_bf16 v[156:159], a[12:15], a[84:87], v[156:159]
    ds_read_b64_tr_b16 a[6:7], v5 offset:28672
    s_waitcnt lgkmcnt(8)
    v_mfma_f32_16x16x32_bf16 v[160:163], a[16:19], a[80:83], v[160:163]
    ds_read_b64_tr_b16 a[8:9], v6 offset:24576
    v_mfma_f32_16x16x32_bf16 v[164:167], a[16:19], a[84:87], v[164:167]
    ds_read_b64_tr_b16 a[10:11], v6 offset:28672
    v_mfma_f32_16x16x32_bf16 v[168:171], a[20:23], a[80:83], v[168:171]
    ds_read_b64_tr_b16 a[12:13], v7 offset:24576
    v_mfma_f32_16x16x32_bf16 v[172:175], a[20:23], a[84:87], v[172:175]
    ds_read_b64_tr_b16 a[14:15], v7 offset:28672
    s_waitcnt lgkmcnt(8)
    v_mfma_f32_16x16x32_bf16 v[176:179], a[24:27], a[80:83], v[176:179]
    ds_read_b64_tr_b16 a[16:17], v8 offset:24576
    v_mfma_f32_16x16x32_bf16 v[180:183], a[24:27], a[84:87], v[180:183]
    ds_read_b64_tr_b16 a[18:19], v8 offset:28672
    v_mfma_f32_16x16x32_bf16 v[184:187], a[28:31], a[80:83], v[184:187]
    ds_read_b64_tr_b16 a[20:21], v9 offset:24576
    v_mfma_f32_16x16x32_bf16 v[188:191], a[28:31], a[84:87], v[188:191]
    ds_read_b64_tr_b16 a[22:23], v9 offset:28672
    s_waitcnt vmcnt(0) lgkmcnt(8)
    v_mfma_f32_16x16x32_bf16 v[128:131], a[0:3], a[32:35], v[128:131]
    ds_read_b64_tr_b16 a[24:25], v10 offset:24576
    v_mfma_f32_16x16x32_bf16 v[132:135], a[0:3], a[36:39], v[132:135]
    ds_read_b64_tr_b16 a[26:27], v10 offset:28672
    v_mfma_f32_16x16x32_bf16 v[136:139], a[4:7], a[32:35], v[136:139]
    ds_read_b64_tr_b16 a[28:29], v11 offset:24576
    v_mfma_f32_16x16x32_bf16 v[140:143], a[4:7], a[36:39], v[140:143]
    ds_read_b64_tr_b16 a[30:31], v11 offset:28672
    s_waitcnt lgkmcnt(8)
    v_mfma_f32_16x16x32_bf16 v[144:147], a[8:11], a[32:35], v[144:147]
    v_mfma_f32_16x16x32_bf16 v[148:151], a[8:11], a[36:39], v[148:151]
    v_mfma_f32_16x16x32_bf16 v[152:155], a[12:15], a[32:35], v[152:155]
    v_mfma_f32_16x16x32_bf16 v[156:159], a[12:15], a[36:39], v[156:159]
    s_waitcnt lgkmcnt(4)
    v_mfma_f32_16x16x32_bf16 v[160:163], a[16:19], a[32:35], v[160:163]
    v_mfma_f32_16x16x32_bf16 v[164:167], a[16:19], a[36:39], v[164:167]
    v_mfma_f32_16x16x32_bf16 v[168:171], a[20:23], a[32:35], v[168:171]
    v_mfma_f32_16x16x32_bf16 v[172:175], a[20:23], a[36:39], v[172:175]
    s_waitcnt lgkmcnt(0)
    v_mfma_f32_16x16x32_bf16 v[176:179], a[24:27], a[32:35], v[176:179]
    v_mfma_f32_16x16x32_bf16 v[180:183], a[24:27], a[36:39], v[180:183]
    v_mfma_f32_16x16x32_bf16 v[184:187], a[28:31], a[32:35], v[184:187]
    v_mfma_f32_16x16x32_bf16 v[188:191], a[28:31], a[36:39], v[188:191]
    v_lshlrev_b32 v22, 4, v1
    s_mul_i32 s44, s42, 10
    s_lshl_b32 s45, s58, 1
    s_add_u32 s44, s44, s45
    s_lshl_b32 s44, s44, 14
    s_lshl_b32 s45, s41, 12
    s_add_u32 s44, s44, s45
    s_add_u32 s44, s44, 19988480
    v_cvt_pk_bf16_f32 v64, v128, v129
    v_cvt_pk_bf16_f32 v65, v130, v131
    v_cvt_pk_bf16_f32 v66, v132, v133
    v_cvt_pk_bf16_f32 v67, v134, v135
    buffer_store_dwordx4 v[64:67], v22, s[28:31], s44 offen offset:0 sc1
    v_cvt_pk_bf16_f32 v68, v136, v137
    v_cvt_pk_bf16_f32 v69, v138, v139
    v_cvt_pk_bf16_f32 v70, v140, v141
    v_cvt_pk_bf16_f32 v71, v142, v143
    buffer_store_dwordx4 v[68:71], v22, s[28:31], s44 offen offset:1024 sc1
    v_cvt_pk_bf16_f32 v72, v144, v145
    v_cvt_pk_bf16_f32 v73, v146, v147
    v_cvt_pk_bf16_f32 v74, v148, v149
    v_cvt_pk_bf16_f32 v75, v150, v151
    buffer_store_dwordx4 v[72:75], v22, s[28:31], s44 offen offset:2048 sc1
    v_cvt_pk_bf16_f32 v76, v152, v153
    v_cvt_pk_bf16_f32 v77, v154, v155
    v_cvt_pk_bf16_f32 v78, v156, v157
    v_cvt_pk_bf16_f32 v79, v158, v159
    buffer_store_dwordx4 v[76:79], v22, s[28:31], s44 offen offset:3072 sc1
    v_cvt_pk_bf16_f32 v80, v160, v161
    v_cvt_pk_bf16_f32 v81, v162, v163
    v_cvt_pk_bf16_f32 v82, v164, v165
    v_cvt_pk_bf16_f32 v83, v166, v167
    s_add_u32 s44, s44, 16384
    buffer_store_dwordx4 v[80:83], v22, s[28:31], s44 offen offset:0 sc1
    v_cvt_pk_bf16_f32 v84, v168, v169
    v_cvt_pk_bf16_f32 v85, v170, v171
    v_cvt_pk_bf16_f32 v86, v172, v173
    v_cvt_pk_bf16_f32 v87, v174, v175
    buffer_store_dwordx4 v[84:87], v22, s[28:31], s44 offen offset:1024 sc1
    v_cvt_pk_bf16_f32 v88, v176, v177
    v_cvt_pk_bf16_f32 v89, v178, v179
    v_cvt_pk_bf16_f32 v90, v180, v181
    v_cvt_pk_bf16_f32 v91, v182, v183
    buffer_store_dwordx4 v[88:91], v22, s[28:31], s44 offen offset:2048 sc1
    v_cvt_pk_bf16_f32 v92, v184, v185
    v_cvt_pk_bf16_f32 v93, v186, v187
    v_cvt_pk_bf16_f32 v94, v188, v189
    v_cvt_pk_bf16_f32 v95, v190, v191
    buffer_store_dwordx4 v[92:95], v22, s[28:31], s44 offen offset:3072 sc1
    s_mul_i32 s76, s42, 8
    s_add_u32 s76, s76, s58
    s_lshl_b32 s76, s76, 7
    s_add_u32 s76, s76, 27402240
    s_waitcnt vmcnt(0)
    s_barrier
    buffer_store_dwordx4 v[244:247], v243, s[28:31], s76 offen sc1
    s_branch L_fin
L_g4:
    s_barrier
    s_mov_b32 s58, s83
    v_lshrrev_b32 v22, 2, v1
    v_and_b32 v24, 6, v22
    v_bfe_u32 v23, v1, 1, 1
    v_xor_b32 v23, v23, v24
    v_lshlrev_b32 v22, 7, v22
    v_lshl_add_u32 v22, v23, 4, v22
    v_and_b32 v23, 1, v1
    v_lshl_add_u32 v4, v23, 3, v22
    v_xor_b32 v5, 32, v4
    v_xor_b32 v6, 64, v4
    v_xor_b32 v7, 96, v4
    v_lshrrev_b32 v22, 4, v1
    v_lshlrev_b32 v22, 11, v22
    v_and_b32 v23, 15, v1
    v_lshl_add_u32 v22, v23, 4, v22
    s_lshl_b32 s44, s41, 9
    v_add_u32 v19, s44, v22
    s_mul_i32 s44, s42, 16
    s_lshl_b32 s44, s44, 7
    s_add_u32 s44, s44, 27361280
    v_lshlrev_b32 v22, 7, v1
    v_add_u32 v22, s44, v22
    v_mov_b32 v61, v22
    s_mul_i32 s44, s42, 16
    s_lshl_b32 s44, s44, 7
    s_add_u32 s44, s44, 27446272
    s_add_u32 s44, s44, 512
    v_mov_b32 v23, s44
    s_mov_b32 vcc_lo, 32767
    s_mov_b32 vcc_hi, 0
    v_cndmask_b32 v61, v23, v61, vcc
    v_lshrrev_b32 v24, 3, v1
    v_mul_u32_u24 v24, 1280, v24
    v_and_b32 v23, 7, v1
    v_lshl_add_u32 v60, v23, 4, v24
    s_lshl_b32 s44, s42, 7
    s_lshl_b32 s45, s41, 5
    s_add_u32 s44, s44, s45
    s_mul_i32 s44, s44, 1280
    s_lshl_b32 s45, s58, 7
    s_add_u32 s79, s44, s45
    s_mov_b32 s36, s4
    s_mov_b32 s37, s5
    s_mov_b32 s38, 2621440
    s_mov_b32 s39, 0x20000
    s_mul_i32 s44, s42, 16
    s_lshl_b32 s44, s44, 7
    s_add_u32 s44, s44, 27446272
    v_lshlrev_b32 v22, 7, v1
    v_add_u32 v22, s44, v22
    s_cmp_lg_u32 s41, 0
    s_cbranch_scc1 L_f1_29
    s_mov_b32 exec_lo, 32752
    s_mov_b32 exec_hi, 0
    buffer_load_dword v63, v22, s[28:31], 0 offen sc1
    s_mov_b64 exec, -1
L_f1_29:
    s_waitcnt vmcnt(0)
    s_waitcnt vmcnt(0)
    s_cmp_lg_u32 s41, 0
    s_cbranch_scc1 L_f2_30
    s_mov_b32 exec_lo, 32752
    s_mov_b32 exec_hi, 0
    s_mov_b32 s57, 200000
L_fp_31:
    v_cmp_ne_u32 vcc, s40, v63
    s_nop 1
    s_cbranch_vccz L_fd_32
    buffer_load_dword v63, v22, s[28:31], 0 offen sc1
    s_waitcnt vmcnt(0)
    s_sub_u32 s57, s57, 1
    s_cmp_lg_u32 s57, 0
    s_cbranch_scc1 L_fp_31
L_fd_32:
    s_mov_b64 exec, -1
L_f2_30:
    s_barrier
    buffer_store_dwordx4 v[244:247], v243, s[28:31], s76 offen sc1
    s_add_u32 s91, s91, 16384
    s_lshr_b32 s45, s58, 1
    s_mul_i32 s44, s42, 8
    s_add_u32 s44, s44, s45
    s_lshl_b32 s44, s44, 7
    s_add_u32 s44, s44, 27402240
    v_mov_b32 v59, s44
    v_lshlrev_b32 v57, 4, v1
    s_mul_i32 s44, s42, 10
    s_add_u32 s44, s44, s58
    s_lshl_b32 s44, s44, 14
    s_lshl_b32 s45, s41, 12
    s_add_u32 s44, s44, s45
    s_add_u32 s80, s44, 19988480
    s_mov_b32 s84, 0
    s_mul_i32 s54, s42, 442368
    s_add_u32 s54, s54, 12910592
    s_mul_i32 s56, s50, 32768
    s_add_u32 s56, s56, s54
    s_add_u32 s89, s54, 360448
    v_add_u32 v253, 8192, v19
    buffer_load_dwordx4 a[32:35], v19, s[28:31], s56 offen sc1
    buffer_load_dwordx4 a[36:39], v19, s[28:31], s56 offen offset:256 sc1
    buffer_load_dwordx4 a[40:43], v253, s[28:31], s56 offen sc1
    buffer_load_dwordx4 a[44:47], v253, s[28:31], s56 offen offset:256 sc1
    s_add_u32 s56, s56, 32768
    buffer_load_dwordx4 a[48:51], v19, s[28:31], s56 offen sc1
    buffer_load_dwordx4 a[52:55], v19, s[28:31], s56 offen offset:256 sc1
    buffer_load_dwordx4 a[56:59], v253, s[28:31], s56 offen sc1
    buffer_load_dwordx4 a[60:63], v253, s[28:31], s56 offen offset:256 sc1
    s_add_u32 s56, s56, 32768
    buffer_load_dwordx4 a[64:67], v19, s[28:31], s56 offen sc1
    buffer_load_dwordx4 a[68:71], v19, s[28:31], s56 offen offset:256 sc1
    buffer_load_dwordx4 a[72:75], v253, s[28:31], s56 offen sc1
    buffer_load_dwordx4 a[76:79], v253, s[28:31], s56 offen offset:256 sc1
    s_add_u32 s56, s56, 32768
    s_waitcnt vmcnt(13)
    s_barrier
    ds_read_b64_tr_b16 a[0:1], v4 offset:16384
    ds_read_b64_tr_b16 a[2:3], v4 offset:18432
    ds_read_b64_tr_b16 a[4:5], v5 offset:16384
    ds_read_b64_tr_b16 a[6:7], v5 offset:18432
    ds_read_b64_tr_b16 a[8:9], v6 offset:16384
    ds_read_b64_tr_b16 a[10:11], v6 offset:18432
    ds_read_b64_tr_b16 a[12:13], v7 offset:16384
    ds_read_b64_tr_b16 a[14:15], v7 offset:18432
    ds_read_b64_tr_b16 a[16:17], v4 offset:20480
    ds_read_b64_tr_b16 a[18:19], v4 offset:22528
    ds_read_b64_tr_b16 a[20:21], v5 offset:20480
    ds_read_b64_tr_b16 a[22:23], v5 offset:22528
    s_waitcnt vmcnt(10) lgkmcnt(8)
    v_mfma_f32_16x16x32_bf16 v[64:67], a[0:3], a[32:35], 0
    ds_read_b64_tr_b16 a[24:25], v6 offset:20480
    buffer_load_dwordx4 a[80:83], v19, s[28:31], s56 offen sc1
    v_mfma_f32_16x16x32_bf16 v[68:71], a[0:3], a[36:39], 0
    ds_read_b64_tr_b16 a[26:27], v6 offset:22528
    buffer_load_dwordx4 a[84:87], v19, s[28:31], s56 offen offset:256 sc1
    v_mfma_f32_16x16x32_bf16 v[72:75], a[4:7], a[32:35], 0
    ds_read_b64_tr_b16 a[28:29], v7 offset:20480
    s_add_u32 m0, s53, 147456
    v_mfma_f32_16x16x32_bf16 v[76:79], a[4:7], a[36:39], 0
    ds_read_b64_tr_b16 a[30:31], v7 offset:22528
    s_waitcnt lgkmcnt(8)
    v_mfma_f32_16x16x32_bf16 v[80:83], a[8:11], a[32:35], 0
    ds_read_b64_tr_b16 a[0:1], v4 offset:24576
    buffer_load_dwordx4 v14, s[32:35], s55 offen lds
    v_mfma_f32_16x16x32_bf16 v[84:87], a[8:11], a[36:39], 0
    ds_read_b64_tr_b16 a[2:3], v4 offset:26624
    buffer_load_dwordx4 v15, s[32:35], s55 offen offset:1024 lds
    v_mfma_f32_16x16x32_bf16 v[88:91], a[12:15], a[32:35], 0
    ds_read_b64_tr_b16 a[4:5], v5 offset:24576
    s_add_u32 s55, s55, 163840
    v_mfma_f32_16x16x32_bf16 v[92:95], a[12:15], a[36:39], 0
    ds_read_b64_tr_b16 a[6:7], v5 offset:26624
    s_waitcnt vmcnt(12) lgkmcnt(8)
    v_mfma_f32_16x16x32_bf16 v[64:67], a[16:19], a[40:43], v[64:67]
    ds_read_b64_tr_b16 a[8:9], v6 offset:24576
    buffer_load_dwordx4 a[32:35], v253, s[28:31], s56 offen sc1
    v_mfma_f32_16x16x32_bf16 v[68:71], a[16:19], a[44:47], v[68:71]
    ds_read_b64_tr_b16 a[10:11], v6 offset:26624
    buffer_load_dwordx4 a[36:39], v253, s[28:31], s56 offen offset:256 sc1
    v_mfma_f32_16x16x32_bf16 v[72:75], a[20:23], a[40:43], v[72:75]
    ds_read_b64_tr_b16 a[12:13], v7 offset:24576
    s_add_u32 s56, s56, 32768
    v_mfma_f32_16x16x32_bf16 v[76:79], a[20:23], a[44:47], v[76:79]
    ds_read_b64_tr_b16 a[14:15], v7 offset:26624
    s_waitcnt lgkmcnt(8)
    v_mfma_f32_16x16x32_bf16 v[80:83], a[24:27], a[40:43], v[80:83]
    ds_read_b64_tr_b16 a[16:17], v4 offset:28672
    s_add_u32 m0, s53, 0
    v_mfma_f32_16x16x32_bf16 v[84:87], a[24:27], a[44:47], v[84:87]
    ds_read_b64_tr_b16 a[18:19], v4 offset:30720
    buffer_load_dwordx4 v14, s[32:35], s55 offen lds
    v_mfma_f32_16x16x32_bf16 v[88:91], a[28:31], a[40:43], v[88:91]
    ds_read_b64_tr_b16 a[20:21], v5 offset:28672
    buffer_load_dwordx4 v15, s[32:35], s55 offen offset:1024 lds
    v_mfma_f32_16x16x32_bf16 v[92:95], a[28:31], a[44:47], v[92:95]
    ds_read_b64_tr_b16 a[22:23], v5 offset:30720
    s_waitcnt vmcnt(14) lgkmcnt(8)
    v_mfma_f32_16x16x32_bf16 v[64:67], a[0:3], a[48:51], v[64:67]
    ds_read_b64_tr_b16 a[24:25], v6 offset:28672
    buffer_load_dwordx4 a[40:43], v19, s[28:31], s56 offen sc1
    v_mfma_f32_16x16x32_bf16 v[68:71], a[0:3], a[52:55], v[68:71]
    ds_read_b64_tr_b16 a[26:27], v6 offset:30720
    buffer_load_dwordx4 a[44:47], v19, s[28:31], s56 offen offset:256 sc1
    v_mfma_f32_16x16x32_bf16 v[72:75], a[4:7], a[48:51], v[72:75]
    ds_read_b64_tr_b16 a[28:29], v7 offset:28672
    s_add_u32 s55, s55, 163840
    v_mfma_f32_16x16x32_bf16 v[76:79], a[4:7], a[52:55], v[76:79]
    ds_read_b64_tr_b16 a[30:31], v7 offset:30720
    s_waitcnt lgkmcnt(8)
    v_mfma_f32_16x16x32_bf16 v[80:83], a[8:11], a[48:51], v[80:83]
    s_barrier
    ds_read_b64_tr_b16 a[0:1], v4 offset:32768
    s_add_u32 m0, s53, 8192
    v_mfma_f32_16x16x32_bf16 v[84:87], a[8:11], a[52:55], v[84:87]
    ds_read_b64_tr_b16 a[2:3], v4 offset:34816
    buffer_load_dwordx4 v14, s[32:35], s55 offen lds
    v_mfma_f32_16x16x32_bf16 v[88:91], a[12:15], a[48:51], v[88:91]
    ds_read_b64_tr_b16 a[4:5], v5 offset:32768
    buffer_load_dwordx4 v15, s[32:35], s55 offen offset:1024 lds
    v_mfma_f32_16x16x32_bf16 v[92:95], a[12:15], a[52:55], v[92:95]
    ds_read_b64_tr_b16 a[6:7], v5 offset:34816
    s_waitcnt vmcnt(16) lgkmcnt(8)
    v_mfma_f32_16x16x32_bf16 v[64:67], a[16:19], a[56:59], v[64:67]
    ds_read_b64_tr_b16 a[8:9], v6 offset:32768
    buffer_load_dwordx4 a[48:51], v253, s[28:31], s56 offen sc1
    v_mfma_f32_16x16x32_bf16 v[68:71], a[16:19], a[60:63], v[68:71]
    ds_read_b64_tr_b16 a[10:11], v6 offset:34816
    buffer_load_dwordx4 a[52:55], v253, s[28:31], s56 offen offset:256 sc1
    v_mfma_f32_16x16x32_bf16 v[72:75], a[20:23], a[56:59], v[72:75]
    ds_read_b64_tr_b16 a[12:13], v7 offset:32768
    s_add_u32 s56, s56, 32768
    v_mfma_f32_16x16x32_bf16 v[76:79], a[20:23], a[60:63], v[76:79]
    ds_read_b64_tr_b16 a[14:15], v7 offset:34816
    s_waitcnt lgkmcnt(8)
    v_mfma_f32_16x16x32_bf16 v[80:83], a[24:27], a[56:59], v[80:83]
    ds_read_b64_tr_b16 a[16:17], v4 offset:36864
    s_add_u32 s55, s55, 163840
    v_mfma_f32_16x16x32_bf16 v[84:87], a[24:27], a[60:63], v[84:87]
    ds_read_b64_tr_b16 a[18:19], v4 offset:38912
    s_add_u32 m0, s53, 16384
    v_mfma_f32_16x16x32_bf16 v[88:91], a[28:31], a[56:59], v[88:91]
    ds_read_b64_tr_b16 a[20:21], v5 offset:36864
    buffer_load_dwordx4 v14, s[32:35], s55 offen lds
    v_mfma_f32_16x16x32_bf16 v[92:95], a[28:31], a[60:63], v[92:95]
    ds_read_b64_tr_b16 a[22:23], v5 offset:38912
    s_waitcnt vmcnt(17) lgkmcnt(8)
    v_mfma_f32_16x16x32_bf16 v[64:67], a[0:3], a[64:67], v[64:67]
    ds_read_b64_tr_b16 a[24:25], v6 offset:36864
    buffer_load_dwordx4 a[56:59], v19, s[28:31], s56 offen sc1
    v_mfma_f32_16x16x32_bf16 v[68:71], a[0:3], a[68:71], v[68:71]
    ds_read_b64_tr_b16 a[26:27], v6 offset:38912
    buffer_load_dwordx4 a[60:63], v19, s[28:31], s56 offen offset:256 sc1
    v_mfma_f32_16x16x32_bf16 v[72:75], a[4:7], a[64:67], v[72:75]
    ds_read_b64_tr_b16 a[28:29], v7 offset:36864
    buffer_load_dwordx4 v15, s[32:35], s55 offen offset:1024 lds
    v_mfma_f32_16x16x32_bf16 v[76:79], a[4:7], a[68:71], v[76:79]
    ds_read_b64_tr_b16 a[30:31], v7 offset:38912
    s_waitcnt lgkmcnt(8)
    v_mfma_f32_16x16x32_bf16 v[80:83], a[8:11], a[64:67], v[80:83]
    s_barrier
    ds_read_b64_tr_b16 a[0:1], v4 offset:40960
    s_add_u32 s55, s55, 163840
    v_mfma_f32_16x16x32_bf16 v[84:87], a[8:11], a[68:71], v[84:87]
    ds_read_b64_tr_b16 a[2:3], v4 offset:43008
    s_add_u32 m0, s53, 24576
    v_mfma_f32_16x16x32_bf16 v[88:91], a[12:15], a[64:67], v[88:91]
    ds_read_b64_tr_b16 a[4:5], v5 offset:40960
    buffer_load_dwordx4 v14, s[32:35], s55 offen lds
    v_mfma_f32_16x16x32_bf16 v[92:95], a[12:15], a[68:71], v[92:95]
    ds_read_b64_tr_b16 a[6:7], v5 offset:43008
    s_waitcnt vmcnt(19) lgkmcnt(8)
    v_mfma_f32_16x16x32_bf16 v[64:67], a[16:19], a[72:75], v[64:67]
    ds_read_b64_tr_b16 a[8:9], v6 offset:40960
    buffer_load_dwordx4 a[64:67], v253, s[28:31], s56 offen sc1
    v_mfma_f32_16x16x32_bf16 v[68:71], a[16:19], a[76:79], v[68:71]
    ds_read_b64_tr_b16 a[10:11], v6 offset:43008
    buffer_load_dwordx4 a[68:71], v253, s[28:31], s56 offen offset:256 sc1
    v_mfma_f32_16x16x32_bf16 v[72:75], a[20:23], a[72:75], v[72:75]
    ds_read_b64_tr_b16 a[12:13], v7 offset:40960
    s_add_u32 s56, s56, 32768
    v_mfma_f32_16x16x32_bf16 v[76:79], a[20:23], a[76:79], v[76:79]
    ds_read_b64_tr_b16 a[14:15], v7 offset:43008
    s_waitcnt lgkmcnt(8)
    v_mfma_f32_16x16x32_bf16 v[80:83], a[24:27], a[72:75], v[80:83]
    ds_read_b64_tr_b16 a[16:17], v4 offset:45056
    buffer_load_dwordx4 v15, s[32:35], s55 offen offset:1024 lds
    v_mfma_f32_16x16x32_bf16 v[84:87], a[24:27], a[76:79], v[84:87]
    ds_read_b64_tr_b16 a[18:19], v4 offset:47104
    s_add_u32 s55, s55, 163840
    v_mfma_f32_16x16x32_bf16 v[88:91], a[28:31], a[72:75], v[88:91]
    ds_read_b64_tr_b16 a[20:21], v5 offset:45056
    v_mfma_f32_16x16x32_bf16 v[92:95], a[28:31], a[76:79], v[92:95]
    ds_read_b64_tr_b16 a[22:23], v5 offset:47104
    s_waitcnt vmcnt(20) lgkmcnt(8)
    v_mfma_f32_16x16x32_bf16 v[64:67], a[0:3], a[80:83], v[64:67]
    ds_read_b64_tr_b16 a[24:25], v6 offset:45056
    buffer_load_dwordx4 a[72:75], v19, s[28:31], s56 offen sc1
    v_mfma_f32_16x16x32_bf16 v[68:71], a[0:3], a[84:87], v[68:71]
    ds_read_b64_tr_b16 a[26:27], v6 offset:47104
    buffer_load_dwordx4 a[76:79], v19, s[28:31], s56 offen offset:256 sc1
    v_mfma_f32_16x16x32_bf16 v[72:75], a[4:7], a[80:83], v[72:75]
    ds_read_b64_tr_b16 a[28:29], v7 offset:45056
    v_mfma_f32_16x16x32_bf16 v[76:79], a[4:7], a[84:87], v[76:79]
    ds_read_b64_tr_b16 a[30:31], v7 offset:47104
    s_waitcnt lgkmcnt(8)
    v_mfma_f32_16x16x32_bf16 v[80:83], a[8:11], a[80:83], v[80:83]
    s_barrier
    ds_read_b64_tr_b16 a[0:1], v4 offset:49152
    s_add_u32 m0, s53, 32768
    v_mfma_f32_16x16x32_bf16 v[84:87], a[8:11], a[84:87], v[84:87]
    ds_read_b64_tr_b16 a[2:3], v4 offset:51200
    buffer_load_dwordx4 v14, s[32:35], s55 offen lds
    v_mfma_f32_16x16x32_bf16 v[88:91], a[12:15], a[80:83], v[88:91]
    ds_read_b64_tr_b16 a[4:5], v5 offset:49152
    buffer_load_dwordx4 v15, s[32:35], s55 offen offset:1024 lds
    v_mfma_f32_16x16x32_bf16 v[92:95], a[12:15], a[84:87], v[92:95]
    ds_read_b64_tr_b16 a[6:7], v5 offset:51200
    s_waitcnt vmcnt(20) lgkmcnt(8)
    v_mfma_f32_16x16x32_bf16 v[64:67], a[16:19], a[32:35], v[64:67]
    ds_read_b64_tr_b16 a[8:9], v6 offset:49152
    buffer_load_dwordx4 a[80:83], v253, s[28:31], s56 offen sc1
    v_mfma_f32_16x16x32_bf16 v[68:71], a[16:19], a[36:39], v[68:71]
    ds_read_b64_tr_b16 a[10:11], v6 offset:51200
    buffer_load_dwordx4 a[84:87], v253, s[28:31], s56 offen offset:256 sc1
    v_mfma_f32_16x16x32_bf16 v[72:75], a[20:23], a[32:35], v[72:75]
    ds_read_b64_tr_b16 a[12:13], v7 offset:49152
    s_add_u32 s56, s56, 32768
    v_mfma_f32_16x16x32_bf16 v[76:79], a[20:23], a[36:39], v[76:79]
    ds_read_b64_tr_b16 a[14:15], v7 offset:51200
    s_waitcnt lgkmcnt(8)
    v_mfma_f32_16x16x32_bf16 v[80:83], a[24:27], a[32:35], v[80:83]
    ds_read_b64_tr_b16 a[16:17], v4 offset:53248
    v_mfma_f32_16x16x32_bf16 v[84:87], a[24:27], a[36:39], v[84:87]
    ds_read_b64_tr_b16 a[18:19], v4 offset:55296
    v_mfma_f32_16x16x32_bf16 v[88:91], a[28:31], a[32:35], v[88:91]
    ds_read_b64_tr_b16 a[20:21], v5 offset:53248
    v_mfma_f32_16x16x32_bf16 v[92:95], a[28:31], a[36:39], v[92:95]
    ds_read_b64_tr_b16 a[22:23], v5 offset:55296
    s_waitcnt vmcnt(18) lgkmcnt(8)
    v_mfma_f32_16x16x32_bf16 v[64:67], a[0:3], a[40:43], v[64:67]
    ds_read_b64_tr_b16 a[24:25], v6 offset:53248
    buffer_load_dwordx4 a[32:35], v19, s[28:31], s56 offen sc1
    v_mfma_f32_16x16x32_bf16 v[68:71], a[0:3], a[44:47], v[68:71]
    ds_read_b64_tr_b16 a[26:27], v6 offset:55296
    buffer_load_dwordx4 a[36:39], v19, s[28:31], s56 offen offset:256 sc1
    v_mfma_f32_16x16x32_bf16 v[72:75], a[4:7], a[40:43], v[72:75]
    ds_read_b64_tr_b16 a[28:29], v7 offset:53248
    v_mfma_f32_16x16x32_bf16 v[76:79], a[4:7], a[44:47], v[76:79]
    ds_read_b64_tr_b16 a[30:31], v7 offset:55296
    s_waitcnt lgkmcnt(8)
    v_mfma_f32_16x16x32_bf16 v[80:83], a[8:11], a[40:43], v[80:83]
    s_barrier
    ds_read_b64_tr_b16 a[0:1], v4 offset:57344
    s_add_u32 s51, s78, 1802240
    v_mfma_f32_16x16x32_bf16 v[84:87], a[8:11], a[44:47], v[84:87]
    ds_read_b64_tr_b16 a[2:3], v4 offset:59392
    s_lshl_b32 s82, s41, 4
    v_mfma_f32_16x16x32_bf16 v[88:91], a[12:15], a[40:43], v[88:91]
    ds_read_b64_tr_b16 a[4:5], v5 offset:57344
    s_mul_i32 s82, s82, 1280
    v_mfma_f32_16x16x32_bf16 v[92:95], a[12:15], a[44:47], v[92:95]
    ds_read_b64_tr_b16 a[6:7], v5 offset:59392
    s_waitcnt vmcnt(16) lgkmcnt(8)
    v_mfma_f32_16x16x32_bf16 v[64:67], a[16:19], a[48:51], v[64:67]
    ds_read_b64_tr_b16 a[8:9], v6 offset:57344
    buffer_load_dwordx4 a[40:43], v253, s[28:31], s56 offen sc1
    v_mfma_f32_16x16x32_bf16 v[68:71], a[16:19], a[52:55], v[68:71]
    ds_read_b64_tr_b16 a[10:11], v6 offset:59392
    buffer_load_dwordx4 a[44:47], v253, s[28:31], s56 offen offset:256 sc1
    v_mfma_f32_16x16x32_bf16 v[72:75], a[20:23], a[48:51], v[72:75]
    ds_read_b64_tr_b16 a[12:13], v7 offset:57344
    s_add_u32 s56, s56, 32768
    v_mfma_f32_16x16x32_bf16 v[76:79], a[20:23], a[52:55], v[76:79]
    ds_read_b64_tr_b16 a[14:15], v7 offset:59392
    s_waitcnt lgkmcnt(8)
    v_mfma_f32_16x16x32_bf16 v[80:83], a[24:27], a[48:51], v[80:83]
    ds_read_b64_tr_b16 a[16:17], v4 offset:61440
    s_add_u32 s51, s51, s82
    v_mfma_f32_16x16x32_bf16 v[84:87], a[24:27], a[52:55], v[84:87]
    ds_read_b64_tr_b16 a[18:19], v4 offset:63488
    s_mov_b32 s55, s51
    v_mfma_f32_16x16x32_bf16 v[88:91], a[28:31], a[48:51], v[88:91]
    ds_read_b64_tr_b16 a[20:21], v5 offset:61440
    s_add_u32 s90, s51, 327680
    v_mfma_f32_16x16x32_bf16 v[92:95], a[28:31], a[52:55], v[92:95]
    ds_read_b64_tr_b16 a[22:23], v5 offset:63488
    s_waitcnt vmcnt(15) lgkmcnt(8)
    v_mfma_f32_16x16x32_bf16 v[64:67], a[0:3], a[56:59], v[64:67]
    ds_read_b64_tr_b16 a[24:25], v6 offset:61440
    buffer_load_dwordx4 a[48:51], v19, s[28:31], s56 offen sc1
    v_mfma_f32_16x16x32_bf16 v[68:71], a[0:3], a[60:63], v[68:71]
    ds_read_b64_tr_b16 a[26:27], v6 offset:63488
    buffer_load_dwordx4 a[52:55], v19, s[28:31], s56 offen offset:256 sc1
    v_mfma_f32_16x16x32_bf16 v[72:75], a[4:7], a[56:59], v[72:75]
    ds_read_b64_tr_b16 a[28:29], v7 offset:61440
    s_add_u32 m0, s53, 40960
    v_mfma_f32_16x16x32_bf16 v[76:79], a[4:7], a[60:63], v[76:79]
    ds_read_b64_tr_b16 a[30:31], v7 offset:63488
    s_waitcnt lgkmcnt(8)
    v_mfma_f32_16x16x32_bf16 v[80:83], a[8:11], a[56:59], v[80:83]
    s_barrier
    v_add_u32 v4, 65536, v4
    v_add_u32 v5, 65536, v5
    v_add_u32 v6, 65536, v6
    v_add_u32 v7, 65536, v7
    ds_read_b64_tr_b16 a[0:1], v4 offset:0
    buffer_load_dwordx4 v14, s[32:35], s55 offen lds
    v_mfma_f32_16x16x32_bf16 v[84:87], a[8:11], a[60:63], v[84:87]
    ds_read_b64_tr_b16 a[2:3], v4 offset:2048
    buffer_load_dwordx4 v15, s[32:35], s55 offen offset:1024 lds
    v_mfma_f32_16x16x32_bf16 v[88:91], a[12:15], a[56:59], v[88:91]
    ds_read_b64_tr_b16 a[4:5], v5 offset:0
    s_add_u32 s55, s55, 81920
    v_mfma_f32_16x16x32_bf16 v[92:95], a[12:15], a[60:63], v[92:95]
    ds_read_b64_tr_b16 a[6:7], v5 offset:2048
    s_waitcnt vmcnt(15) lgkmcnt(8)
    v_mfma_f32_16x16x32_bf16 v[64:67], a[16:19], a[64:67], v[64:67]
    ds_read_b64_tr_b16 a[8:9], v6 offset:0
    buffer_load_dwordx4 a[56:59], v253, s[28:31], s56 offen sc1
    v_mfma_f32_16x16x32_bf16 v[68:71], a[16:19], a[68:71], v[68:71]
    ds_read_b64_tr_b16 a[10:11], v6 offset:2048
    buffer_load_dwordx4 a[60:63], v253, s[28:31], s56 offen offset:256 sc1
    v_mfma_f32_16x16x32_bf16 v[72:75], a[20:23], a[64:67], v[72:75]
    ds_read_b64_tr_b16 a[12:13], v7 offset:0
    s_add_u32 s56, s56, 32768
    v_mfma_f32_16x16x32_bf16 v[76:79], a[20:23], a[68:71], v[76:79]
    ds_read_b64_tr_b16 a[14:15], v7 offset:2048
    s_waitcnt lgkmcnt(8)
    v_mfma_f32_16x16x32_bf16 v[80:83], a[24:27], a[64:67], v[80:83]
    ds_read_b64_tr_b16 a[16:17], v4 offset:4096
    s_add_u32 m0, s53, 49152
    v_mfma_f32_16x16x32_bf16 v[84:87], a[24:27], a[68:71], v[84:87]
    ds_read_b64_tr_b16 a[18:19], v4 offset:6144
    buffer_load_dwordx4 v14, s[32:35], s55 offen lds
    v_mfma_f32_16x16x32_bf16 v[88:91], a[28:31], a[64:67], v[88:91]
    ds_read_b64_tr_b16 a[20:21], v5 offset:4096
    buffer_load_dwordx4 v15, s[32:35], s55 offen offset:1024 lds
    v_mfma_f32_16x16x32_bf16 v[92:95], a[28:31], a[68:71], v[92:95]
    ds_read_b64_tr_b16 a[22:23], v5 offset:6144
    s_waitcnt vmcnt(16) lgkmcnt(8)
    v_mfma_f32_16x16x32_bf16 v[64:67], a[0:3], a[72:75], v[64:67]
    ds_read_b64_tr_b16 a[24:25], v6 offset:4096
    buffer_load_dwordx4 a[64:67], v19, s[28:31], s56 offen sc1
    v_mfma_f32_16x16x32_bf16 v[68:71], a[0:3], a[76:79], v[68:71]
    ds_read_b64_tr_b16 a[26:27], v6 offset:6144
    buffer_load_dwordx4 a[68:71], v19, s[28:31], s56 offen offset:256 sc1
    v_mfma_f32_16x16x32_bf16 v[72:75], a[4:7], a[72:75], v[72:75]
    ds_read_b64_tr_b16 a[28:29], v7 offset:4096
    s_add_u32 s55, s55, 81920
    v_mfma_f32_16x16x32_bf16 v[76:79], a[4:7], a[76:79], v[76:79]
    ds_read_b64_tr_b16 a[30:31], v7 offset:6144
    s_waitcnt lgkmcnt(8)
    v_mfma_f32_16x16x32_bf16 v[80:83], a[8:11], a[72:75], v[80:83]
    s_barrier
    ds_read_b64_tr_b16 a[0:1], v4 offset:8192
    buffer_load_dword v62, v61, s[28:31], 0 offen sc1
    v_mfma_f32_16x16x32_bf16 v[84:87], a[8:11], a[76:79], v[84:87]
    ds_read_b64_tr_b16 a[2:3], v4 offset:10240
    s_add_u32 m0, s53, 57344
    v_mfma_f32_16x16x32_bf16 v[88:91], a[12:15], a[72:75], v[88:91]
    ds_read_b64_tr_b16 a[4:5], v5 offset:8192
    buffer_load_dwordx4 v14, s[32:35], s55 offen lds
    v_mfma_f32_16x16x32_bf16 v[92:95], a[12:15], a[76:79], v[92:95]
    ds_read_b64_tr_b16 a[6:7], v5 offset:10240
    s_waitcnt vmcnt(16) lgkmcnt(8)
    v_mfma_f32_16x16x32_bf16 v[64:67], a[16:19], a[80:83], v[64:67]
    ds_read_b64_tr_b16 a[8:9], v6 offset:8192
    buffer_load_dwordx4 a[72:75], v253, s[28:31], s56 offen sc1
    v_mfma_f32_16x16x32_bf16 v[68:71], a[16:19], a[84:87], v[68:71]
    ds_read_b64_tr_b16 a[10:11], v6 offset:10240
    buffer_load_dwordx4 a[76:79], v253, s[28:31], s56 offen offset:256 sc1
    v_mfma_f32_16x16x32_bf16 v[72:75], a[20:23], a[80:83], v[72:75]
    ds_read_b64_tr_b16 a[12:13], v7 offset:8192
    s_add_u32 s56, s56, 32768
    v_mfma_f32_16x16x32_bf16 v[76:79], a[20:23], a[84:87], v[76:79]
    ds_read_b64_tr_b16 a[14:15], v7 offset:10240
    s_waitcnt lgkmcnt(8)
    v_mfma_f32_16x16x32_bf16 v[80:83], a[24:27], a[80:83], v[80:83]
    ds_read_b64_tr_b16 a[16:17], v4 offset:12288
    buffer_load_dwordx4 v15, s[32:35], s55 offen offset:1024 lds
    v_mfma_f32_16x16x32_bf16 v[84:87], a[24:27], a[84:87], v[84:87]
    ds_read_b64_tr_b16 a[18:19], v4 offset:14336
    s_add_u32 s55, s55, 81920
    v_mfma_f32_16x16x32_bf16 v[88:91], a[28:31], a[80:83], v[88:91]
    ds_read_b64_tr_b16 a[20:21], v5 offset:12288
    v_mfma_f32_16x16x32_bf16 v[92:95], a[28:31], a[84:87], v[92:95]
    ds_read_b64_tr_b16 a[22:23], v5 offset:14336
    s_waitcnt vmcnt(17) lgkmcnt(8)
    v_mfma_f32_16x16x32_bf16 v[64:67], a[0:3], a[32:35], v[64:67]
    ds_read_b64_tr_b16 a[24:25], v6 offset:12288
    buffer_load_dwordx4 a[80:83], v19, s[28:31], s56 offen sc1
    v_mfma_f32_16x16x32_bf16 v[68:71], a[0:3], a[36:39], v[68:71]
    ds_read_b64_tr_b16 a[26:27], v6 offset:14336
    buffer_load_dwordx4 a[84:87], v19, s[28:31], s56 offen offset:256 sc1
    v_mfma_f32_16x16x32_bf16 v[72:75], a[4:7], a[32:35], v[72:75]
    ds_read_b64_tr_b16 a[28:29], v7 offset:12288
    v_mfma_f32_16x16x32_bf16 v[76:79], a[4:7], a[36:39], v[76:79]
    ds_read_b64_tr_b16 a[30:31], v7 offset:14336
    s_waitcnt lgkmcnt(8)
    v_mfma_f32_16x16x32_bf16 v[80:83], a[8:11], a[32:35], v[80:83]
    s_barrier
    ds_read_b64_tr_b16 a[0:1], v4 offset:16384
    s_add_u32 m0, s53, 65536
    v_mfma_f32_16x16x32_bf16 v[84:87], a[8:11], a[36:39], v[84:87]
    ds_read_b64_tr_b16 a[2:3], v4 offset:18432
    buffer_load_dwordx4 v14, s[32:35], s55 offen lds
    v_mfma_f32_16x16x32_bf16 v[88:91], a[12:15], a[32:35], v[88:91]
    ds_read_b64_tr_b16 a[4:5], v5 offset:16384
    buffer_load_dwordx4 v15, s[32:35], s55 offen offset:1024 lds
    v_mfma_f32_16x16x32_bf16 v[92:95], a[12:15], a[36:39], v[92:95]
    ds_read_b64_tr_b16 a[6:7], v5 offset:18432
    s_waitcnt vmcnt(19) lgkmcnt(8)
    v_mfma_f32_16x16x32_bf16 v[64:67], a[16:19], a[40:43], v[64:67]
    ds_read_b64_tr_b16 a[8:9], v6 offset:16384
    buffer_load_dwordx4 a[32:35], v253, s[28:31], s56 offen sc1
    v_mfma_f32_16x16x32_bf16 v[68:71], a[16:19], a[44:47], v[68:71]
    ds_read_b64_tr_b16 a[10:11], v6 offset:18432
    buffer_load_dwordx4 a[36:39], v253, s[28:31], s56 offen offset:256 sc1
    v_mfma_f32_16x16x32_bf16 v[72:75], a[20:23], a[40:43], v[72:75]
    ds_read_b64_tr_b16 a[12:13], v7 offset:16384
    v_mfma_f32_16x16x32_bf16 v[76:79], a[20:23], a[44:47], v[76:79]
    ds_read_b64_tr_b16 a[14:15], v7 offset:18432
    s_waitcnt lgkmcnt(8)
    v_mfma_f32_16x16x32_bf16 v[80:83], a[24:27], a[40:43], v[80:83]
    ds_read_b64_tr_b16 a[16:17], v4 offset:20480
    v_mfma_f32_16x16x32_bf16 v[84:87], a[24:27], a[44:47], v[84:87]
    ds_read_b64_tr_b16 a[18:19], v4 offset:22528
    v_mfma_f32_16x16x32_bf16 v[88:91], a[28:31], a[40:43], v[88:91]
    ds_read_b64_tr_b16 a[20:21], v5 offset:20480
    v_mfma_f32_16x16x32_bf16 v[92:95], a[28:31], a[44:47], v[92:95]
    ds_read_b64_tr_b16 a[22:23], v5 offset:22528
    s_waitcnt vmcnt(19) lgkmcnt(8)
    s_waitcnt vmcnt(10)
    s_mov_b32 s57, 200000
L_cp_33:
    v_cmp_ne_u32 vcc, s40, v62
    s_nop 1
    s_cbranch_vccz L_cd_34
    buffer_load_dword v62, v61, s[28:31], 0 offen sc1
    s_waitcnt vmcnt(0)
    s_sub_u32 s57, s57, 1
    s_cmp_lg_u32 s57, 0
    s_cbranch_scc1 L_cp_33
L_cd_34:
    v_mfma_f32_16x16x32_bf16 v[64:67], a[0:3], a[48:51], v[64:67]
    ds_read_b64_tr_b16 a[24:25], v6 offset:20480
    s_mul_i32 s54, s42, 442368
    v_mfma_f32_16x16x32_bf16 v[68:71], a[0:3], a[52:55], v[68:71]
    ds_read_b64_tr_b16 a[26:27], v6 offset:22528
    s_add_u32 s54, s54, 12926976
    v_mfma_f32_16x16x32_bf16 v[72:75], a[4:7], a[48:51], v[72:75]
    ds_read_b64_tr_b16 a[28:29], v7 offset:20480
    s_mul_i32 s56, s50, 32768
    v_mfma_f32_16x16x32_bf16 v[76:79], a[4:7], a[52:55], v[76:79]
    ds_read_b64_tr_b16 a[30:31], v7 offset:22528
    s_waitcnt lgkmcnt(8)
    v_mfma_f32_16x16x32_bf16 v[80:83], a[8:11], a[48:51], v[80:83]
    ds_read_b64_tr_b16 a[0:1], v4 offset:24576
    s_add_u32 s56, s56, s54
    v_mfma_f32_16x16x32_bf16 v[84:87], a[8:11], a[52:55], v[84:87]
    ds_read_b64_tr_b16 a[2:3], v4 offset:26624
    s_add_u32 s89, s54, 360448
    v_mfma_f32_16x16x32_bf16 v[88:91], a[12:15], a[48:51], v[88:91]
    ds_read_b64_tr_b16 a[4:5], v5 offset:24576
    buffer_load_dwordx4 a[40:43], v19, s[28:31], s56 offen sc1
    v_mfma_f32_16x16x32_bf16 v[92:95], a[12:15], a[52:55], v[92:95]
    ds_read_b64_tr_b16 a[6:7], v5 offset:26624
    s_waitcnt vmcnt(16) lgkmcnt(8)
    v_mfma_f32_16x16x32_bf16 v[64:67], a[16:19], a[56:59], v[64:67]
    ds_read_b64_tr_b16 a[8:9], v6 offset:24576
    buffer_load_dwordx4 a[44:47], v19, s[28:31], s56 offen offset:256 sc1
    v_mfma_f32_16x16x32_bf16 v[68:71], a[16:19], a[60:63], v[68:71]
    ds_read_b64_tr_b16 a[10:11], v6 offset:26624
    buffer_load_dwordx4 a[48:51], v253, s[28:31], s56 offen sc1
    v_mfma_f32_16x16x32_bf16 v[72:75], a[20:23], a[56:59], v[72:75]
    ds_read_b64_tr_b16 a[12:13], v7 offset:24576
    buffer_load_dwordx4 a[52:55], v253, s[28:31], s56 offen offset:256 sc1
    v_mfma_f32_16x16x32_bf16 v[76:79], a[20:23], a[60:63], v[76:79]
    ds_read_b64_tr_b16 a[14:15], v7 offset:26624
    s_waitcnt lgkmcnt(8)
    v_mfma_f32_16x16x32_bf16 v[80:83], a[24:27], a[56:59], v[80:83]
    ds_read_b64_tr_b16 a[16:17], v4 offset:28672
    s_add_u32 s56, s56, 32768
    v_mfma_f32_16x16x32_bf16 v[84:87], a[24:27], a[60:63], v[84:87]
    ds_read_b64_tr_b16 a[18:19], v4 offset:30720
    v_mfma_f32_16x16x32_bf16 v[88:91], a[28:31], a[56:59], v[88:91]
    ds_read_b64_tr_b16 a[20:21], v5 offset:28672
    v_mfma_f32_16x16x32_bf16 v[92:95], a[28:31], a[60:63], v[92:95]
    ds_read_b64_tr_b16 a[22:23], v5 offset:30720
    s_waitcnt vmcnt(15) lgkmcnt(8)
    v_mfma_f32_16x16x32_bf16 v[64:67], a[0:3], a[64:67], v[64:67]
    ds_read_b64_tr_b16 a[24:25], v6 offset:28672
    buffer_load_dwordx4 a[56:59], v19, s[28:31], s56 offen sc1
    v_mfma_f32_16x16x32_bf16 v[68:71], a[0:3], a[68:71], v[68:71]
    ds_read_b64_tr_b16 a[26:27], v6 offset:30720
    buffer_load_dwordx4 a[60:63], v19, s[28:31], s56 offen offset:256 sc1
    v_mfma_f32_16x16x32_bf16 v[72:75], a[4:7], a[64:67], v[72:75]
    ds_read_b64_tr_b16 a[28:29], v7 offset:28672
    v_mfma_f32_16x16x32_bf16 v[76:79], a[4:7], a[68:71], v[76:79]
    ds_read_b64_tr_b16 a[30:31], v7 offset:30720
    s_waitcnt lgkmcnt(8)
    v_mfma_f32_16x16x32_bf16 v[80:83], a[8:11], a[64:67], v[80:83]
    ds_read_b64_tr_b16 a[0:1], v4 offset:32768
    v_mfma_f32_16x16x32_bf16 v[84:87], a[8:11], a[68:71], v[84:87]
    ds_read_b64_tr_b16 a[2:3], v4 offset:34816
    v_mfma_f32_16x16x32_bf16 v[88:91], a[12:15], a[64:67], v[88:91]
    ds_read_b64_tr_b16 a[4:5], v5 offset:32768
    v_mfma_f32_16x16x32_bf16 v[92:95], a[12:15], a[68:71], v[92:95]
    ds_read_b64_tr_b16 a[6:7], v5 offset:34816
    s_waitcnt vmcnt(13) lgkmcnt(8)
    v_mfma_f32_16x16x32_bf16 v[64:67], a[16:19], a[72:75], v[64:67]
    ds_read_b64_tr_b16 a[8:9], v6 offset:32768
    buffer_load_dwordx4 a[64:67], v253, s[28:31], s56 offen sc1
    v_mfma_f32_16x16x32_bf16 v[68:71], a[16:19], a[76:79], v[68:71]
    ds_read_b64_tr_b16 a[10:11], v6 offset:34816
    buffer_load_dwordx4 a[68:71], v253, s[28:31], s56 offen offset:256 sc1
    v_mfma_f32_16x16x32_bf16 v[72:75], a[20:23], a[72:75], v[72:75]
    ds_read_b64_tr_b16 a[12:13], v7 offset:32768
    s_add_u32 s56, s56, 32768
    v_mfma_f32_16x16x32_bf16 v[76:79], a[20:23], a[76:79], v[76:79]
    ds_read_b64_tr_b16 a[14:15], v7 offset:34816
    s_waitcnt lgkmcnt(8)
    v_mfma_f32_16x16x32_bf16 v[80:83], a[24:27], a[72:75], v[80:83]
    ds_read_b64_tr_b16 a[16:17], v4 offset:36864
    v_mfma_f32_16x16x32_bf16 v[84:87], a[24:27], a[76:79], v[84:87]
    ds_read_b64_tr_b16 a[18:19], v4 offset:38912
    v_mfma_f32_16x16x32_bf16 v[88:91], a[28:31], a[72:75], v[88:91]
    ds_read_b64_tr_b16 a[20:21], v5 offset:36864
    v_mfma_f32_16x16x32_bf16 v[92:95], a[28:31], a[76:79], v[92:95]
    ds_read_b64_tr_b16 a[22:23], v5 offset:38912
    s_waitcnt vmcnt(12) lgkmcnt(8)
    v_mfma_f32_16x16x32_bf16 v[64:67], a[0:3], a[80:83], v[64:67]
    ds_read_b64_tr_b16 a[24:25], v6 offset:36864
    buffer_load_dwordx4 a[72:75], v19, s[28:31], s56 offen sc1
    v_mfma_f32_16x16x32_bf16 v[68:71], a[0:3], a[84:87], v[68:71]
    ds_read_b64_tr_b16 a[26:27], v6 offset:38912
    buffer_load_dwordx4 a[76:79], v19, s[28:31], s56 offen offset:256 sc1
    v_mfma_f32_16x16x32_bf16 v[72:75], a[4:7], a[80:83], v[72:75]
    ds_read_b64_tr_b16 a[28:29], v7 offset:36864
    v_mfma_f32_16x16x32_bf16 v[76:79], a[4:7], a[84:87], v[76:79]
    ds_read_b64_tr_b16 a[30:31], v7 offset:38912
    s_waitcnt lgkmcnt(8)
    v_mfma_f32_16x16x32_bf16 v[80:83], a[8:11], a[80:83], v[80:83]
    ds_read_b64_tr_b16 a[0:1], v4 offset:40960
    v_mfma_f32_16x16x32_bf16 v[84:87], a[8:11], a[84:87], v[84:87]
    ds_read_b64_tr_b16 a[2:3], v4 offset:43008
    v_mfma_f32_16x16x32_bf16 v[88:91], a[12:15], a[80:83], v[88:91]
    ds_read_b64_tr_b16 a[4:5], v5 offset:40960
    v_mfma_f32_16x16x32_bf16 v[92:95], a[12:15], a[84:87], v[92:95]
    ds_read_b64_tr_b16 a[6:7], v5 offset:43008
    s_waitcnt vmcnt(10) lgkmcnt(8)
    v_mfma_f32_16x16x32_bf16 v[64:67], a[16:19], a[32:35], v[64:67]
    ds_read_b64_tr_b16 a[8:9], v6 offset:40960
    buffer_load_dwordx4 a[80:83], v253, s[28:31], s56 offen sc1
    v_mfma_f32_16x16x32_bf16 v[68:71], a[16:19], a[36:39], v[68:71]
    ds_read_b64_tr_b16 a[10:11], v6 offset:43008
    buffer_load_dwordx4 a[84:87], v253, s[28:31], s56 offen offset:256 sc1
    v_mfma_f32_16x16x32_bf16 v[72:75], a[20:23], a[32:35], v[72:75]
    ds_read_b64_tr_b16 a[12:13], v7 offset:40960
    s_add_u32 s56, s56, 32768
    v_mfma_f32_16x16x32_bf16 v[76:79], a[20:23], a[36:39], v[76:79]
    ds_read_b64_tr_b16 a[14:15], v7 offset:43008
    s_waitcnt lgkmcnt(8)
    v_mfma_f32_16x16x32_bf16 v[80:83], a[24:27], a[32:35], v[80:83]
    ds_read_b64_tr_b16 a[16:17], v4 offset:45056
    v_mfma_f32_16x16x32_bf16 v[84:87], a[24:27], a[36:39], v[84:87]
    ds_read_b64_tr_b16 a[18:19], v4 offset:47104
    v_mfma_f32_16x16x32_bf16 v[88:91], a[28:31], a[32:35], v[88:91]
    ds_read_b64_tr_b16 a[20:21], v5 offset:45056
    v_mfma_f32_16x16x32_bf16 v[92:95], a[28:31], a[36:39], v[92:95]
    ds_read_b64_tr_b16 a[22:23], v5 offset:47104
    s_waitcnt vmcnt(10) lgkmcnt(8)
    v_mfma_f32_16x16x32_bf16 v[64:67], a[0:3], a[40:43], v[64:67]
    ds_read_b64_tr_b16 a[24:25], v6 offset:45056
    buffer_load_dwordx4 a[32:35], v19, s[28:31], s56 offen sc1
    v_mfma_f32_16x16x32_bf16 v[68:71], a[0:3], a[44:47], v[68:71]
    ds_read_b64_tr_b16 a[26:27], v6 offset:47104
    buffer_load_dwordx4 a[36:39], v19, s[28:31], s56 offen offset:256 sc1
    v_mfma_f32_16x16x32_bf16 v[72:75], a[4:7], a[40:43], v[72:75]
    ds_read_b64_tr_b16 a[28:29], v7 offset:45056
    v_mfma_f32_16x16x32_bf16 v[76:79], a[4:7], a[44:47], v[76:79]
    ds_read_b64_tr_b16 a[30:31], v7 offset:47104
    s_waitcnt lgkmcnt(8)
    v_mfma_f32_16x16x32_bf16 v[80:83], a[8:11], a[40:43], v[80:83]
    ds_read_b64_tr_b16 a[0:1], v4 offset:49152
    v_mfma_f32_16x16x32_bf16 v[84:87], a[8:11], a[44:47], v[84:87]
    ds_read_b64_tr_b16 a[2:3], v4 offset:51200
    v_mfma_f32_16x16x32_bf16 v[88:91], a[12:15], a[40:43], v[88:91]
    ds_read_b64_tr_b16 a[4:5], v5 offset:49152
    v_mfma_f32_16x16x32_bf16 v[92:95], a[12:15], a[44:47], v[92:95]
    ds_read_b64_tr_b16 a[6:7], v5 offset:51200
    s_waitcnt vmcnt(10) lgkmcnt(8)
    v_mfma_f32_16x16x32_bf16 v[64:67], a[16:19], a[48:51], v[64:67]
    ds_read_b64_tr_b16 a[8:9], v6 offset:49152
    buffer_load_dwordx4 a[40:43], v253, s[28:31], s56 offen sc1
    v_mfma_f32_16x16x32_bf16 v[68:71], a[16:19], a[52:55], v[68:71]
    ds_read_b64_tr_b16 a[10:11], v6 offset:51200
    buffer_load_dwordx4 a[44:47], v253, s[28:31], s56 offen offset:256 sc1
    v_mfma_f32_16x16x32_bf16 v[72:75], a[20:23], a[48:51], v[72:75]
    ds_read_b64_tr_b16 a[12:13], v7 offset:49152
    s_add_u32 s56, s56, 32768
    v_mfma_f32_16x16x32_bf16 v[76:79], a[20:23], a[52:55], v[76:79]
    ds_read_b64_tr_b16 a[14:15], v7 offset:51200
    s_waitcnt lgkmcnt(8)
    v_mfma_f32_16x16x32_bf16 v[80:83], a[24:27], a[48:51], v[80:83]
    ds_read_b64_tr_b16 a[16:17], v4 offset:53248
    v_mfma_f32_16x16x32_bf16 v[84:87], a[24:27], a[52:55], v[84:87]
    ds_read_b64_tr_b16 a[18:19], v4 offset:55296
    v_mfma_f32_16x16x32_bf16 v[88:91], a[28:31], a[48:51], v[88:91]
    ds_read_b64_tr_b16 a[20:21], v5 offset:53248
    v_mfma_f32_16x16x32_bf16 v[92:95], a[28:31], a[52:55], v[92:95]
    ds_read_b64_tr_b16 a[22:23], v5 offset:55296
    s_waitcnt vmcnt(10) lgkmcnt(8)
    v_mfma_f32_16x16x32_bf16 v[64:67], a[0:3], a[56:59], v[64:67]
    ds_read_b64_tr_b16 a[24:25], v6 offset:53248
    buffer_load_dwordx4 a[48:51], v19, s[28:31], s56 offen sc1
    v_mfma_f32_16x16x32_bf16 v[68:71], a[0:3], a[60:63], v[68:71]
    ds_read_b64_tr_b16 a[26:27], v6 offset:55296
    buffer_load_dwordx4 a[52:55], v19, s[28:31], s56 offen offset:256 sc1
    v_mfma_f32_16x16x32_bf16 v[72:75], a[4:7], a[56:59], v[72:75]
    ds_read_b64_tr_b16 a[28:29], v7 offset:53248
    v_mfma_f32_16x16x32_bf16 v[76:79], a[4:7], a[60:63], v[76:79]
    ds_read_b64_tr_b16 a[30:31], v7 offset:55296
    s_waitcnt lgkmcnt(8)
    v_mfma_f32_16x16x32_bf16 v[80:83], a[8:11], a[56:59], v[80:83]
    ds_read_b64_tr_b16 a[0:1], v4 offset:57344
    v_mfma_f32_16x16x32_bf16 v[84:87], a[8:11], a[60:63], v[84:87]
    ds_read_b64_tr_b16 a[2:3], v4 offset:59392
    v_mfma_f32_16x16x32_bf16 v[88:91], a[12:15], a[56:59], v[88:91]
    ds_read_b64_tr_b16 a[4:5], v5 offset:57344
    v_mfma_f32_16x16x32_bf16 v[92:95], a[12:15], a[60:63], v[92:95]
    ds_read_b64_tr_b16 a[6:7], v5 offset:59392
    s_waitcnt vmcnt(10) lgkmcnt(8)
    v_mfma_f32_16x16x32_bf16 v[64:67], a[16:19], a[64:67], v[64:67]
    ds_read_b64_tr_b16 a[8:9], v6 offset:57344
    buffer_load_dwordx4 a[56:59], v253, s[28:31], s56 offen sc1
    v_mfma_f32_16x16x32_bf16 v[68:71], a[16:19], a[68:71], v[68:71]
    ds_read_b64_tr_b16 a[10:11], v6 offset:59392
    buffer_load_dwordx4 a[60:63], v253, s[28:31], s56 offen offset:256 sc1
    v_mfma_f32_16x16x32_bf16 v[72:75], a[20:23], a[64:67], v[72:75]
    ds_read_b64_tr_b16 a[12:13], v7 offset:57344
    s_add_u32 s56, s56, 32768
    v_mfma_f32_16x16x32_bf16 v[76:79], a[20:23], a[68:71], v[76:79]
    ds_read_b64_tr_b16 a[14:15], v7 offset:59392
    s_waitcnt lgkmcnt(8)
    v_mfma_f32_16x16x32_bf16 v[80:83], a[24:27], a[64:67], v[80:83]
    ds_read_b64_tr_b16 a[16:17], v4 offset:61440
    v_mfma_f32_16x16x32_bf16 v[84:87], a[24:27], a[68:71], v[84:87]
    ds_read_b64_tr_b16 a[18:19], v4 offset:63488
    v_mfma_f32_16x16x32_bf16 v[88:91], a[28:31], a[64:67], v[88:91]
    ds_read_b64_tr_b16 a[20:21], v5 offset:61440
    v_mfma_f32_16x16x32_bf16 v[92:95], a[28:31], a[68:71], v[92:95]
    ds_read_b64_tr_b16 a[22:23], v5 offset:63488
    s_waitcnt vmcnt(10) lgkmcnt(8)
    v_mfma_f32_16x16x32_bf16 v[64:67], a[0:3], a[72:75], v[64:67]
    ds_read_b64_tr_b16 a[24:25], v6 offset:61440
    buffer_load_dwordx4 a[64:67], v19, s[28:31], s56 offen sc1
    v_mfma_f32_16x16x32_bf16 v[68:71], a[0:3], a[76:79], v[68:71]
    ds_read_b64_tr_b16 a[26:27], v6 offset:63488
    buffer_load_dwordx4 a[68:71], v19, s[28:31], s56 offen offset:256 sc1
    v_mfma_f32_16x16x32_bf16 v[72:75], a[4:7], a[72:75], v[72:75]
    ds_read_b64_tr_b16 a[28:29], v7 offset:61440
    v_mfma_f32_16x16x32_bf16 v[76:79], a[4:7], a[76:79], v[76:79]
    ds_read_b64_tr_b16 a[30:31], v7 offset:63488
    s_waitcnt lgkmcnt(8)
    v_mfma_f32_16x16x32_bf16 v[80:83], a[8:11], a[72:75], v[80:83]
    v_add_u32 v4, 65536, v4
    v_add_u32 v5, 65536, v5
    v_add_u32 v6, 65536, v6
    v_add_u32 v7, 65536, v7
    ds_read_b64_tr_b16 a[0:1], v4 offset:0
    v_mfma_f32_16x16x32_bf16 v[84:87], a[8:11], a[76:79], v[84:87]
    ds_read_b64_tr_b16 a[2:3], v4 offset:2048
    v_mfma_f32_16x16x32_bf16 v[88:91], a[12:15], a[72:75], v[88:91]
    ds_read_b64_tr_b16 a[4:5], v5 offset:0
    v_mfma_f32_16x16x32_bf16 v[92:95], a[12:15], a[76:79], v[92:95]
    ds_read_b64_tr_b16 a[6:7], v5 offset:2048
    s_waitcnt vmcnt(10) lgkmcnt(8)
    v_mfma_f32_16x16x32_bf16 v[64:67], a[16:19], a[80:83], v[64:67]
    ds_read_b64_tr_b16 a[8:9], v6 offset:0
    buffer_load_dwordx4 a[72:75], v253, s[28:31], s56 offen sc1
    v_mfma_f32_16x16x32_bf16 v[68:71], a[16:19], a[84:87], v[68:71]
    ds_read_b64_tr_b16 a[10:11], v6 offset:2048
    buffer_load_dwordx4 a[76:79], v253, s[28:31], s56 offen offset:256 sc1
    v_mfma_f32_16x16x32_bf16 v[72:75], a[20:23], a[80:83], v[72:75]
    ds_read_b64_tr_b16 a[12:13], v7 offset:0
    s_add_u32 s56, s56, 32768
    v_mfma_f32_16x16x32_bf16 v[76:79], a[20:23], a[84:87], v[76:79]
    ds_read_b64_tr_b16 a[14:15], v7 offset:2048
    s_waitcnt lgkmcnt(8)
    v_mfma_f32_16x16x32_bf16 v[80:83], a[24:27], a[80:83], v[80:83]
    ds_read_b64_tr_b16 a[16:17], v4 offset:4096
    v_mfma_f32_16x16x32_bf16 v[84:87], a[24:27], a[84:87], v[84:87]
    ds_read_b64_tr_b16 a[18:19], v4 offset:6144
    v_mfma_f32_16x16x32_bf16 v[88:91], a[28:31], a[80:83], v[88:91]
    ds_read_b64_tr_b16 a[20:21], v5 offset:4096
    v_mfma_f32_16x16x32_bf16 v[92:95], a[28:31], a[84:87], v[92:95]
    ds_read_b64_tr_b16 a[22:23], v5 offset:6144
    s_waitcnt vmcnt(10) lgkmcnt(8)
    v_mfma_f32_16x16x32_bf16 v[64:67], a[0:3], a[32:35], v[64:67]
    ds_read_b64_tr_b16 a[24:25], v6 offset:4096
    buffer_load_dwordx4 a[80:83], v19, s[28:31], s56 offen sc1
    v_mfma_f32_16x16x32_bf16 v[68:71], a[0:3], a[36:39], v[68:71]
    ds_read_b64_tr_b16 a[26:27], v6 offset:6144
    buffer_load_dwordx4 a[84:87], v19, s[28:31], s56 offen offset:256 sc1
    v_mfma_f32_16x16x32_bf16 v[72:75], a[4:7], a[32:35], v[72:75]
    ds_read_b64_tr_b16 a[28:29], v7 offset:4096
    v_mfma_f32_16x16x32_bf16 v[76:79], a[4:7], a[36:39], v[76:79]
    ds_read_b64_tr_b16 a[30:31], v7 offset:6144
    s_waitcnt lgkmcnt(8)
    v_mfma_f32_16x16x32_bf16 v[80:83], a[8:11], a[32:35], v[80:83]
    ds_read_b64_tr_b16 a[0:1], v4 offset:8192
    v_mfma_f32_16x16x32_bf16 v[84:87], a[8:11], a[36:39], v[84:87]
    ds_read_b64_tr_b16 a[2:3], v4 offset:10240
    v_mfma_f32_16x16x32_bf16 v[88:91], a[12:15], a[32:35], v[88:91]
    ds_read_b64_tr_b16 a[4:5], v5 offset:8192
    v_mfma_f32_16x16x32_bf16 v[92:95], a[12:15], a[36:39], v[92:95]
    ds_read_b64_tr_b16 a[6:7], v5 offset:10240
    s_waitcnt vmcnt(10) lgkmcnt(8)
    v_mfma_f32_16x16x32_bf16 v[64:67], a[16:19], a[40:43], v[64:67]
    ds_read_b64_tr_b16 a[8:9], v6 offset:8192
    buffer_load_dwordx4 a[32:35], v253, s[28:31], s56 offen sc1
    v_mfma_f32_16x16x32_bf16 v[68:71], a[16:19], a[44:47], v[68:71]
    ds_read_b64_tr_b16 a[10:11], v6 offset:10240
    buffer_load_dwordx4 a[36:39], v253, s[28:31], s56 offen offset:256 sc1
    v_mfma_f32_16x16x32_bf16 v[72:75], a[20:23], a[40:43], v[72:75]
    ds_read_b64_tr_b16 a[12:13], v7 offset:8192
    s_add_u32 s56, s56, 32768
    v_mfma_f32_16x16x32_bf16 v[76:79], a[20:23], a[44:47], v[76:79]
    ds_read_b64_tr_b16 a[14:15], v7 offset:10240
    s_waitcnt lgkmcnt(8)
    v_mfma_f32_16x16x32_bf16 v[80:83], a[24:27], a[40:43], v[80:83]
    ds_read_b64_tr_b16 a[16:17], v4 offset:12288
    v_mfma_f32_16x16x32_bf16 v[84:87], a[24:27], a[44:47], v[84:87]
    ds_read_b64_tr_b16 a[18:19], v4 offset:14336
    v_mfma_f32_16x16x32_bf16 v[88:91], a[28:31], a[40:43], v[88:91]
    ds_read_b64_tr_b16 a[20:21], v5 offset:12288
    v_mfma_f32_16x16x32_bf16 v[92:95], a[28:31], a[44:47], v[92:95]
    ds_read_b64_tr_b16 a[22:23], v5 offset:14336
    s_waitcnt vmcnt(10) lgkmcnt(8)
    v_mfma_f32_16x16x32_bf16 v[64:67], a[0:3], a[48:51], v[64:67]
    ds_read_b64_tr_b16 a[24:25], v6 offset:12288
    buffer_load_dwordx4 a[40:43], v19, s[28:31], s56 offen sc1
    v_mfma_f32_16x16x32_bf16 v[68:71], a[0:3], a[52:55], v[68:71]
    ds_read_b64_tr_b16 a[26:27], v6 offset:14336
    buffer_load_dwordx4 a[44:47], v19, s[28:31], s56 offen offset:256 sc1
    v_mfma_f32_16x16x32_bf16 v[72:75], a[4:7], a[48:51], v[72:75]
    ds_read_b64_tr_b16 a[28:29], v7 offset:12288
    v_mfma_f32_16x16x32_bf16 v[76:79], a[4:7], a[52:55], v[76:79]
    ds_read_b64_tr_b16 a[30:31], v7 offset:14336
    s_waitcnt lgkmcnt(8)
    v_mfma_f32_16x16x32_bf16 v[80:83], a[8:11], a[48:51], v[80:83]
    s_waitcnt vmcnt(63)
    s_barrier
    ds_read_b64_tr_b16 a[0:1], v4 offset:16384
    v_mfma_f32_16x16x32_bf16 v[84:87], a[8:11], a[52:55], v[84:87]
    ds_read_b64_tr_b16 a[2:3], v4 offset:18432
    v_mfma_f32_16x16x32_bf16 v[88:91], a[12:15], a[48:51], v[88:91]
    ds_read_b64_tr_b16 a[4:5], v5 offset:16384
    v_mfma_f32_16x16x32_bf16 v[92:95], a[12:15], a[52:55], v[92:95]
    ds_read_b64_tr_b16 a[6:7], v5 offset:18432
    s_waitcnt vmcnt(10) lgkmcnt(8)
    v_mfma_f32_16x16x32_bf16 v[64:67], a[16:19], a[56:59], v[64:67]
    ds_read_b64_tr_b16 a[8:9], v6 offset:16384
    buffer_load_dwordx4 a[48:51], v253, s[28:31], s56 offen sc1
    v_mfma_f32_16x16x32_bf16 v[68:71], a[16:19], a[60:63], v[68:71]
    ds_read_b64_tr_b16 a[10:11], v6 offset:18432
    buffer_load_dwordx4 a[52:55], v253, s[28:31], s56 offen offset:256 sc1
    v_mfma_f32_16x16x32_bf16 v[72:75], a[20:23], a[56:59], v[72:75]
    ds_read_b64_tr_b16 a[12:13], v7 offset:16384
    s_add_u32 s56, s56, 32768
    v_mfma_f32_16x16x32_bf16 v[76:79], a[20:23], a[60:63], v[76:79]
    ds_read_b64_tr_b16 a[14:15], v7 offset:18432
    s_waitcnt lgkmcnt(8)
    v_mfma_f32_16x16x32_bf16 v[80:83], a[24:27], a[56:59], v[80:83]
    ds_read_b64_tr_b16 a[16:17], v4 offset:20480
    v_mfma_f32_16x16x32_bf16 v[84:87], a[24:27], a[60:63], v[84:87]
    ds_read_b64_tr_b16 a[18:19], v4 offset:22528
    v_mfma_f32_16x16x32_bf16 v[88:91], a[28:31], a[56:59], v[88:91]
    ds_read_b64_tr_b16 a[20:21], v5 offset:20480
    v_mfma_f32_16x16x32_bf16 v[92:95], a[28:31], a[60:63], v[92:95]
    ds_read_b64_tr_b16 a[22:23], v5 offset:22528
    s_waitcnt vmcnt(10) lgkmcnt(8)
    v_mfma_f32_16x16x32_bf16 v[64:67], a[0:3], a[64:67], v[64:67]
    ds_read_b64_tr_b16 a[24:25], v6 offset:20480
    buffer_load_dwordx4 a[56:59], v19, s[28:31], s56 offen sc1
    v_mfma_f32_16x16x32_bf16 v[68:71], a[0:3], a[68:71], v[68:71]
    ds_read_b64_tr_b16 a[26:27], v6 offset:22528
    buffer_load_dwordx4 a[60:63], v19, s[28:31], s56 offen offset:256 sc1
    v_mfma_f32_16x16x32_bf16 v[72:75], a[4:7], a[64:67], v[72:75]
    ds_read_b64_tr_b16 a[28:29], v7 offset:20480
    v_mfma_f32_16x16x32_bf16 v[76:79], a[4:7], a[68:71], v[76:79]
    ds_read_b64_tr_b16 a[30:31], v7 offset:22528
    s_waitcnt lgkmcnt(8)
    v_mfma_f32_16x16x32_bf16 v[80:83], a[8:11], a[64:67], v[80:83]
    s_waitcnt vmcnt(63)
    s_barrier
    v_add_u32 v4, 4294836224, v4
    v_add_u32 v5, 4294836224, v5
    v_add_u32 v6, 4294836224, v6
    v_add_u32 v7, 4294836224, v7
    ds_read_b64_tr_b16 a[0:1], v4 offset:0
    v_mfma_f32_16x16x32_bf16 v[84:87], a[8:11], a[68:71], v[84:87]
    ds_read_b64_tr_b16 a[2:3], v4 offset:2048
    v_mfma_f32_16x16x32_bf16 v[88:91], a[12:15], a[64:67], v[88:91]
    ds_read_b64_tr_b16 a[4:5], v5 offset:0
    v_mfma_f32_16x16x32_bf16 v[92:95], a[12:15], a[68:71], v[92:95]
    ds_read_b64_tr_b16 a[6:7], v5 offset:2048
    s_waitcnt vmcnt(10) lgkmcnt(8)
    v_mfma_f32_16x16x32_bf16 v[64:67], a[16:19], a[72:75], v[64:67]
    ds_read_b64_tr_b16 a[8:9], v6 offset:0
    buffer_load_dwordx4 a[64:67], v253, s[28:31], s56 offen sc1
    v_mfma_f32_16x16x32_bf16 v[68:71], a[16:19], a[76:79], v[68:71]
    ds_read_b64_tr_b16 a[10:11], v6 offset:2048
    buffer_load_dwordx4 a[68:71], v253, s[28:31], s56 offen offset:256 sc1
    v_mfma_f32_16x16x32_bf16 v[72:75], a[20:23], a[72:75], v[72:75]
    ds_read_b64_tr_b16 a[12:13], v7 offset:0
    s_add_u32 s56, s56, 32768
    v_mfma_f32_16x16x32_bf16 v[76:79], a[20:23], a[76:79], v[76:79]
    ds_read_b64_tr_b16 a[14:15], v7 offset:2048
    s_waitcnt lgkmcnt(8)
    v_mfma_f32_16x16x32_bf16 v[80:83], a[24:27], a[72:75], v[80:83]
    ds_read_b64_tr_b16 a[16:17], v4 offset:4096
    v_mfma_f32_16x16x32_bf16 v[84:87], a[24:27], a[76:79], v[84:87]
    ds_read_b64_tr_b16 a[18:19], v4 offset:6144
    v_mfma_f32_16x16x32_bf16 v[88:91], a[28:31], a[72:75], v[88:91]
    ds_read_b64_tr_b16 a[20:21], v5 offset:4096
    v_mfma_f32_16x16x32_bf16 v[92:95], a[28:31], a[76:79], v[92:95]
    ds_read_b64_tr_b16 a[22:23], v5 offset:6144
    s_waitcnt vmcnt(10) lgkmcnt(8)
    v_mfma_f32_16x16x32_bf16 v[64:67], a[0:3], a[80:83], v[64:67]
    ds_read_b64_tr_b16 a[24:25], v6 offset:4096
    buffer_load_dwordx4 a[72:75], v19, s[28:31], s56 offen sc1
    v_mfma_f32_16x16x32_bf16 v[68:71], a[0:3], a[84:87], v[68:71]
    ds_read_b64_tr_b16 a[26:27], v6 offset:6144
    buffer_load_dwordx4 a[76:79], v19, s[28:31], s56 offen offset:256 sc1
    v_mfma_f32_16x16x32_bf16 v[72:75], a[4:7], a[80:83], v[72:75]
    ds_read_b64_tr_b16 a[28:29], v7 offset:4096
    v_mfma_f32_16x16x32_bf16 v[76:79], a[4:7], a[84:87], v[76:79]
    ds_read_b64_tr_b16 a[30:31], v7 offset:6144
    s_waitcnt lgkmcnt(8)
    v_mfma_f32_16x16x32_bf16 v[80:83], a[8:11], a[80:83], v[80:83]
    s_waitcnt vmcnt(63)
    s_barrier
    ds_read_b64_tr_b16 a[0:1], v4 offset:8192
    v_mfma_f32_16x16x32_bf16 v[84:87], a[8:11], a[84:87], v[84:87]
    ds_read_b64_tr_b16 a[2:3], v4 offset:10240
    v_mfma_f32_16x16x32_bf16 v[88:91], a[12:15], a[80:83], v[88:91]
    ds_read_b64_tr_b16 a[4:5], v5 offset:8192
    v_mfma_f32_16x16x32_bf16 v[92:95], a[12:15], a[84:87], v[92:95]
    ds_read_b64_tr_b16 a[6:7], v5 offset:10240
    s_waitcnt vmcnt(10) lgkmcnt(8)
    v_mfma_f32_16x16x32_bf16 v[64:67], a[16:19], a[32:35], v[64:67]
    ds_read_b64_tr_b16 a[8:9], v6 offset:8192
    buffer_load_dwordx4 a[80:83], v253, s[28:31], s56 offen sc1
    v_mfma_f32_16x16x32_bf16 v[68:71], a[16:19], a[36:39], v[68:71]
    ds_read_b64_tr_b16 a[10:11], v6 offset:10240
    buffer_load_dwordx4 a[84:87], v253, s[28:31], s56 offen offset:256 sc1
    v_mfma_f32_16x16x32_bf16 v[72:75], a[20:23], a[32:35], v[72:75]
    ds_read_b64_tr_b16 a[12:13], v7 offset:8192
    s_add_u32 s56, s56, 32768
    v_mfma_f32_16x16x32_bf16 v[76:79], a[20:23], a[36:39], v[76:79]
    ds_read_b64_tr_b16 a[14:15], v7 offset:10240
    s_waitcnt lgkmcnt(8)
    v_mfma_f32_16x16x32_bf16 v[80:83], a[24:27], a[32:35], v[80:83]
    ds_read_b64_tr_b16 a[16:17], v4 offset:12288
    v_mfma_f32_16x16x32_bf16 v[84:87], a[24:27], a[36:39], v[84:87]
    ds_read_b64_tr_b16 a[18:19], v4 offset:14336
    v_mfma_f32_16x16x32_bf16 v[88:91], a[28:31], a[32:35], v[88:91]
    ds_read_b64_tr_b16 a[20:21], v5 offset:12288
    v_mfma_f32_16x16x32_bf16 v[92:95], a[28:31], a[36:39], v[92:95]
    ds_read_b64_tr_b16 a[22:23], v5 offset:14336
    s_waitcnt vmcnt(10) lgkmcnt(8)
    v_mfma_f32_16x16x32_bf16 v[64:67], a[0:3], a[40:43], v[64:67]
    ds_read_b64_tr_b16 a[24:25], v6 offset:12288
    buffer_load_dwordx4 a[32:35], v19, s[28:31], s56 offen sc1
    v_mfma_f32_16x16x32_bf16 v[68:71], a[0:3], a[44:47], v[68:71]
    ds_read_b64_tr_b16 a[26:27], v6 offset:14336
    buffer_load_dwordx4 a[36:39], v19, s[28:31], s56 offen offset:256 sc1
    v_mfma_f32_16x16x32_bf16 v[72:75], a[4:7], a[40:43], v[72:75]
    ds_read_b64_tr_b16 a[28:29], v7 offset:12288
    v_mfma_f32_16x16x32_bf16 v[76:79], a[4:7], a[44:47], v[76:79]
    ds_read_b64_tr_b16 a[30:31], v7 offset:14336
    s_waitcnt lgkmcnt(8)
    v_mfma_f32_16x16x32_bf16 v[80:83], a[8:11], a[40:43], v[80:83]
    s_waitcnt vmcnt(63)
    s_barrier
    ds_read_b64_tr_b16 a[0:1], v4 offset:16384
    v_mfma_f32_16x16x32_bf16 v[84:87], a[8:11], a[44:47], v[84:87]
    ds_read_b64_tr_b16 a[2:3], v4 offset:18432
    v_mfma_f32_16x16x32_bf16 v[88:91], a[12:15], a[40:43], v[88:91]
    ds_read_b64_tr_b16 a[4:5], v5 offset:16384
    v_mfma_f32_16x16x32_bf16 v[92:95], a[12:15], a[44:47], v[92:95]
    ds_read_b64_tr_b16 a[6:7], v5 offset:18432
    s_waitcnt vmcnt(10) lgkmcnt(8)
    v_mfma_f32_16x16x32_bf16 v[64:67], a[16:19], a[48:51], v[64:67]
    ds_read_b64_tr_b16 a[8:9], v6 offset:16384
    buffer_load_dwordx4 a[40:43], v253, s[28:31], s56 offen sc1
    v_mfma_f32_16x16x32_bf16 v[68:71], a[16:19], a[52:55], v[68:71]
    ds_read_b64_tr_b16 a[10:11], v6 offset:18432
    buffer_load_dwordx4 a[44:47], v253, s[28:31], s56 offen offset:256 sc1
    v_mfma_f32_16x16x32_bf16 v[72:75], a[20:23], a[48:51], v[72:75]
    ds_read_b64_tr_b16 a[12:13], v7 offset:16384
    v_mfma_f32_16x16x32_bf16 v[76:79], a[20:23], a[52:55], v[76:79]
    ds_read_b64_tr_b16 a[14:15], v7 offset:18432
    s_waitcnt lgkmcnt(8)
    v_mfma_f32_16x16x32_bf16 v[80:83], a[24:27], a[48:51], v[80:83]
    ds_read_b64_tr_b16 a[16:17], v4 offset:20480
    v_mfma_f32_16x16x32_bf16 v[84:87], a[24:27], a[52:55], v[84:87]
    ds_read_b64_tr_b16 a[18:19], v4 offset:22528
    v_mfma_f32_16x16x32_bf16 v[88:91], a[28:31], a[48:51], v[88:91]
    ds_read_b64_tr_b16 a[20:21], v5 offset:20480
    v_mfma_f32_16x16x32_bf16 v[92:95], a[28:31], a[52:55], v[92:95]
    ds_read_b64_tr_b16 a[22:23], v5 offset:22528
    s_waitcnt vmcnt(10) lgkmcnt(8)
    v_mfma_f32_16x16x32_bf16 v[64:67], a[0:3], a[56:59], v[64:67]
    ds_read_b64_tr_b16 a[24:25], v6 offset:20480
    s_mul_i32 s54, s42, 442368
    v_mfma_f32_16x16x32_bf16 v[68:71], a[0:3], a[60:63], v[68:71]
    ds_read_b64_tr_b16 a[26:27], v6 offset:22528
    s_add_u32 s54, s54, 13271040
    v_mfma_f32_16x16x32_bf16 v[72:75], a[4:7], a[56:59], v[72:75]
    ds_read_b64_tr_b16 a[28:29], v7 offset:20480
    s_mov_b32 s56, s54
    v_mfma_f32_16x16x32_bf16 v[76:79], a[4:7], a[60:63], v[76:79]
    ds_read_b64_tr_b16 a[30:31], v7 offset:22528
    s_waitcnt lgkmcnt(8)
    v_mfma_f32_16x16x32_bf16 v[80:83], a[8:11], a[56:59], v[80:83]
    s_waitcnt vmcnt(63)
    s_barrier
    ds_read_b64_tr_b16 a[0:1], v4 offset:24576
    s_add_u32 s89, s54, 65536
    v_mfma_f32_16x16x32_bf16 v[84:87], a[8:11], a[60:63], v[84:87]
    ds_read_b64_tr_b16 a[2:3], v4 offset:26624
    buffer_load_dwordx4 a[48:51], v19, s[28:31], s56 offen sc1
    v_mfma_f32_16x16x32_bf16 v[88:91], a[12:15], a[56:59], v[88:91]
    ds_read_b64_tr_b16 a[4:5], v5 offset:24576
    buffer_load_dwordx4 a[52:55], v19, s[28:31], s56 offen offset:256 sc1
    v_mfma_f32_16x16x32_bf16 v[92:95], a[12:15], a[60:63], v[92:95]
    ds_read_b64_tr_b16 a[6:7], v5 offset:26624
    s_waitcnt vmcnt(10) lgkmcnt(8)
    v_mfma_f32_16x16x32_bf16 v[64:67], a[16:19], a[64:67], v[64:67]
    ds_read_b64_tr_b16 a[8:9], v6 offset:24576
    buffer_load_dwordx4 a[56:59], v253, s[28:31], s56 offen sc1
    v_mfma_f32_16x16x32_bf16 v[68:71], a[16:19], a[68:71], v[68:71]
    ds_read_b64_tr_b16 a[10:11], v6 offset:26624
    buffer_load_dwordx4 a[60:63], v253, s[28:31], s56 offen offset:256 sc1
    v_mfma_f32_16x16x32_bf16 v[72:75], a[20:23], a[64:67], v[72:75]
    ds_read_b64_tr_b16 a[12:13], v7 offset:24576
    s_add_u32 s56, s56, 16384
    v_mfma_f32_16x16x32_bf16 v[76:79], a[20:23], a[68:71], v[76:79]
    ds_read_b64_tr_b16 a[14:15], v7 offset:26624
    s_waitcnt lgkmcnt(8)
    v_mfma_f32_16x16x32_bf16 v[80:83], a[24:27], a[64:67], v[80:83]
    ds_read_b64_tr_b16 a[16:17], v4 offset:28672
    v_mfma_f32_16x16x32_bf16 v[84:87], a[24:27], a[68:71], v[84:87]
    ds_read_b64_tr_b16 a[18:19], v4 offset:30720
    v_mfma_f32_16x16x32_bf16 v[88:91], a[28:31], a[64:67], v[88:91]
    ds_read_b64_tr_b16 a[20:21], v5 offset:28672
    v_mfma_f32_16x16x32_bf16 v[92:95], a[28:31], a[68:71], v[92:95]
    ds_read_b64_tr_b16 a[22:23], v5 offset:30720
    s_waitcnt vmcnt(10) lgkmcnt(8)
    v_mfma_f32_16x16x32_bf16 v[64:67], a[0:3], a[72:75], v[64:67]
    ds_read_b64_tr_b16 a[24:25], v6 offset:28672
    buffer_load_dwordx4 a[64:67], v19, s[28:31], s56 offen sc1
    v_mfma_f32_16x16x32_bf16 v[68:71], a[0:3], a[76:79], v[68:71]
    ds_read_b64_tr_b16 a[26:27], v6 offset:30720
    buffer_load_dwordx4 a[68:71], v19, s[28:31], s56 offen offset:256 sc1
    v_mfma_f32_16x16x32_bf16 v[72:75], a[4:7], a[72:75], v[72:75]
    ds_read_b64_tr_b16 a[28:29], v7 offset:28672
    v_mfma_f32_16x16x32_bf16 v[76:79], a[4:7], a[76:79], v[76:79]
    ds_read_b64_tr_b16 a[30:31], v7 offset:30720
    s_waitcnt lgkmcnt(8)
    v_mfma_f32_16x16x32_bf16 v[80:83], a[8:11], a[72:75], v[80:83]
    s_waitcnt vmcnt(63)
    s_barrier
    ds_read_b64_tr_b16 a[0:1], v4 offset:32768
    buffer_load_dword v58, v59, s[28:31], 0 offen sc1
    v_mfma_f32_16x16x32_bf16 v[84:87], a[8:11], a[76:79], v[84:87]
    ds_read_b64_tr_b16 a[2:3], v4 offset:34816
    v_mfma_f32_16x16x32_bf16 v[88:91], a[12:15], a[72:75], v[88:91]
    ds_read_b64_tr_b16 a[4:5], v5 offset:32768
    v_mfma_f32_16x16x32_bf16 v[92:95], a[12:15], a[76:79], v[92:95]
    ds_read_b64_tr_b16 a[6:7], v5 offset:34816
    s_waitcnt vmcnt(11) lgkmcnt(8)
    v_mfma_f32_16x16x32_bf16 v[64:67], a[16:19], a[80:83], v[64:67]
    ds_read_b64_tr_b16 a[8:9], v6 offset:32768
    buffer_load_dwordx4 a[72:75], v253, s[28:31], s56 offen sc1
    v_mfma_f32_16x16x32_bf16 v[68:71], a[16:19], a[84:87], v[68:71]
    ds_read_b64_tr_b16 a[10:11], v6 offset:34816
    buffer_load_dwordx4 a[76:79], v253, s[28:31], s56 offen offset:256 sc1
    v_mfma_f32_16x16x32_bf16 v[72:75], a[20:23], a[80:83], v[72:75]
    ds_read_b64_tr_b16 a[12:13], v7 offset:32768
    s_add_u32 s56, s56, 16384
    v_mfma_f32_16x16x32_bf16 v[76:79], a[20:23], a[84:87], v[76:79]
    ds_read_b64_tr_b16 a[14:15], v7 offset:34816
    s_waitcnt lgkmcnt(8)
    v_mfma_f32_16x16x32_bf16 v[80:83], a[24:27], a[80:83], v[80:83]
    ds_read_b64_tr_b16 a[16:17], v4 offset:36864
    v_mfma_f32_16x16x32_bf16 v[84:87], a[24:27], a[84:87], v[84:87]
    ds_read_b64_tr_b16 a[18:19], v4 offset:38912
    v_mfma_f32_16x16x32_bf16 v[88:91], a[28:31], a[80:83], v[88:91]
    ds_read_b64_tr_b16 a[20:21], v5 offset:36864
    v_mfma_f32_16x16x32_bf16 v[92:95], a[28:31], a[84:87], v[92:95]
    ds_read_b64_tr_b16 a[22:23], v5 offset:38912
    s_waitcnt vmcnt(11) lgkmcnt(8)
    v_mfma_f32_16x16x32_bf16 v[64:67], a[0:3], a[32:35], v[64:67]
    ds_read_b64_tr_b16 a[24:25], v6 offset:36864
    buffer_load_dwordx4 a[80:83], v19, s[28:31], s56 offen sc1
    v_mfma_f32_16x16x32_bf16 v[68:71], a[0:3], a[36:39], v[68:71]
    ds_read_b64_tr_b16 a[26:27], v6 offset:38912
    buffer_load_dwordx4 a[84:87], v19, s[28:31], s56 offen offset:256 sc1
    v_mfma_f32_16x16x32_bf16 v[72:75], a[4:7], a[32:35], v[72:75]
    ds_read_b64_tr_b16 a[28:29], v7 offset:36864
    v_mfma_f32_16x16x32_bf16 v[76:79], a[4:7], a[36:39], v[76:79]
    ds_read_b64_tr_b16 a[30:31], v7 offset:38912
    s_waitcnt lgkmcnt(8)
    v_mfma_f32_16x16x32_bf16 v[80:83], a[8:11], a[32:35], v[80:83]
    s_waitcnt vmcnt(63)
    s_barrier
    ds_read_b64_tr_b16 a[0:1], v4 offset:40960
    v_mfma_f32_16x16x32_bf16 v[84:87], a[8:11], a[36:39], v[84:87]
    ds_read_b64_tr_b16 a[2:3], v4 offset:43008
    v_mfma_f32_16x16x32_bf16 v[88:91], a[12:15], a[32:35], v[88:91]
    ds_read_b64_tr_b16 a[4:5], v5 offset:40960
    v_mfma_f32_16x16x32_bf16 v[92:95], a[12:15], a[36:39], v[92:95]
    ds_read_b64_tr_b16 a[6:7], v5 offset:43008
    s_waitcnt vmcnt(11) lgkmcnt(8)
    v_mfma_f32_16x16x32_bf16 v[64:67], a[16:19], a[40:43], v[64:67]
    ds_read_b64_tr_b16 a[8:9], v6 offset:40960
    buffer_load_dwordx4 a[32:35], v253, s[28:31], s56 offen sc1
    v_mfma_f32_16x16x32_bf16 v[68:71], a[16:19], a[44:47], v[68:71]
    ds_read_b64_tr_b16 a[10:11], v6 offset:43008
    buffer_load_dwordx4 a[36:39], v253, s[28:31], s56 offen offset:256 sc1
    v_mfma_f32_16x16x32_bf16 v[72:75], a[20:23], a[40:43], v[72:75]
    ds_read_b64_tr_b16 a[12:13], v7 offset:40960
    s_add_u32 s56, s56, 16384
    v_mfma_f32_16x16x32_bf16 v[76:79], a[20:23], a[44:47], v[76:79]
    ds_read_b64_tr_b16 a[14:15], v7 offset:43008
    s_waitcnt lgkmcnt(8)
    v_mfma_f32_16x16x32_bf16 v[80:83], a[24:27], a[40:43], v[80:83]
    ds_read_b64_tr_b16 a[16:17], v4 offset:45056
    v_mfma_f32_16x16x32_bf16 v[84:87], a[24:27], a[44:47], v[84:87]
    ds_read_b64_tr_b16 a[18:19], v4 offset:47104
    v_mfma_f32_16x16x32_bf16 v[88:91], a[28:31], a[40:43], v[88:91]
    ds_read_b64_tr_b16 a[20:21], v5 offset:45056
    v_mfma_f32_16x16x32_bf16 v[92:95], a[28:31], a[44:47], v[92:95]
    ds_read_b64_tr_b16 a[22:23], v5 offset:47104
    s_waitcnt vmcnt(11) lgkmcnt(8)
    v_mfma_f32_16x16x32_bf16 v[64:67], a[0:3], a[48:51], v[64:67]
    ds_read_b64_tr_b16 a[24:25], v6 offset:45056
    buffer_load_dwordx4 a[40:43], v19, s[28:31], s56 offen sc1
    v_mfma_f32_16x16x32_bf16 v[68:71], a[0:3], a[52:55], v[68:71]
    ds_read_b64_tr_b16 a[26:27], v6 offset:47104
    buffer_load_dwordx4 a[44:47], v19, s[28:31], s56 offen offset:256 sc1
    v_mfma_f32_16x16x32_bf16 v[72:75], a[4:7], a[48:51], v[72:75]
    ds_read_b64_tr_b16 a[28:29], v7 offset:45056
    v_mfma_f32_16x16x32_bf16 v[76:79], a[4:7], a[52:55], v[76:79]
    ds_read_b64_tr_b16 a[30:31], v7 offset:47104
    s_waitcnt lgkmcnt(8)
    v_mfma_f32_16x16x32_bf16 v[80:83], a[8:11], a[48:51], v[80:83]
    s_waitcnt vmcnt(63)
    s_barrier
    ds_read_b64_tr_b16 a[0:1], v4 offset:49152
    v_mfma_f32_16x16x32_bf16 v[84:87], a[8:11], a[52:55], v[84:87]
    ds_read_b64_tr_b16 a[2:3], v4 offset:51200
    v_mfma_f32_16x16x32_bf16 v[88:91], a[12:15], a[48:51], v[88:91]
    ds_read_b64_tr_b16 a[4:5], v5 offset:49152
    v_mfma_f32_16x16x32_bf16 v[92:95], a[12:15], a[52:55], v[92:95]
    ds_read_b64_tr_b16 a[6:7], v5 offset:51200
    s_waitcnt vmcnt(11) lgkmcnt(8)
    v_mfma_f32_16x16x32_bf16 v[64:67], a[16:19], a[56:59], v[64:67]
    ds_read_b64_tr_b16 a[8:9], v6 offset:49152
    buffer_load_dwordx4 a[48:51], v253, s[28:31], s56 offen sc1
    v_mfma_f32_16x16x32_bf16 v[68:71], a[16:19], a[60:63], v[68:71]
    ds_read_b64_tr_b16 a[10:11], v6 offset:51200
    buffer_load_dwordx4 a[52:55], v253, s[28:31], s56 offen offset:256 sc1
    v_mfma_f32_16x16x32_bf16 v[72:75], a[20:23], a[56:59], v[72:75]
    ds_read_b64_tr_b16 a[12:13], v7 offset:49152
    v_mfma_f32_16x16x32_bf16 v[76:79], a[20:23], a[60:63], v[76:79]
    ds_read_b64_tr_b16 a[14:15], v7 offset:51200
    s_waitcnt lgkmcnt(8)
    v_mfma_f32_16x16x32_bf16 v[80:83], a[24:27], a[56:59], v[80:83]
    ds_read_b64_tr_b16 a[16:17], v4 offset:53248
    v_mfma_f32_16x16x32_bf16 v[84:87], a[24:27], a[60:63], v[84:87]
    ds_read_b64_tr_b16 a[18:19], v4 offset:55296
    v_mfma_f32_16x16x32_bf16 v[88:91], a[28:31], a[56:59], v[88:91]
    ds_read_b64_tr_b16 a[20:21], v5 offset:53248
    v_mfma_f32_16x16x32_bf16 v[92:95], a[28:31], a[60:63], v[92:95]
    ds_read_b64_tr_b16 a[22:23], v5 offset:55296
    s_waitcnt vmcnt(11) lgkmcnt(8)
    v_mfma_f32_16x16x32_bf16 v[64:67], a[0:3], a[64:67], v[64:67]
    ds_read_b64_tr_b16 a[24:25], v6 offset:53248
    v_mfma_f32_16x16x32_bf16 v[68:71], a[0:3], a[68:71], v[68:71]
    ds_read_b64_tr_b16 a[26:27], v6 offset:55296
    v_mfma_f32_16x16x32_bf16 v[72:75], a[4:7], a[64:67], v[72:75]
    ds_read_b64_tr_b16 a[28:29], v7 offset:53248
    v_mfma_f32_16x16x32_bf16 v[76:79], a[4:7], a[68:71], v[76:79]
    ds_read_b64_tr_b16 a[30:31], v7 offset:55296
    s_waitcnt lgkmcnt(8)
    v_mfma_f32_16x16x32_bf16 v[80:83], a[8:11], a[64:67], v[80:83]
    s_waitcnt vmcnt(63)
    s_barrier
    ds_read_b64_tr_b16 a[0:1], v4 offset:57344
    v_mfma_f32_16x16x32_bf16 v[84:87], a[8:11], a[68:71], v[84:87]
    ds_read_b64_tr_b16 a[2:3], v4 offset:59392
    v_mfma_f32_16x16x32_bf16 v[88:91], a[12:15], a[64:67], v[88:91]
    ds_read_b64_tr_b16 a[4:5], v5 offset:57344
    v_mfma_f32_16x16x32_bf16 v[92:95], a[12:15], a[68:71], v[92:95]
    ds_read_b64_tr_b16 a[6:7], v5 offset:59392
    s_waitcnt vmcnt(8) lgkmcnt(8)
    v_mfma_f32_16x16x32_bf16 v[64:67], a[16:19], a[72:75], v[64:67]
    ds_read_b64_tr_b16 a[8:9], v6 offset:57344
    v_mfma_f32_16x16x32_bf16 v[68:71], a[16:19], a[76:79], v[68:71]
    ds_read_b64_tr_b16 a[10:11], v6 offset:59392
    v_mfma_f32_16x16x32_bf16 v[72:75], a[20:23], a[72:75], v[72:75]
    ds_read_b64_tr_b16 a[12:13], v7 offset:57344
    v_mfma_f32_16x16x32_bf16 v[76:79], a[20:23], a[76:79], v[76:79]
    ds_read_b64_tr_b16 a[14:15], v7 offset:59392
    s_waitcnt lgkmcnt(8)
    v_mfma_f32_16x16x32_bf16 v[80:83], a[24:27], a[72:75], v[80:83]
    ds_read_b64_tr_b16 a[16:17], v4 offset:61440
    v_mfma_f32_16x16x32_bf16 v[84:87], a[24:27], a[76:79], v[84:87]
    ds_read_b64_tr_b16 a[18:19], v4 offset:63488
    v_mfma_f32_16x16x32_bf16 v[88:91], a[28:31], a[72:75], v[88:91]
    ds_read_b64_tr_b16 a[20:21], v5 offset:61440
    v_mfma_f32_16x16x32_bf16 v[92:95], a[28:31], a[76:79], v[92:95]
    ds_read_b64_tr_b16 a[22:23], v5 offset:63488
    s_waitcnt vmcnt(10)
    v_cmp_ne_u32 vcc, s40, v58
    s_nop 1
    s_cbranch_vccnz L_aot_35
    buffer_load_dwordx4 v[144:147], v57, s[28:31], s80 offen offset:0 sc1
    buffer_load_dwordx4 v[148:151], v57, s[28:31], s80 offen offset:1024 sc1
    buffer_load_dwordx4 v[152:155], v57, s[28:31], s80 offen offset:2048 sc1
    buffer_load_dwordx4 v[156:159], v57, s[28:31], s80 offen offset:3072 sc1
    s_mov_b32 s84, 1
L_aot_35:
    s_waitcnt vmcnt(6) lgkmcnt(8)
    v_mfma_f32_16x16x32_bf16 v[64:67], a[0:3], a[80:83], v[64:67]
    ds_read_b64_tr_b16 a[24:25], v6 offset:61440
    v_mfma_f32_16x16x32_bf16 v[68:71], a[0:3], a[84:87], v[68:71]
    ds_read_b64_tr_b16 a[26:27], v6 offset:63488
    v_mfma_f32_16x16x32_bf16 v[72:75], a[4:7], a[80:83], v[72:75]
    ds_read_b64_tr_b16 a[28:29], v7 offset:61440
    v_mfma_f32_16x16x32_bf16 v[76:79], a[4:7], a[84:87], v[76:79]
    ds_read_b64_tr_b16 a[30:31], v7 offset:63488
    s_waitcnt lgkmcnt(8)
    v_mfma_f32_16x16x32_bf16 v[80:83], a[8:11], a[80:83], v[80:83]
    s_waitcnt vmcnt(63)
    s_barrier
    v_add_u32 v4, 65536, v4
    v_add_u32 v5, 65536, v5
    v_add_u32 v6, 65536, v6
    v_add_u32 v7, 65536, v7
    ds_read_b64_tr_b16 a[0:1], v4 offset:0
    v_mfma_f32_16x16x32_bf16 v[84:87], a[8:11], a[84:87], v[84:87]
    ds_read_b64_tr_b16 a[2:3], v4 offset:2048
    v_mfma_f32_16x16x32_bf16 v[88:91], a[12:15], a[80:83], v[88:91]
    ds_read_b64_tr_b16 a[4:5], v5 offset:0
    v_mfma_f32_16x16x32_bf16 v[92:95], a[12:15], a[84:87], v[92:95]
    ds_read_b64_tr_b16 a[6:7], v5 offset:2048
    s_waitcnt vmcnt(4) lgkmcnt(8)
    v_mfma_f32_16x16x32_bf16 v[64:67], a[16:19], a[32:35], v[64:67]
    ds_read_b64_tr_b16 a[8:9], v6 offset:0
    v_mfma_f32_16x16x32_bf16 v[68:71], a[16:19], a[36:39], v[68:71]
    ds_read_b64_tr_b16 a[10:11], v6 offset:2048
    v_mfma_f32_16x16x32_bf16 v[72:75], a[20:23], a[32:35], v[72:75]
    ds_read_b64_tr_b16 a[12:13], v7 offset:0
    v_mfma_f32_16x16x32_bf16 v[76:79], a[20:23], a[36:39], v[76:79]
    ds_read_b64_tr_b16 a[14:15], v7 offset:2048
    s_waitcnt lgkmcnt(8)
    v_mfma_f32_16x16x32_bf16 v[80:83], a[24:27], a[32:35], v[80:83]
    ds_read_b64_tr_b16 a[16:17], v4 offset:4096
    v_mfma_f32_16x16x32_bf16 v[84:87], a[24:27], a[36:39], v[84:87]
    ds_read_b64_tr_b16 a[18:19], v4 offset:6144
    v_mfma_f32_16x16x32_bf16 v[88:91], a[28:31], a[32:35], v[88:91]
    ds_read_b64_tr_b16 a[20:21], v5 offset:4096
    v_mfma_f32_16x16x32_bf16 v[92:95], a[28:31], a[36:39], v[92:95]
    ds_read_b64_tr_b16 a[22:23], v5 offset:6144
    s_waitcnt vmcnt(2) lgkmcnt(8)
    v_mfma_f32_16x16x32_bf16 v[64:67], a[0:3], a[40:43], v[64:67]
    ds_read_b64_tr_b16 a[24:25], v6 offset:4096
    v_mfma_f32_16x16x32_bf16 v[68:71], a[0:3], a[44:47], v[68:71]
    ds_read_b64_tr_b16 a[26:27], v6 offset:6144
    v_mfma_f32_16x16x32_bf16 v[72:75], a[4:7], a[40:43], v[72:75]
    ds_read_b64_tr_b16 a[28:29], v7 offset:4096
    v_mfma_f32_16x16x32_bf16 v[76:79], a[4:7], a[44:47], v[76:79]
    ds_read_b64_tr_b16 a[30:31], v7 offset:6144
    s_waitcnt lgkmcnt(8)
    v_mfma_f32_16x16x32_bf16 v[80:83], a[8:11], a[40:43], v[80:83]
    v_mfma_f32_16x16x32_bf16 v[84:87], a[8:11], a[44:47], v[84:87]
    v_mfma_f32_16x16x32_bf16 v[88:91], a[12:15], a[40:43], v[88:91]
    v_mfma_f32_16x16x32_bf16 v[92:95], a[12:15], a[44:47], v[92:95]
    s_waitcnt vmcnt(0) lgkmcnt(4)
    v_mfma_f32_16x16x32_bf16 v[64:67], a[16:19], a[48:51], v[64:67]
    v_mfma_f32_16x16x32_bf16 v[68:71], a[16:19], a[52:55], v[68:71]
    v_mfma_f32_16x16x32_bf16 v[72:75], a[20:23], a[48:51], v[72:75]
    v_mfma_f32_16x16x32_bf16 v[76:79], a[20:23], a[52:55], v[76:79]
    s_waitcnt lgkmcnt(0)
    v_mfma_f32_16x16x32_bf16 v[80:83], a[24:27], a[48:51], v[80:83]
    v_mfma_f32_16x16x32_bf16 v[84:87], a[24:27], a[52:55], v[84:87]
    v_mfma_f32_16x16x32_bf16 v[88:91], a[28:31], a[48:51], v[88:91]
    v_mfma_f32_16x16x32_bf16 v[92:95], a[28:31], a[52:55], v[92:95]
    v_add_u32 v4, 4294901760, v4
    v_add_u32 v5, 4294901760, v5
    v_add_u32 v6, 4294901760, v6
    v_add_u32 v7, 4294901760, v7
    s_barrier
    v_pk_add_f32 v[64:65], v[64:65], v[96:97]
    v_pk_add_f32 v[66:67], v[66:67], v[98:99]
    v_pk_add_f32 v[68:69], v[68:69], v[100:101]
    v_pk_add_f32 v[70:71], v[70:71], v[102:103]
    v_pk_add_f32 v[72:73], v[72:73], v[104:105]
    v_pk_add_f32 v[74:75], v[74:75], v[106:107]
    v_pk_add_f32 v[76:77], v[76:77], v[108:109]
    v_pk_add_f32 v[78:79], v[78:79], v[110:111]
    v_pk_add_f32 v[80:81], v[80:81], v[112:113]
    v_pk_add_f32 v[82:83], v[82:83], v[114:115]
    v_pk_add_f32 v[84:85], v[84:85], v[116:117]
    v_pk_add_f32 v[86:87], v[86:87], v[118:119]
    v_pk_add_f32 v[88:89], v[88:89], v[120:121]
    v_pk_add_f32 v[90:91], v[90:91], v[122:123]
    v_pk_add_f32 v[92:93], v[92:93], v[124:125]
    v_pk_add_f32 v[94:95], v[94:95], v[126:127]
    s_cmp_eq_u32 s84, 1
    s_cbranch_scc1 L_aod_36
    s_mov_b32 s57, 200000
L_aop_37:
    buffer_load_dword v58, v59, s[28:31], 0 offen sc1
    s_waitcnt vmcnt(0)
    v_cmp_ne_u32 vcc, s40, v58
    s_nop 1
    s_cbranch_vccz L_aoq_38
    s_sub_u32 s57, s57, 1
    s_cmp_lg_u32 s57, 0
    s_cbranch_scc1 L_aop_37
L_aoq_38:
    buffer_load_dwordx4 v[144:147], v57, s[28:31], s80 offen offset:0 sc1
    buffer_load_dwordx4 v[148:151], v57, s[28:31], s80 offen offset:1024 sc1
    buffer_load_dwordx4 v[152:155], v57, s[28:31], s80 offen offset:2048 sc1
    buffer_load_dwordx4 v[156:159], v57, s[28:31], s80 offen offset:3072 sc1
L_aod_36:
    s_waitcnt vmcnt(0)
    v_lshlrev_b32 v24, 16, v144
    v_and_b32 v25, 0xffff0000, v144
    v_pk_add_f32 v[64:65], v[64:65], v[24:25]
    v_lshlrev_b32 v24, 16, v145
    v_and_b32 v25, 0xffff0000, v145
    v_pk_add_f32 v[66:67], v[66:67], v[24:25]
    v_lshlrev_b32 v24, 16, v146
    v_and_b32 v25, 0xffff0000, v146
    v_pk_add_f32 v[68:69], v[68:69], v[24:25]
    v_lshlrev_b32 v24, 16, v147
    v_and_b32 v25, 0xffff0000, v147
    v_pk_add_f32 v[70:71], v[70:71], v[24:25]
    v_lshlrev_b32 v24, 16, v148
    v_and_b32 v25, 0xffff0000, v148
    v_pk_add_f32 v[72:73], v[72:73], v[24:25]
    v_lshlrev_b32 v24, 16, v149
    v_and_b32 v25, 0xffff0000, v149
    v_pk_add_f32 v[74:75], v[74:75], v[24:25]
    v_lshlrev_b32 v24, 16, v150
    v_and_b32 v25, 0xffff0000, v150
    v_pk_add_f32 v[76:77], v[76:77], v[24:25]
    v_lshlrev_b32 v24, 16, v151
    v_and_b32 v25, 0xffff0000, v151
    v_pk_add_f32 v[78:79], v[78:79], v[24:25]
    v_lshlrev_b32 v24, 16, v152
    v_and_b32 v25, 0xffff0000, v152
    v_pk_add_f32 v[80:81], v[80:81], v[24:25]
    v_lshlrev_b32 v24, 16, v153
    v_and_b32 v25, 0xffff0000, v153
    v_pk_add_f32 v[82:83], v[82:83], v[24:25]
    v_lshlrev_b32 v24, 16, v154
    v_and_b32 v25, 0xffff0000, v154
    v_pk_add_f32 v[84:85], v[84:85], v[24:25]
    v_lshlrev_b32 v24, 16, v155
    v_and_b32 v25, 0xffff0000, v155
    v_pk_add_f32 v[86:87], v[86:87], v[24:25]
    v_lshlrev_b32 v24, 16, v156
    v_and_b32 v25, 0xffff0000, v156
    v_pk_add_f32 v[88:89], v[88:89], v[24:25]
    v_lshlrev_b32 v24, 16, v157
    v_and_b32 v25, 0xffff0000, v157
    v_pk_add_f32 v[90:91], v[90:91], v[24:25]
    v_lshlrev_b32 v24, 16, v158
    v_and_b32 v25, 0xffff0000, v158
    v_pk_add_f32 v[92:93], v[92:93], v[24:25]
    v_lshlrev_b32 v24, 16, v159
    v_and_b32 v25, 0xffff0000, v159
    v_pk_add_f32 v[94:95], v[94:95], v[24:25]
    v_and_b32 v22, 15, v1
    v_mul_u32_u24 v22, 272, v22
    v_lshrrev_b32 v23, 4, v1
    v_lshl_add_u32 v22, v23, 4, v22
    s_mul_i32 s44, s41, 8704
    v_add_u32 v22, s44, v22
    ds_write_b128 v22, v[64:67] offset:0
    ds_write_b128 v22, v[68:71] offset:4352
    ds_write_b128 v22, v[72:75] offset:64
    ds_write_b128 v22, v[76:79] offset:4416
    ds_write_b128 v22, v[80:83] offset:128
    ds_write_b128 v22, v[84:87] offset:4480
    ds_write_b128 v22, v[88:91] offset:192
    ds_write_b128 v22, v[92:95] offset:4544
    v_lshrrev_b32 v23, 3, v1
    v_mul_u32_u24 v23, 272, v23
    v_and_b32 v24, 7, v1
    v_lshl_add_u32 v23, v24, 5, v23
    v_add_u32 v23, s44, v23
    s_waitcnt lgkmcnt(0)
    ds_read_b128 v[64:67], v23 offset:0
    ds_read_b128 v[68:71], v23 offset:16
    ds_read_b128 v[72:75], v23 offset:2176
    ds_read_b128 v[76:79], v23 offset:2192
    ds_read_b128 v[80:83], v23 offset:4352
    ds_read_b128 v[84:87], v23 offset:4368
    ds_read_b128 v[88:91], v23 offset:6528
    ds_read_b128 v[92:95], v23 offset:6544
    s_mov_b32 s32, s22
    s_mov_b32 s33, s23
    s_mov_b32 s34, 2621440
    s_mov_b32 s35, 0x20000
    v_accvgpr_read_b32 v128, a128
    v_accvgpr_read_b32 v129, a129
    v_accvgpr_read_b32 v130, a130
    v_accvgpr_read_b32 v131, a131
    v_accvgpr_read_b32 v132, a132
    v_accvgpr_read_b32 v133, a133
    v_accvgpr_read_b32 v134, a134
    v_accvgpr_read_b32 v135, a135
    v_accvgpr_read_b32 v136, a136
    v_accvgpr_read_b32 v137, a137
    v_accvgpr_read_b32 v138, a138
    v_accvgpr_read_b32 v139, a139
    v_accvgpr_read_b32 v140, a140
    v_accvgpr_read_b32 v141, a141
    v_accvgpr_read_b32 v142, a142
    v_accvgpr_read_b32 v143, a143
    s_waitcnt lgkmcnt(0)
    v_lshlrev_b32 v24, 16, v128
    v_and_b32 v25, 0xffff0000, v128
    v_pk_add_f32 v[64:65], v[64:65], v[24:25]
    v_cvt_pk_bf16_f32 v128, v64, v65
    v_lshlrev_b32 v24, 16, v129
    v_and_b32 v25, 0xffff0000, v129
    v_pk_add_f32 v[66:67], v[66:67], v[24:25]
    v_cvt_pk_bf16_f32 v129, v66, v67
    v_lshlrev_b32 v24, 16, v130
    v_and_b32 v25, 0xffff0000, v130
    v_pk_add_f32 v[68:69], v[68:69], v[24:25]
    v_cvt_pk_bf16_f32 v130, v68, v69
    v_lshlrev_b32 v24, 16, v131
    v_and_b32 v25, 0xffff0000, v131
    v_pk_add_f32 v[70:71], v[70:71], v[24:25]
    v_cvt_pk_bf16_f32 v131, v70, v71
    s_add_u32 s44, s79, 0
    buffer_store_dwordx4 v[128:131], v60, s[32:35], s44 offen sc1
    v_lshlrev_b32 v24, 16, v132
    v_and_b32 v25, 0xffff0000, v132
    v_pk_add_f32 v[72:73], v[72:73], v[24:25]
    v_cvt_pk_bf16_f32 v132, v72, v73
    v_lshlrev_b32 v24, 16, v133
    v_and_b32 v25, 0xffff0000, v133
    v_pk_add_f32 v[74:75], v[74:75], v[24:25]
    v_cvt_pk_bf16_f32 v133, v74, v75
    v_lshlrev_b32 v24, 16, v134
    v_and_b32 v25, 0xffff0000, v134
    v_pk_add_f32 v[76:77], v[76:77], v[24:25]
    v_cvt_pk_bf16_f32 v134, v76, v77
    v_lshlrev_b32 v24, 16, v135
    v_and_b32 v25, 0xffff0000, v135
    v_pk_add_f32 v[78:79], v[78:79], v[24:25]
    v_cvt_pk_bf16_f32 v135, v78, v79
    s_add_u32 s44, s79, 10240
    buffer_store_dwordx4 v[132:135], v60, s[32:35], s44 offen sc1
    v_lshlrev_b32 v24, 16, v136
    v_and_b32 v25, 0xffff0000, v136
    v_pk_add_f32 v[80:81], v[80:81], v[24:25]
    v_cvt_pk_bf16_f32 v136, v80, v81
    v_lshlrev_b32 v24, 16, v137
    v_and_b32 v25, 0xffff0000, v137
    v_pk_add_f32 v[82:83], v[82:83], v[24:25]
    v_cvt_pk_bf16_f32 v137, v82, v83
    v_lshlrev_b32 v24, 16, v138
    v_and_b32 v25, 0xffff0000, v138
    v_pk_add_f32 v[84:85], v[84:85], v[24:25]
    v_cvt_pk_bf16_f32 v138, v84, v85
    v_lshlrev_b32 v24, 16, v139
    v_and_b32 v25, 0xffff0000, v139
    v_pk_add_f32 v[86:87], v[86:87], v[24:25]
    v_cvt_pk_bf16_f32 v139, v86, v87
    s_add_u32 s44, s79, 20480
    buffer_store_dwordx4 v[136:139], v60, s[32:35], s44 offen sc1
    v_lshlrev_b32 v24, 16, v140
    v_and_b32 v25, 0xffff0000, v140
    v_pk_add_f32 v[88:89], v[88:89], v[24:25]
    v_cvt_pk_bf16_f32 v140, v88, v89
    v_lshlrev_b32 v24, 16, v141
    v_and_b32 v25, 0xffff0000, v141
    v_pk_add_f32 v[90:91], v[90:91], v[24:25]
    v_cvt_pk_bf16_f32 v141, v90, v91
    v_lshlrev_b32 v24, 16, v142
    v_and_b32 v25, 0xffff0000, v142
    v_pk_add_f32 v[92:93], v[92:93], v[24:25]
    v_cvt_pk_bf16_f32 v142, v92, v93
    v_lshlrev_b32 v24, 16, v143
    v_and_b32 v25, 0xffff0000, v143
    v_pk_add_f32 v[94:95], v[94:95], v[24:25]
    v_cvt_pk_bf16_f32 v143, v94, v95
    s_add_u32 s44, s79, 30720
    buffer_store_dwordx4 v[140:143], v60, s[32:35], s44 offen sc1
L_fin:
    s_cmp_lg_u32 s2, 0
    s_cbranch_scc1 L_end
    s_cmp_lg_u32 s41, 0
    s_cbranch_scc1 L_end
    v_lshlrev_b32 v22, 7, v1
    v_add_u32 v22, 27262976, v22
    s_mov_b32 s57, 200000
L_fin_poll:
    s_mov_b32 s44, 0
    buffer_load_dword v24, v22, s[28:31], s44 offen sc1
    s_mov_b32 s44, 8192
    buffer_load_dword v25, v22, s[28:31], s44 offen sc1
    s_mov_b32 s44, 16384
    buffer_load_dword v26, v22, s[28:31], s44 offen sc1
    s_mov_b32 s44, 24576
    buffer_load_dword v27, v22, s[28:31], s44 offen sc1
    s_waitcnt vmcnt(0)
    v_xor_b32 v24, s40, v24
    v_xor_b32 v25, s40, v25
    v_xor_b32 v26, s40, v26
    v_xor_b32 v27, s40, v27
    v_or_b32 v24, v24, v25
    v_or_b32 v26, v26, v27
    v_or_b32 v24, v24, v26
    v_cmp_ne_u32 vcc, 0, v24
    s_nop 1
    s_cbranch_vccz L_fin_go
    s_sub_u32 s57, s57, 1
    s_cmp_lg_u32 s57, 0
    s_cbranch_scc1 L_fin_poll
L_fin_go:
    buffer_store_dword v2, v3, s[28:31], 0 offen sc1
L_end:
    s_endpgm
L_code_end:

.section .rodata,"a"
.p2align 6
.amdhsa_kernel parallel_sum__linear_kernel_hedgehog__mixer_s_mlp__prompt_kernel
  .amdhsa_next_free_vgpr 448
  .amdhsa_next_free_sgpr 102
  .amdhsa_accum_offset 256
  .amdhsa_group_segment_fixed_size 0
  .amdhsa_kernarg_size 96
  .amdhsa_user_sgpr_count 2
  .amdhsa_user_sgpr_kernarg_segment_ptr 1
  .amdhsa_system_sgpr_workgroup_id_x 1
  .amdhsa_float_denorm_mode_32 3
.end_amdhsa_kernel
```
